```python
import torch

def _softmax(x, axis=-1):
    return torch.softmax(x, dim=axis)
def _gelu(x):
    return torch.nn.functional.gelu(x, approximate="tanh")
def _silu(x):
    return torch.nn.functional.silu(x)
def _sigmoid(x):
    return torch.sigmoid(x)
def _layernorm(x, axis=-1, eps=1e-5):
    m = x.mean(dim=axis, keepdim=True)
    v = x.var(dim=axis, keepdim=True, unbiased=False)
    return (x - m) / torch.sqrt(v + eps)
def _scatter_add(tgt, idx, src, axis=0):
    return tgt.clone().index_add_(axis, idx, src)
def _segment_sum(src, seg, n):
    out = torch.zeros((n,) + src.shape[1:], dtype=src.dtype)
    return out.index_add_(0, seg, src)
def _pad(x, pw):
    flat = tuple(v for pair in reversed(pw) for v in pair)
    return torch.nn.functional.pad(x, flat)

kernel_name = 'sequential_preLN__sliding_local_dilated__glu_gated_glu__prompt'

def setup_inputs():

    _w = (lambda a: (lambda t: t.to(torch.bfloat16) if t.is_floating_point() else t)(torch.as_tensor(a)))
    def _A_setup():
        B, S, D = 1, 2048, 576
        return {
            "x": _w((lambda *s: torch.randn(*s, dtype=torch.bfloat16) * 0.05)(B, S, D)),
            "wqkv": _w((lambda *s: torch.randn(*s, dtype=torch.bfloat16) * 0.05)(D, 3 * D)),
            "wo": _w((lambda *s: torch.randn(*s, dtype=torch.bfloat16) * 0.05)(D, D)),
        }
    _A_in = _A_setup()

    def _B_setup():
        B, S, D, F = 1, 2048, 576, 4608
        return {
            "x": _w((lambda *s: torch.randn(*s, dtype=torch.bfloat16) * 0.05)(B, S, D)),
            "w_gate": _w((lambda *s: torch.randn(*s, dtype=torch.bfloat16) * 0.05)(D, F)),
            "w_up": _w((lambda *s: torch.randn(*s, dtype=torch.bfloat16) * 0.05)(D, F)),
            "w_down": _w((lambda *s: torch.randn(*s, dtype=torch.bfloat16) * 0.05)(F, D)),
        }
    _B_in = _B_setup()

    return {
        "A_x": _A_in["x"],
        "A_wqkv": _A_in["wqkv"],
        "A_wo": _A_in["wo"],
        "B_x": _B_in["x"],
        "B_w_gate": _B_in["w_gate"],
        "B_w_up": _B_in["w_up"],
        "B_w_down": _B_in["w_down"],
    }

def reference(A_x, A_wqkv, A_wo, B_x, B_w_gate, B_w_up, B_w_down):
    def _A_ref(x, wqkv, wo):
        B, S, D = x.shape
        H = 32; Dh = D // H
        W, dil = 8, 2
        qkv = (lambda x, *d: x.permute(*d))((x @ wqkv).reshape(B, S, 3, H, Dh), 2, 0, 3, 1, 4)
        q, k, v = qkv[0], qkv[1], qkv[2]
        scale = Dh ** -0.5
        pos = torch.arange(S)
        off = torch.arange(W) * dil
        idx = pos[:, None] - off[None, :]
        mask = idx >= 0
        idx_c = torch.where(mask, idx, 0).reshape(-1)
        kg = k[:, :, idx_c, :].reshape(B, H, S, W, Dh)
        vg = v[:, :, idx_c, :].reshape(B, H, S, W, Dh)
        logits = torch.einsum("bhsd,bhswd->bhsw", q, kg) * scale
        logits = torch.where(mask[None, None, :, :], logits, -1e9)
        attn = _softmax(logits, axis=-1)
        o = torch.einsum("bhsw,bhswd->bhsd", attn, vg)
        return (lambda x, *d: x.permute(*d))(o, 0, 2, 1, 3).reshape(B, S, D) @ wo

    def _B_ref(x, w_gate, w_up, w_down):
        g = torch.einsum("bsd,df->bsf", x, w_gate)
        u = torch.einsum("bsd,df->bsf", x, w_up)
        h = _sigmoid(g) * u
        return torch.einsum("bsf,fd->bsd", h, w_down)

    x = A_x
    h = x + _A_ref(_layernorm(x, axis=-1), A_wqkv, A_wo)
    h2 = h + _B_ref(_layernorm(h, axis=-1), B_w_gate, B_w_up, B_w_down)
    return h2
```

```asm
; @launch grid=(256,1,1) block=(256,1,1) lds=162048
.amdgcn_target "amdgcn-amd-amdhsa--gfx950"
.text
.globl sequential_preLN__sliding_local_dilated__glu_gated_glu__prompt_kernel
.p2align 8
.type sequential_preLN__sliding_local_dilated__glu_gated_glu__prompt_kernel,@function
sequential_preLN__sliding_local_dilated__glu_gated_glu__prompt_kernel:
    s_cmp_ge_u32 s2, 256
    s_cbranch_scc1 KF_END
    s_getpc_b64 s[36:37]
KF_PC:
    s_lshr_b32 s38, s2, 3
    s_lshl_b32 s38, s38, 12
    v_lshlrev_b32 v4, 4, v0
    v_add_u32 v4, s38, v4
    v_min_u32 v4, KF_END-KF_PC-16, v4
    global_load_dwordx4 v[196:199], v4, s[36:37]
    s_load_dwordx4 s[20:23], s[0:1], 0
    s_load_dwordx4 s[24:27], s[0:1], 64
    s_load_dwordx2 s[28:29], s[0:1], 16
    s_load_dwordx4 s[32:35], s[0:1], 32
    s_load_dwordx2 s[30:31], s[0:1], 48
    v_lshrrev_b32 v1, 6, v0
    v_and_b32 v2, 63, v0
    v_readfirstlane_b32 s3, v1
    v_mov_b32 v3, 0
    v_lshrrev_b32 v14, 3, v2
    v_lshrrev_b32 v15, 1, v14
    v_and_b32 v16, 7, v2
    s_waitcnt lgkmcnt(0)
    s_mov_b32 s12, s20
    s_and_b32 s13, s21, 0xffff
    s_mov_b32 s14, 0x240000
    s_mov_b32 s15, 0x00020000
    s_mov_b32 s16, s22
    s_and_b32 s17, s23, 0xffff
    s_mov_b32 s18, 0x1e6000
    s_mov_b32 s19, 0x00020000
    s_mov_b32 s8, s26
    s_and_b32 s9, s27, 0xffff
    s_mov_b32 s10, 0x4000000
    s_mov_b32 s11, 0x00020000
    s_mov_b32 s48, s24
    s_and_b32 s49, s25, 0xffff
    s_mov_b32 s50, 0x100
    s_mov_b32 s51, 0x00020000
    s_mov_b32 s44, s28
    s_and_b32 s45, s29, 0xffff
    s_mov_b32 s46, 0xa2000
    s_mov_b32 s47, 0x00020000
    s_mov_b32 s52, s32
    s_and_b32 s53, s33, 0xffff
    s_mov_b32 s54, 0x510000
    s_mov_b32 s55, 0x00020000
    s_mov_b32 s56, s34
    s_and_b32 s57, s35, 0xffff
    s_mov_b32 s58, 0x510000
    s_mov_b32 s59, 0x00020000
    s_mov_b32 s60, s30
    s_and_b32 s61, s31, 0xffff
    s_mov_b32 s62, 0x510000
    s_mov_b32 s63, 0x00020000
    s_bfe_u32 s20, s2, 0x20001
    s_lshl_b32 s20, s20, 3
    s_bfe_u32 s21, s2, 0x30003
    s_add_u32 s20, s20, s21
    s_and_b32 s21, s2, 1
    s_lshl_b32 s21, s21, 2
    s_lshr_b32 s22, s2, 6
    s_add_u32 s21, s21, s22
    s_and_b32 s27, s3, 1
    s_lshr_b32 s28, s3, 1
    s_mov_b32 s23, 1152
    s_lshl_b32 s22, s27, 2
    v_add_u32 v15, s22, v15
    v_xor_b32 v15, v15, v16
    s_lshl_b32 s22, s20, 6
    s_lshl_b32 s24, s27, 4
    s_add_u32 s24, s24, s22
    v_lshl_add_u32 v16, v14, 1, s24
    v_mul_lo_u32 v16, v16, s23
    v_lshl_add_u32 v4, v15, 4, v16
    s_add_u32 s24, s22, s27
    s_sub_u32 s24, s24, 16
    v_lshl_add_u32 v16, v14, 1, s24
    v_mul_lo_u32 v16, v16, s23
    v_lshl_add_u32 v5, v15, 4, v16
    s_mul_i32 s22, s28, 14
    s_add_u32 s22, s22, s27
    s_lshl_b32 s24, s22, 6
    v_add_u32 v18, s24, v2
    s_lshl_b32 s24, s22, 10
    s_add_u32 s24, s24, 10240
    s_lshl_b32 s37, s27, 10
    s_mul_i32 s25, s21, 144
    s_mov_b32 s26, s25
    s_and_b32 s34, s20, 7
    s_and_b32 s35, s21, 3
    s_lshl_b32 s35, s35, 1
    s_add_u32 s34, s34, s35
    s_sub_u32 s35, s34, 9
    s_cmp_ge_u32 s34, 9
    s_cselect_b32 s34, s35, s34
    s_mul_i32 s35, s34, 221184
    s_add_u32 s25, s25, s35
    s_lshl_b32 s34, s34, 7
    s_or_b32 s22, s2, s3
    s_cmp_lg_u32 s22, 0
    s_cbranch_scc1 KAB_NN
    s_memrealtime s[22:23]
    s_waitcnt lgkmcnt(0)
    s_or_b32 s22, s22, 1
    v_mov_b32 v248, s22
    v_mov_b32 v249, s23
    buffer_store_dwordx2 v[248:249], v3, s[48:51], 0 offen sc1
KAB_NN:
    s_lshl_b32 s42, s2, 2
    s_add_u32 s42, s42, s3
    s_mul_i32 s7, s3, 6144
    s_add_u32 s7, s7, 122880
    v_lshrrev_b32 v168, 3, v2
    v_and_b32 v169, 7, v2
    v_lshrrev_b32 v170, 4, v2
    v_bfe_u32 v171, v2, 2, 2
    v_and_b32 v172, 3, v2
    v_and_b32 v173, 15, v2
    v_lshlrev_b32 v161, 7, v171
    v_add_u32 v161, s7, v161
    v_mov_b32 v164, 0
    v_mov_b32 v165, 0
    v_mov_b32 v166, 0x3f803f80
    s_cmp_ge_u32 s42, 648
    s_cbranch_scc1 KAB_PW
    s_mov_b32 s4, 1
    s_mul_i32 s43, s42, 911
    s_lshr_b32 s43, s43, 16
    s_mul_i32 s5, s43, 72
    s_sub_u32 s42, s42, s5
    s_mul_i32 s5, s43, 589824
    s_lshl_b32 s6, s42, 7
    s_add_u32 s5, s5, s6
    s_mul_i32 s6, s42, 147456
    s_lshl_b32 s41, s43, 13
    s_add_u32 s6, s6, s41
    s_add_u32 s6, s6, 0x1e00000
    s_mul_i32 s43, s43, 36864
    s_lshl_b32 s42, s42, 9
    s_add_u32 s43, s43, s42
    s_add_u32 s43, s43, 0x2900000
    v_mov_b32 v163, s43
    v_mul_u32_u24 v160, 9216, v168
    v_lshrrev_b32 v174, 1, v170
    v_and_b32 v175, 1, v170
    v_lshl_add_u32 v161, v174, 6, v161
    v_lshl_add_u32 v161, v172, 4, v161
    v_lshl_add_u32 v161, v175, 3, v161
    v_mul_u32_u24 v162, 73728, v174
    v_lshl_add_u32 v162, v175, 10, v162
    v_lshl_add_u32 v163, v174, 8, v163
    v_lshl_add_u32 v163, v175, 6, v163
    v_lshl_add_u32 v163, v173, 2, v163
    s_branch KAB_PD
KAB_PW:
    s_mov_b32 s4, 0
    s_sub_u32 s42, s42, 648
    s_mul_i32 s43, s42, 7282
    s_lshr_b32 s43, s43, 16
    s_mul_i32 s5, s43, 9
    s_sub_u32 s41, s42, s5
    s_cmp_ge_u32 s42, 324
    s_cselect_b32 s43, 0x1000, s43
    s_mul_i32 s5, s43, 147456
    s_lshl_b32 s6, s41, 7
    s_add_u32 s5, s5, s6
    s_mul_i32 s6, s43, 147456
    s_lshl_b32 s41, s41, 12
    s_add_u32 s6, s6, s41
    s_add_u32 s6, s6, 0x1800000
    v_mov_b32 v163, 0x7fffff00
    v_mul_u32_u24 v160, 1152, v168
    v_lshl_add_u32 v161, v170, 5, v161
    v_lshl_add_u32 v161, v172, 3, v161
    v_lshlrev_b32 v162, 10, v170
    s_mov_b32 s52, s60
    s_mov_b32 s53, s61
    s_mov_b32 s56, s60
    s_mov_b32 s57, s61
KAB_PD:
    v_lshl_add_u32 v160, v169, 4, v160
    v_lshl_add_u32 v162, v173, 4, v162
    v_lshrrev_b32 v52, 4, v2
    v_lshlrev_b32 v52, 3, v52
    v_bfe_u32 v53, v2, 2, 2
    v_add_u32 v52, v52, v53
    v_mul_u32_u24 v52, 144, v52
    v_and_b32 v53, 3, v2
    v_lshl_add_u32 v192, v53, 3, v52
    v_add_u32 v193, 41472, v192
    s_cmp_lg_u32 s28, 0
    s_cbranch_scc1 KAB_A1
    s_add_u32 m0, s37, 0
    s_add_u32 s38, s34, 0
    buffer_load_dwordx4 v5, s[12:15], s38 offen lds
    s_add_u32 m0, s37, 2048
    s_add_u32 s38, s34, 0
    buffer_load_dwordx4 v4, s[12:15], s38 offen lds
    s_add_u32 m0, s37, 4096
    s_add_u32 s38, s34, 36864
    buffer_load_dwordx4 v4, s[12:15], s38 offen lds
    v_add_u32 v14, 0, v18
    v_mul_u32_u24 v15, 18559, v14
    v_lshrrev_b32 v15, 22, v15
    v_mul_u32_u24 v16, 226, v15
    v_sub_u32 v14, v14, v16
    v_mul_u32_u24 v16, 2341, v14
    v_lshrrev_b32 v16, 16, v16
    v_min_u32 v16, 7, v16
    v_lshl_add_u32 v15, v15, 3, v16
    v_mul_u32_u24 v16, 28, v16
    v_sub_u32 v14, v14, v16
    v_min_u32 v14, 26, v14
    v_mul_u32_u24 v16, 57, v14
    v_lshrrev_b32 v16, 9, v16
    v_mul_u32_u24 v15, 3456, v15
    v_lshl_add_u32 v15, v14, 4, v15
    v_mul_u32_u24 v16, 1008, v16
    v_add_u32 v6, v15, v16
    s_add_u32 m0, s24, 0
    s_nop 0
    buffer_load_dwordx4 v6, s[16:19], s25 offen lds
    v_add_u32 v14, 128, v18
    v_mul_u32_u24 v15, 18559, v14
    v_lshrrev_b32 v15, 22, v15
    v_mul_u32_u24 v16, 226, v15
    v_sub_u32 v14, v14, v16
    v_mul_u32_u24 v16, 2341, v14
    v_lshrrev_b32 v16, 16, v16
    v_min_u32 v16, 7, v16
    v_lshl_add_u32 v15, v15, 3, v16
    v_mul_u32_u24 v16, 28, v16
    v_sub_u32 v14, v14, v16
    v_min_u32 v14, 26, v14
    v_mul_u32_u24 v16, 57, v14
    v_lshrrev_b32 v16, 9, v16
    v_mul_u32_u24 v15, 3456, v15
    v_lshl_add_u32 v15, v14, 4, v15
    v_mul_u32_u24 v16, 1008, v16
    v_add_u32 v7, v15, v16
    s_add_u32 m0, s24, 2048
    s_nop 0
    buffer_load_dwordx4 v7, s[16:19], s25 offen lds
    v_add_u32 v14, 256, v18
    v_mul_u32_u24 v15, 18559, v14
    v_lshrrev_b32 v15, 22, v15
    v_mul_u32_u24 v16, 226, v15
    v_sub_u32 v14, v14, v16
    v_mul_u32_u24 v16, 2341, v14
    v_lshrrev_b32 v16, 16, v16
    v_min_u32 v16, 7, v16
    v_lshl_add_u32 v15, v15, 3, v16
    v_mul_u32_u24 v16, 28, v16
    v_sub_u32 v14, v14, v16
    v_min_u32 v14, 26, v14
    v_mul_u32_u24 v16, 57, v14
    v_lshrrev_b32 v16, 9, v16
    v_mul_u32_u24 v15, 3456, v15
    v_lshl_add_u32 v15, v14, 4, v15
    v_mul_u32_u24 v16, 1008, v16
    v_add_u32 v8, v15, v16
    s_add_u32 m0, s24, 4096
    s_nop 0
    buffer_load_dwordx4 v8, s[16:19], s25 offen lds
    v_add_u32 v14, 384, v18
    v_mul_u32_u24 v15, 18559, v14
    v_lshrrev_b32 v15, 22, v15
    v_mul_u32_u24 v16, 226, v15
    v_sub_u32 v14, v14, v16
    v_mul_u32_u24 v16, 2341, v14
    v_lshrrev_b32 v16, 16, v16
    v_min_u32 v16, 7, v16
    v_lshl_add_u32 v15, v15, 3, v16
    v_mul_u32_u24 v16, 28, v16
    v_sub_u32 v14, v14, v16
    v_min_u32 v14, 26, v14
    v_mul_u32_u24 v16, 57, v14
    v_lshrrev_b32 v16, 9, v16
    v_mul_u32_u24 v15, 3456, v15
    v_lshl_add_u32 v15, v14, 4, v15
    v_mul_u32_u24 v16, 1008, v16
    v_add_u32 v9, v15, v16
    s_add_u32 m0, s24, 6144
    s_nop 0
    buffer_load_dwordx4 v9, s[16:19], s25 offen lds
    v_add_u32 v14, 512, v18
    v_mul_u32_u24 v15, 18559, v14
    v_lshrrev_b32 v15, 22, v15
    v_mul_u32_u24 v16, 226, v15
    v_sub_u32 v14, v14, v16
    v_mul_u32_u24 v16, 2341, v14
    v_lshrrev_b32 v16, 16, v16
    v_min_u32 v16, 7, v16
    v_lshl_add_u32 v15, v15, 3, v16
    v_mul_u32_u24 v16, 28, v16
    v_sub_u32 v14, v14, v16
    v_min_u32 v14, 26, v14
    v_mul_u32_u24 v16, 57, v14
    v_lshrrev_b32 v16, 9, v16
    v_mul_u32_u24 v15, 3456, v15
    v_lshl_add_u32 v15, v14, 4, v15
    v_mul_u32_u24 v16, 1008, v16
    v_add_u32 v10, v15, v16
    s_add_u32 m0, s24, 8192
    s_nop 0
    buffer_load_dwordx4 v10, s[16:19], s25 offen lds
    v_add_u32 v14, 640, v18
    v_mul_u32_u24 v15, 18559, v14
    v_lshrrev_b32 v15, 22, v15
    v_mul_u32_u24 v16, 226, v15
    v_sub_u32 v14, v14, v16
    v_mul_u32_u24 v16, 2341, v14
    v_lshrrev_b32 v16, 16, v16
    v_min_u32 v16, 7, v16
    v_lshl_add_u32 v15, v15, 3, v16
    v_mul_u32_u24 v16, 28, v16
    v_sub_u32 v14, v14, v16
    v_min_u32 v14, 26, v14
    v_mul_u32_u24 v16, 57, v14
    v_lshrrev_b32 v16, 9, v16
    v_mul_u32_u24 v15, 3456, v15
    v_lshl_add_u32 v15, v14, 4, v15
    v_mul_u32_u24 v16, 1008, v16
    v_add_u32 v11, v15, v16
    s_add_u32 m0, s24, 10240
    s_nop 0
    buffer_load_dwordx4 v11, s[16:19], s25 offen lds
    v_add_u32 v14, 768, v18
    v_mul_u32_u24 v15, 18559, v14
    v_lshrrev_b32 v15, 22, v15
    v_mul_u32_u24 v16, 226, v15
    v_sub_u32 v14, v14, v16
    v_mul_u32_u24 v16, 2341, v14
    v_lshrrev_b32 v16, 16, v16
    v_min_u32 v16, 7, v16
    v_lshl_add_u32 v15, v15, 3, v16
    v_mul_u32_u24 v16, 28, v16
    v_sub_u32 v14, v14, v16
    v_min_u32 v14, 26, v14
    v_mul_u32_u24 v16, 57, v14
    v_lshrrev_b32 v16, 9, v16
    v_mul_u32_u24 v15, 3456, v15
    v_lshl_add_u32 v15, v14, 4, v15
    v_mul_u32_u24 v16, 1008, v16
    v_add_u32 v12, v15, v16
    s_add_u32 m0, s24, 12288
    s_nop 0
    buffer_load_dwordx4 v12, s[16:19], s25 offen lds
    s_add_u32 s25, s25, 221184
    s_add_u32 s34, s34, 128
    s_cmp_ge_u32 s34, 1152
    s_cselect_b32 s34, 0, s34
    s_cselect_b32 s25, s26, s25
    v_and_b32 v14, 15, v2
    v_lshrrev_b32 v15, 1, v14
    v_lshrrev_b32 v16, 4, v2
    v_xor_b32 v15, v15, v16
    v_lshlrev_b32 v14, 7, v14
    v_lshl_add_u32 v20, v15, 4, v14
    v_xor_b32 v21, 64, v20
    v_add_u32 v22, 39936, v20
    v_add_u32 v23, 39936, v21
    v_add_u32 v24, 79872, v20
    v_add_u32 v25, 79872, v21
    s_add_u32 s39, s27, 1
    s_xor_b32 s36, s27, 1
    s_add_u32 s36, s36, 1
    s_lshl_b32 s22, s39, 11
    v_add_u32 v26, s22, v20
    v_add_u32 v27, s22, v21
    v_add_u32 v28, s22, v22
    v_add_u32 v29, s22, v23
    v_add_u32 v30, s22, v24
    v_add_u32 v31, s22, v25
    s_lshl_b32 s22, s36, 11
    v_add_u32 v32, s22, v20
    v_add_u32 v33, s22, v21
    v_add_u32 v34, s22, v22
    v_add_u32 v35, s22, v23
    v_add_u32 v36, s22, v24
    v_add_u32 v37, s22, v25
    v_lshrrev_b32 v14, 4, v2
    v_mul_u32_u24 v14, 3616, v14
    v_bfe_u32 v15, v2, 2, 2
    v_mul_u32_u24 v15, 448, v15
    v_add_u32 v14, v14, v15
    v_and_b32 v15, 3, v2
    v_lshl_add_u32 v14, v15, 3, v14
    s_mul_i32 s22, s27, 224
    s_add_u32 s22, s22, 10240
    v_add_u32 v38, s22, v14
    v_add_u32 v39, 39936, v38
    v_add_u32 v40, 79872, v38
    v_and_b32 v14, 15, v2
    v_cmp_eq_u32 s[30:31], 0, v14
    s_lshl_b32 s22, s27, 3
    v_add_u32 v14, s22, v14
    v_cmp_le_u32 s[32:33], 16, v14
    v_and_b32 v14, 15, v2
    v_lshrrev_b32 v15, 4, v2
    v_mul_u32_u24 v240, 440, v14
    v_lshl_add_u32 v240, v15, 4, v240
    v_lshrrev_b32 v241, 2, v2
    v_mul_u32_u24 v241, 440, v241
    v_and_b32 v16, 3, v2
    v_lshl_add_u32 v241, v16, 3, v241
    s_mul_i32 s23, s3, s27
    s_mul_i32 s23, s23, 7040
    s_add_u32 s23, s23, 83968
    s_add_u32 s22, s3, 1
    s_mul_i32 s22, s22, 7040
    s_add_u32 s22, s22, 83968
    v_add_u32 v242, s23, v240
    v_add_u32 v243, s23, v241
    v_add_u32 v240, s22, v240
    v_add_u32 v241, s22, v241
    v_mov_b32 v16, 0xf149f2ca
    v_lshlrev_b32 v17, 2, v15
    v_sub_u32 v17, v14, v17
    s_cmp_eq_u32 s3, 0
    s_cselect_b32 s22, 8, 0
    s_cselect_b32 s23, 8, 16
    s_or_b32 s38, s20, s27
    s_cmp_eq_u32 s38, 0
    s_cselect_b32 s23, 0, s23
    v_subrev_u32 v246, 0, v17
    v_cmp_gt_u32 vcc, 8, v246
    s_nop 1
    v_cndmask_b32 v216, v16, 0, vcc
    v_subrev_u32 v247, s22, v246
    v_cmp_gt_i32 vcc, -8, v247
    v_lshl_add_u32 v247, v15, 2, 0
    v_cmp_gt_u32 s[40:41], s23, v247
    s_nop 0
    s_and_b64 vcc, vcc, s[40:41]
    v_cndmask_b32 v224, v16, 0, vcc
    v_cmp_gt_u32 vcc, 9, v247
    s_nop 1
    v_cndmask_b32 v228, 0, -1, vcc
    v_subrev_u32 v247, 1, v247
    v_cmp_gt_u32 vcc, 9, v247
    s_nop 1
    v_cndmask_b32 v232, 0, -1, vcc
    v_mov_b32 v236, 0x3f803f80
    v_subrev_u32 v246, 1, v17
    v_cmp_gt_u32 vcc, 8, v246
    s_nop 1
    v_cndmask_b32 v217, v16, 0, vcc
    v_subrev_u32 v247, s22, v246
    v_cmp_gt_i32 vcc, -8, v247
    v_lshl_add_u32 v247, v15, 2, 1
    v_cmp_gt_u32 s[40:41], s23, v247
    s_nop 0
    s_and_b64 vcc, vcc, s[40:41]
    v_cndmask_b32 v225, v16, 0, vcc
    v_cmp_gt_u32 vcc, 9, v247
    s_nop 1
    v_cndmask_b32 v229, 0, -1, vcc
    v_subrev_u32 v247, 1, v247
    v_cmp_gt_u32 vcc, 9, v247
    s_nop 1
    v_cndmask_b32 v233, 0, -1, vcc
    v_mov_b32 v237, 0x3f803f80
    v_subrev_u32 v246, 2, v17
    v_cmp_gt_u32 vcc, 8, v246
    s_nop 1
    v_cndmask_b32 v218, v16, 0, vcc
    v_subrev_u32 v247, s22, v246
    v_cmp_gt_i32 vcc, -8, v247
    v_lshl_add_u32 v247, v15, 2, 2
    v_cmp_gt_u32 s[40:41], s23, v247
    s_nop 0
    s_and_b64 vcc, vcc, s[40:41]
    v_cndmask_b32 v226, v16, 0, vcc
    v_cmp_gt_u32 vcc, 9, v247
    s_nop 1
    v_cndmask_b32 v230, 0, -1, vcc
    v_subrev_u32 v247, 1, v247
    v_cmp_gt_u32 vcc, 9, v247
    s_nop 1
    v_cndmask_b32 v234, 0, -1, vcc
    v_mov_b32 v238, 0x3f803f80
    v_subrev_u32 v246, 3, v17
    v_cmp_gt_u32 vcc, 8, v246
    s_nop 1
    v_cndmask_b32 v219, v16, 0, vcc
    v_subrev_u32 v247, s22, v246
    v_cmp_gt_i32 vcc, -8, v247
    v_lshl_add_u32 v247, v15, 2, 3
    v_cmp_gt_u32 s[40:41], s23, v247
    s_nop 0
    s_and_b64 vcc, vcc, s[40:41]
    v_cndmask_b32 v227, v16, 0, vcc
    v_cmp_gt_u32 vcc, 9, v247
    s_nop 1
    v_cndmask_b32 v231, 0, -1, vcc
    v_subrev_u32 v247, 1, v247
    v_cmp_gt_u32 vcc, 9, v247
    s_nop 1
    v_cndmask_b32 v235, 0, -1, vcc
    v_mov_b32 v239, 0x3f803f80
    v_lshlrev_b32 v246, 1, v14
    v_add_u32 v246, s28, v246
    v_lshrrev_b32 v247, 4, v246
    v_mul_u32_u24 v247, 2304, v247
    v_and_b32 v246, 15, v246
    v_lshl_add_u32 v247, v246, 4, v247
    s_mul_i32 s22, s27, 4608
    s_add_u32 s22, s22, 122880
    v_add_u32 v247, s22, v247
    v_lshrrev_b32 v246, 1, v15
    v_lshl_add_u32 v244, v246, 8, v247
    v_and_b32 v246, 1, v15
    v_lshl_add_u32 v244, v246, 3, v244
    v_add_u32 v16, 1, v15
    v_lshrrev_b32 v246, 1, v16
    v_lshl_add_u32 v245, v246, 8, v247
    v_and_b32 v246, 1, v16
    v_lshl_add_u32 v245, v246, 3, v245
    s_add_u32 m0, s37, 39936
    s_add_u32 s38, s34, 0
    buffer_load_dwordx4 v5, s[12:15], s38 offen lds
    s_add_u32 m0, s37, 41984
    s_add_u32 s38, s34, 0
    buffer_load_dwordx4 v4, s[12:15], s38 offen lds
    s_add_u32 m0, s37, 44032
    s_add_u32 s38, s34, 36864
    buffer_load_dwordx4 v4, s[12:15], s38 offen lds
    s_add_u32 m0, s24, 39936
    s_nop 0
    buffer_load_dwordx4 v6, s[16:19], s25 offen lds
    s_add_u32 m0, s24, 41984
    s_nop 0
    buffer_load_dwordx4 v7, s[16:19], s25 offen lds
    s_add_u32 m0, s24, 44032
    s_nop 0
    buffer_load_dwordx4 v8, s[16:19], s25 offen lds
    s_add_u32 m0, s24, 46080
    s_nop 0
    buffer_load_dwordx4 v9, s[16:19], s25 offen lds
    s_add_u32 m0, s24, 48128
    s_nop 0
    buffer_load_dwordx4 v10, s[16:19], s25 offen lds
    s_add_u32 m0, s24, 50176
    s_nop 0
    buffer_load_dwordx4 v11, s[16:19], s25 offen lds
    s_add_u32 m0, s24, 52224
    s_nop 0
    buffer_load_dwordx4 v12, s[16:19], s25 offen lds
    s_add_u32 s25, s25, 221184
    s_add_u32 s34, s34, 128
    s_cmp_ge_u32 s34, 1152
    s_cselect_b32 s34, 0, s34
    s_cselect_b32 s25, s26, s25
    s_waitcnt vmcnt(10)
    s_barrier
    ds_read_b128 a[0:3], v26
    ds_read_b128 a[4:7], v32
    ds_read_b128 v[144:147], v20
    ds_read_b64_tr_b16 a[8:9], v38 offset:0
    ds_read_b64_tr_b16 a[10:11], v38 offset:1792
    ds_read_b64_tr_b16 a[12:13], v38 offset:32
    ds_read_b64_tr_b16 a[14:15], v38 offset:1824
    ds_read_b64_tr_b16 a[16:17], v38 offset:64
    ds_read_b64_tr_b16 a[18:19], v38 offset:1856
    ds_read_b64_tr_b16 a[20:21], v38 offset:96
    ds_read_b64_tr_b16 a[22:23], v38 offset:1888
    ds_read_b64_tr_b16 a[24:25], v38 offset:128
    ds_read_b64_tr_b16 a[26:27], v38 offset:1920
    ds_read_b64_tr_b16 a[28:29], v38 offset:160
    ds_read_b64_tr_b16 a[30:31], v38 offset:1952
    ds_read_b64_tr_b16 v[200:201], v38 offset:192
    ds_read_b64_tr_b16 v[202:203], v38 offset:1984
    ds_read_b128 a[32:35], v27
    ds_read_b128 a[36:39], v33
    ds_read_b128 v[148:151], v21
    ds_read_b64_tr_b16 a[40:41], v38 offset:14464
    ds_read_b64_tr_b16 a[42:43], v38 offset:16256
    ds_read_b64_tr_b16 a[44:45], v38 offset:14496
    ds_read_b64_tr_b16 a[46:47], v38 offset:16288
    ds_read_b64_tr_b16 a[48:49], v38 offset:14528
    ds_read_b64_tr_b16 a[50:51], v38 offset:16320
    ds_read_b64_tr_b16 a[52:53], v38 offset:14560
    ds_read_b64_tr_b16 a[54:55], v38 offset:16352
    ds_read_b64_tr_b16 a[56:57], v38 offset:14592
    ds_read_b64_tr_b16 a[58:59], v38 offset:16384
    ds_read_b64_tr_b16 a[60:61], v38 offset:14624
    ds_read_b64_tr_b16 a[62:63], v38 offset:16416
    ds_read_b64_tr_b16 v[204:205], v38 offset:14656
    ds_read_b64_tr_b16 v[206:207], v38 offset:16448
    s_add_u32 m0, s37, 79872
    s_add_u32 s38, s34, 0
    buffer_load_dwordx4 v5, s[12:15], s38 offen lds
    s_add_u32 m0, s37, 81920
    s_add_u32 s38, s34, 0
    buffer_load_dwordx4 v4, s[12:15], s38 offen lds
    s_add_u32 m0, s37, 83968
    s_add_u32 s38, s34, 36864
    buffer_load_dwordx4 v4, s[12:15], s38 offen lds
    s_add_u32 m0, s24, 79872
    s_nop 0
    buffer_load_dwordx4 v6, s[16:19], s25 offen lds
    s_add_u32 m0, s24, 81920
    s_nop 0
    buffer_load_dwordx4 v7, s[16:19], s25 offen lds
    s_add_u32 m0, s24, 83968
    s_nop 0
    buffer_load_dwordx4 v8, s[16:19], s25 offen lds
    s_add_u32 m0, s24, 86016
    s_nop 0
    buffer_load_dwordx4 v9, s[16:19], s25 offen lds
    s_add_u32 m0, s24, 88064
    s_nop 0
    buffer_load_dwordx4 v10, s[16:19], s25 offen lds
    s_add_u32 m0, s24, 90112
    s_nop 0
    buffer_load_dwordx4 v11, s[16:19], s25 offen lds
    s_add_u32 m0, s24, 92160
    s_nop 0
    buffer_load_dwordx4 v12, s[16:19], s25 offen lds
    s_add_u32 s25, s25, 221184
    s_add_u32 s34, s34, 128
    s_cmp_ge_u32 s34, 1152
    s_cselect_b32 s34, 0, s34
    s_cselect_b32 s25, s26, s25
    s_waitcnt lgkmcnt(0)
    s_barrier
    s_add_u32 m0, s37, 0
    s_add_u32 s38, s34, 0
    buffer_load_dwordx4 v5, s[12:15], s38 offen lds
    s_add_u32 m0, s37, 2048
    s_add_u32 s38, s34, 0
    buffer_load_dwordx4 v4, s[12:15], s38 offen lds
    s_add_u32 m0, s37, 4096
    s_add_u32 s38, s34, 36864
    buffer_load_dwordx4 v4, s[12:15], s38 offen lds
    s_add_u32 m0, s24, 0
    s_nop 0
    buffer_load_dwordx4 v6, s[16:19], s25 offen lds
    s_add_u32 m0, s24, 2048
    s_nop 0
    buffer_load_dwordx4 v7, s[16:19], s25 offen lds
    s_add_u32 m0, s24, 4096
    s_nop 0
    buffer_load_dwordx4 v8, s[16:19], s25 offen lds
    s_add_u32 m0, s24, 6144
    s_nop 0
    buffer_load_dwordx4 v9, s[16:19], s25 offen lds
    s_add_u32 m0, s24, 8192
    s_nop 0
    buffer_load_dwordx4 v10, s[16:19], s25 offen lds
    s_add_u32 m0, s24, 10240
    s_nop 0
    buffer_load_dwordx4 v11, s[16:19], s25 offen lds
    s_add_u32 m0, s24, 12288
    s_nop 0
    buffer_load_dwordx4 v12, s[16:19], s25 offen lds
    s_add_u32 s25, s25, 221184
    s_add_u32 s34, s34, 128
    s_cmp_ge_u32 s34, 1152
    s_cselect_b32 s34, 0, s34
    s_cselect_b32 s25, s26, s25
    v_lshlrev_b32 v188, 2, v2
    s_lshl_b32 s22, s2, 7
    s_add_u32 s22, s22, 0x2c00000
    s_add_u32 s23, s22, 0x10000
    v_min_u32 v188, 124, v188
    buffer_store_dword v3, v188, s[8:11], s22 offen sc1
    buffer_store_dword v3, v188, s[8:11], s23 offen sc1
    s_mul_i32 s42, s4, 0
    s_add_u32 s42, s42, s5
    s_add_u32 m0, s7, 0
    s_nop 0
    buffer_load_dwordx4 v160, s[52:55], s42 offen nt lds
    s_mul_i32 s42, s4, -9216
    s_add_u32 s42, s42, s5
    s_add_u32 s42, s42, 9216
    s_add_u32 m0, s7, 1024
    s_nop 0
    buffer_load_dwordx4 v160, s[56:59], s42 offen nt lds
    s_mul_i32 s42, s4, 55296
    s_add_u32 s42, s42, s5
    s_add_u32 s42, s42, 18432
    s_add_u32 m0, s7, 2048
    s_nop 0
    buffer_load_dwordx4 v160, s[52:55], s42 offen nt lds
    s_mul_i32 s42, s4, 46080
    s_add_u32 s42, s42, s5
    s_add_u32 s42, s42, 27648
    s_add_u32 m0, s7, 3072
    s_nop 0
    buffer_load_dwordx4 v160, s[56:59], s42 offen nt lds
    s_waitcnt vmcnt(26)
    s_barrier
    v_mfma_f32_16x16x32_bf16 v[44:47], a[0:3], a[0:3], 0
    ds_read_b128 a[64:67], v28
    ds_read_b128 a[68:71], v34
    v_mfma_f32_16x16x32_bf16 v[72:75], a[8:11], a[0:3], 0
    ds_read_b128 v[152:155], v22
    ds_read_b64_tr_b16 a[72:73], v39 offset:0
    v_mfma_f32_16x16x32_bf16 v[76:79], a[8:11], a[4:7], 0
    ds_read_b64_tr_b16 a[74:75], v39 offset:1792
    ds_read_b64_tr_b16 a[76:77], v39 offset:32
    v_cndmask_b32 v144, v144, v236, s[30:31]
    v_cndmask_b32 v145, v145, v236, s[30:31]
    v_cndmask_b32 v146, v146, v236, s[30:31]
    v_cndmask_b32 v147, v147, v236, s[30:31]
    v_mfma_f32_16x16x32_bf16 v[80:83], a[12:15], a[0:3], 0
    ds_read_b64_tr_b16 a[78:79], v39 offset:1824
    ds_read_b64_tr_b16 a[80:81], v39 offset:64
    v_cndmask_b32 v200, v200, v236, s[32:33]
    v_cndmask_b32 v201, v201, v236, s[32:33]
    v_cndmask_b32 v202, v202, v236, s[32:33]
    v_cndmask_b32 v203, v203, v236, s[32:33]
    v_mfma_f32_16x16x32_bf16 v[84:87], a[12:15], a[4:7], 0
    ds_read_b64_tr_b16 a[82:83], v39 offset:1856
    ds_read_b64_tr_b16 a[84:85], v39 offset:96
    v_mfma_f32_16x16x32_bf16 v[88:91], a[16:19], a[0:3], 0
    ds_read_b64_tr_b16 a[86:87], v39 offset:1888
    ds_read_b64_tr_b16 a[88:89], v39 offset:128
    v_mfma_f32_16x16x32_bf16 v[92:95], a[16:19], a[4:7], 0
    ds_read_b64_tr_b16 a[90:91], v39 offset:1920
    ds_read_b64_tr_b16 a[92:93], v39 offset:160
    v_mfma_f32_16x16x32_bf16 v[96:99], a[20:23], a[0:3], 0
    ds_read_b64_tr_b16 a[94:95], v39 offset:1952
    ds_read_b64_tr_b16 v[208:209], v39 offset:192
    v_mfma_f32_16x16x32_bf16 v[100:103], a[20:23], a[4:7], 0
    ds_read_b64_tr_b16 v[210:211], v39 offset:1984
    ds_read_b128 a[96:99], v29
    v_mfma_f32_16x16x32_bf16 v[104:107], a[24:27], a[0:3], 0
    ds_read_b128 a[100:103], v35
    ds_read_b128 v[156:159], v23
    v_mfma_f32_16x16x32_bf16 v[108:111], a[24:27], a[4:7], 0
    ds_read_b64_tr_b16 a[104:105], v39 offset:14464
    ds_read_b64_tr_b16 a[106:107], v39 offset:16256
    v_mfma_f32_16x16x32_bf16 v[112:115], a[28:31], a[0:3], 0
    ds_read_b64_tr_b16 a[108:109], v39 offset:14496
    ds_read_b64_tr_b16 a[110:111], v39 offset:16288
    v_mfma_f32_16x16x32_bf16 v[116:119], a[28:31], a[4:7], 0
    ds_read_b64_tr_b16 a[112:113], v39 offset:14528
    ds_read_b64_tr_b16 a[114:115], v39 offset:16320
    v_mfma_f32_16x16x32_bf16 v[120:123], v[200:203], a[0:3], 0
    ds_read_b64_tr_b16 a[116:117], v39 offset:14560
    ds_read_b64_tr_b16 a[118:119], v39 offset:16352
    v_mfma_f32_16x16x32_bf16 v[124:127], v[200:203], a[4:7], 0
    ds_read_b64_tr_b16 a[120:121], v39 offset:14592
    ds_read_b64_tr_b16 a[122:123], v39 offset:16384
    v_mfma_f32_16x16x32_bf16 v[128:131], a[8:11], v[144:147], 0
    ds_read_b64_tr_b16 a[124:125], v39 offset:14624
    ds_read_b64_tr_b16 a[126:127], v39 offset:16416
    v_mfma_f32_16x16x32_bf16 v[132:135], a[12:15], v[144:147], 0
    ds_read_b64_tr_b16 v[212:213], v39 offset:14656
    ds_read_b64_tr_b16 v[214:215], v39 offset:16448
    v_mfma_f32_16x16x32_bf16 v[136:139], a[16:19], v[144:147], 0
    v_mfma_f32_16x16x32_bf16 v[140:143], a[20:23], v[144:147], 0
    s_waitcnt lgkmcnt(0)
    s_barrier
    v_mfma_f32_16x16x32_bf16 v[44:47], a[32:35], a[32:35], v[44:47]
    s_add_u32 m0, s37, 39936
    s_add_u32 s38, s34, 0
    buffer_load_dwordx4 v5, s[12:15], s38 offen lds
    s_add_u32 m0, s37, 41984
    s_add_u32 s38, s34, 0
    buffer_load_dwordx4 v4, s[12:15], s38 offen lds
    v_mfma_f32_16x16x32_bf16 v[72:75], a[40:43], a[32:35], v[72:75]
    s_add_u32 m0, s37, 44032
    s_add_u32 s38, s34, 36864
    buffer_load_dwordx4 v4, s[12:15], s38 offen lds
    s_add_u32 m0, s24, 39936
    s_nop 0
    buffer_load_dwordx4 v6, s[16:19], s25 offen lds
    v_mfma_f32_16x16x32_bf16 v[76:79], a[40:43], a[36:39], v[76:79]
    s_add_u32 m0, s24, 41984
    s_nop 0
    buffer_load_dwordx4 v7, s[16:19], s25 offen lds
    s_add_u32 m0, s24, 44032
    s_nop 0
    buffer_load_dwordx4 v8, s[16:19], s25 offen lds
    v_cndmask_b32 v148, v148, v236, s[30:31]
    v_cndmask_b32 v149, v149, v236, s[30:31]
    v_cndmask_b32 v150, v150, v236, s[30:31]
    v_cndmask_b32 v151, v151, v236, s[30:31]
    v_mfma_f32_16x16x32_bf16 v[80:83], a[44:47], a[32:35], v[80:83]
    s_add_u32 m0, s24, 46080
    s_nop 0
    buffer_load_dwordx4 v9, s[16:19], s25 offen lds
    s_add_u32 m0, s24, 48128
    s_nop 0
    buffer_load_dwordx4 v10, s[16:19], s25 offen lds
    v_cndmask_b32 v204, v204, v236, s[32:33]
    v_cndmask_b32 v205, v205, v236, s[32:33]
    v_cndmask_b32 v206, v206, v236, s[32:33]
    v_cndmask_b32 v207, v207, v236, s[32:33]
    v_mfma_f32_16x16x32_bf16 v[84:87], a[44:47], a[36:39], v[84:87]
    s_add_u32 m0, s24, 50176
    s_nop 0
    buffer_load_dwordx4 v11, s[16:19], s25 offen lds
    s_add_u32 m0, s24, 52224
    s_nop 0
    buffer_load_dwordx4 v12, s[16:19], s25 offen lds
    s_add_u32 s25, s25, 221184
    s_add_u32 s34, s34, 128
    s_cmp_ge_u32 s34, 1152
    s_cselect_b32 s34, 0, s34
    s_cselect_b32 s25, s26, s25
    v_mfma_f32_16x16x32_bf16 v[88:91], a[48:51], a[32:35], v[88:91]
    s_mul_i32 s42, s4, 110592
    s_add_u32 s42, s42, s5
    s_add_u32 s42, s42, 36864
    s_add_u32 m0, s7, 4096
    s_nop 0
    buffer_load_dwordx4 v160, s[52:55], s42 offen nt lds
    s_mul_i32 s42, s4, 101376
    s_add_u32 s42, s42, s5
    s_add_u32 s42, s42, 46080
    s_add_u32 m0, s7, 5120
    s_nop 0
    buffer_load_dwordx4 v160, s[56:59], s42 offen nt lds
    v_mfma_f32_16x16x32_bf16 v[92:95], a[48:51], a[36:39], v[92:95]
    v_mfma_f32_16x16x32_bf16 v[96:99], a[52:55], a[32:35], v[96:99]
    v_mfma_f32_16x16x32_bf16 v[100:103], a[52:55], a[36:39], v[100:103]
    v_mfma_f32_16x16x32_bf16 v[104:107], a[56:59], a[32:35], v[104:107]
    v_mfma_f32_16x16x32_bf16 v[108:111], a[56:59], a[36:39], v[108:111]
    v_mfma_f32_16x16x32_bf16 v[112:115], a[60:63], a[32:35], v[112:115]
    v_mfma_f32_16x16x32_bf16 v[116:119], a[60:63], a[36:39], v[116:119]
    v_mfma_f32_16x16x32_bf16 v[120:123], v[204:207], a[32:35], v[120:123]
    v_mfma_f32_16x16x32_bf16 v[124:127], v[204:207], a[36:39], v[124:127]
    v_mfma_f32_16x16x32_bf16 v[128:131], a[40:43], v[148:151], v[128:131]
    v_mfma_f32_16x16x32_bf16 v[132:135], a[44:47], v[148:151], v[132:135]
    v_mfma_f32_16x16x32_bf16 v[136:139], a[48:51], v[148:151], v[136:139]
    v_mfma_f32_16x16x32_bf16 v[140:143], a[52:55], v[148:151], v[140:143]
    s_waitcnt vmcnt(28)
    s_barrier
    v_mfma_f32_16x16x32_bf16 v[44:47], a[64:67], a[64:67], v[44:47]
    ds_read_b128 a[0:3], v30
    ds_read_b128 a[4:7], v36
    v_mfma_f32_16x16x32_bf16 v[72:75], a[72:75], a[64:67], v[72:75]
    ds_read_b128 v[144:147], v24
    ds_read_b64_tr_b16 a[8:9], v40 offset:0
    v_mfma_f32_16x16x32_bf16 v[76:79], a[72:75], a[68:71], v[76:79]
    ds_read_b64_tr_b16 a[10:11], v40 offset:1792
    ds_read_b64_tr_b16 a[12:13], v40 offset:32
    v_cndmask_b32 v152, v152, v236, s[30:31]
    v_cndmask_b32 v153, v153, v236, s[30:31]
    v_cndmask_b32 v154, v154, v236, s[30:31]
    v_cndmask_b32 v155, v155, v236, s[30:31]
    v_mfma_f32_16x16x32_bf16 v[80:83], a[76:79], a[64:67], v[80:83]
    ds_read_b64_tr_b16 a[14:15], v40 offset:1824
    ds_read_b64_tr_b16 a[16:17], v40 offset:64
    v_cndmask_b32 v208, v208, v236, s[32:33]
    v_cndmask_b32 v209, v209, v236, s[32:33]
    v_cndmask_b32 v210, v210, v236, s[32:33]
    v_cndmask_b32 v211, v211, v236, s[32:33]
    v_mfma_f32_16x16x32_bf16 v[84:87], a[76:79], a[68:71], v[84:87]
    ds_read_b64_tr_b16 a[18:19], v40 offset:1856
    ds_read_b64_tr_b16 a[20:21], v40 offset:96
    v_mfma_f32_16x16x32_bf16 v[88:91], a[80:83], a[64:67], v[88:91]
    ds_read_b64_tr_b16 a[22:23], v40 offset:1888
    ds_read_b64_tr_b16 a[24:25], v40 offset:128
    v_mfma_f32_16x16x32_bf16 v[92:95], a[80:83], a[68:71], v[92:95]
    ds_read_b64_tr_b16 a[26:27], v40 offset:1920
    ds_read_b64_tr_b16 a[28:29], v40 offset:160
    v_mfma_f32_16x16x32_bf16 v[96:99], a[84:87], a[64:67], v[96:99]
    ds_read_b64_tr_b16 a[30:31], v40 offset:1952
    ds_read_b64_tr_b16 v[200:201], v40 offset:192
    v_mfma_f32_16x16x32_bf16 v[100:103], a[84:87], a[68:71], v[100:103]
    ds_read_b64_tr_b16 v[202:203], v40 offset:1984
    ds_read_b128 a[32:35], v31
    v_mfma_f32_16x16x32_bf16 v[104:107], a[88:91], a[64:67], v[104:107]
    ds_read_b128 a[36:39], v37
    ds_read_b128 v[148:151], v25
    v_mfma_f32_16x16x32_bf16 v[108:111], a[88:91], a[68:71], v[108:111]
    ds_read_b64_tr_b16 a[40:41], v40 offset:14464
    ds_read_b64_tr_b16 a[42:43], v40 offset:16256
    v_mfma_f32_16x16x32_bf16 v[112:115], a[92:95], a[64:67], v[112:115]
    ds_read_b64_tr_b16 a[44:45], v40 offset:14496
    ds_read_b64_tr_b16 a[46:47], v40 offset:16288
    v_mfma_f32_16x16x32_bf16 v[116:119], a[92:95], a[68:71], v[116:119]
    ds_read_b64_tr_b16 a[48:49], v40 offset:14528
    ds_read_b64_tr_b16 a[50:51], v40 offset:16320
    v_mfma_f32_16x16x32_bf16 v[120:123], v[208:211], a[64:67], v[120:123]
    ds_read_b64_tr_b16 a[52:53], v40 offset:14560
    ds_read_b64_tr_b16 a[54:55], v40 offset:16352
    v_mfma_f32_16x16x32_bf16 v[124:127], v[208:211], a[68:71], v[124:127]
    ds_read_b64_tr_b16 a[56:57], v40 offset:14592
    ds_read_b64_tr_b16 a[58:59], v40 offset:16384
    v_mfma_f32_16x16x32_bf16 v[128:131], a[72:75], v[152:155], v[128:131]
    ds_read_b64_tr_b16 a[60:61], v40 offset:14624
    ds_read_b64_tr_b16 a[62:63], v40 offset:16416
    v_mfma_f32_16x16x32_bf16 v[132:135], a[76:79], v[152:155], v[132:135]
    ds_read_b64_tr_b16 v[204:205], v40 offset:14656
    ds_read_b64_tr_b16 v[206:207], v40 offset:16448
    v_mfma_f32_16x16x32_bf16 v[136:139], a[80:83], v[152:155], v[136:139]
    s_waitcnt vmcnt(15)
    ds_read_b64_tr_b16 v[168:169], v161 offset:0
    ds_read_b64_tr_b16 v[170:171], v161 offset:512
    s_waitcnt vmcnt(14)
    ds_read_b64_tr_b16 v[172:173], v161 offset:1024
    ds_read_b64_tr_b16 v[174:175], v161 offset:1536
    v_mfma_f32_16x16x32_bf16 v[140:143], a[84:87], v[152:155], v[140:143]
    s_waitcnt lgkmcnt(0)
    s_barrier
    v_mfma_f32_16x16x32_bf16 v[44:47], a[96:99], a[96:99], v[44:47]
    s_add_u32 m0, s37, 79872
    s_add_u32 s38, s34, 0
    buffer_load_dwordx4 v5, s[12:15], s38 offen lds
    s_add_u32 m0, s37, 81920
    s_add_u32 s38, s34, 0
    buffer_load_dwordx4 v4, s[12:15], s38 offen lds
    v_mfma_f32_16x16x32_bf16 v[72:75], a[104:107], a[96:99], v[72:75]
    s_add_u32 m0, s37, 83968
    s_add_u32 s38, s34, 36864
    buffer_load_dwordx4 v4, s[12:15], s38 offen lds
    s_add_u32 m0, s24, 79872
    s_nop 0
    buffer_load_dwordx4 v6, s[16:19], s25 offen lds
    v_mfma_f32_16x16x32_bf16 v[76:79], a[104:107], a[100:103], v[76:79]
    s_add_u32 m0, s24, 81920
    s_nop 0
    buffer_load_dwordx4 v7, s[16:19], s25 offen lds
    s_add_u32 m0, s24, 83968
    s_nop 0
    buffer_load_dwordx4 v8, s[16:19], s25 offen lds
    v_cndmask_b32 v156, v156, v236, s[30:31]
    v_cndmask_b32 v157, v157, v236, s[30:31]
    v_cndmask_b32 v158, v158, v236, s[30:31]
    v_cndmask_b32 v159, v159, v236, s[30:31]
    v_mfma_f32_16x16x32_bf16 v[80:83], a[108:111], a[96:99], v[80:83]
    s_add_u32 m0, s24, 86016
    s_nop 0
    buffer_load_dwordx4 v9, s[16:19], s25 offen lds
    s_add_u32 m0, s24, 88064
    s_nop 0
    buffer_load_dwordx4 v10, s[16:19], s25 offen lds
    v_cndmask_b32 v212, v212, v236, s[32:33]
    v_cndmask_b32 v213, v213, v236, s[32:33]
    v_cndmask_b32 v214, v214, v236, s[32:33]
    v_cndmask_b32 v215, v215, v236, s[32:33]
    v_mfma_f32_16x16x32_bf16 v[84:87], a[108:111], a[100:103], v[84:87]
    s_add_u32 m0, s24, 90112
    s_nop 0
    buffer_load_dwordx4 v11, s[16:19], s25 offen lds
    s_add_u32 m0, s24, 92160
    s_nop 0
    buffer_load_dwordx4 v12, s[16:19], s25 offen lds
    s_add_u32 s25, s25, 221184
    s_add_u32 s34, s34, 128
    s_cmp_ge_u32 s34, 1152
    s_cselect_b32 s34, 0, s34
    s_cselect_b32 s25, s26, s25
    v_mfma_f32_16x16x32_bf16 v[88:91], a[112:115], a[96:99], v[88:91]
    v_dot2c_f32_bf16 v164, v168, v166
    v_dot2c_f32_bf16 v164, v169, v166
    v_dot2c_f32_bf16 v164, v170, v166
    v_dot2c_f32_bf16 v164, v171, v166
    v_accvgpr_write_b32 a128, v168
    v_accvgpr_write_b32 a129, v169
    v_accvgpr_write_b32 a130, v170
    v_accvgpr_write_b32 a131, v171
    v_dot2c_f32_bf16 v165, v172, v166
    v_dot2c_f32_bf16 v165, v173, v166
    v_dot2c_f32_bf16 v165, v174, v166
    v_dot2c_f32_bf16 v165, v175, v166
    v_accvgpr_write_b32 a132, v172
    v_accvgpr_write_b32 a133, v173
    v_accvgpr_write_b32 a134, v174
    v_accvgpr_write_b32 a135, v175
    v_mfma_f32_16x16x32_bf16 v[92:95], a[112:115], a[100:103], v[92:95]
    s_mul_i32 s42, s4, 165888
    s_add_u32 s42, s42, s5
    s_add_u32 s42, s42, 55296
    s_add_u32 m0, s7, 0
    s_nop 0
    buffer_load_dwordx4 v160, s[52:55], s42 offen nt lds
    s_mul_i32 s42, s4, 156672
    s_add_u32 s42, s42, s5
    s_add_u32 s42, s42, 64512
    s_add_u32 m0, s7, 1024
    s_nop 0
    buffer_load_dwordx4 v160, s[56:59], s42 offen nt lds
    v_mfma_f32_16x16x32_bf16 v[96:99], a[116:119], a[96:99], v[96:99]
    v_mfma_f32_16x16x32_bf16 v[100:103], a[116:119], a[100:103], v[100:103]
    v_mfma_f32_16x16x32_bf16 v[104:107], a[120:123], a[96:99], v[104:107]
    v_mfma_f32_16x16x32_bf16 v[108:111], a[120:123], a[100:103], v[108:111]
    v_mfma_f32_16x16x32_bf16 v[112:115], a[124:127], a[96:99], v[112:115]
    v_mfma_f32_16x16x32_bf16 v[116:119], a[124:127], a[100:103], v[116:119]
    v_mfma_f32_16x16x32_bf16 v[120:123], v[212:215], a[96:99], v[120:123]
    v_mfma_f32_16x16x32_bf16 v[124:127], v[212:215], a[100:103], v[124:127]
    v_mfma_f32_16x16x32_bf16 v[128:131], a[104:107], v[156:159], v[128:131]
    v_mfma_f32_16x16x32_bf16 v[132:135], a[108:111], v[156:159], v[132:135]
    v_mfma_f32_16x16x32_bf16 v[136:139], a[112:115], v[156:159], v[136:139]
    v_mfma_f32_16x16x32_bf16 v[140:143], a[116:119], v[156:159], v[140:143]
    s_barrier
    v_mfma_f32_16x16x32_bf16 v[44:47], a[0:3], a[0:3], v[44:47]
    ds_read_b128 a[64:67], v26
    ds_read_b128 a[68:71], v32
    v_mfma_f32_16x16x32_bf16 v[72:75], a[8:11], a[0:3], v[72:75]
    ds_read_b128 v[152:155], v20
    ds_read_b64_tr_b16 a[72:73], v38 offset:0
    v_mfma_f32_16x16x32_bf16 v[76:79], a[8:11], a[4:7], v[76:79]
    ds_read_b64_tr_b16 a[74:75], v38 offset:1792
    ds_read_b64_tr_b16 a[76:77], v38 offset:32
    v_cndmask_b32 v144, v144, v236, s[30:31]
    v_cndmask_b32 v145, v145, v236, s[30:31]
    v_cndmask_b32 v146, v146, v236, s[30:31]
    v_cndmask_b32 v147, v147, v236, s[30:31]
    v_mfma_f32_16x16x32_bf16 v[80:83], a[12:15], a[0:3], v[80:83]
    ds_read_b64_tr_b16 a[78:79], v38 offset:1824
    ds_read_b64_tr_b16 a[80:81], v38 offset:64
    v_cndmask_b32 v200, v200, v236, s[32:33]
    v_cndmask_b32 v201, v201, v236, s[32:33]
    v_cndmask_b32 v202, v202, v236, s[32:33]
    v_cndmask_b32 v203, v203, v236, s[32:33]
    v_mfma_f32_16x16x32_bf16 v[84:87], a[12:15], a[4:7], v[84:87]
    ds_read_b64_tr_b16 a[82:83], v38 offset:1856
    ds_read_b64_tr_b16 a[84:85], v38 offset:96
    v_mfma_f32_16x16x32_bf16 v[88:91], a[16:19], a[0:3], v[88:91]
    ds_read_b64_tr_b16 a[86:87], v38 offset:1888
    ds_read_b64_tr_b16 a[88:89], v38 offset:128
    v_mfma_f32_16x16x32_bf16 v[92:95], a[16:19], a[4:7], v[92:95]
    ds_read_b64_tr_b16 a[90:91], v38 offset:1920
    ds_read_b64_tr_b16 a[92:93], v38 offset:160
    v_mfma_f32_16x16x32_bf16 v[96:99], a[20:23], a[0:3], v[96:99]
    ds_read_b64_tr_b16 a[94:95], v38 offset:1952
    ds_read_b64_tr_b16 v[208:209], v38 offset:192
    v_mfma_f32_16x16x32_bf16 v[100:103], a[20:23], a[4:7], v[100:103]
    ds_read_b64_tr_b16 v[210:211], v38 offset:1984
    ds_read_b128 a[96:99], v27
    v_mfma_f32_16x16x32_bf16 v[104:107], a[24:27], a[0:3], v[104:107]
    ds_read_b128 a[100:103], v33
    ds_read_b128 v[156:159], v21
    v_mfma_f32_16x16x32_bf16 v[108:111], a[24:27], a[4:7], v[108:111]
    ds_read_b64_tr_b16 a[104:105], v38 offset:14464
    ds_read_b64_tr_b16 a[106:107], v38 offset:16256
    v_mfma_f32_16x16x32_bf16 v[112:115], a[28:31], a[0:3], v[112:115]
    ds_read_b64_tr_b16 a[108:109], v38 offset:14496
    ds_read_b64_tr_b16 a[110:111], v38 offset:16288
    v_mfma_f32_16x16x32_bf16 v[116:119], a[28:31], a[4:7], v[116:119]
    ds_read_b64_tr_b16 a[112:113], v38 offset:14528
    ds_read_b64_tr_b16 a[114:115], v38 offset:16320
    v_mfma_f32_16x16x32_bf16 v[120:123], v[200:203], a[0:3], v[120:123]
    ds_read_b64_tr_b16 a[116:117], v38 offset:14560
    ds_read_b64_tr_b16 a[118:119], v38 offset:16352
    v_mfma_f32_16x16x32_bf16 v[124:127], v[200:203], a[4:7], v[124:127]
    ds_read_b64_tr_b16 a[120:121], v38 offset:14592
    ds_read_b64_tr_b16 a[122:123], v38 offset:16384
    v_mfma_f32_16x16x32_bf16 v[128:131], a[8:11], v[144:147], v[128:131]
    ds_read_b64_tr_b16 a[124:125], v38 offset:14624
    ds_read_b64_tr_b16 a[126:127], v38 offset:16416
    v_mfma_f32_16x16x32_bf16 v[132:135], a[12:15], v[144:147], v[132:135]
    ds_read_b64_tr_b16 v[212:213], v38 offset:14656
    ds_read_b64_tr_b16 v[214:215], v38 offset:16448
    v_mfma_f32_16x16x32_bf16 v[136:139], a[16:19], v[144:147], v[136:139]
    s_waitcnt vmcnt(25)
    ds_read_b64_tr_b16 v[176:177], v161 offset:2048
    ds_read_b64_tr_b16 v[178:179], v161 offset:2560
    s_waitcnt vmcnt(24)
    ds_read_b64_tr_b16 v[180:181], v161 offset:3072
    ds_read_b64_tr_b16 v[182:183], v161 offset:3584
    v_mfma_f32_16x16x32_bf16 v[140:143], a[20:23], v[144:147], v[140:143]
    s_waitcnt lgkmcnt(0)
    s_barrier
    v_mfma_f32_16x16x32_bf16 v[44:47], a[32:35], a[32:35], v[44:47]
    s_add_u32 m0, s37, 0
    s_add_u32 s38, s34, 0
    buffer_load_dwordx4 v5, s[12:15], s38 offen lds
    s_add_u32 m0, s37, 2048
    s_add_u32 s38, s34, 0
    buffer_load_dwordx4 v4, s[12:15], s38 offen lds
    v_mfma_f32_16x16x32_bf16 v[72:75], a[40:43], a[32:35], v[72:75]
    s_add_u32 m0, s37, 4096
    s_add_u32 s38, s34, 36864
    buffer_load_dwordx4 v4, s[12:15], s38 offen lds
    s_add_u32 m0, s24, 0
    s_nop 0
    buffer_load_dwordx4 v6, s[16:19], s25 offen lds
    v_mfma_f32_16x16x32_bf16 v[76:79], a[40:43], a[36:39], v[76:79]
    s_add_u32 m0, s24, 2048
    s_nop 0
    buffer_load_dwordx4 v7, s[16:19], s25 offen lds
    s_add_u32 m0, s24, 4096
    s_nop 0
    buffer_load_dwordx4 v8, s[16:19], s25 offen lds
    v_cndmask_b32 v148, v148, v236, s[30:31]
    v_cndmask_b32 v149, v149, v236, s[30:31]
    v_cndmask_b32 v150, v150, v236, s[30:31]
    v_cndmask_b32 v151, v151, v236, s[30:31]
    v_mfma_f32_16x16x32_bf16 v[80:83], a[44:47], a[32:35], v[80:83]
    s_add_u32 m0, s24, 6144
    s_nop 0
    buffer_load_dwordx4 v9, s[16:19], s25 offen lds
    s_add_u32 m0, s24, 8192
    s_nop 0
    buffer_load_dwordx4 v10, s[16:19], s25 offen lds
    v_cndmask_b32 v204, v204, v236, s[32:33]
    v_cndmask_b32 v205, v205, v236, s[32:33]
    v_cndmask_b32 v206, v206, v236, s[32:33]
    v_cndmask_b32 v207, v207, v236, s[32:33]
    v_mfma_f32_16x16x32_bf16 v[84:87], a[44:47], a[36:39], v[84:87]
    s_add_u32 m0, s24, 10240
    s_nop 0
    buffer_load_dwordx4 v11, s[16:19], s25 offen lds
    s_add_u32 m0, s24, 12288
    s_nop 0
    buffer_load_dwordx4 v12, s[16:19], s25 offen lds
    s_add_u32 s25, s25, 221184
    s_add_u32 s34, s34, 128
    s_cmp_ge_u32 s34, 1152
    s_cselect_b32 s34, 0, s34
    s_cselect_b32 s25, s26, s25
    v_mfma_f32_16x16x32_bf16 v[88:91], a[48:51], a[32:35], v[88:91]
    v_dot2c_f32_bf16 v164, v176, v166
    v_dot2c_f32_bf16 v164, v177, v166
    v_dot2c_f32_bf16 v164, v178, v166
    v_dot2c_f32_bf16 v164, v179, v166
    v_accvgpr_write_b32 a136, v176
    v_accvgpr_write_b32 a137, v177
    v_accvgpr_write_b32 a138, v178
    v_accvgpr_write_b32 a139, v179
    v_dot2c_f32_bf16 v165, v180, v166
    v_dot2c_f32_bf16 v165, v181, v166
    v_dot2c_f32_bf16 v165, v182, v166
    v_dot2c_f32_bf16 v165, v183, v166
    v_accvgpr_write_b32 a140, v180
    v_accvgpr_write_b32 a141, v181
    v_accvgpr_write_b32 a142, v182
    v_accvgpr_write_b32 a143, v183
    v_mfma_f32_16x16x32_bf16 v[92:95], a[48:51], a[36:39], v[92:95]
    s_mul_i32 s42, s4, 221184
    s_add_u32 s42, s42, s5
    s_add_u32 s42, s42, 73728
    s_add_u32 m0, s7, 2048
    s_nop 0
    buffer_load_dwordx4 v160, s[52:55], s42 offen nt lds
    s_mul_i32 s42, s4, 211968
    s_add_u32 s42, s42, s5
    s_add_u32 s42, s42, 82944
    s_add_u32 m0, s7, 3072
    s_nop 0
    buffer_load_dwordx4 v160, s[56:59], s42 offen nt lds
    v_mfma_f32_16x16x32_bf16 v[96:99], a[52:55], a[32:35], v[96:99]
    v_mfma_f32_16x16x32_bf16 v[100:103], a[52:55], a[36:39], v[100:103]
    v_mfma_f32_16x16x32_bf16 v[104:107], a[56:59], a[32:35], v[104:107]
    v_mfma_f32_16x16x32_bf16 v[108:111], a[56:59], a[36:39], v[108:111]
    v_mfma_f32_16x16x32_bf16 v[112:115], a[60:63], a[32:35], v[112:115]
    v_mfma_f32_16x16x32_bf16 v[116:119], a[60:63], a[36:39], v[116:119]
    v_mfma_f32_16x16x32_bf16 v[120:123], v[204:207], a[32:35], v[120:123]
    v_mfma_f32_16x16x32_bf16 v[124:127], v[204:207], a[36:39], v[124:127]
    v_mfma_f32_16x16x32_bf16 v[128:131], a[40:43], v[148:151], v[128:131]
    v_mfma_f32_16x16x32_bf16 v[132:135], a[44:47], v[148:151], v[132:135]
    v_mfma_f32_16x16x32_bf16 v[136:139], a[48:51], v[148:151], v[136:139]
    v_mfma_f32_16x16x32_bf16 v[140:143], a[52:55], v[148:151], v[140:143]
    s_waitcnt vmcnt(26)
    s_barrier
    v_mfma_f32_16x16x32_bf16 v[44:47], a[64:67], a[64:67], v[44:47]
    ds_read_b128 a[0:3], v28
    ds_read_b128 a[4:7], v34
    v_mfma_f32_16x16x32_bf16 v[72:75], a[72:75], a[64:67], v[72:75]
    ds_read_b128 v[144:147], v22
    ds_read_b64_tr_b16 a[8:9], v39 offset:0
    v_mfma_f32_16x16x32_bf16 v[76:79], a[72:75], a[68:71], v[76:79]
    ds_read_b64_tr_b16 a[10:11], v39 offset:1792
    ds_read_b64_tr_b16 a[12:13], v39 offset:32
    v_cndmask_b32 v152, v152, v236, s[30:31]
    v_cndmask_b32 v153, v153, v236, s[30:31]
    v_cndmask_b32 v154, v154, v236, s[30:31]
    v_cndmask_b32 v155, v155, v236, s[30:31]
    v_mfma_f32_16x16x32_bf16 v[80:83], a[76:79], a[64:67], v[80:83]
    ds_read_b64_tr_b16 a[14:15], v39 offset:1824
    ds_read_b64_tr_b16 a[16:17], v39 offset:64
    v_cndmask_b32 v208, v208, v236, s[32:33]
    v_cndmask_b32 v209, v209, v236, s[32:33]
    v_cndmask_b32 v210, v210, v236, s[32:33]
    v_cndmask_b32 v211, v211, v236, s[32:33]
    v_mfma_f32_16x16x32_bf16 v[84:87], a[76:79], a[68:71], v[84:87]
    ds_read_b64_tr_b16 a[18:19], v39 offset:1856
    ds_read_b64_tr_b16 a[20:21], v39 offset:96
    v_mfma_f32_16x16x32_bf16 v[88:91], a[80:83], a[64:67], v[88:91]
    ds_read_b64_tr_b16 a[22:23], v39 offset:1888
    ds_read_b64_tr_b16 a[24:25], v39 offset:128
    v_mfma_f32_16x16x32_bf16 v[92:95], a[80:83], a[68:71], v[92:95]
    ds_read_b64_tr_b16 a[26:27], v39 offset:1920
    ds_read_b64_tr_b16 a[28:29], v39 offset:160
    v_mfma_f32_16x16x32_bf16 v[96:99], a[84:87], a[64:67], v[96:99]
    ds_read_b64_tr_b16 a[30:31], v39 offset:1952
    ds_read_b64_tr_b16 v[200:201], v39 offset:192
    v_mfma_f32_16x16x32_bf16 v[100:103], a[84:87], a[68:71], v[100:103]
    ds_read_b64_tr_b16 v[202:203], v39 offset:1984
    ds_read_b128 a[32:35], v29
    v_mfma_f32_16x16x32_bf16 v[104:107], a[88:91], a[64:67], v[104:107]
    ds_read_b128 a[36:39], v35
    ds_read_b128 v[148:151], v23
    v_mfma_f32_16x16x32_bf16 v[108:111], a[88:91], a[68:71], v[108:111]
    ds_read_b64_tr_b16 a[40:41], v39 offset:14464
    ds_read_b64_tr_b16 a[42:43], v39 offset:16256
    v_mfma_f32_16x16x32_bf16 v[112:115], a[92:95], a[64:67], v[112:115]
    ds_read_b64_tr_b16 a[44:45], v39 offset:14496
    ds_read_b64_tr_b16 a[46:47], v39 offset:16288
    v_mfma_f32_16x16x32_bf16 v[116:119], a[92:95], a[68:71], v[116:119]
    ds_read_b64_tr_b16 a[48:49], v39 offset:14528
    ds_read_b64_tr_b16 a[50:51], v39 offset:16320
    v_mfma_f32_16x16x32_bf16 v[120:123], v[208:211], a[64:67], v[120:123]
    ds_read_b64_tr_b16 a[52:53], v39 offset:14560
    ds_read_b64_tr_b16 a[54:55], v39 offset:16352
    v_mfma_f32_16x16x32_bf16 v[124:127], v[208:211], a[68:71], v[124:127]
    ds_read_b64_tr_b16 a[56:57], v39 offset:14592
    ds_read_b64_tr_b16 a[58:59], v39 offset:16384
    v_mfma_f32_16x16x32_bf16 v[128:131], a[72:75], v[152:155], v[128:131]
    ds_read_b64_tr_b16 a[60:61], v39 offset:14624
    ds_read_b64_tr_b16 a[62:63], v39 offset:16416
    v_mfma_f32_16x16x32_bf16 v[132:135], a[76:79], v[152:155], v[132:135]
    ds_read_b64_tr_b16 v[204:205], v39 offset:14656
    ds_read_b64_tr_b16 v[206:207], v39 offset:16448
    v_mfma_f32_16x16x32_bf16 v[136:139], a[80:83], v[152:155], v[136:139]
    s_waitcnt vmcnt(25)
    ds_read_b64_tr_b16 v[168:169], v161 offset:4096
    ds_read_b64_tr_b16 v[170:171], v161 offset:4608
    s_waitcnt vmcnt(24)
    ds_read_b64_tr_b16 v[172:173], v161 offset:5120
    ds_read_b64_tr_b16 v[174:175], v161 offset:5632
    v_mfma_f32_16x16x32_bf16 v[140:143], a[84:87], v[152:155], v[140:143]
    s_waitcnt lgkmcnt(0)
    s_barrier
    v_mfma_f32_16x16x32_bf16 v[44:47], a[96:99], a[96:99], v[44:47]
    s_add_u32 m0, s37, 39936
    s_add_u32 s38, s34, 0
    buffer_load_dwordx4 v5, s[12:15], s38 offen lds
    s_add_u32 m0, s37, 41984
    s_add_u32 s38, s34, 0
    buffer_load_dwordx4 v4, s[12:15], s38 offen lds
    v_mfma_f32_16x16x32_bf16 v[72:75], a[104:107], a[96:99], v[72:75]
    s_add_u32 m0, s37, 44032
    s_add_u32 s38, s34, 36864
    buffer_load_dwordx4 v4, s[12:15], s38 offen lds
    s_add_u32 m0, s24, 39936
    s_nop 0
    buffer_load_dwordx4 v6, s[16:19], s25 offen lds
    v_mfma_f32_16x16x32_bf16 v[76:79], a[104:107], a[100:103], v[76:79]
    s_add_u32 m0, s24, 41984
    s_nop 0
    buffer_load_dwordx4 v7, s[16:19], s25 offen lds
    s_add_u32 m0, s24, 44032
    s_nop 0
    buffer_load_dwordx4 v8, s[16:19], s25 offen lds
    v_cndmask_b32 v156, v156, v236, s[30:31]
    v_cndmask_b32 v157, v157, v236, s[30:31]
    v_cndmask_b32 v158, v158, v236, s[30:31]
    v_cndmask_b32 v159, v159, v236, s[30:31]
    v_mfma_f32_16x16x32_bf16 v[80:83], a[108:111], a[96:99], v[80:83]
    s_add_u32 m0, s24, 46080
    s_nop 0
    buffer_load_dwordx4 v9, s[16:19], s25 offen lds
    s_add_u32 m0, s24, 48128
    s_nop 0
    buffer_load_dwordx4 v10, s[16:19], s25 offen lds
    v_cndmask_b32 v212, v212, v236, s[32:33]
    v_cndmask_b32 v213, v213, v236, s[32:33]
    v_cndmask_b32 v214, v214, v236, s[32:33]
    v_cndmask_b32 v215, v215, v236, s[32:33]
    v_mfma_f32_16x16x32_bf16 v[84:87], a[108:111], a[100:103], v[84:87]
    s_add_u32 m0, s24, 50176
    s_nop 0
    buffer_load_dwordx4 v11, s[16:19], s25 offen lds
    s_add_u32 m0, s24, 52224
    s_nop 0
    buffer_load_dwordx4 v12, s[16:19], s25 offen lds
    s_add_u32 s25, s25, 221184
    s_add_u32 s34, s34, 128
    s_cmp_ge_u32 s34, 1152
    s_cselect_b32 s34, 0, s34
    s_cselect_b32 s25, s26, s25
    v_mfma_f32_16x16x32_bf16 v[88:91], a[112:115], a[96:99], v[88:91]
    v_dot2c_f32_bf16 v164, v168, v166
    v_dot2c_f32_bf16 v164, v169, v166
    v_dot2c_f32_bf16 v164, v170, v166
    v_dot2c_f32_bf16 v164, v171, v166
    v_accvgpr_write_b32 a144, v168
    v_accvgpr_write_b32 a145, v169
    v_accvgpr_write_b32 a146, v170
    v_accvgpr_write_b32 a147, v171
    v_dot2c_f32_bf16 v165, v172, v166
    v_dot2c_f32_bf16 v165, v173, v166
    v_dot2c_f32_bf16 v165, v174, v166
    v_dot2c_f32_bf16 v165, v175, v166
    v_accvgpr_write_b32 a148, v172
    v_accvgpr_write_b32 a149, v173
    v_accvgpr_write_b32 a150, v174
    v_accvgpr_write_b32 a151, v175
    v_mfma_f32_16x16x32_bf16 v[92:95], a[112:115], a[100:103], v[92:95]
    s_mul_i32 s42, s4, 276480
    s_add_u32 s42, s42, s5
    s_add_u32 s42, s42, 92160
    s_add_u32 m0, s7, 4096
    s_nop 0
    buffer_load_dwordx4 v160, s[52:55], s42 offen nt lds
    s_mul_i32 s42, s4, 267264
    s_add_u32 s42, s42, s5
    s_add_u32 s42, s42, 101376
    s_add_u32 m0, s7, 5120
    s_nop 0
    buffer_load_dwordx4 v160, s[56:59], s42 offen nt lds
    v_mfma_f32_16x16x32_bf16 v[96:99], a[116:119], a[96:99], v[96:99]
    v_mfma_f32_16x16x32_bf16 v[100:103], a[116:119], a[100:103], v[100:103]
    v_mfma_f32_16x16x32_bf16 v[104:107], a[120:123], a[96:99], v[104:107]
    v_mfma_f32_16x16x32_bf16 v[108:111], a[120:123], a[100:103], v[108:111]
    v_mfma_f32_16x16x32_bf16 v[112:115], a[124:127], a[96:99], v[112:115]
    v_mfma_f32_16x16x32_bf16 v[116:119], a[124:127], a[100:103], v[116:119]
    v_mfma_f32_16x16x32_bf16 v[120:123], v[212:215], a[96:99], v[120:123]
    v_mfma_f32_16x16x32_bf16 v[124:127], v[212:215], a[100:103], v[124:127]
    v_mfma_f32_16x16x32_bf16 v[128:131], a[104:107], v[156:159], v[128:131]
    v_mfma_f32_16x16x32_bf16 v[132:135], a[108:111], v[156:159], v[132:135]
    v_mfma_f32_16x16x32_bf16 v[136:139], a[112:115], v[156:159], v[136:139]
    v_mfma_f32_16x16x32_bf16 v[140:143], a[116:119], v[156:159], v[140:143]
    s_waitcnt vmcnt(26)
    s_barrier
    v_mfma_f32_16x16x32_bf16 v[44:47], a[0:3], a[0:3], v[44:47]
    ds_read_b128 a[64:67], v30
    ds_read_b128 a[68:71], v36
    v_mfma_f32_16x16x32_bf16 v[72:75], a[8:11], a[0:3], v[72:75]
    ds_read_b128 v[152:155], v24
    ds_read_b64_tr_b16 a[72:73], v40 offset:0
    v_mfma_f32_16x16x32_bf16 v[76:79], a[8:11], a[4:7], v[76:79]
    ds_read_b64_tr_b16 a[74:75], v40 offset:1792
    ds_read_b64_tr_b16 a[76:77], v40 offset:32
    v_cndmask_b32 v144, v144, v236, s[30:31]
    v_cndmask_b32 v145, v145, v236, s[30:31]
    v_cndmask_b32 v146, v146, v236, s[30:31]
    v_cndmask_b32 v147, v147, v236, s[30:31]
    v_mfma_f32_16x16x32_bf16 v[80:83], a[12:15], a[0:3], v[80:83]
    ds_read_b64_tr_b16 a[78:79], v40 offset:1824
    ds_read_b64_tr_b16 a[80:81], v40 offset:64
    v_cndmask_b32 v200, v200, v236, s[32:33]
    v_cndmask_b32 v201, v201, v236, s[32:33]
    v_cndmask_b32 v202, v202, v236, s[32:33]
    v_cndmask_b32 v203, v203, v236, s[32:33]
    v_mfma_f32_16x16x32_bf16 v[84:87], a[12:15], a[4:7], v[84:87]
    ds_read_b64_tr_b16 a[82:83], v40 offset:1856
    ds_read_b64_tr_b16 a[84:85], v40 offset:96
    v_mfma_f32_16x16x32_bf16 v[88:91], a[16:19], a[0:3], v[88:91]
    ds_read_b64_tr_b16 a[86:87], v40 offset:1888
    ds_read_b64_tr_b16 a[88:89], v40 offset:128
    v_mfma_f32_16x16x32_bf16 v[92:95], a[16:19], a[4:7], v[92:95]
    ds_read_b64_tr_b16 a[90:91], v40 offset:1920
    ds_read_b64_tr_b16 a[92:93], v40 offset:160
    v_mfma_f32_16x16x32_bf16 v[96:99], a[20:23], a[0:3], v[96:99]
    ds_read_b64_tr_b16 a[94:95], v40 offset:1952
    ds_read_b64_tr_b16 v[208:209], v40 offset:192
    v_mfma_f32_16x16x32_bf16 v[100:103], a[20:23], a[4:7], v[100:103]
    ds_read_b64_tr_b16 v[210:211], v40 offset:1984
    ds_read_b128 a[96:99], v31
    v_mfma_f32_16x16x32_bf16 v[104:107], a[24:27], a[0:3], v[104:107]
    ds_read_b128 a[100:103], v37
    ds_read_b128 v[156:159], v25
    v_mfma_f32_16x16x32_bf16 v[108:111], a[24:27], a[4:7], v[108:111]
    ds_read_b64_tr_b16 a[104:105], v40 offset:14464
    ds_read_b64_tr_b16 a[106:107], v40 offset:16256
    v_mfma_f32_16x16x32_bf16 v[112:115], a[28:31], a[0:3], v[112:115]
    ds_read_b64_tr_b16 a[108:109], v40 offset:14496
    ds_read_b64_tr_b16 a[110:111], v40 offset:16288
    v_mfma_f32_16x16x32_bf16 v[116:119], a[28:31], a[4:7], v[116:119]
    ds_read_b64_tr_b16 a[112:113], v40 offset:14528
    ds_read_b64_tr_b16 a[114:115], v40 offset:16320
    v_mfma_f32_16x16x32_bf16 v[120:123], v[200:203], a[0:3], v[120:123]
    ds_read_b64_tr_b16 a[116:117], v40 offset:14560
    ds_read_b64_tr_b16 a[118:119], v40 offset:16352
    v_mfma_f32_16x16x32_bf16 v[124:127], v[200:203], a[4:7], v[124:127]
    ds_read_b64_tr_b16 a[120:121], v40 offset:14592
    ds_read_b64_tr_b16 a[122:123], v40 offset:16384
    v_mfma_f32_16x16x32_bf16 v[128:131], a[8:11], v[144:147], v[128:131]
    ds_read_b64_tr_b16 a[124:125], v40 offset:14624
    ds_read_b64_tr_b16 a[126:127], v40 offset:16416
    v_mfma_f32_16x16x32_bf16 v[132:135], a[12:15], v[144:147], v[132:135]
    ds_read_b64_tr_b16 v[212:213], v40 offset:14656
    ds_read_b64_tr_b16 v[214:215], v40 offset:16448
    v_mfma_f32_16x16x32_bf16 v[136:139], a[16:19], v[144:147], v[136:139]
    s_waitcnt vmcnt(25)
    ds_read_b64_tr_b16 v[176:177], v161 offset:0
    ds_read_b64_tr_b16 v[178:179], v161 offset:512
    s_waitcnt vmcnt(24)
    ds_read_b64_tr_b16 v[180:181], v161 offset:1024
    ds_read_b64_tr_b16 v[182:183], v161 offset:1536
    v_mfma_f32_16x16x32_bf16 v[140:143], a[20:23], v[144:147], v[140:143]
    s_waitcnt lgkmcnt(0)
    s_barrier
    v_mfma_f32_16x16x32_bf16 v[44:47], a[32:35], a[32:35], v[44:47]
    s_add_u32 m0, s37, 79872
    s_add_u32 s38, s34, 0
    buffer_load_dwordx4 v5, s[12:15], s38 offen lds
    s_add_u32 m0, s37, 81920
    s_add_u32 s38, s34, 0
    buffer_load_dwordx4 v4, s[12:15], s38 offen lds
    v_mfma_f32_16x16x32_bf16 v[72:75], a[40:43], a[32:35], v[72:75]
    s_add_u32 m0, s37, 83968
    s_add_u32 s38, s34, 36864
    buffer_load_dwordx4 v4, s[12:15], s38 offen lds
    s_add_u32 m0, s24, 79872
    s_nop 0
    buffer_load_dwordx4 v6, s[16:19], s25 offen lds
    v_mfma_f32_16x16x32_bf16 v[76:79], a[40:43], a[36:39], v[76:79]
    s_add_u32 m0, s24, 81920
    s_nop 0
    buffer_load_dwordx4 v7, s[16:19], s25 offen lds
    s_add_u32 m0, s24, 83968
    s_nop 0
    buffer_load_dwordx4 v8, s[16:19], s25 offen lds
    v_cndmask_b32 v148, v148, v236, s[30:31]
    v_cndmask_b32 v149, v149, v236, s[30:31]
    v_cndmask_b32 v150, v150, v236, s[30:31]
    v_cndmask_b32 v151, v151, v236, s[30:31]
    v_mfma_f32_16x16x32_bf16 v[80:83], a[44:47], a[32:35], v[80:83]
    s_add_u32 m0, s24, 86016
    s_nop 0
    buffer_load_dwordx4 v9, s[16:19], s25 offen lds
    s_add_u32 m0, s24, 88064
    s_nop 0
    buffer_load_dwordx4 v10, s[16:19], s25 offen lds
    v_cndmask_b32 v204, v204, v236, s[32:33]
    v_cndmask_b32 v205, v205, v236, s[32:33]
    v_cndmask_b32 v206, v206, v236, s[32:33]
    v_cndmask_b32 v207, v207, v236, s[32:33]
    v_mfma_f32_16x16x32_bf16 v[84:87], a[44:47], a[36:39], v[84:87]
    s_add_u32 m0, s24, 90112
    s_nop 0
    buffer_load_dwordx4 v11, s[16:19], s25 offen lds
    s_add_u32 m0, s24, 92160
    s_nop 0
    buffer_load_dwordx4 v12, s[16:19], s25 offen lds
    s_add_u32 s25, s25, 221184
    s_add_u32 s34, s34, 128
    s_cmp_ge_u32 s34, 1152
    s_cselect_b32 s34, 0, s34
    s_cselect_b32 s25, s26, s25
    v_mfma_f32_16x16x32_bf16 v[88:91], a[48:51], a[32:35], v[88:91]
    v_dot2c_f32_bf16 v164, v176, v166
    v_dot2c_f32_bf16 v164, v177, v166
    v_dot2c_f32_bf16 v164, v178, v166
    v_dot2c_f32_bf16 v164, v179, v166
    v_accvgpr_write_b32 a152, v176
    v_accvgpr_write_b32 a153, v177
    v_accvgpr_write_b32 a154, v178
    v_accvgpr_write_b32 a155, v179
    v_dot2c_f32_bf16 v165, v180, v166
    v_dot2c_f32_bf16 v165, v181, v166
    v_dot2c_f32_bf16 v165, v182, v166
    v_dot2c_f32_bf16 v165, v183, v166
    v_accvgpr_write_b32 a156, v180
    v_accvgpr_write_b32 a157, v181
    v_accvgpr_write_b32 a158, v182
    v_accvgpr_write_b32 a159, v183
    v_mfma_f32_16x16x32_bf16 v[92:95], a[48:51], a[36:39], v[92:95]
    s_mul_i32 s42, s4, 331776
    s_add_u32 s42, s42, s5
    s_add_u32 s42, s42, 110592
    s_add_u32 m0, s7, 0
    s_nop 0
    buffer_load_dwordx4 v160, s[52:55], s42 offen nt lds
    s_mul_i32 s42, s4, 322560
    s_add_u32 s42, s42, s5
    s_add_u32 s42, s42, 119808
    s_add_u32 m0, s7, 1024
    s_nop 0
    buffer_load_dwordx4 v160, s[56:59], s42 offen nt lds
    v_mfma_f32_16x16x32_bf16 v[96:99], a[52:55], a[32:35], v[96:99]
    v_mfma_f32_16x16x32_bf16 v[100:103], a[52:55], a[36:39], v[100:103]
    v_mfma_f32_16x16x32_bf16 v[104:107], a[56:59], a[32:35], v[104:107]
    v_mfma_f32_16x16x32_bf16 v[108:111], a[56:59], a[36:39], v[108:111]
    v_mfma_f32_16x16x32_bf16 v[112:115], a[60:63], a[32:35], v[112:115]
    v_mfma_f32_16x16x32_bf16 v[116:119], a[60:63], a[36:39], v[116:119]
    v_mfma_f32_16x16x32_bf16 v[120:123], v[204:207], a[32:35], v[120:123]
    v_mfma_f32_16x16x32_bf16 v[124:127], v[204:207], a[36:39], v[124:127]
    v_mfma_f32_16x16x32_bf16 v[128:131], a[40:43], v[148:151], v[128:131]
    v_mfma_f32_16x16x32_bf16 v[132:135], a[44:47], v[148:151], v[132:135]
    v_mfma_f32_16x16x32_bf16 v[136:139], a[48:51], v[148:151], v[136:139]
    v_mfma_f32_16x16x32_bf16 v[140:143], a[52:55], v[148:151], v[140:143]
    s_waitcnt vmcnt(26)
    s_barrier
    v_mfma_f32_16x16x32_bf16 v[44:47], a[64:67], a[64:67], v[44:47]
    ds_read_b128 a[0:3], v26
    ds_read_b128 a[4:7], v32
    v_mfma_f32_16x16x32_bf16 v[72:75], a[72:75], a[64:67], v[72:75]
    ds_read_b128 v[144:147], v20
    ds_read_b64_tr_b16 a[8:9], v38 offset:0
    v_mfma_f32_16x16x32_bf16 v[76:79], a[72:75], a[68:71], v[76:79]
    ds_read_b64_tr_b16 a[10:11], v38 offset:1792
    ds_read_b64_tr_b16 a[12:13], v38 offset:32
    v_cndmask_b32 v152, v152, v236, s[30:31]
    v_cndmask_b32 v153, v153, v236, s[30:31]
    v_cndmask_b32 v154, v154, v236, s[30:31]
    v_cndmask_b32 v155, v155, v236, s[30:31]
    v_mfma_f32_16x16x32_bf16 v[80:83], a[76:79], a[64:67], v[80:83]
    ds_read_b64_tr_b16 a[14:15], v38 offset:1824
    ds_read_b64_tr_b16 a[16:17], v38 offset:64
    v_cndmask_b32 v208, v208, v236, s[32:33]
    v_cndmask_b32 v209, v209, v236, s[32:33]
    v_cndmask_b32 v210, v210, v236, s[32:33]
    v_cndmask_b32 v211, v211, v236, s[32:33]
    v_mfma_f32_16x16x32_bf16 v[84:87], a[76:79], a[68:71], v[84:87]
    ds_read_b64_tr_b16 a[18:19], v38 offset:1856
    ds_read_b64_tr_b16 a[20:21], v38 offset:96
    v_mfma_f32_16x16x32_bf16 v[88:91], a[80:83], a[64:67], v[88:91]
    ds_read_b64_tr_b16 a[22:23], v38 offset:1888
    ds_read_b64_tr_b16 a[24:25], v38 offset:128
    v_mfma_f32_16x16x32_bf16 v[92:95], a[80:83], a[68:71], v[92:95]
    ds_read_b64_tr_b16 a[26:27], v38 offset:1920
    ds_read_b64_tr_b16 a[28:29], v38 offset:160
    v_mfma_f32_16x16x32_bf16 v[96:99], a[84:87], a[64:67], v[96:99]
    ds_read_b64_tr_b16 a[30:31], v38 offset:1952
    ds_read_b64_tr_b16 v[200:201], v38 offset:192
    v_mfma_f32_16x16x32_bf16 v[100:103], a[84:87], a[68:71], v[100:103]
    ds_read_b64_tr_b16 v[202:203], v38 offset:1984
    ds_read_b128 a[32:35], v27
    v_mfma_f32_16x16x32_bf16 v[104:107], a[88:91], a[64:67], v[104:107]
    ds_read_b128 a[36:39], v33
    ds_read_b128 v[148:151], v21
    v_mfma_f32_16x16x32_bf16 v[108:111], a[88:91], a[68:71], v[108:111]
    ds_read_b64_tr_b16 a[40:41], v38 offset:14464
    ds_read_b64_tr_b16 a[42:43], v38 offset:16256
    v_mfma_f32_16x16x32_bf16 v[112:115], a[92:95], a[64:67], v[112:115]
    ds_read_b64_tr_b16 a[44:45], v38 offset:14496
    ds_read_b64_tr_b16 a[46:47], v38 offset:16288
    v_mfma_f32_16x16x32_bf16 v[116:119], a[92:95], a[68:71], v[116:119]
    ds_read_b64_tr_b16 a[48:49], v38 offset:14528
    ds_read_b64_tr_b16 a[50:51], v38 offset:16320
    v_mfma_f32_16x16x32_bf16 v[120:123], v[208:211], a[64:67], v[120:123]
    ds_read_b64_tr_b16 a[52:53], v38 offset:14560
    ds_read_b64_tr_b16 a[54:55], v38 offset:16352
    v_mfma_f32_16x16x32_bf16 v[124:127], v[208:211], a[68:71], v[124:127]
    ds_read_b64_tr_b16 a[56:57], v38 offset:14592
    ds_read_b64_tr_b16 a[58:59], v38 offset:16384
    v_mfma_f32_16x16x32_bf16 v[128:131], a[72:75], v[152:155], v[128:131]
    ds_read_b64_tr_b16 a[60:61], v38 offset:14624
    ds_read_b64_tr_b16 a[62:63], v38 offset:16416
    v_mfma_f32_16x16x32_bf16 v[132:135], a[76:79], v[152:155], v[132:135]
    ds_read_b64_tr_b16 v[204:205], v38 offset:14656
    ds_read_b64_tr_b16 v[206:207], v38 offset:16448
    v_mfma_f32_16x16x32_bf16 v[136:139], a[80:83], v[152:155], v[136:139]
    s_waitcnt vmcnt(25)
    ds_read_b64_tr_b16 v[168:169], v161 offset:2048
    ds_read_b64_tr_b16 v[170:171], v161 offset:2560
    s_waitcnt vmcnt(24)
    ds_read_b64_tr_b16 v[172:173], v161 offset:3072
    ds_read_b64_tr_b16 v[174:175], v161 offset:3584
    v_mfma_f32_16x16x32_bf16 v[140:143], a[84:87], v[152:155], v[140:143]
    s_waitcnt lgkmcnt(0)
    s_barrier
    v_mfma_f32_16x16x32_bf16 v[44:47], a[96:99], a[96:99], v[44:47]
    v_add_u32 v250, 0, v0
    s_lshl_b32 s29, s3, 10
    s_add_u32 m0, s29, 0
    v_mul_u32_u24 v251, 7282, v250
    v_lshrrev_b32 v251, 16, v251
    v_mul_u32_u24 v251, 1008, v251
    v_lshl_add_u32 v251, v250, 4, v251
    buffer_load_dwordx4 v251, s[44:47], s26 offen lds
    v_add_u32 v250, 256, v0
    s_lshl_b32 s29, s3, 10
    s_add_u32 m0, s29, 4096
    v_mul_u32_u24 v251, 7282, v250
    v_lshrrev_b32 v251, 16, v251
    v_mul_u32_u24 v251, 1008, v251
    v_lshl_add_u32 v251, v250, 4, v251
    buffer_load_dwordx4 v251, s[44:47], s26 offen lds
    v_mfma_f32_16x16x32_bf16 v[72:75], a[104:107], a[96:99], v[72:75]
    v_add_u32 v250, 512, v0
    s_lshl_b32 s29, s3, 10
    s_add_u32 m0, s29, 8192
    v_mul_u32_u24 v251, 7282, v250
    v_lshrrev_b32 v251, 16, v251
    v_mul_u32_u24 v251, 1008, v251
    v_lshl_add_u32 v251, v250, 4, v251
    buffer_load_dwordx4 v251, s[44:47], s26 offen lds
    v_add_u32 v250, 768, v0
    s_lshl_b32 s29, s3, 10
    s_add_u32 m0, s29, 12288
    v_mul_u32_u24 v251, 7282, v250
    v_lshrrev_b32 v251, 16, v251
    v_mul_u32_u24 v251, 1008, v251
    v_lshl_add_u32 v251, v250, 4, v251
    buffer_load_dwordx4 v251, s[44:47], s26 offen lds
    v_mfma_f32_16x16x32_bf16 v[76:79], a[104:107], a[100:103], v[76:79]
    v_add_u32 v250, 1024, v0
    s_lshl_b32 s29, s3, 10
    s_add_u32 m0, s29, 16384
    v_mul_u32_u24 v251, 7282, v250
    v_lshrrev_b32 v251, 16, v251
    v_mul_u32_u24 v251, 1008, v251
    v_lshl_add_u32 v251, v250, 4, v251
    buffer_load_dwordx4 v251, s[44:47], s26 offen lds
    v_add_u32 v250, 1280, v0
    s_lshl_b32 s29, s3, 10
    s_add_u32 m0, s29, 20480
    v_mul_u32_u24 v251, 7282, v250
    v_lshrrev_b32 v251, 16, v251
    v_mul_u32_u24 v251, 1008, v251
    v_lshl_add_u32 v251, v250, 4, v251
    buffer_load_dwordx4 v251, s[44:47], s26 offen lds
    v_cndmask_b32 v156, v156, v236, s[30:31]
    v_cndmask_b32 v157, v157, v236, s[30:31]
    v_cndmask_b32 v158, v158, v236, s[30:31]
    v_cndmask_b32 v159, v159, v236, s[30:31]
    v_mfma_f32_16x16x32_bf16 v[80:83], a[108:111], a[96:99], v[80:83]
    v_add_u32 v250, 1536, v0
    s_lshl_b32 s29, s3, 10
    s_add_u32 m0, s29, 24576
    v_mul_u32_u24 v251, 7282, v250
    v_lshrrev_b32 v251, 16, v251
    v_mul_u32_u24 v251, 1008, v251
    v_lshl_add_u32 v251, v250, 4, v251
    buffer_load_dwordx4 v251, s[44:47], s26 offen lds
    v_add_u32 v250, 1792, v0
    s_lshl_b32 s29, s3, 10
    s_add_u32 m0, s29, 28672
    v_mul_u32_u24 v251, 7282, v250
    v_lshrrev_b32 v251, 16, v251
    v_mul_u32_u24 v251, 1008, v251
    v_lshl_add_u32 v251, v250, 4, v251
    buffer_load_dwordx4 v251, s[44:47], s26 offen lds
    v_cndmask_b32 v212, v212, v236, s[32:33]
    v_cndmask_b32 v213, v213, v236, s[32:33]
    v_cndmask_b32 v214, v214, v236, s[32:33]
    v_cndmask_b32 v215, v215, v236, s[32:33]
    v_mfma_f32_16x16x32_bf16 v[84:87], a[108:111], a[100:103], v[84:87]
    v_add_u32 v250, 2048, v0
    s_lshl_b32 s29, s3, 10
    s_add_u32 m0, s29, 32768
    v_mul_u32_u24 v251, 7282, v250
    v_lshrrev_b32 v251, 16, v251
    v_mul_u32_u24 v251, 1008, v251
    v_lshl_add_u32 v251, v250, 4, v251
    buffer_load_dwordx4 v251, s[44:47], s26 offen lds
    s_add_u32 s29, s3, 36
    s_min_u32 s29, s29, 38
    s_add_u32 s29, s29, 0
    s_lshl_b32 m0, s29, 10
    s_lshl_b32 s29, s29, 6
    v_add_u32 v250, s29, v2
    v_mul_u32_u24 v251, 7282, v250
    v_lshrrev_b32 v251, 16, v251
    v_mul_u32_u24 v251, 1008, v251
    v_lshl_add_u32 v251, v250, 4, v251
    buffer_load_dwordx4 v251, s[44:47], s26 offen lds
    v_mfma_f32_16x16x32_bf16 v[88:91], a[112:115], a[96:99], v[88:91]
    v_dot2c_f32_bf16 v164, v168, v166
    v_dot2c_f32_bf16 v164, v169, v166
    v_dot2c_f32_bf16 v164, v170, v166
    v_dot2c_f32_bf16 v164, v171, v166
    v_accvgpr_write_b32 a160, v168
    v_accvgpr_write_b32 a161, v169
    v_accvgpr_write_b32 a162, v170
    v_accvgpr_write_b32 a163, v171
    v_dot2c_f32_bf16 v165, v172, v166
    v_dot2c_f32_bf16 v165, v173, v166
    v_dot2c_f32_bf16 v165, v174, v166
    v_dot2c_f32_bf16 v165, v175, v166
    v_accvgpr_write_b32 a164, v172
    v_accvgpr_write_b32 a165, v173
    v_accvgpr_write_b32 a166, v174
    v_accvgpr_write_b32 a167, v175
    v_mfma_f32_16x16x32_bf16 v[92:95], a[112:115], a[100:103], v[92:95]
    s_mul_i32 s42, s4, 387072
    s_add_u32 s42, s42, s5
    s_add_u32 s42, s42, 129024
    s_add_u32 m0, s7, 2048
    s_nop 0
    buffer_load_dwordx4 v160, s[52:55], s42 offen nt lds
    s_mul_i32 s42, s4, 377856
    s_add_u32 s42, s42, s5
    s_add_u32 s42, s42, 138240
    s_add_u32 m0, s7, 3072
    s_nop 0
    buffer_load_dwordx4 v160, s[56:59], s42 offen nt lds
    v_mfma_f32_16x16x32_bf16 v[96:99], a[116:119], a[96:99], v[96:99]
    v_mfma_f32_16x16x32_bf16 v[100:103], a[116:119], a[100:103], v[100:103]
    v_mfma_f32_16x16x32_bf16 v[104:107], a[120:123], a[96:99], v[104:107]
    v_mfma_f32_16x16x32_bf16 v[108:111], a[120:123], a[100:103], v[108:111]
    v_mfma_f32_16x16x32_bf16 v[112:115], a[124:127], a[96:99], v[112:115]
    v_mfma_f32_16x16x32_bf16 v[116:119], a[124:127], a[100:103], v[116:119]
    v_mfma_f32_16x16x32_bf16 v[120:123], v[212:215], a[96:99], v[120:123]
    v_mfma_f32_16x16x32_bf16 v[124:127], v[212:215], a[100:103], v[124:127]
    v_mfma_f32_16x16x32_bf16 v[128:131], a[104:107], v[156:159], v[128:131]
    v_mfma_f32_16x16x32_bf16 v[132:135], a[108:111], v[156:159], v[132:135]
    v_mfma_f32_16x16x32_bf16 v[136:139], a[112:115], v[156:159], v[136:139]
    v_mfma_f32_16x16x32_bf16 v[140:143], a[116:119], v[156:159], v[140:143]
    s_waitcnt vmcnt(26)
    s_barrier
    v_mfma_f32_16x16x32_bf16 v[44:47], a[0:3], a[0:3], v[44:47]
    ds_read_b128 a[64:67], v28
    ds_read_b128 a[68:71], v34
    v_mfma_f32_16x16x32_bf16 v[72:75], a[8:11], a[0:3], v[72:75]
    ds_read_b128 v[152:155], v22
    ds_read_b64_tr_b16 a[72:73], v39 offset:0
    v_mfma_f32_16x16x32_bf16 v[76:79], a[8:11], a[4:7], v[76:79]
    ds_read_b64_tr_b16 a[74:75], v39 offset:1792
    ds_read_b64_tr_b16 a[76:77], v39 offset:32
    v_cndmask_b32 v144, v144, v236, s[30:31]
    v_cndmask_b32 v145, v145, v236, s[30:31]
    v_cndmask_b32 v146, v146, v236, s[30:31]
    v_cndmask_b32 v147, v147, v236, s[30:31]
    v_mfma_f32_16x16x32_bf16 v[80:83], a[12:15], a[0:3], v[80:83]
    ds_read_b64_tr_b16 a[78:79], v39 offset:1824
    ds_read_b64_tr_b16 a[80:81], v39 offset:64
    v_cndmask_b32 v200, v200, v236, s[32:33]
    v_cndmask_b32 v201, v201, v236, s[32:33]
    v_cndmask_b32 v202, v202, v236, s[32:33]
    v_cndmask_b32 v203, v203, v236, s[32:33]
    v_mfma_f32_16x16x32_bf16 v[84:87], a[12:15], a[4:7], v[84:87]
    ds_read_b64_tr_b16 a[82:83], v39 offset:1856
    ds_read_b64_tr_b16 a[84:85], v39 offset:96
    v_mfma_f32_16x16x32_bf16 v[88:91], a[16:19], a[0:3], v[88:91]
    ds_read_b64_tr_b16 a[86:87], v39 offset:1888
    ds_read_b64_tr_b16 a[88:89], v39 offset:128
    v_mfma_f32_16x16x32_bf16 v[92:95], a[16:19], a[4:7], v[92:95]
    ds_read_b64_tr_b16 a[90:91], v39 offset:1920
    ds_read_b64_tr_b16 a[92:93], v39 offset:160
    v_mfma_f32_16x16x32_bf16 v[96:99], a[20:23], a[0:3], v[96:99]
    ds_read_b64_tr_b16 a[94:95], v39 offset:1952
    ds_read_b64_tr_b16 v[208:209], v39 offset:192
    v_mfma_f32_16x16x32_bf16 v[100:103], a[20:23], a[4:7], v[100:103]
    ds_read_b64_tr_b16 v[210:211], v39 offset:1984
    ds_read_b128 a[96:99], v29
    v_mfma_f32_16x16x32_bf16 v[104:107], a[24:27], a[0:3], v[104:107]
    ds_read_b128 a[100:103], v35
    ds_read_b128 v[156:159], v23
    v_mfma_f32_16x16x32_bf16 v[108:111], a[24:27], a[4:7], v[108:111]
    ds_read_b64_tr_b16 a[104:105], v39 offset:14464
    ds_read_b64_tr_b16 a[106:107], v39 offset:16256
    v_mfma_f32_16x16x32_bf16 v[112:115], a[28:31], a[0:3], v[112:115]
    ds_read_b64_tr_b16 a[108:109], v39 offset:14496
    ds_read_b64_tr_b16 a[110:111], v39 offset:16288
    v_mfma_f32_16x16x32_bf16 v[116:119], a[28:31], a[4:7], v[116:119]
    ds_read_b64_tr_b16 a[112:113], v39 offset:14528
    ds_read_b64_tr_b16 a[114:115], v39 offset:16320
    v_mfma_f32_16x16x32_bf16 v[120:123], v[200:203], a[0:3], v[120:123]
    ds_read_b64_tr_b16 a[116:117], v39 offset:14560
    ds_read_b64_tr_b16 a[118:119], v39 offset:16352
    v_mfma_f32_16x16x32_bf16 v[124:127], v[200:203], a[4:7], v[124:127]
    ds_read_b64_tr_b16 a[120:121], v39 offset:14592
    ds_read_b64_tr_b16 a[122:123], v39 offset:16384
    v_mfma_f32_16x16x32_bf16 v[128:131], a[8:11], v[144:147], v[128:131]
    ds_read_b64_tr_b16 a[124:125], v39 offset:14624
    ds_read_b64_tr_b16 a[126:127], v39 offset:16416
    v_mfma_f32_16x16x32_bf16 v[132:135], a[12:15], v[144:147], v[132:135]
    ds_read_b64_tr_b16 v[212:213], v39 offset:14656
    ds_read_b64_tr_b16 v[214:215], v39 offset:16448
    v_mfma_f32_16x16x32_bf16 v[136:139], a[16:19], v[144:147], v[136:139]
    s_waitcnt vmcnt(25)
    ds_read_b64_tr_b16 v[176:177], v161 offset:4096
    ds_read_b64_tr_b16 v[178:179], v161 offset:4608
    s_waitcnt vmcnt(24)
    ds_read_b64_tr_b16 v[180:181], v161 offset:5120
    ds_read_b64_tr_b16 v[182:183], v161 offset:5632
    v_mfma_f32_16x16x32_bf16 v[140:143], a[20:23], v[144:147], v[140:143]
    s_waitcnt lgkmcnt(0)
    s_barrier
    v_mfma_f32_16x16x32_bf16 v[44:47], a[32:35], a[32:35], v[44:47]
    v_add_u32 v250, 2496, v0
    s_lshl_b32 s29, s3, 10
    s_add_u32 m0, s29, 39936
    v_mul_u32_u24 v251, 7282, v250
    v_lshrrev_b32 v251, 16, v251
    v_mul_u32_u24 v251, 1008, v251
    v_lshl_add_u32 v251, v250, 4, v251
    buffer_load_dwordx4 v251, s[44:47], s26 offen lds
    v_add_u32 v250, 2752, v0
    s_lshl_b32 s29, s3, 10
    s_add_u32 m0, s29, 44032
    v_mul_u32_u24 v251, 7282, v250
    v_lshrrev_b32 v251, 16, v251
    v_mul_u32_u24 v251, 1008, v251
    v_lshl_add_u32 v251, v250, 4, v251
    buffer_load_dwordx4 v251, s[44:47], s26 offen lds
    v_mfma_f32_16x16x32_bf16 v[72:75], a[40:43], a[32:35], v[72:75]
    v_add_u32 v250, 3008, v0
    s_lshl_b32 s29, s3, 10
    s_add_u32 m0, s29, 48128
    v_mul_u32_u24 v251, 7282, v250
    v_lshrrev_b32 v251, 16, v251
    v_mul_u32_u24 v251, 1008, v251
    v_lshl_add_u32 v251, v250, 4, v251
    buffer_load_dwordx4 v251, s[44:47], s26 offen lds
    v_add_u32 v250, 3264, v0
    s_lshl_b32 s29, s3, 10
    s_add_u32 m0, s29, 52224
    v_mul_u32_u24 v251, 7282, v250
    v_lshrrev_b32 v251, 16, v251
    v_mul_u32_u24 v251, 1008, v251
    v_lshl_add_u32 v251, v250, 4, v251
    buffer_load_dwordx4 v251, s[44:47], s26 offen lds
    v_mfma_f32_16x16x32_bf16 v[76:79], a[40:43], a[36:39], v[76:79]
    v_add_u32 v250, 3520, v0
    s_lshl_b32 s29, s3, 10
    s_add_u32 m0, s29, 56320
    v_mul_u32_u24 v251, 7282, v250
    v_lshrrev_b32 v251, 16, v251
    v_mul_u32_u24 v251, 1008, v251
    v_lshl_add_u32 v251, v250, 4, v251
    buffer_load_dwordx4 v251, s[44:47], s26 offen lds
    v_add_u32 v250, 3776, v0
    s_lshl_b32 s29, s3, 10
    s_add_u32 m0, s29, 60416
    v_mul_u32_u24 v251, 7282, v250
    v_lshrrev_b32 v251, 16, v251
    v_mul_u32_u24 v251, 1008, v251
    v_lshl_add_u32 v251, v250, 4, v251
    buffer_load_dwordx4 v251, s[44:47], s26 offen lds
    v_cndmask_b32 v148, v148, v236, s[30:31]
    v_cndmask_b32 v149, v149, v236, s[30:31]
    v_cndmask_b32 v150, v150, v236, s[30:31]
    v_cndmask_b32 v151, v151, v236, s[30:31]
    v_mfma_f32_16x16x32_bf16 v[80:83], a[44:47], a[32:35], v[80:83]
    v_add_u32 v250, 4032, v0
    s_lshl_b32 s29, s3, 10
    s_add_u32 m0, s29, 64512
    v_mul_u32_u24 v251, 7282, v250
    v_lshrrev_b32 v251, 16, v251
    v_mul_u32_u24 v251, 1008, v251
    v_lshl_add_u32 v251, v250, 4, v251
    buffer_load_dwordx4 v251, s[44:47], s26 offen lds
    v_add_u32 v250, 4288, v0
    s_lshl_b32 s29, s3, 10
    s_add_u32 m0, s29, 68608
    v_mul_u32_u24 v251, 7282, v250
    v_lshrrev_b32 v251, 16, v251
    v_mul_u32_u24 v251, 1008, v251
    v_lshl_add_u32 v251, v250, 4, v251
    buffer_load_dwordx4 v251, s[44:47], s26 offen lds
    v_cndmask_b32 v204, v204, v236, s[32:33]
    v_cndmask_b32 v205, v205, v236, s[32:33]
    v_cndmask_b32 v206, v206, v236, s[32:33]
    v_cndmask_b32 v207, v207, v236, s[32:33]
    v_mfma_f32_16x16x32_bf16 v[84:87], a[44:47], a[36:39], v[84:87]
    v_add_u32 v250, 4544, v0
    s_lshl_b32 s29, s3, 10
    s_add_u32 m0, s29, 72704
    v_mul_u32_u24 v251, 7282, v250
    v_lshrrev_b32 v251, 16, v251
    v_mul_u32_u24 v251, 1008, v251
    v_lshl_add_u32 v251, v250, 4, v251
    buffer_load_dwordx4 v251, s[44:47], s26 offen lds
    s_add_u32 s29, s3, 36
    s_min_u32 s29, s29, 38
    s_add_u32 s29, s29, 39
    s_lshl_b32 m0, s29, 10
    s_lshl_b32 s29, s29, 6
    v_add_u32 v250, s29, v2
    v_mul_u32_u24 v251, 7282, v250
    v_lshrrev_b32 v251, 16, v251
    v_mul_u32_u24 v251, 1008, v251
    v_lshl_add_u32 v251, v250, 4, v251
    buffer_load_dwordx4 v251, s[44:47], s26 offen lds
    v_mfma_f32_16x16x32_bf16 v[88:91], a[48:51], a[32:35], v[88:91]
    v_dot2c_f32_bf16 v164, v176, v166
    v_dot2c_f32_bf16 v164, v177, v166
    v_dot2c_f32_bf16 v164, v178, v166
    v_dot2c_f32_bf16 v164, v179, v166
    v_accvgpr_write_b32 a168, v176
    v_accvgpr_write_b32 a169, v177
    v_accvgpr_write_b32 a170, v178
    v_accvgpr_write_b32 a171, v179
    v_dot2c_f32_bf16 v165, v180, v166
    v_dot2c_f32_bf16 v165, v181, v166
    v_dot2c_f32_bf16 v165, v182, v166
    v_dot2c_f32_bf16 v165, v183, v166
    v_accvgpr_write_b32 a172, v180
    v_accvgpr_write_b32 a173, v181
    v_accvgpr_write_b32 a174, v182
    v_accvgpr_write_b32 a175, v183
    v_mfma_f32_16x16x32_bf16 v[92:95], a[48:51], a[36:39], v[92:95]
    v_mfma_f32_16x16x32_bf16 v[96:99], a[52:55], a[32:35], v[96:99]
    v_mfma_f32_16x16x32_bf16 v[100:103], a[52:55], a[36:39], v[100:103]
    v_mfma_f32_16x16x32_bf16 v[104:107], a[56:59], a[32:35], v[104:107]
    v_mfma_f32_16x16x32_bf16 v[108:111], a[56:59], a[36:39], v[108:111]
    v_mfma_f32_16x16x32_bf16 v[112:115], a[60:63], a[32:35], v[112:115]
    v_mfma_f32_16x16x32_bf16 v[116:119], a[60:63], a[36:39], v[116:119]
    v_mfma_f32_16x16x32_bf16 v[120:123], v[204:207], a[32:35], v[120:123]
    v_mfma_f32_16x16x32_bf16 v[124:127], v[204:207], a[36:39], v[124:127]
    v_mfma_f32_16x16x32_bf16 v[128:131], a[40:43], v[148:151], v[128:131]
    v_mfma_f32_16x16x32_bf16 v[132:135], a[44:47], v[148:151], v[132:135]
    v_mfma_f32_16x16x32_bf16 v[136:139], a[48:51], v[148:151], v[136:139]
    v_mfma_f32_16x16x32_bf16 v[140:143], a[52:55], v[148:151], v[140:143]
    s_waitcnt vmcnt(24)
    s_barrier
    v_mfma_f32_16x16x32_bf16 v[44:47], a[64:67], a[64:67], v[44:47]
    ds_read_b128 a[0:3], v30
    ds_read_b128 a[4:7], v36
    v_mfma_f32_16x16x32_bf16 v[72:75], a[72:75], a[64:67], v[72:75]
    ds_read_b128 v[144:147], v24
    ds_read_b64_tr_b16 a[8:9], v40 offset:0
    v_mfma_f32_16x16x32_bf16 v[76:79], a[72:75], a[68:71], v[76:79]
    ds_read_b64_tr_b16 a[10:11], v40 offset:1792
    ds_read_b64_tr_b16 a[12:13], v40 offset:32
    v_cndmask_b32 v152, v152, v236, s[30:31]
    v_cndmask_b32 v153, v153, v236, s[30:31]
    v_cndmask_b32 v154, v154, v236, s[30:31]
    v_cndmask_b32 v155, v155, v236, s[30:31]
    v_mfma_f32_16x16x32_bf16 v[80:83], a[76:79], a[64:67], v[80:83]
    ds_read_b64_tr_b16 a[14:15], v40 offset:1824
    ds_read_b64_tr_b16 a[16:17], v40 offset:64
    v_cndmask_b32 v208, v208, v236, s[32:33]
    v_cndmask_b32 v209, v209, v236, s[32:33]
    v_cndmask_b32 v210, v210, v236, s[32:33]
    v_cndmask_b32 v211, v211, v236, s[32:33]
    v_mfma_f32_16x16x32_bf16 v[84:87], a[76:79], a[68:71], v[84:87]
    ds_read_b64_tr_b16 a[18:19], v40 offset:1856
    ds_read_b64_tr_b16 a[20:21], v40 offset:96
    v_mfma_f32_16x16x32_bf16 v[88:91], a[80:83], a[64:67], v[88:91]
    ds_read_b64_tr_b16 a[22:23], v40 offset:1888
    ds_read_b64_tr_b16 a[24:25], v40 offset:128
    v_mfma_f32_16x16x32_bf16 v[92:95], a[80:83], a[68:71], v[92:95]
    ds_read_b64_tr_b16 a[26:27], v40 offset:1920
    ds_read_b64_tr_b16 a[28:29], v40 offset:160
    v_mfma_f32_16x16x32_bf16 v[96:99], a[84:87], a[64:67], v[96:99]
    ds_read_b64_tr_b16 a[30:31], v40 offset:1952
    ds_read_b64_tr_b16 v[200:201], v40 offset:192
    v_mfma_f32_16x16x32_bf16 v[100:103], a[84:87], a[68:71], v[100:103]
    ds_read_b64_tr_b16 v[202:203], v40 offset:1984
    ds_read_b128 a[32:35], v31
    v_mfma_f32_16x16x32_bf16 v[104:107], a[88:91], a[64:67], v[104:107]
    ds_read_b128 a[36:39], v37
    ds_read_b128 v[148:151], v25
    v_mfma_f32_16x16x32_bf16 v[108:111], a[88:91], a[68:71], v[108:111]
    ds_read_b64_tr_b16 a[40:41], v40 offset:14464
    ds_read_b64_tr_b16 a[42:43], v40 offset:16256
    v_mfma_f32_16x16x32_bf16 v[112:115], a[92:95], a[64:67], v[112:115]
    ds_read_b64_tr_b16 a[44:45], v40 offset:14496
    ds_read_b64_tr_b16 a[46:47], v40 offset:16288
    v_mfma_f32_16x16x32_bf16 v[116:119], a[92:95], a[68:71], v[116:119]
    ds_read_b64_tr_b16 a[48:49], v40 offset:14528
    ds_read_b64_tr_b16 a[50:51], v40 offset:16320
    v_mfma_f32_16x16x32_bf16 v[120:123], v[208:211], a[64:67], v[120:123]
    ds_read_b64_tr_b16 a[52:53], v40 offset:14560
    ds_read_b64_tr_b16 a[54:55], v40 offset:16352
    v_mfma_f32_16x16x32_bf16 v[124:127], v[208:211], a[68:71], v[124:127]
    ds_read_b64_tr_b16 a[56:57], v40 offset:14592
    ds_read_b64_tr_b16 a[58:59], v40 offset:16384
    v_mfma_f32_16x16x32_bf16 v[128:131], a[72:75], v[152:155], v[128:131]
    ds_read_b64_tr_b16 a[60:61], v40 offset:14624
    ds_read_b64_tr_b16 a[62:63], v40 offset:16416
    v_mfma_f32_16x16x32_bf16 v[132:135], a[76:79], v[152:155], v[132:135]
    ds_read_b64_tr_b16 v[204:205], v40 offset:14656
    ds_read_b64_tr_b16 v[206:207], v40 offset:16448
    v_mfma_f32_16x16x32_bf16 v[136:139], a[80:83], v[152:155], v[136:139]
    s_waitcnt vmcnt(23)
    ds_read_b64_tr_b16 v[168:169], v161 offset:0
    ds_read_b64_tr_b16 v[170:171], v161 offset:512
    s_waitcnt vmcnt(22)
    ds_read_b64_tr_b16 v[172:173], v161 offset:1024
    ds_read_b64_tr_b16 v[174:175], v161 offset:1536
    v_mfma_f32_16x16x32_bf16 v[140:143], a[84:87], v[152:155], v[140:143]
    s_waitcnt lgkmcnt(0)
    s_barrier
    v_mfma_f32_16x16x32_bf16 v[44:47], a[96:99], a[96:99], v[44:47]
    v_dot2c_f32_bf16 v164, v168, v166
    v_dot2c_f32_bf16 v164, v169, v166
    v_dot2c_f32_bf16 v164, v170, v166
    v_dot2c_f32_bf16 v164, v171, v166
    v_accvgpr_write_b32 a176, v168
    v_accvgpr_write_b32 a177, v169
    v_accvgpr_write_b32 a178, v170
    v_accvgpr_write_b32 a179, v171
    v_dot2c_f32_bf16 v165, v172, v166
    v_dot2c_f32_bf16 v165, v173, v166
    v_dot2c_f32_bf16 v165, v174, v166
    v_dot2c_f32_bf16 v165, v175, v166
    v_accvgpr_write_b32 a180, v172
    v_accvgpr_write_b32 a181, v173
    v_accvgpr_write_b32 a182, v174
    v_accvgpr_write_b32 a183, v175
    v_mfma_f32_16x16x32_bf16 v[72:75], a[104:107], a[96:99], v[72:75]
    v_mfma_f32_16x16x32_bf16 v[76:79], a[104:107], a[100:103], v[76:79]
    v_cndmask_b32 v156, v156, v236, s[30:31]
    v_cndmask_b32 v157, v157, v236, s[30:31]
    v_cndmask_b32 v158, v158, v236, s[30:31]
    v_cndmask_b32 v159, v159, v236, s[30:31]
    v_mfma_f32_16x16x32_bf16 v[80:83], a[108:111], a[96:99], v[80:83]
    v_cndmask_b32 v212, v212, v236, s[32:33]
    v_cndmask_b32 v213, v213, v236, s[32:33]
    v_cndmask_b32 v214, v214, v236, s[32:33]
    v_cndmask_b32 v215, v215, v236, s[32:33]
    v_mfma_f32_16x16x32_bf16 v[84:87], a[108:111], a[100:103], v[84:87]
    v_mfma_f32_16x16x32_bf16 v[88:91], a[112:115], a[96:99], v[88:91]
    v_mfma_f32_16x16x32_bf16 v[92:95], a[112:115], a[100:103], v[92:95]
    v_mfma_f32_16x16x32_bf16 v[96:99], a[116:119], a[96:99], v[96:99]
    v_mfma_f32_16x16x32_bf16 v[100:103], a[116:119], a[100:103], v[100:103]
    v_mfma_f32_16x16x32_bf16 v[104:107], a[120:123], a[96:99], v[104:107]
    v_mfma_f32_16x16x32_bf16 v[108:111], a[120:123], a[100:103], v[108:111]
    v_mfma_f32_16x16x32_bf16 v[112:115], a[124:127], a[96:99], v[112:115]
    v_mfma_f32_16x16x32_bf16 v[116:119], a[124:127], a[100:103], v[116:119]
    v_mfma_f32_16x16x32_bf16 v[120:123], v[212:215], a[96:99], v[120:123]
    v_mfma_f32_16x16x32_bf16 v[124:127], v[212:215], a[100:103], v[124:127]
    v_mfma_f32_16x16x32_bf16 v[128:131], a[104:107], v[156:159], v[128:131]
    v_mfma_f32_16x16x32_bf16 v[132:135], a[108:111], v[156:159], v[132:135]
    v_mfma_f32_16x16x32_bf16 v[136:139], a[112:115], v[156:159], v[136:139]
    v_mfma_f32_16x16x32_bf16 v[140:143], a[116:119], v[156:159], v[140:143]
    v_mfma_f32_16x16x32_bf16 v[44:47], a[0:3], a[0:3], v[44:47]
    s_waitcnt vmcnt(11)
    ds_read_b64_tr_b16 v[176:177], v161 offset:2048
    ds_read_b64_tr_b16 v[178:179], v161 offset:2560
    v_mfma_f32_16x16x32_bf16 v[72:75], a[8:11], a[0:3], v[72:75]
    s_waitcnt vmcnt(10)
    ds_read_b64_tr_b16 v[180:181], v161 offset:3072
    ds_read_b64_tr_b16 v[182:183], v161 offset:3584
    v_mfma_f32_16x16x32_bf16 v[76:79], a[8:11], a[4:7], v[76:79]
    s_mul_i32 s42, s4, 0
    s_add_u32 s42, s42, s6
    buffer_store_dwordx4 a[128:131], v162, s[8:11], s42 offen sc1
    v_cndmask_b32 v144, v144, v236, s[30:31]
    v_cndmask_b32 v145, v145, v236, s[30:31]
    v_cndmask_b32 v146, v146, v236, s[30:31]
    v_cndmask_b32 v147, v147, v236, s[30:31]
    v_mfma_f32_16x16x32_bf16 v[80:83], a[12:15], a[0:3], v[80:83]
    v_cndmask_b32 v200, v200, v236, s[32:33]
    v_cndmask_b32 v201, v201, v236, s[32:33]
    v_cndmask_b32 v202, v202, v236, s[32:33]
    v_cndmask_b32 v203, v203, v236, s[32:33]
    v_mfma_f32_16x16x32_bf16 v[84:87], a[12:15], a[4:7], v[84:87]
    v_mfma_f32_16x16x32_bf16 v[88:91], a[16:19], a[0:3], v[88:91]
    s_mul_i32 s42, s4, 1792
    s_add_u32 s42, s42, s6
    s_add_u32 s42, s42, 256
    buffer_store_dwordx4 a[132:135], v162, s[8:11], s42 offen sc1
    v_mfma_f32_16x16x32_bf16 v[92:95], a[16:19], a[4:7], v[92:95]
    v_mfma_f32_16x16x32_bf16 v[96:99], a[20:23], a[0:3], v[96:99]
    v_mfma_f32_16x16x32_bf16 v[100:103], a[20:23], a[4:7], v[100:103]
    s_mul_i32 s42, s4, -256
    s_add_u32 s42, s42, s6
    s_add_u32 s42, s42, 512
    buffer_store_dwordx4 a[136:139], v162, s[8:11], s42 offen sc1
    v_mfma_f32_16x16x32_bf16 v[104:107], a[24:27], a[0:3], v[104:107]
    v_mfma_f32_16x16x32_bf16 v[108:111], a[24:27], a[4:7], v[108:111]
    v_mfma_f32_16x16x32_bf16 v[112:115], a[28:31], a[0:3], v[112:115]
    s_mul_i32 s42, s4, 1536
    s_add_u32 s42, s42, s6
    s_add_u32 s42, s42, 768
    buffer_store_dwordx4 a[140:143], v162, s[8:11], s42 offen sc1
    v_mfma_f32_16x16x32_bf16 v[116:119], a[28:31], a[4:7], v[116:119]
    v_mfma_f32_16x16x32_bf16 v[120:123], v[200:203], a[0:3], v[120:123]
    v_mfma_f32_16x16x32_bf16 v[124:127], v[200:203], a[4:7], v[124:127]
    s_mul_i32 s42, s4, -36352
    s_add_u32 s42, s42, s6
    s_add_u32 s42, s42, 36864
    buffer_store_dwordx4 a[144:147], v162, s[8:11], s42 offen sc1
    v_mfma_f32_16x16x32_bf16 v[128:131], a[8:11], v[144:147], v[128:131]
    v_mfma_f32_16x16x32_bf16 v[132:135], a[12:15], v[144:147], v[132:135]
    v_mfma_f32_16x16x32_bf16 v[136:139], a[16:19], v[144:147], v[136:139]
    s_mul_i32 s42, s4, -34560
    s_add_u32 s42, s42, s6
    s_add_u32 s42, s42, 37120
    buffer_store_dwordx4 a[148:151], v162, s[8:11], s42 offen sc1
    v_mfma_f32_16x16x32_bf16 v[140:143], a[20:23], v[144:147], v[140:143]
    v_mfma_f32_16x16x32_bf16 v[44:47], a[32:35], a[32:35], v[44:47]
    s_waitcnt lgkmcnt(3)
    v_dot2c_f32_bf16 v164, v176, v166
    v_dot2c_f32_bf16 v164, v177, v166
    s_waitcnt lgkmcnt(2)
    v_dot2c_f32_bf16 v164, v178, v166
    v_dot2c_f32_bf16 v164, v179, v166
    v_accvgpr_write_b32 a184, v176
    v_accvgpr_write_b32 a185, v177
    v_accvgpr_write_b32 a186, v178
    v_accvgpr_write_b32 a187, v179
    v_mfma_f32_16x16x32_bf16 v[72:75], a[40:43], a[32:35], v[72:75]
    s_waitcnt lgkmcnt(1)
    v_dot2c_f32_bf16 v165, v180, v166
    v_dot2c_f32_bf16 v165, v181, v166
    s_waitcnt lgkmcnt(0)
    v_dot2c_f32_bf16 v165, v182, v166
    v_dot2c_f32_bf16 v165, v183, v166
    v_accvgpr_write_b32 a188, v180
    v_accvgpr_write_b32 a189, v181
    v_accvgpr_write_b32 a190, v182
    v_accvgpr_write_b32 a191, v183
    v_mfma_f32_16x16x32_bf16 v[76:79], a[40:43], a[36:39], v[76:79]
    s_mul_i32 s42, s4, -36608
    s_add_u32 s42, s42, s6
    s_add_u32 s42, s42, 37376
    buffer_store_dwordx4 a[152:155], v162, s[8:11], s42 offen sc1
    v_cndmask_b32 v148, v148, v236, s[30:31]
    v_cndmask_b32 v149, v149, v236, s[30:31]
    v_cndmask_b32 v150, v150, v236, s[30:31]
    v_cndmask_b32 v151, v151, v236, s[30:31]
    v_mfma_f32_16x16x32_bf16 v[80:83], a[44:47], a[32:35], v[80:83]
    v_cndmask_b32 v204, v204, v236, s[32:33]
    v_cndmask_b32 v205, v205, v236, s[32:33]
    v_cndmask_b32 v206, v206, v236, s[32:33]
    v_cndmask_b32 v207, v207, v236, s[32:33]
    v_mfma_f32_16x16x32_bf16 v[84:87], a[44:47], a[36:39], v[84:87]
    v_mfma_f32_16x16x32_bf16 v[88:91], a[48:51], a[32:35], v[88:91]
    s_mul_i32 s42, s4, -34816
    s_add_u32 s42, s42, s6
    s_add_u32 s42, s42, 37632
    buffer_store_dwordx4 a[156:159], v162, s[8:11], s42 offen sc1
    v_mfma_f32_16x16x32_bf16 v[92:95], a[48:51], a[36:39], v[92:95]
    v_mfma_f32_16x16x32_bf16 v[96:99], a[52:55], a[32:35], v[96:99]
    v_mfma_f32_16x16x32_bf16 v[100:103], a[52:55], a[36:39], v[100:103]
    s_mul_i32 s42, s4, -69632
    s_add_u32 s42, s42, s6
    s_add_u32 s42, s42, 73728
    buffer_store_dwordx4 a[160:163], v162, s[8:11], s42 offen sc1
    v_mfma_f32_16x16x32_bf16 v[104:107], a[56:59], a[32:35], v[104:107]
    v_mfma_f32_16x16x32_bf16 v[108:111], a[56:59], a[36:39], v[108:111]
    v_mfma_f32_16x16x32_bf16 v[112:115], a[60:63], a[32:35], v[112:115]
    s_mul_i32 s42, s4, -67840
    s_add_u32 s42, s42, s6
    s_add_u32 s42, s42, 73984
    buffer_store_dwordx4 a[164:167], v162, s[8:11], s42 offen sc1
    v_mfma_f32_16x16x32_bf16 v[116:119], a[60:63], a[36:39], v[116:119]
    v_mfma_f32_16x16x32_bf16 v[120:123], v[204:207], a[32:35], v[120:123]
    v_mfma_f32_16x16x32_bf16 v[124:127], v[204:207], a[36:39], v[124:127]
    s_mul_i32 s42, s4, -69888
    s_add_u32 s42, s42, s6
    s_add_u32 s42, s42, 74240
    buffer_store_dwordx4 a[168:171], v162, s[8:11], s42 offen sc1
    v_mfma_f32_16x16x32_bf16 v[128:131], a[40:43], v[148:151], v[128:131]
    v_mfma_f32_16x16x32_bf16 v[132:135], a[44:47], v[148:151], v[132:135]
    v_mfma_f32_16x16x32_bf16 v[136:139], a[48:51], v[148:151], v[136:139]
    s_mul_i32 s42, s4, -68096
    s_add_u32 s42, s42, s6
    s_add_u32 s42, s42, 74496
    buffer_store_dwordx4 a[172:175], v162, s[8:11], s42 offen sc1
    v_mfma_f32_16x16x32_bf16 v[140:143], a[52:55], v[148:151], v[140:143]
    v_and_b32 v14, 15, v2
    v_lshrrev_b32 v17, 4, v2
    v_lshlrev_b32 v15, 3, v14
    v_add_u32 v15, 119808, v15
    s_lshl_b32 s22, s39, 7
    v_add_u32 v20, s22, v15
    s_lshl_b32 s22, s36, 7
    v_add_u32 v21, s22, v15
    v_and_b32 v18, 3, v14
    v_cmp_eq_u32 vcc, 1, v18
    s_nop 1
    v_cndmask_b32 v44, v44, v45, vcc
    v_cmp_eq_u32 vcc, 2, v18
    s_nop 1
    v_cndmask_b32 v44, v44, v46, vcc
    v_cmp_eq_u32 vcc, 3, v18
    s_nop 1
    v_cndmask_b32 v44, v44, v47, vcc
    v_lshrrev_b32 v18, 2, v14
    v_cmp_eq_u32 s[34:35], v18, v17
    v_lshlrev_b32 v18, 4, v17
    s_mul_i32 s22, s27, 448
    s_add_u32 s22, s22, 120576
    v_add_u32 v18, s22, v18
    s_lshl_b32 s22, s27, 2
    v_add_u32 v25, s22, v17
    v_cmp_eq_u32 s[40:41], 6, v25
    s_lshl_b32 s22, s27, 1
    v_add_u32 v25, s22, v17
    v_cmp_gt_u32 s[32:33], 4, v25
    s_mov_b64 exec, s[34:35]
    ds_write_b32 v20, v44 offset:4
    s_mov_b64 exec, s[30:31]
    ds_write_b128 v18, v[128:131] offset:0
    ds_write_b128 v18, v[132:135] offset:64
    ds_write_b128 v18, v[136:139] offset:128
    ds_write_b128 v18, v[140:143] offset:192
    s_cmp_eq_u32 s27, 0
    s_cbranch_scc1 KAB_G0_NS
    s_mov_b64 exec, s[40:41]
    ds_write_b32 v20, v120
    ds_write_b32 v21, v124
KAB_G0_NS:
    s_mov_b64 exec, -1
    s_add_u32 s29, s3, 0
    s_min_u32 s29, s29, 2
    s_add_u32 s29, s29, 78
    s_lshl_b32 m0, s29, 10
    s_lshl_b32 s29, s29, 6
    v_add_u32 v250, s29, v2
    v_mul_u32_u24 v251, 7282, v250
    v_lshrrev_b32 v251, 16, v251
    v_mul_u32_u24 v251, 1008, v251
    v_lshl_add_u32 v251, v250, 4, v251
    buffer_load_dwordx4 v251, s[44:47], s26 offen lds
    v_mov_b32 v26, 0x3ae38e39
    v_mov_b32 v27, 0x3ae38e39
    v_mul_u32_u24 v22, 440, v14
    v_lshl_add_u32 v22, v17, 3, v22
    s_mul_i32 s22, s27, 224
    s_add_u32 s22, s22, 83968
    v_add_u32 v22, s22, v22
    s_mul_i32 s22, s39, 7040
    v_add_u32 v23, s22, v22
    s_mul_i32 s22, s36, 7040
    v_add_u32 v24, s22, v22
    s_waitcnt lgkmcnt(0)
    s_barrier
    ds_read_b64 v[28:29], v20
    ds_read_b64 v[30:31], v21
    ds_read_b64 v[32:33], v15
    ds_read_b128 v[40:43], v18 offset:0
    ds_read_b128 v[44:47], v18 offset:64
    ds_read_b128 v[48:51], v18 offset:128
    ds_read_b128 v[52:55], v18 offset:192
    ds_read_b128 v[56:59], v18 offset:256
    ds_read_b128 v[60:63], v18 offset:320
    ds_read_b128 v[64:67], v18 offset:384
    s_waitcnt lgkmcnt(9)
    v_pk_mul_f32 v[28:29], v[28:29], v[26:27]
    s_waitcnt lgkmcnt(8)
    v_pk_mul_f32 v[30:31], v[30:31], v[26:27]
    s_waitcnt lgkmcnt(7)
    v_pk_mul_f32 v[32:33], v[32:33], v[26:27]
    v_fma_f32 v29, -v28, v28, v29
    v_fma_f32 v31, -v30, v30, v31
    v_fma_f32 v33, -v32, v32, v33
    v_max_f32 v29, 0, v29
    v_max_f32 v31, 0, v31
    v_max_f32 v33, 0, v33
    v_add_f32 v29, 0x3727c5ac, v29
    v_add_f32 v31, 0x3727c5ac, v31
    v_add_f32 v33, 0x3727c5ac, v33
    v_rsq_f32 v29, v29
    v_rsq_f32 v31, v31
    v_rsq_f32 v33, v33
    v_mul_f32 v28, -v28, v29
    v_mul_f32 v30, -v30, v31
    v_mul_f32 v32, -v32, v33
    v_pk_mul_f32 v[72:73], v[72:73], v[28:29] op_sel:[0,1] op_sel_hi:[1,1]
    v_pk_mul_f32 v[74:75], v[74:75], v[28:29] op_sel:[0,1] op_sel_hi:[1,1]
    s_waitcnt lgkmcnt(6)
    v_pk_fma_f32 v[72:73], v[40:41], v[28:29], v[72:73] op_sel:[0,0,0] op_sel_hi:[1,0,1]
    v_pk_fma_f32 v[74:75], v[42:43], v[28:29], v[74:75] op_sel:[0,0,0] op_sel_hi:[1,0,1]
    v_cvt_pk_bf16_f32 v72, v72, v73
    v_cvt_pk_bf16_f32 v73, v74, v75
    ds_write_b64 v23, v[72:73] offset:0
    v_pk_mul_f32 v[76:77], v[76:77], v[30:31] op_sel:[0,1] op_sel_hi:[1,1]
    v_pk_mul_f32 v[78:79], v[78:79], v[30:31] op_sel:[0,1] op_sel_hi:[1,1]
    v_pk_fma_f32 v[76:77], v[40:41], v[30:31], v[76:77] op_sel:[0,0,0] op_sel_hi:[1,0,1]
    v_pk_fma_f32 v[78:79], v[42:43], v[30:31], v[78:79] op_sel:[0,0,0] op_sel_hi:[1,0,1]
    v_cvt_pk_bf16_f32 v76, v76, v77
    v_cvt_pk_bf16_f32 v77, v78, v79
    ds_write_b64 v24, v[76:77] offset:0
    s_mul_i32 s42, s4, -105984
    s_add_u32 s42, s42, s6
    s_add_u32 s42, s42, 110592
    buffer_store_dwordx4 a[176:179], v162, s[8:11], s42 offen sc1
    v_pk_mul_f32 v[80:81], v[80:81], v[28:29] op_sel:[0,1] op_sel_hi:[1,1]
    v_pk_mul_f32 v[82:83], v[82:83], v[28:29] op_sel:[0,1] op_sel_hi:[1,1]
    s_waitcnt lgkmcnt(7)
    v_pk_fma_f32 v[80:81], v[44:45], v[28:29], v[80:81] op_sel:[0,0,0] op_sel_hi:[1,0,1]
    v_pk_fma_f32 v[82:83], v[46:47], v[28:29], v[82:83] op_sel:[0,0,0] op_sel_hi:[1,0,1]
    v_cvt_pk_bf16_f32 v80, v80, v81
    v_cvt_pk_bf16_f32 v81, v82, v83
    ds_write_b64 v23, v[80:81] offset:32
    v_pk_mul_f32 v[84:85], v[84:85], v[30:31] op_sel:[0,1] op_sel_hi:[1,1]
    v_pk_mul_f32 v[86:87], v[86:87], v[30:31] op_sel:[0,1] op_sel_hi:[1,1]
    v_pk_fma_f32 v[84:85], v[44:45], v[30:31], v[84:85] op_sel:[0,0,0] op_sel_hi:[1,0,1]
    v_pk_fma_f32 v[86:87], v[46:47], v[30:31], v[86:87] op_sel:[0,0,0] op_sel_hi:[1,0,1]
    v_cvt_pk_bf16_f32 v84, v84, v85
    v_cvt_pk_bf16_f32 v85, v86, v87
    ds_write_b64 v24, v[84:85] offset:32
    s_mul_i32 s42, s4, -104192
    s_add_u32 s42, s42, s6
    s_add_u32 s42, s42, 110848
    buffer_store_dwordx4 a[180:183], v162, s[8:11], s42 offen sc1
    v_pk_mul_f32 v[88:89], v[88:89], v[28:29] op_sel:[0,1] op_sel_hi:[1,1]
    v_pk_mul_f32 v[90:91], v[90:91], v[28:29] op_sel:[0,1] op_sel_hi:[1,1]
    s_waitcnt lgkmcnt(8)
    v_pk_fma_f32 v[88:89], v[48:49], v[28:29], v[88:89] op_sel:[0,0,0] op_sel_hi:[1,0,1]
    v_pk_fma_f32 v[90:91], v[50:51], v[28:29], v[90:91] op_sel:[0,0,0] op_sel_hi:[1,0,1]
    v_cvt_pk_bf16_f32 v88, v88, v89
    v_cvt_pk_bf16_f32 v89, v90, v91
    ds_write_b64 v23, v[88:89] offset:64
    v_pk_mul_f32 v[92:93], v[92:93], v[30:31] op_sel:[0,1] op_sel_hi:[1,1]
    v_pk_mul_f32 v[94:95], v[94:95], v[30:31] op_sel:[0,1] op_sel_hi:[1,1]
    v_pk_fma_f32 v[92:93], v[48:49], v[30:31], v[92:93] op_sel:[0,0,0] op_sel_hi:[1,0,1]
    v_pk_fma_f32 v[94:95], v[50:51], v[30:31], v[94:95] op_sel:[0,0,0] op_sel_hi:[1,0,1]
    v_cvt_pk_bf16_f32 v92, v92, v93
    v_cvt_pk_bf16_f32 v93, v94, v95
    ds_write_b64 v24, v[92:93] offset:64
    s_mul_i32 s42, s4, -106240
    s_add_u32 s42, s42, s6
    s_add_u32 s42, s42, 111104
    buffer_store_dwordx4 a[184:187], v162, s[8:11], s42 offen sc1
    v_pk_mul_f32 v[96:97], v[96:97], v[28:29] op_sel:[0,1] op_sel_hi:[1,1]
    v_pk_mul_f32 v[98:99], v[98:99], v[28:29] op_sel:[0,1] op_sel_hi:[1,1]
    s_waitcnt lgkmcnt(9)
    v_pk_fma_f32 v[96:97], v[52:53], v[28:29], v[96:97] op_sel:[0,0,0] op_sel_hi:[1,0,1]
    v_pk_fma_f32 v[98:99], v[54:55], v[28:29], v[98:99] op_sel:[0,0,0] op_sel_hi:[1,0,1]
    v_cvt_pk_bf16_f32 v96, v96, v97
    v_cvt_pk_bf16_f32 v97, v98, v99
    ds_write_b64 v23, v[96:97] offset:96
    v_pk_mul_f32 v[100:101], v[100:101], v[30:31] op_sel:[0,1] op_sel_hi:[1,1]
    v_pk_mul_f32 v[102:103], v[102:103], v[30:31] op_sel:[0,1] op_sel_hi:[1,1]
    v_pk_fma_f32 v[100:101], v[52:53], v[30:31], v[100:101] op_sel:[0,0,0] op_sel_hi:[1,0,1]
    v_pk_fma_f32 v[102:103], v[54:55], v[30:31], v[102:103] op_sel:[0,0,0] op_sel_hi:[1,0,1]
    v_cvt_pk_bf16_f32 v100, v100, v101
    v_cvt_pk_bf16_f32 v101, v102, v103
    ds_write_b64 v24, v[100:101] offset:96
    s_mul_i32 s42, s4, -104448
    s_add_u32 s42, s42, s6
    s_add_u32 s42, s42, 111360
    buffer_store_dwordx4 a[188:191], v162, s[8:11], s42 offen sc1
    v_pk_mul_f32 v[104:105], v[104:105], v[28:29] op_sel:[0,1] op_sel_hi:[1,1]
    v_pk_mul_f32 v[106:107], v[106:107], v[28:29] op_sel:[0,1] op_sel_hi:[1,1]
    s_waitcnt lgkmcnt(10)
    v_pk_fma_f32 v[104:105], v[56:57], v[28:29], v[104:105] op_sel:[0,0,0] op_sel_hi:[1,0,1]
    v_pk_fma_f32 v[106:107], v[58:59], v[28:29], v[106:107] op_sel:[0,0,0] op_sel_hi:[1,0,1]
    v_cvt_pk_bf16_f32 v104, v104, v105
    v_cvt_pk_bf16_f32 v105, v106, v107
    ds_write_b64 v23, v[104:105] offset:128
    v_pk_mul_f32 v[108:109], v[108:109], v[30:31] op_sel:[0,1] op_sel_hi:[1,1]
    v_pk_mul_f32 v[110:111], v[110:111], v[30:31] op_sel:[0,1] op_sel_hi:[1,1]
    v_pk_fma_f32 v[108:109], v[56:57], v[30:31], v[108:109] op_sel:[0,0,0] op_sel_hi:[1,0,1]
    v_pk_fma_f32 v[110:111], v[58:59], v[30:31], v[110:111] op_sel:[0,0,0] op_sel_hi:[1,0,1]
    v_cvt_pk_bf16_f32 v108, v108, v109
    v_cvt_pk_bf16_f32 v109, v110, v111
    ds_write_b64 v24, v[108:109] offset:128
    buffer_store_dword v164, v163, s[8:11], 0 offen offset:0 sc1
    v_pk_mul_f32 v[112:113], v[112:113], v[28:29] op_sel:[0,1] op_sel_hi:[1,1]
    v_pk_mul_f32 v[114:115], v[114:115], v[28:29] op_sel:[0,1] op_sel_hi:[1,1]
    s_waitcnt lgkmcnt(11)
    v_pk_fma_f32 v[112:113], v[60:61], v[28:29], v[112:113] op_sel:[0,0,0] op_sel_hi:[1,0,1]
    v_pk_fma_f32 v[114:115], v[62:63], v[28:29], v[114:115] op_sel:[0,0,0] op_sel_hi:[1,0,1]
    v_cvt_pk_bf16_f32 v112, v112, v113
    v_cvt_pk_bf16_f32 v113, v114, v115
    ds_write_b64 v23, v[112:113] offset:160
    v_pk_mul_f32 v[116:117], v[116:117], v[30:31] op_sel:[0,1] op_sel_hi:[1,1]
    v_pk_mul_f32 v[118:119], v[118:119], v[30:31] op_sel:[0,1] op_sel_hi:[1,1]
    v_pk_fma_f32 v[116:117], v[60:61], v[30:31], v[116:117] op_sel:[0,0,0] op_sel_hi:[1,0,1]
    v_pk_fma_f32 v[118:119], v[62:63], v[30:31], v[118:119] op_sel:[0,0,0] op_sel_hi:[1,0,1]
    v_cvt_pk_bf16_f32 v116, v116, v117
    v_cvt_pk_bf16_f32 v117, v118, v119
    ds_write_b64 v24, v[116:117] offset:160
    buffer_store_dword v165, v163, s[8:11], 0 offen offset:128 sc1
    v_pk_mul_f32 v[120:121], v[120:121], v[28:29] op_sel:[0,1] op_sel_hi:[1,1]
    v_pk_mul_f32 v[122:123], v[122:123], v[28:29] op_sel:[0,1] op_sel_hi:[1,1]
    s_waitcnt lgkmcnt(12)
    v_pk_fma_f32 v[120:121], v[64:65], v[28:29], v[120:121] op_sel:[0,0,0] op_sel_hi:[1,0,1]
    v_pk_fma_f32 v[122:123], v[66:67], v[28:29], v[122:123] op_sel:[0,0,0] op_sel_hi:[1,0,1]
    v_cvt_pk_bf16_f32 v120, v120, v121
    v_cvt_pk_bf16_f32 v121, v122, v123
    s_mov_b64 exec, s[32:33]
    ds_write_b64 v23, v[120:121] offset:192
    s_mov_b64 exec, -1
    v_pk_mul_f32 v[124:125], v[124:125], v[30:31] op_sel:[0,1] op_sel_hi:[1,1]
    v_pk_mul_f32 v[126:127], v[126:127], v[30:31] op_sel:[0,1] op_sel_hi:[1,1]
    v_pk_fma_f32 v[124:125], v[64:65], v[30:31], v[124:125] op_sel:[0,0,0] op_sel_hi:[1,0,1]
    v_pk_fma_f32 v[126:127], v[66:67], v[30:31], v[126:127] op_sel:[0,0,0] op_sel_hi:[1,0,1]
    v_cvt_pk_bf16_f32 v124, v124, v125
    v_cvt_pk_bf16_f32 v125, v126, v127
    s_mov_b64 exec, s[32:33]
    ds_write_b64 v24, v[124:125] offset:192
    s_mov_b64 exec, -1
    v_pk_mul_f32 v[128:129], v[128:129], v[32:33] op_sel:[0,1] op_sel_hi:[1,1]
    v_pk_mul_f32 v[130:131], v[130:131], v[32:33] op_sel:[0,1] op_sel_hi:[1,1]
    v_pk_fma_f32 v[128:129], v[40:41], v[32:33], v[128:129] op_sel:[0,0,0] op_sel_hi:[1,0,1]
    v_pk_fma_f32 v[130:131], v[42:43], v[32:33], v[130:131] op_sel:[0,0,0] op_sel_hi:[1,0,1]
    v_cvt_pk_bf16_f32 v128, v128, v129
    v_cvt_pk_bf16_f32 v129, v130, v131
    ds_write_b64 v22, v[128:129] offset:0
    v_pk_mul_f32 v[132:133], v[132:133], v[32:33] op_sel:[0,1] op_sel_hi:[1,1]
    v_pk_mul_f32 v[134:135], v[134:135], v[32:33] op_sel:[0,1] op_sel_hi:[1,1]
    v_pk_fma_f32 v[132:133], v[44:45], v[32:33], v[132:133] op_sel:[0,0,0] op_sel_hi:[1,0,1]
    v_pk_fma_f32 v[134:135], v[46:47], v[32:33], v[134:135] op_sel:[0,0,0] op_sel_hi:[1,0,1]
    v_cvt_pk_bf16_f32 v132, v132, v133
    v_cvt_pk_bf16_f32 v133, v134, v135
    ds_write_b64 v22, v[132:133] offset:32
    v_pk_mul_f32 v[136:137], v[136:137], v[32:33] op_sel:[0,1] op_sel_hi:[1,1]
    v_pk_mul_f32 v[138:139], v[138:139], v[32:33] op_sel:[0,1] op_sel_hi:[1,1]
    v_pk_fma_f32 v[136:137], v[48:49], v[32:33], v[136:137] op_sel:[0,0,0] op_sel_hi:[1,0,1]
    v_pk_fma_f32 v[138:139], v[50:51], v[32:33], v[138:139] op_sel:[0,0,0] op_sel_hi:[1,0,1]
    v_cvt_pk_bf16_f32 v136, v136, v137
    v_cvt_pk_bf16_f32 v137, v138, v139
    ds_write_b64 v22, v[136:137] offset:64
    v_pk_mul_f32 v[140:141], v[140:141], v[32:33] op_sel:[0,1] op_sel_hi:[1,1]
    v_pk_mul_f32 v[142:143], v[142:143], v[32:33] op_sel:[0,1] op_sel_hi:[1,1]
    v_pk_fma_f32 v[140:141], v[52:53], v[32:33], v[140:141] op_sel:[0,0,0] op_sel_hi:[1,0,1]
    v_pk_fma_f32 v[142:143], v[54:55], v[32:33], v[142:143] op_sel:[0,0,0] op_sel_hi:[1,0,1]
    v_cvt_pk_bf16_f32 v140, v140, v141
    v_cvt_pk_bf16_f32 v141, v142, v143
    ds_write_b64 v22, v[140:141] offset:96
    s_branch KAB_AJ
KAB_A1:
    s_add_u32 m0, s37, 6144
    s_add_u32 s38, s34, 1152
    buffer_load_dwordx4 v4, s[12:15], s38 offen lds
    s_add_u32 m0, s37, 8192
    s_add_u32 s38, s34, 38016
    buffer_load_dwordx4 v4, s[12:15], s38 offen lds
    v_add_u32 v14, 0, v18
    v_mul_u32_u24 v15, 18559, v14
    v_lshrrev_b32 v15, 22, v15
    v_mul_u32_u24 v16, 226, v15
    v_sub_u32 v14, v14, v16
    v_mul_u32_u24 v16, 2341, v14
    v_lshrrev_b32 v16, 16, v16
    v_min_u32 v16, 7, v16
    v_lshl_add_u32 v15, v15, 3, v16
    v_mul_u32_u24 v16, 28, v16
    v_sub_u32 v14, v14, v16
    v_min_u32 v14, 26, v14
    v_mul_u32_u24 v16, 57, v14
    v_lshrrev_b32 v16, 9, v16
    v_mul_u32_u24 v15, 3456, v15
    v_lshl_add_u32 v15, v14, 4, v15
    v_mul_u32_u24 v16, 1008, v16
    v_add_u32 v6, v15, v16
    s_add_u32 m0, s24, 0
    s_nop 0
    buffer_load_dwordx4 v6, s[16:19], s25 offen lds
    v_add_u32 v14, 128, v18
    v_mul_u32_u24 v15, 18559, v14
    v_lshrrev_b32 v15, 22, v15
    v_mul_u32_u24 v16, 226, v15
    v_sub_u32 v14, v14, v16
    v_mul_u32_u24 v16, 2341, v14
    v_lshrrev_b32 v16, 16, v16
    v_min_u32 v16, 7, v16
    v_lshl_add_u32 v15, v15, 3, v16
    v_mul_u32_u24 v16, 28, v16
    v_sub_u32 v14, v14, v16
    v_min_u32 v14, 26, v14
    v_mul_u32_u24 v16, 57, v14
    v_lshrrev_b32 v16, 9, v16
    v_mul_u32_u24 v15, 3456, v15
    v_lshl_add_u32 v15, v14, 4, v15
    v_mul_u32_u24 v16, 1008, v16
    v_add_u32 v7, v15, v16
    s_add_u32 m0, s24, 2048
    s_nop 0
    buffer_load_dwordx4 v7, s[16:19], s25 offen lds
    v_add_u32 v14, 256, v18
    v_mul_u32_u24 v15, 18559, v14
    v_lshrrev_b32 v15, 22, v15
    v_mul_u32_u24 v16, 226, v15
    v_sub_u32 v14, v14, v16
    v_mul_u32_u24 v16, 2341, v14
    v_lshrrev_b32 v16, 16, v16
    v_min_u32 v16, 7, v16
    v_lshl_add_u32 v15, v15, 3, v16
    v_mul_u32_u24 v16, 28, v16
    v_sub_u32 v14, v14, v16
    v_min_u32 v14, 26, v14
    v_mul_u32_u24 v16, 57, v14
    v_lshrrev_b32 v16, 9, v16
    v_mul_u32_u24 v15, 3456, v15
    v_lshl_add_u32 v15, v14, 4, v15
    v_mul_u32_u24 v16, 1008, v16
    v_add_u32 v8, v15, v16
    s_add_u32 m0, s24, 4096
    s_nop 0
    buffer_load_dwordx4 v8, s[16:19], s25 offen lds
    v_add_u32 v14, 384, v18
    v_mul_u32_u24 v15, 18559, v14
    v_lshrrev_b32 v15, 22, v15
    v_mul_u32_u24 v16, 226, v15
    v_sub_u32 v14, v14, v16
    v_mul_u32_u24 v16, 2341, v14
    v_lshrrev_b32 v16, 16, v16
    v_min_u32 v16, 7, v16
    v_lshl_add_u32 v15, v15, 3, v16
    v_mul_u32_u24 v16, 28, v16
    v_sub_u32 v14, v14, v16
    v_min_u32 v14, 26, v14
    v_mul_u32_u24 v16, 57, v14
    v_lshrrev_b32 v16, 9, v16
    v_mul_u32_u24 v15, 3456, v15
    v_lshl_add_u32 v15, v14, 4, v15
    v_mul_u32_u24 v16, 1008, v16
    v_add_u32 v9, v15, v16
    s_add_u32 m0, s24, 6144
    s_nop 0
    buffer_load_dwordx4 v9, s[16:19], s25 offen lds
    v_add_u32 v14, 512, v18
    v_mul_u32_u24 v15, 18559, v14
    v_lshrrev_b32 v15, 22, v15
    v_mul_u32_u24 v16, 226, v15
    v_sub_u32 v14, v14, v16
    v_mul_u32_u24 v16, 2341, v14
    v_lshrrev_b32 v16, 16, v16
    v_min_u32 v16, 7, v16
    v_lshl_add_u32 v15, v15, 3, v16
    v_mul_u32_u24 v16, 28, v16
    v_sub_u32 v14, v14, v16
    v_min_u32 v14, 26, v14
    v_mul_u32_u24 v16, 57, v14
    v_lshrrev_b32 v16, 9, v16
    v_mul_u32_u24 v15, 3456, v15
    v_lshl_add_u32 v15, v14, 4, v15
    v_mul_u32_u24 v16, 1008, v16
    v_add_u32 v10, v15, v16
    s_add_u32 m0, s24, 8192
    s_nop 0
    buffer_load_dwordx4 v10, s[16:19], s25 offen lds
    v_add_u32 v14, 640, v18
    v_mul_u32_u24 v15, 18559, v14
    v_lshrrev_b32 v15, 22, v15
    v_mul_u32_u24 v16, 226, v15
    v_sub_u32 v14, v14, v16
    v_mul_u32_u24 v16, 2341, v14
    v_lshrrev_b32 v16, 16, v16
    v_min_u32 v16, 7, v16
    v_lshl_add_u32 v15, v15, 3, v16
    v_mul_u32_u24 v16, 28, v16
    v_sub_u32 v14, v14, v16
    v_min_u32 v14, 26, v14
    v_mul_u32_u24 v16, 57, v14
    v_lshrrev_b32 v16, 9, v16
    v_mul_u32_u24 v15, 3456, v15
    v_lshl_add_u32 v15, v14, 4, v15
    v_mul_u32_u24 v16, 1008, v16
    v_add_u32 v11, v15, v16
    s_add_u32 m0, s24, 10240
    s_nop 0
    buffer_load_dwordx4 v11, s[16:19], s25 offen lds
    v_add_u32 v14, 768, v18
    v_mul_u32_u24 v15, 18559, v14
    v_lshrrev_b32 v15, 22, v15
    v_mul_u32_u24 v16, 226, v15
    v_sub_u32 v14, v14, v16
    v_mul_u32_u24 v16, 2341, v14
    v_lshrrev_b32 v16, 16, v16
    v_min_u32 v16, 7, v16
    v_lshl_add_u32 v15, v15, 3, v16
    v_mul_u32_u24 v16, 28, v16
    v_sub_u32 v14, v14, v16
    v_min_u32 v14, 26, v14
    v_mul_u32_u24 v16, 57, v14
    v_lshrrev_b32 v16, 9, v16
    v_mul_u32_u24 v15, 3456, v15
    v_lshl_add_u32 v15, v14, 4, v15
    v_mul_u32_u24 v16, 1008, v16
    v_add_u32 v12, v15, v16
    s_add_u32 m0, s24, 12288
    s_nop 0
    buffer_load_dwordx4 v12, s[16:19], s25 offen lds
    v_add_u32 v14, 896, v18
    v_add_u32 v15, 1792, v2
    v_min_u32 v14, v14, v15
    v_min_u32 v14, 1807, v14
    v_mul_u32_u24 v15, 18559, v14
    v_lshrrev_b32 v15, 22, v15
    v_mul_u32_u24 v16, 226, v15
    v_sub_u32 v14, v14, v16
    v_mul_u32_u24 v16, 2341, v14
    v_lshrrev_b32 v16, 16, v16
    v_min_u32 v16, 7, v16
    v_lshl_add_u32 v15, v15, 3, v16
    v_mul_u32_u24 v16, 28, v16
    v_sub_u32 v14, v14, v16
    v_min_u32 v14, 26, v14
    v_mul_u32_u24 v16, 57, v14
    v_lshrrev_b32 v16, 9, v16
    v_mul_u32_u24 v15, 3456, v15
    v_lshl_add_u32 v15, v14, 4, v15
    v_mul_u32_u24 v16, 1008, v16
    v_add_u32 v13, v15, v16
    s_mov_b32 m0, 38912
    s_nop 0
    buffer_load_dwordx4 v13, s[16:19], s25 offen lds
    s_add_u32 s25, s25, 221184
    s_add_u32 s34, s34, 128
    s_cmp_ge_u32 s34, 1152
    s_cselect_b32 s34, 0, s34
    s_cselect_b32 s25, s26, s25
    v_and_b32 v14, 15, v2
    v_lshrrev_b32 v15, 1, v14
    v_lshrrev_b32 v16, 4, v2
    v_xor_b32 v15, v15, v16
    v_lshlrev_b32 v14, 7, v14
    v_lshl_add_u32 v20, v15, 4, v14
    v_xor_b32 v21, 64, v20
    v_add_u32 v22, 39936, v20
    v_add_u32 v23, 39936, v21
    v_add_u32 v24, 79872, v20
    v_add_u32 v25, 79872, v21
    s_add_u32 s39, s27, 3
    s_xor_b32 s36, s27, 1
    s_add_u32 s36, s36, 3
    s_lshl_b32 s22, s39, 11
    v_add_u32 v26, s22, v20
    v_add_u32 v27, s22, v21
    v_add_u32 v28, s22, v22
    v_add_u32 v29, s22, v23
    v_add_u32 v30, s22, v24
    v_add_u32 v31, s22, v25
    s_lshl_b32 s22, s36, 11
    v_add_u32 v32, s22, v20
    v_add_u32 v33, s22, v21
    v_add_u32 v34, s22, v22
    v_add_u32 v35, s22, v23
    v_add_u32 v36, s22, v24
    v_add_u32 v37, s22, v25
    v_lshrrev_b32 v14, 4, v2
    v_mul_u32_u24 v14, 3616, v14
    v_bfe_u32 v15, v2, 2, 2
    v_mul_u32_u24 v15, 448, v15
    v_add_u32 v14, v14, v15
    v_and_b32 v15, 3, v2
    v_lshl_add_u32 v14, v15, 3, v14
    s_mul_i32 s22, s27, 224
    s_add_u32 s22, s22, 10240
    v_add_u32 v38, s22, v14
    v_add_u32 v39, 39936, v38
    v_add_u32 v40, 79872, v38
    v_and_b32 v14, 15, v2
    v_cmp_eq_u32 s[30:31], 0, v14
    s_lshl_b32 s22, s27, 3
    v_add_u32 v14, s22, v14
    v_cmp_le_u32 s[32:33], 16, v14
    v_and_b32 v14, 15, v2
    v_lshrrev_b32 v15, 4, v2
    v_mul_u32_u24 v240, 440, v14
    v_lshl_add_u32 v240, v15, 4, v240
    v_lshrrev_b32 v241, 2, v2
    v_mul_u32_u24 v241, 440, v241
    v_and_b32 v16, 3, v2
    v_lshl_add_u32 v241, v16, 3, v241
    s_mul_i32 s23, s3, s27
    s_mul_i32 s23, s23, 7040
    s_add_u32 s23, s23, 83968
    s_add_u32 s22, s3, 1
    s_mul_i32 s22, s22, 7040
    s_add_u32 s22, s22, 83968
    v_add_u32 v242, s23, v240
    v_add_u32 v243, s23, v241
    v_add_u32 v240, s22, v240
    v_add_u32 v241, s22, v241
    v_mov_b32 v16, 0xf149f2ca
    v_lshlrev_b32 v17, 2, v15
    v_sub_u32 v17, v14, v17
    s_cmp_eq_u32 s3, 0
    s_cselect_b32 s22, 8, 0
    s_cselect_b32 s23, 8, 16
    s_or_b32 s38, s20, s27
    s_cmp_eq_u32 s38, 0
    s_cselect_b32 s23, 0, s23
    v_subrev_u32 v246, 0, v17
    v_cmp_gt_u32 vcc, 8, v246
    s_nop 1
    v_cndmask_b32 v216, v16, 0, vcc
    v_subrev_u32 v247, s22, v246
    v_cmp_gt_i32 vcc, -8, v247
    v_lshl_add_u32 v247, v15, 2, 0
    v_cmp_gt_u32 s[40:41], s23, v247
    s_nop 0
    s_and_b64 vcc, vcc, s[40:41]
    v_cndmask_b32 v224, v16, 0, vcc
    v_cmp_gt_u32 vcc, 9, v247
    s_nop 1
    v_cndmask_b32 v228, 0, -1, vcc
    v_subrev_u32 v247, 1, v247
    v_cmp_gt_u32 vcc, 9, v247
    s_nop 1
    v_cndmask_b32 v232, 0, -1, vcc
    v_mov_b32 v236, 0x3f803f80
    v_subrev_u32 v246, 1, v17
    v_cmp_gt_u32 vcc, 8, v246
    s_nop 1
    v_cndmask_b32 v217, v16, 0, vcc
    v_subrev_u32 v247, s22, v246
    v_cmp_gt_i32 vcc, -8, v247
    v_lshl_add_u32 v247, v15, 2, 1
    v_cmp_gt_u32 s[40:41], s23, v247
    s_nop 0
    s_and_b64 vcc, vcc, s[40:41]
    v_cndmask_b32 v225, v16, 0, vcc
    v_cmp_gt_u32 vcc, 9, v247
    s_nop 1
    v_cndmask_b32 v229, 0, -1, vcc
    v_subrev_u32 v247, 1, v247
    v_cmp_gt_u32 vcc, 9, v247
    s_nop 1
    v_cndmask_b32 v233, 0, -1, vcc
    v_mov_b32 v237, 0x3f803f80
    v_subrev_u32 v246, 2, v17
    v_cmp_gt_u32 vcc, 8, v246
    s_nop 1
    v_cndmask_b32 v218, v16, 0, vcc
    v_subrev_u32 v247, s22, v246
    v_cmp_gt_i32 vcc, -8, v247
    v_lshl_add_u32 v247, v15, 2, 2
    v_cmp_gt_u32 s[40:41], s23, v247
    s_nop 0
    s_and_b64 vcc, vcc, s[40:41]
    v_cndmask_b32 v226, v16, 0, vcc
    v_cmp_gt_u32 vcc, 9, v247
    s_nop 1
    v_cndmask_b32 v230, 0, -1, vcc
    v_subrev_u32 v247, 1, v247
    v_cmp_gt_u32 vcc, 9, v247
    s_nop 1
    v_cndmask_b32 v234, 0, -1, vcc
    v_mov_b32 v238, 0x3f803f80
    v_subrev_u32 v246, 3, v17
    v_cmp_gt_u32 vcc, 8, v246
    s_nop 1
    v_cndmask_b32 v219, v16, 0, vcc
    v_subrev_u32 v247, s22, v246
    v_cmp_gt_i32 vcc, -8, v247
    v_lshl_add_u32 v247, v15, 2, 3
    v_cmp_gt_u32 s[40:41], s23, v247
    s_nop 0
    s_and_b64 vcc, vcc, s[40:41]
    v_cndmask_b32 v227, v16, 0, vcc
    v_cmp_gt_u32 vcc, 9, v247
    s_nop 1
    v_cndmask_b32 v231, 0, -1, vcc
    v_subrev_u32 v247, 1, v247
    v_cmp_gt_u32 vcc, 9, v247
    s_nop 1
    v_cndmask_b32 v235, 0, -1, vcc
    v_mov_b32 v239, 0x3f803f80
    v_lshlrev_b32 v246, 1, v14
    v_add_u32 v246, s28, v246
    v_lshrrev_b32 v247, 4, v246
    v_mul_u32_u24 v247, 2304, v247
    v_and_b32 v246, 15, v246
    v_lshl_add_u32 v247, v246, 4, v247
    s_mul_i32 s22, s27, 4608
    s_add_u32 s22, s22, 122880
    v_add_u32 v247, s22, v247
    v_lshrrev_b32 v246, 1, v15
    v_lshl_add_u32 v244, v246, 8, v247
    v_and_b32 v246, 1, v15
    v_lshl_add_u32 v244, v246, 3, v244
    v_add_u32 v16, 1, v15
    v_lshrrev_b32 v246, 1, v16
    v_lshl_add_u32 v245, v246, 8, v247
    v_and_b32 v246, 1, v16
    v_lshl_add_u32 v245, v246, 3, v245
    s_add_u32 m0, s37, 46080
    s_add_u32 s38, s34, 1152
    buffer_load_dwordx4 v4, s[12:15], s38 offen lds
    s_add_u32 m0, s37, 48128
    s_add_u32 s38, s34, 38016
    buffer_load_dwordx4 v4, s[12:15], s38 offen lds
    s_add_u32 m0, s24, 39936
    s_nop 0
    buffer_load_dwordx4 v6, s[16:19], s25 offen lds
    s_add_u32 m0, s24, 41984
    s_nop 0
    buffer_load_dwordx4 v7, s[16:19], s25 offen lds
    s_add_u32 m0, s24, 44032
    s_nop 0
    buffer_load_dwordx4 v8, s[16:19], s25 offen lds
    s_add_u32 m0, s24, 46080
    s_nop 0
    buffer_load_dwordx4 v9, s[16:19], s25 offen lds
    s_add_u32 m0, s24, 48128
    s_nop 0
    buffer_load_dwordx4 v10, s[16:19], s25 offen lds
    s_add_u32 m0, s24, 50176
    s_nop 0
    buffer_load_dwordx4 v11, s[16:19], s25 offen lds
    s_add_u32 m0, s24, 52224
    s_nop 0
    buffer_load_dwordx4 v12, s[16:19], s25 offen lds
    s_mov_b32 m0, 78848
    s_nop 0
    buffer_load_dwordx4 v13, s[16:19], s25 offen lds
    s_add_u32 s25, s25, 221184
    s_add_u32 s34, s34, 128
    s_cmp_ge_u32 s34, 1152
    s_cselect_b32 s34, 0, s34
    s_cselect_b32 s25, s26, s25
    s_waitcnt vmcnt(10)
    s_barrier
    ds_read_b128 a[0:3], v26
    ds_read_b128 a[4:7], v32
    ds_read_b128 v[144:147], v20
    ds_read_b64_tr_b16 a[8:9], v38 offset:0
    ds_read_b64_tr_b16 a[10:11], v38 offset:1792
    ds_read_b64_tr_b16 a[12:13], v38 offset:32
    ds_read_b64_tr_b16 a[14:15], v38 offset:1824
    ds_read_b64_tr_b16 a[16:17], v38 offset:64
    ds_read_b64_tr_b16 a[18:19], v38 offset:1856
    ds_read_b64_tr_b16 a[20:21], v38 offset:96
    ds_read_b64_tr_b16 a[22:23], v38 offset:1888
    ds_read_b64_tr_b16 a[24:25], v38 offset:128
    ds_read_b64_tr_b16 a[26:27], v38 offset:1920
    ds_read_b64_tr_b16 a[28:29], v38 offset:160
    ds_read_b64_tr_b16 a[30:31], v38 offset:1952
    ds_read_b64_tr_b16 v[200:201], v38 offset:192
    ds_read_b64_tr_b16 v[202:203], v38 offset:1984
    ds_read_b128 a[32:35], v27
    ds_read_b128 a[36:39], v33
    ds_read_b128 v[148:151], v21
    ds_read_b64_tr_b16 a[40:41], v38 offset:14464
    ds_read_b64_tr_b16 a[42:43], v38 offset:16256
    ds_read_b64_tr_b16 a[44:45], v38 offset:14496
    ds_read_b64_tr_b16 a[46:47], v38 offset:16288
    ds_read_b64_tr_b16 a[48:49], v38 offset:14528
    ds_read_b64_tr_b16 a[50:51], v38 offset:16320
    ds_read_b64_tr_b16 a[52:53], v38 offset:14560
    ds_read_b64_tr_b16 a[54:55], v38 offset:16352
    ds_read_b64_tr_b16 a[56:57], v38 offset:14592
    ds_read_b64_tr_b16 a[58:59], v38 offset:16384
    ds_read_b64_tr_b16 a[60:61], v38 offset:14624
    ds_read_b64_tr_b16 a[62:63], v38 offset:16416
    ds_read_b64_tr_b16 v[204:205], v38 offset:14656
    ds_read_b64_tr_b16 v[206:207], v38 offset:16448
    s_add_u32 m0, s37, 86016
    s_add_u32 s38, s34, 1152
    buffer_load_dwordx4 v4, s[12:15], s38 offen lds
    s_add_u32 m0, s37, 88064
    s_add_u32 s38, s34, 38016
    buffer_load_dwordx4 v4, s[12:15], s38 offen lds
    s_add_u32 m0, s24, 79872
    s_nop 0
    buffer_load_dwordx4 v6, s[16:19], s25 offen lds
    s_add_u32 m0, s24, 81920
    s_nop 0
    buffer_load_dwordx4 v7, s[16:19], s25 offen lds
    s_add_u32 m0, s24, 83968
    s_nop 0
    buffer_load_dwordx4 v8, s[16:19], s25 offen lds
    s_add_u32 m0, s24, 86016
    s_nop 0
    buffer_load_dwordx4 v9, s[16:19], s25 offen lds
    s_add_u32 m0, s24, 88064
    s_nop 0
    buffer_load_dwordx4 v10, s[16:19], s25 offen lds
    s_add_u32 m0, s24, 90112
    s_nop 0
    buffer_load_dwordx4 v11, s[16:19], s25 offen lds
    s_add_u32 m0, s24, 92160
    s_nop 0
    buffer_load_dwordx4 v12, s[16:19], s25 offen lds
    s_mov_b32 m0, 118784
    s_nop 0
    buffer_load_dwordx4 v13, s[16:19], s25 offen lds
    s_add_u32 s25, s25, 221184
    s_add_u32 s34, s34, 128
    s_cmp_ge_u32 s34, 1152
    s_cselect_b32 s34, 0, s34
    s_cselect_b32 s25, s26, s25
    s_waitcnt lgkmcnt(0)
    s_barrier
    s_add_u32 m0, s37, 6144
    s_add_u32 s38, s34, 1152
    buffer_load_dwordx4 v4, s[12:15], s38 offen lds
    s_add_u32 m0, s37, 8192
    s_add_u32 s38, s34, 38016
    buffer_load_dwordx4 v4, s[12:15], s38 offen lds
    s_add_u32 m0, s24, 0
    s_nop 0
    buffer_load_dwordx4 v6, s[16:19], s25 offen lds
    s_add_u32 m0, s24, 2048
    s_nop 0
    buffer_load_dwordx4 v7, s[16:19], s25 offen lds
    s_add_u32 m0, s24, 4096
    s_nop 0
    buffer_load_dwordx4 v8, s[16:19], s25 offen lds
    s_add_u32 m0, s24, 6144
    s_nop 0
    buffer_load_dwordx4 v9, s[16:19], s25 offen lds
    s_add_u32 m0, s24, 8192
    s_nop 0
    buffer_load_dwordx4 v10, s[16:19], s25 offen lds
    s_add_u32 m0, s24, 10240
    s_nop 0
    buffer_load_dwordx4 v11, s[16:19], s25 offen lds
    s_add_u32 m0, s24, 12288
    s_nop 0
    buffer_load_dwordx4 v12, s[16:19], s25 offen lds
    s_mov_b32 m0, 38912
    s_nop 0
    buffer_load_dwordx4 v13, s[16:19], s25 offen lds
    s_add_u32 s25, s25, 221184
    s_add_u32 s34, s34, 128
    s_cmp_ge_u32 s34, 1152
    s_cselect_b32 s34, 0, s34
    s_cselect_b32 s25, s26, s25
    v_lshlrev_b32 v188, 2, v2
    s_lshl_b32 s22, s2, 7
    s_add_u32 s22, s22, 0x2c00000
    s_add_u32 s23, s22, 0x10000
    v_min_u32 v188, 124, v188
    buffer_store_dword v3, v188, s[8:11], s22 offen sc1
    buffer_store_dword v3, v188, s[8:11], s23 offen sc1
    s_mul_i32 s42, s4, 0
    s_add_u32 s42, s42, s5
    s_add_u32 m0, s7, 0
    s_nop 0
    buffer_load_dwordx4 v160, s[52:55], s42 offen nt lds
    s_mul_i32 s42, s4, -9216
    s_add_u32 s42, s42, s5
    s_add_u32 s42, s42, 9216
    s_add_u32 m0, s7, 1024
    s_nop 0
    buffer_load_dwordx4 v160, s[56:59], s42 offen nt lds
    s_mul_i32 s42, s4, 55296
    s_add_u32 s42, s42, s5
    s_add_u32 s42, s42, 18432
    s_add_u32 m0, s7, 2048
    s_nop 0
    buffer_load_dwordx4 v160, s[52:55], s42 offen nt lds
    s_mul_i32 s42, s4, 46080
    s_add_u32 s42, s42, s5
    s_add_u32 s42, s42, 27648
    s_add_u32 m0, s7, 3072
    s_nop 0
    buffer_load_dwordx4 v160, s[56:59], s42 offen nt lds
    s_waitcnt vmcnt(26)
    s_barrier
    v_mfma_f32_16x16x32_bf16 v[44:47], a[0:3], a[0:3], 0
    ds_read_b128 a[64:67], v28
    ds_read_b128 a[68:71], v34
    v_mfma_f32_16x16x32_bf16 v[48:51], v[144:147], v[144:147], 0
    ds_read_b128 v[152:155], v22
    ds_read_b64_tr_b16 a[72:73], v39 offset:0
    v_mfma_f32_16x16x32_bf16 v[72:75], a[8:11], a[0:3], 0
    ds_read_b64_tr_b16 a[74:75], v39 offset:1792
    ds_read_b64_tr_b16 a[76:77], v39 offset:32
    v_cndmask_b32 v144, v144, v236, s[30:31]
    v_cndmask_b32 v145, v145, v236, s[30:31]
    v_cndmask_b32 v146, v146, v236, s[30:31]
    v_cndmask_b32 v147, v147, v236, s[30:31]
    v_mfma_f32_16x16x32_bf16 v[76:79], a[8:11], a[4:7], 0
    ds_read_b64_tr_b16 a[78:79], v39 offset:1824
    ds_read_b64_tr_b16 a[80:81], v39 offset:64
    v_cndmask_b32 v200, v200, v236, s[32:33]
    v_cndmask_b32 v201, v201, v236, s[32:33]
    v_cndmask_b32 v202, v202, v236, s[32:33]
    v_cndmask_b32 v203, v203, v236, s[32:33]
    v_mfma_f32_16x16x32_bf16 v[80:83], a[12:15], a[0:3], 0
    ds_read_b64_tr_b16 a[82:83], v39 offset:1856
    ds_read_b64_tr_b16 a[84:85], v39 offset:96
    v_mfma_f32_16x16x32_bf16 v[84:87], a[12:15], a[4:7], 0
    ds_read_b64_tr_b16 a[86:87], v39 offset:1888
    ds_read_b64_tr_b16 a[88:89], v39 offset:128
    v_mfma_f32_16x16x32_bf16 v[88:91], a[16:19], a[0:3], 0
    ds_read_b64_tr_b16 a[90:91], v39 offset:1920
    ds_read_b64_tr_b16 a[92:93], v39 offset:160
    v_mfma_f32_16x16x32_bf16 v[92:95], a[16:19], a[4:7], 0
    ds_read_b64_tr_b16 a[94:95], v39 offset:1952
    ds_read_b64_tr_b16 v[208:209], v39 offset:192
    v_mfma_f32_16x16x32_bf16 v[96:99], a[20:23], a[0:3], 0
    ds_read_b64_tr_b16 v[210:211], v39 offset:1984
    ds_read_b128 a[96:99], v29
    v_mfma_f32_16x16x32_bf16 v[100:103], a[20:23], a[4:7], 0
    ds_read_b128 a[100:103], v35
    ds_read_b128 v[156:159], v23
    v_mfma_f32_16x16x32_bf16 v[104:107], a[24:27], a[0:3], 0
    ds_read_b64_tr_b16 a[104:105], v39 offset:14464
    ds_read_b64_tr_b16 a[106:107], v39 offset:16256
    v_mfma_f32_16x16x32_bf16 v[108:111], a[24:27], a[4:7], 0
    ds_read_b64_tr_b16 a[108:109], v39 offset:14496
    ds_read_b64_tr_b16 a[110:111], v39 offset:16288
    v_mfma_f32_16x16x32_bf16 v[112:115], a[28:31], a[0:3], 0
    ds_read_b64_tr_b16 a[112:113], v39 offset:14528
    ds_read_b64_tr_b16 a[114:115], v39 offset:16320
    v_mfma_f32_16x16x32_bf16 v[116:119], a[28:31], a[4:7], 0
    ds_read_b64_tr_b16 a[116:117], v39 offset:14560
    ds_read_b64_tr_b16 a[118:119], v39 offset:16352
    v_mfma_f32_16x16x32_bf16 v[120:123], v[200:203], a[0:3], 0
    ds_read_b64_tr_b16 a[120:121], v39 offset:14592
    ds_read_b64_tr_b16 a[122:123], v39 offset:16384
    v_mfma_f32_16x16x32_bf16 v[124:127], v[200:203], a[4:7], 0
    ds_read_b64_tr_b16 a[124:125], v39 offset:14624
    ds_read_b64_tr_b16 a[126:127], v39 offset:16416
    v_mfma_f32_16x16x32_bf16 v[128:131], a[24:27], v[144:147], 0
    ds_read_b64_tr_b16 v[212:213], v39 offset:14656
    ds_read_b64_tr_b16 v[214:215], v39 offset:16448
    v_mfma_f32_16x16x32_bf16 v[132:135], a[28:31], v[144:147], 0
    v_mfma_f32_16x16x32_bf16 v[136:139], v[200:203], v[144:147], 0
    s_waitcnt lgkmcnt(0)
    s_barrier
    v_mfma_f32_16x16x32_bf16 v[44:47], a[32:35], a[32:35], v[44:47]
    s_add_u32 m0, s37, 46080
    s_add_u32 s38, s34, 1152
    buffer_load_dwordx4 v4, s[12:15], s38 offen lds
    s_add_u32 m0, s37, 48128
    s_add_u32 s38, s34, 38016
    buffer_load_dwordx4 v4, s[12:15], s38 offen lds
    v_mfma_f32_16x16x32_bf16 v[48:51], v[148:151], v[148:151], v[48:51]
    s_add_u32 m0, s24, 39936
    s_nop 0
    buffer_load_dwordx4 v6, s[16:19], s25 offen lds
    s_add_u32 m0, s24, 41984
    s_nop 0
    buffer_load_dwordx4 v7, s[16:19], s25 offen lds
    v_mfma_f32_16x16x32_bf16 v[72:75], a[40:43], a[32:35], v[72:75]
    s_add_u32 m0, s24, 44032
    s_nop 0
    buffer_load_dwordx4 v8, s[16:19], s25 offen lds
    s_add_u32 m0, s24, 46080
    s_nop 0
    buffer_load_dwordx4 v9, s[16:19], s25 offen lds
    v_cndmask_b32 v148, v148, v236, s[30:31]
    v_cndmask_b32 v149, v149, v236, s[30:31]
    v_cndmask_b32 v150, v150, v236, s[30:31]
    v_cndmask_b32 v151, v151, v236, s[30:31]
    v_mfma_f32_16x16x32_bf16 v[76:79], a[40:43], a[36:39], v[76:79]
    s_add_u32 m0, s24, 48128
    s_nop 0
    buffer_load_dwordx4 v10, s[16:19], s25 offen lds
    s_add_u32 m0, s24, 50176
    s_nop 0
    buffer_load_dwordx4 v11, s[16:19], s25 offen lds
    v_cndmask_b32 v204, v204, v236, s[32:33]
    v_cndmask_b32 v205, v205, v236, s[32:33]
    v_cndmask_b32 v206, v206, v236, s[32:33]
    v_cndmask_b32 v207, v207, v236, s[32:33]
    v_mfma_f32_16x16x32_bf16 v[80:83], a[44:47], a[32:35], v[80:83]
    s_add_u32 m0, s24, 52224
    s_nop 0
    buffer_load_dwordx4 v12, s[16:19], s25 offen lds
    s_mov_b32 m0, 78848
    s_nop 0
    buffer_load_dwordx4 v13, s[16:19], s25 offen lds
    s_add_u32 s25, s25, 221184
    s_add_u32 s34, s34, 128
    s_cmp_ge_u32 s34, 1152
    s_cselect_b32 s34, 0, s34
    s_cselect_b32 s25, s26, s25
    v_mfma_f32_16x16x32_bf16 v[84:87], a[44:47], a[36:39], v[84:87]
    s_mul_i32 s42, s4, 110592
    s_add_u32 s42, s42, s5
    s_add_u32 s42, s42, 36864
    s_add_u32 m0, s7, 4096
    s_nop 0
    buffer_load_dwordx4 v160, s[52:55], s42 offen nt lds
    s_mul_i32 s42, s4, 101376
    s_add_u32 s42, s42, s5
    s_add_u32 s42, s42, 46080
    s_add_u32 m0, s7, 5120
    s_nop 0
    buffer_load_dwordx4 v160, s[56:59], s42 offen nt lds
    v_mfma_f32_16x16x32_bf16 v[88:91], a[48:51], a[32:35], v[88:91]
    v_mfma_f32_16x16x32_bf16 v[92:95], a[48:51], a[36:39], v[92:95]
    v_mfma_f32_16x16x32_bf16 v[96:99], a[52:55], a[32:35], v[96:99]
    v_mfma_f32_16x16x32_bf16 v[100:103], a[52:55], a[36:39], v[100:103]
    v_mfma_f32_16x16x32_bf16 v[104:107], a[56:59], a[32:35], v[104:107]
    v_mfma_f32_16x16x32_bf16 v[108:111], a[56:59], a[36:39], v[108:111]
    v_mfma_f32_16x16x32_bf16 v[112:115], a[60:63], a[32:35], v[112:115]
    v_mfma_f32_16x16x32_bf16 v[116:119], a[60:63], a[36:39], v[116:119]
    v_mfma_f32_16x16x32_bf16 v[120:123], v[204:207], a[32:35], v[120:123]
    v_mfma_f32_16x16x32_bf16 v[124:127], v[204:207], a[36:39], v[124:127]
    v_mfma_f32_16x16x32_bf16 v[128:131], a[56:59], v[148:151], v[128:131]
    v_mfma_f32_16x16x32_bf16 v[132:135], a[60:63], v[148:151], v[132:135]
    v_mfma_f32_16x16x32_bf16 v[136:139], v[204:207], v[148:151], v[136:139]
    s_waitcnt vmcnt(28)
    s_barrier
    v_mfma_f32_16x16x32_bf16 v[44:47], a[64:67], a[64:67], v[44:47]
    ds_read_b128 a[0:3], v30
    ds_read_b128 a[4:7], v36
    v_mfma_f32_16x16x32_bf16 v[48:51], v[152:155], v[152:155], v[48:51]
    ds_read_b128 v[144:147], v24
    ds_read_b64_tr_b16 a[8:9], v40 offset:0
    v_mfma_f32_16x16x32_bf16 v[72:75], a[72:75], a[64:67], v[72:75]
    ds_read_b64_tr_b16 a[10:11], v40 offset:1792
    ds_read_b64_tr_b16 a[12:13], v40 offset:32
    v_cndmask_b32 v152, v152, v236, s[30:31]
    v_cndmask_b32 v153, v153, v236, s[30:31]
    v_cndmask_b32 v154, v154, v236, s[30:31]
    v_cndmask_b32 v155, v155, v236, s[30:31]
    v_mfma_f32_16x16x32_bf16 v[76:79], a[72:75], a[68:71], v[76:79]
    ds_read_b64_tr_b16 a[14:15], v40 offset:1824
    ds_read_b64_tr_b16 a[16:17], v40 offset:64
    v_cndmask_b32 v208, v208, v236, s[32:33]
    v_cndmask_b32 v209, v209, v236, s[32:33]
    v_cndmask_b32 v210, v210, v236, s[32:33]
    v_cndmask_b32 v211, v211, v236, s[32:33]
    v_mfma_f32_16x16x32_bf16 v[80:83], a[76:79], a[64:67], v[80:83]
    ds_read_b64_tr_b16 a[18:19], v40 offset:1856
    ds_read_b64_tr_b16 a[20:21], v40 offset:96
    v_mfma_f32_16x16x32_bf16 v[84:87], a[76:79], a[68:71], v[84:87]
    ds_read_b64_tr_b16 a[22:23], v40 offset:1888
    ds_read_b64_tr_b16 a[24:25], v40 offset:128
    v_mfma_f32_16x16x32_bf16 v[88:91], a[80:83], a[64:67], v[88:91]
    ds_read_b64_tr_b16 a[26:27], v40 offset:1920
    ds_read_b64_tr_b16 a[28:29], v40 offset:160
    v_mfma_f32_16x16x32_bf16 v[92:95], a[80:83], a[68:71], v[92:95]
    ds_read_b64_tr_b16 a[30:31], v40 offset:1952
    ds_read_b64_tr_b16 v[200:201], v40 offset:192
    v_mfma_f32_16x16x32_bf16 v[96:99], a[84:87], a[64:67], v[96:99]
    ds_read_b64_tr_b16 v[202:203], v40 offset:1984
    ds_read_b128 a[32:35], v31
    v_mfma_f32_16x16x32_bf16 v[100:103], a[84:87], a[68:71], v[100:103]
    ds_read_b128 a[36:39], v37
    ds_read_b128 v[148:151], v25
    v_mfma_f32_16x16x32_bf16 v[104:107], a[88:91], a[64:67], v[104:107]
    ds_read_b64_tr_b16 a[40:41], v40 offset:14464
    ds_read_b64_tr_b16 a[42:43], v40 offset:16256
    v_mfma_f32_16x16x32_bf16 v[108:111], a[88:91], a[68:71], v[108:111]
    ds_read_b64_tr_b16 a[44:45], v40 offset:14496
    ds_read_b64_tr_b16 a[46:47], v40 offset:16288
    v_mfma_f32_16x16x32_bf16 v[112:115], a[92:95], a[64:67], v[112:115]
    ds_read_b64_tr_b16 a[48:49], v40 offset:14528
    ds_read_b64_tr_b16 a[50:51], v40 offset:16320
    v_mfma_f32_16x16x32_bf16 v[116:119], a[92:95], a[68:71], v[116:119]
    ds_read_b64_tr_b16 a[52:53], v40 offset:14560
    ds_read_b64_tr_b16 a[54:55], v40 offset:16352
    v_mfma_f32_16x16x32_bf16 v[120:123], v[208:211], a[64:67], v[120:123]
    ds_read_b64_tr_b16 a[56:57], v40 offset:14592
    ds_read_b64_tr_b16 a[58:59], v40 offset:16384
    v_mfma_f32_16x16x32_bf16 v[124:127], v[208:211], a[68:71], v[124:127]
    ds_read_b64_tr_b16 a[60:61], v40 offset:14624
    ds_read_b64_tr_b16 a[62:63], v40 offset:16416
    v_mfma_f32_16x16x32_bf16 v[128:131], a[88:91], v[152:155], v[128:131]
    ds_read_b64_tr_b16 v[204:205], v40 offset:14656
    ds_read_b64_tr_b16 v[206:207], v40 offset:16448
    v_mfma_f32_16x16x32_bf16 v[132:135], a[92:95], v[152:155], v[132:135]
    s_waitcnt vmcnt(15)
    ds_read_b64_tr_b16 v[168:169], v161 offset:0
    ds_read_b64_tr_b16 v[170:171], v161 offset:512
    s_waitcnt vmcnt(14)
    ds_read_b64_tr_b16 v[172:173], v161 offset:1024
    ds_read_b64_tr_b16 v[174:175], v161 offset:1536
    v_mfma_f32_16x16x32_bf16 v[136:139], v[208:211], v[152:155], v[136:139]
    s_waitcnt lgkmcnt(0)
    s_barrier
    v_mfma_f32_16x16x32_bf16 v[44:47], a[96:99], a[96:99], v[44:47]
    s_add_u32 m0, s37, 86016
    s_add_u32 s38, s34, 1152
    buffer_load_dwordx4 v4, s[12:15], s38 offen lds
    s_add_u32 m0, s37, 88064
    s_add_u32 s38, s34, 38016
    buffer_load_dwordx4 v4, s[12:15], s38 offen lds
    v_mfma_f32_16x16x32_bf16 v[48:51], v[156:159], v[156:159], v[48:51]
    s_add_u32 m0, s24, 79872
    s_nop 0
    buffer_load_dwordx4 v6, s[16:19], s25 offen lds
    s_add_u32 m0, s24, 81920
    s_nop 0
    buffer_load_dwordx4 v7, s[16:19], s25 offen lds
    v_mfma_f32_16x16x32_bf16 v[72:75], a[104:107], a[96:99], v[72:75]
    s_add_u32 m0, s24, 83968
    s_nop 0
    buffer_load_dwordx4 v8, s[16:19], s25 offen lds
    s_add_u32 m0, s24, 86016
    s_nop 0
    buffer_load_dwordx4 v9, s[16:19], s25 offen lds
    v_cndmask_b32 v156, v156, v236, s[30:31]
    v_cndmask_b32 v157, v157, v236, s[30:31]
    v_cndmask_b32 v158, v158, v236, s[30:31]
    v_cndmask_b32 v159, v159, v236, s[30:31]
    v_mfma_f32_16x16x32_bf16 v[76:79], a[104:107], a[100:103], v[76:79]
    s_add_u32 m0, s24, 88064
    s_nop 0
    buffer_load_dwordx4 v10, s[16:19], s25 offen lds
    s_add_u32 m0, s24, 90112
    s_nop 0
    buffer_load_dwordx4 v11, s[16:19], s25 offen lds
    v_cndmask_b32 v212, v212, v236, s[32:33]
    v_cndmask_b32 v213, v213, v236, s[32:33]
    v_cndmask_b32 v214, v214, v236, s[32:33]
    v_cndmask_b32 v215, v215, v236, s[32:33]
    v_mfma_f32_16x16x32_bf16 v[80:83], a[108:111], a[96:99], v[80:83]
    s_add_u32 m0, s24, 92160
    s_nop 0
    buffer_load_dwordx4 v12, s[16:19], s25 offen lds
    s_mov_b32 m0, 118784
    s_nop 0
    buffer_load_dwordx4 v13, s[16:19], s25 offen lds
    s_add_u32 s25, s25, 221184
    s_add_u32 s34, s34, 128
    s_cmp_ge_u32 s34, 1152
    s_cselect_b32 s34, 0, s34
    s_cselect_b32 s25, s26, s25
    v_mfma_f32_16x16x32_bf16 v[84:87], a[108:111], a[100:103], v[84:87]
    v_dot2c_f32_bf16 v164, v168, v166
    v_dot2c_f32_bf16 v164, v169, v166
    v_dot2c_f32_bf16 v164, v170, v166
    v_dot2c_f32_bf16 v164, v171, v166
    v_accvgpr_write_b32 a128, v168
    v_accvgpr_write_b32 a129, v169
    v_accvgpr_write_b32 a130, v170
    v_accvgpr_write_b32 a131, v171
    v_dot2c_f32_bf16 v165, v172, v166
    v_dot2c_f32_bf16 v165, v173, v166
    v_dot2c_f32_bf16 v165, v174, v166
    v_dot2c_f32_bf16 v165, v175, v166
    v_accvgpr_write_b32 a132, v172
    v_accvgpr_write_b32 a133, v173
    v_accvgpr_write_b32 a134, v174
    v_accvgpr_write_b32 a135, v175
    v_mfma_f32_16x16x32_bf16 v[88:91], a[112:115], a[96:99], v[88:91]
    s_mul_i32 s42, s4, 165888
    s_add_u32 s42, s42, s5
    s_add_u32 s42, s42, 55296
    s_add_u32 m0, s7, 0
    s_nop 0
    buffer_load_dwordx4 v160, s[52:55], s42 offen nt lds
    s_mul_i32 s42, s4, 156672
    s_add_u32 s42, s42, s5
    s_add_u32 s42, s42, 64512
    s_add_u32 m0, s7, 1024
    s_nop 0
    buffer_load_dwordx4 v160, s[56:59], s42 offen nt lds
    v_mfma_f32_16x16x32_bf16 v[92:95], a[112:115], a[100:103], v[92:95]
    v_mfma_f32_16x16x32_bf16 v[96:99], a[116:119], a[96:99], v[96:99]
    v_mfma_f32_16x16x32_bf16 v[100:103], a[116:119], a[100:103], v[100:103]
    v_mfma_f32_16x16x32_bf16 v[104:107], a[120:123], a[96:99], v[104:107]
    v_mfma_f32_16x16x32_bf16 v[108:111], a[120:123], a[100:103], v[108:111]
    v_mfma_f32_16x16x32_bf16 v[112:115], a[124:127], a[96:99], v[112:115]
    v_mfma_f32_16x16x32_bf16 v[116:119], a[124:127], a[100:103], v[116:119]
    v_mfma_f32_16x16x32_bf16 v[120:123], v[212:215], a[96:99], v[120:123]
    v_mfma_f32_16x16x32_bf16 v[124:127], v[212:215], a[100:103], v[124:127]
    v_mfma_f32_16x16x32_bf16 v[128:131], a[120:123], v[156:159], v[128:131]
    v_mfma_f32_16x16x32_bf16 v[132:135], a[124:127], v[156:159], v[132:135]
    v_mfma_f32_16x16x32_bf16 v[136:139], v[212:215], v[156:159], v[136:139]
    s_barrier
    v_mfma_f32_16x16x32_bf16 v[44:47], a[0:3], a[0:3], v[44:47]
    ds_read_b128 a[64:67], v26
    ds_read_b128 a[68:71], v32
    v_mfma_f32_16x16x32_bf16 v[48:51], v[144:147], v[144:147], v[48:51]
    ds_read_b128 v[152:155], v20
    ds_read_b64_tr_b16 a[72:73], v38 offset:0
    v_mfma_f32_16x16x32_bf16 v[72:75], a[8:11], a[0:3], v[72:75]
    ds_read_b64_tr_b16 a[74:75], v38 offset:1792
    ds_read_b64_tr_b16 a[76:77], v38 offset:32
    v_cndmask_b32 v144, v144, v236, s[30:31]
    v_cndmask_b32 v145, v145, v236, s[30:31]
    v_cndmask_b32 v146, v146, v236, s[30:31]
    v_cndmask_b32 v147, v147, v236, s[30:31]
    v_mfma_f32_16x16x32_bf16 v[76:79], a[8:11], a[4:7], v[76:79]
    ds_read_b64_tr_b16 a[78:79], v38 offset:1824
    ds_read_b64_tr_b16 a[80:81], v38 offset:64
    v_cndmask_b32 v200, v200, v236, s[32:33]
    v_cndmask_b32 v201, v201, v236, s[32:33]
    v_cndmask_b32 v202, v202, v236, s[32:33]
    v_cndmask_b32 v203, v203, v236, s[32:33]
    v_mfma_f32_16x16x32_bf16 v[80:83], a[12:15], a[0:3], v[80:83]
    ds_read_b64_tr_b16 a[82:83], v38 offset:1856
    ds_read_b64_tr_b16 a[84:85], v38 offset:96
    v_mfma_f32_16x16x32_bf16 v[84:87], a[12:15], a[4:7], v[84:87]
    ds_read_b64_tr_b16 a[86:87], v38 offset:1888
    ds_read_b64_tr_b16 a[88:89], v38 offset:128
    v_mfma_f32_16x16x32_bf16 v[88:91], a[16:19], a[0:3], v[88:91]
    ds_read_b64_tr_b16 a[90:91], v38 offset:1920
    ds_read_b64_tr_b16 a[92:93], v38 offset:160
    v_mfma_f32_16x16x32_bf16 v[92:95], a[16:19], a[4:7], v[92:95]
    ds_read_b64_tr_b16 a[94:95], v38 offset:1952
    ds_read_b64_tr_b16 v[208:209], v38 offset:192
    v_mfma_f32_16x16x32_bf16 v[96:99], a[20:23], a[0:3], v[96:99]
    ds_read_b64_tr_b16 v[210:211], v38 offset:1984
    ds_read_b128 a[96:99], v27
    v_mfma_f32_16x16x32_bf16 v[100:103], a[20:23], a[4:7], v[100:103]
    ds_read_b128 a[100:103], v33
    ds_read_b128 v[156:159], v21
    v_mfma_f32_16x16x32_bf16 v[104:107], a[24:27], a[0:3], v[104:107]
    ds_read_b64_tr_b16 a[104:105], v38 offset:14464
    ds_read_b64_tr_b16 a[106:107], v38 offset:16256
    v_mfma_f32_16x16x32_bf16 v[108:111], a[24:27], a[4:7], v[108:111]
    ds_read_b64_tr_b16 a[108:109], v38 offset:14496
    ds_read_b64_tr_b16 a[110:111], v38 offset:16288
    v_mfma_f32_16x16x32_bf16 v[112:115], a[28:31], a[0:3], v[112:115]
    ds_read_b64_tr_b16 a[112:113], v38 offset:14528
    ds_read_b64_tr_b16 a[114:115], v38 offset:16320
    v_mfma_f32_16x16x32_bf16 v[116:119], a[28:31], a[4:7], v[116:119]
    ds_read_b64_tr_b16 a[116:117], v38 offset:14560
    ds_read_b64_tr_b16 a[118:119], v38 offset:16352
    v_mfma_f32_16x16x32_bf16 v[120:123], v[200:203], a[0:3], v[120:123]
    ds_read_b64_tr_b16 a[120:121], v38 offset:14592
    ds_read_b64_tr_b16 a[122:123], v38 offset:16384
    v_mfma_f32_16x16x32_bf16 v[124:127], v[200:203], a[4:7], v[124:127]
    ds_read_b64_tr_b16 a[124:125], v38 offset:14624
    ds_read_b64_tr_b16 a[126:127], v38 offset:16416
    v_mfma_f32_16x16x32_bf16 v[128:131], a[24:27], v[144:147], v[128:131]
    ds_read_b64_tr_b16 v[212:213], v38 offset:14656
    ds_read_b64_tr_b16 v[214:215], v38 offset:16448
    v_mfma_f32_16x16x32_bf16 v[132:135], a[28:31], v[144:147], v[132:135]
    s_waitcnt vmcnt(25)
    ds_read_b64_tr_b16 v[176:177], v161 offset:2048
    ds_read_b64_tr_b16 v[178:179], v161 offset:2560
    s_waitcnt vmcnt(24)
    ds_read_b64_tr_b16 v[180:181], v161 offset:3072
    ds_read_b64_tr_b16 v[182:183], v161 offset:3584
    v_mfma_f32_16x16x32_bf16 v[136:139], v[200:203], v[144:147], v[136:139]
    s_waitcnt lgkmcnt(0)
    s_barrier
    v_mfma_f32_16x16x32_bf16 v[44:47], a[32:35], a[32:35], v[44:47]
    s_add_u32 m0, s37, 6144
    s_add_u32 s38, s34, 1152
    buffer_load_dwordx4 v4, s[12:15], s38 offen lds
    s_add_u32 m0, s37, 8192
    s_add_u32 s38, s34, 38016
    buffer_load_dwordx4 v4, s[12:15], s38 offen lds
    v_mfma_f32_16x16x32_bf16 v[48:51], v[148:151], v[148:151], v[48:51]
    s_add_u32 m0, s24, 0
    s_nop 0
    buffer_load_dwordx4 v6, s[16:19], s25 offen lds
    s_add_u32 m0, s24, 2048
    s_nop 0
    buffer_load_dwordx4 v7, s[16:19], s25 offen lds
    v_mfma_f32_16x16x32_bf16 v[72:75], a[40:43], a[32:35], v[72:75]
    s_add_u32 m0, s24, 4096
    s_nop 0
    buffer_load_dwordx4 v8, s[16:19], s25 offen lds
    s_add_u32 m0, s24, 6144
    s_nop 0
    buffer_load_dwordx4 v9, s[16:19], s25 offen lds
    v_cndmask_b32 v148, v148, v236, s[30:31]
    v_cndmask_b32 v149, v149, v236, s[30:31]
    v_cndmask_b32 v150, v150, v236, s[30:31]
    v_cndmask_b32 v151, v151, v236, s[30:31]
    v_mfma_f32_16x16x32_bf16 v[76:79], a[40:43], a[36:39], v[76:79]
    s_add_u32 m0, s24, 8192
    s_nop 0
    buffer_load_dwordx4 v10, s[16:19], s25 offen lds
    s_add_u32 m0, s24, 10240
    s_nop 0
    buffer_load_dwordx4 v11, s[16:19], s25 offen lds
    v_cndmask_b32 v204, v204, v236, s[32:33]
    v_cndmask_b32 v205, v205, v236, s[32:33]
    v_cndmask_b32 v206, v206, v236, s[32:33]
    v_cndmask_b32 v207, v207, v236, s[32:33]
    v_mfma_f32_16x16x32_bf16 v[80:83], a[44:47], a[32:35], v[80:83]
    s_add_u32 m0, s24, 12288
    s_nop 0
    buffer_load_dwordx4 v12, s[16:19], s25 offen lds
    s_mov_b32 m0, 38912
    s_nop 0
    buffer_load_dwordx4 v13, s[16:19], s25 offen lds
    s_add_u32 s25, s25, 221184
    s_add_u32 s34, s34, 128
    s_cmp_ge_u32 s34, 1152
    s_cselect_b32 s34, 0, s34
    s_cselect_b32 s25, s26, s25
    v_mfma_f32_16x16x32_bf16 v[84:87], a[44:47], a[36:39], v[84:87]
    v_dot2c_f32_bf16 v164, v176, v166
    v_dot2c_f32_bf16 v164, v177, v166
    v_dot2c_f32_bf16 v164, v178, v166
    v_dot2c_f32_bf16 v164, v179, v166
    v_accvgpr_write_b32 a136, v176
    v_accvgpr_write_b32 a137, v177
    v_accvgpr_write_b32 a138, v178
    v_accvgpr_write_b32 a139, v179
    v_dot2c_f32_bf16 v165, v180, v166
    v_dot2c_f32_bf16 v165, v181, v166
    v_dot2c_f32_bf16 v165, v182, v166
    v_dot2c_f32_bf16 v165, v183, v166
    v_accvgpr_write_b32 a140, v180
    v_accvgpr_write_b32 a141, v181
    v_accvgpr_write_b32 a142, v182
    v_accvgpr_write_b32 a143, v183
    v_mfma_f32_16x16x32_bf16 v[88:91], a[48:51], a[32:35], v[88:91]
    s_mul_i32 s42, s4, 221184
    s_add_u32 s42, s42, s5
    s_add_u32 s42, s42, 73728
    s_add_u32 m0, s7, 2048
    s_nop 0
    buffer_load_dwordx4 v160, s[52:55], s42 offen nt lds
    s_mul_i32 s42, s4, 211968
    s_add_u32 s42, s42, s5
    s_add_u32 s42, s42, 82944
    s_add_u32 m0, s7, 3072
    s_nop 0
    buffer_load_dwordx4 v160, s[56:59], s42 offen nt lds
    v_mfma_f32_16x16x32_bf16 v[92:95], a[48:51], a[36:39], v[92:95]
    v_mfma_f32_16x16x32_bf16 v[96:99], a[52:55], a[32:35], v[96:99]
    v_mfma_f32_16x16x32_bf16 v[100:103], a[52:55], a[36:39], v[100:103]
    v_mfma_f32_16x16x32_bf16 v[104:107], a[56:59], a[32:35], v[104:107]
    v_mfma_f32_16x16x32_bf16 v[108:111], a[56:59], a[36:39], v[108:111]
    v_mfma_f32_16x16x32_bf16 v[112:115], a[60:63], a[32:35], v[112:115]
    v_mfma_f32_16x16x32_bf16 v[116:119], a[60:63], a[36:39], v[116:119]
    v_mfma_f32_16x16x32_bf16 v[120:123], v[204:207], a[32:35], v[120:123]
    v_mfma_f32_16x16x32_bf16 v[124:127], v[204:207], a[36:39], v[124:127]
    v_mfma_f32_16x16x32_bf16 v[128:131], a[56:59], v[148:151], v[128:131]
    v_mfma_f32_16x16x32_bf16 v[132:135], a[60:63], v[148:151], v[132:135]
    v_mfma_f32_16x16x32_bf16 v[136:139], v[204:207], v[148:151], v[136:139]
    s_waitcnt vmcnt(26)
    s_barrier
    v_mfma_f32_16x16x32_bf16 v[44:47], a[64:67], a[64:67], v[44:47]
    ds_read_b128 a[0:3], v28
    ds_read_b128 a[4:7], v34
    v_mfma_f32_16x16x32_bf16 v[48:51], v[152:155], v[152:155], v[48:51]
    ds_read_b128 v[144:147], v22
    ds_read_b64_tr_b16 a[8:9], v39 offset:0
    v_mfma_f32_16x16x32_bf16 v[72:75], a[72:75], a[64:67], v[72:75]
    ds_read_b64_tr_b16 a[10:11], v39 offset:1792
    ds_read_b64_tr_b16 a[12:13], v39 offset:32
    v_cndmask_b32 v152, v152, v236, s[30:31]
    v_cndmask_b32 v153, v153, v236, s[30:31]
    v_cndmask_b32 v154, v154, v236, s[30:31]
    v_cndmask_b32 v155, v155, v236, s[30:31]
    v_mfma_f32_16x16x32_bf16 v[76:79], a[72:75], a[68:71], v[76:79]
    ds_read_b64_tr_b16 a[14:15], v39 offset:1824
    ds_read_b64_tr_b16 a[16:17], v39 offset:64
    v_cndmask_b32 v208, v208, v236, s[32:33]
    v_cndmask_b32 v209, v209, v236, s[32:33]
    v_cndmask_b32 v210, v210, v236, s[32:33]
    v_cndmask_b32 v211, v211, v236, s[32:33]
    v_mfma_f32_16x16x32_bf16 v[80:83], a[76:79], a[64:67], v[80:83]
    ds_read_b64_tr_b16 a[18:19], v39 offset:1856
    ds_read_b64_tr_b16 a[20:21], v39 offset:96
    v_mfma_f32_16x16x32_bf16 v[84:87], a[76:79], a[68:71], v[84:87]
    ds_read_b64_tr_b16 a[22:23], v39 offset:1888
    ds_read_b64_tr_b16 a[24:25], v39 offset:128
    v_mfma_f32_16x16x32_bf16 v[88:91], a[80:83], a[64:67], v[88:91]
    ds_read_b64_tr_b16 a[26:27], v39 offset:1920
    ds_read_b64_tr_b16 a[28:29], v39 offset:160
    v_mfma_f32_16x16x32_bf16 v[92:95], a[80:83], a[68:71], v[92:95]
    ds_read_b64_tr_b16 a[30:31], v39 offset:1952
    ds_read_b64_tr_b16 v[200:201], v39 offset:192
    v_mfma_f32_16x16x32_bf16 v[96:99], a[84:87], a[64:67], v[96:99]
    ds_read_b64_tr_b16 v[202:203], v39 offset:1984
    ds_read_b128 a[32:35], v29
    v_mfma_f32_16x16x32_bf16 v[100:103], a[84:87], a[68:71], v[100:103]
    ds_read_b128 a[36:39], v35
    ds_read_b128 v[148:151], v23
    v_mfma_f32_16x16x32_bf16 v[104:107], a[88:91], a[64:67], v[104:107]
    ds_read_b64_tr_b16 a[40:41], v39 offset:14464
    ds_read_b64_tr_b16 a[42:43], v39 offset:16256
    v_mfma_f32_16x16x32_bf16 v[108:111], a[88:91], a[68:71], v[108:111]
    ds_read_b64_tr_b16 a[44:45], v39 offset:14496
    ds_read_b64_tr_b16 a[46:47], v39 offset:16288
    v_mfma_f32_16x16x32_bf16 v[112:115], a[92:95], a[64:67], v[112:115]
    ds_read_b64_tr_b16 a[48:49], v39 offset:14528
    ds_read_b64_tr_b16 a[50:51], v39 offset:16320
    v_mfma_f32_16x16x32_bf16 v[116:119], a[92:95], a[68:71], v[116:119]
    ds_read_b64_tr_b16 a[52:53], v39 offset:14560
    ds_read_b64_tr_b16 a[54:55], v39 offset:16352
    v_mfma_f32_16x16x32_bf16 v[120:123], v[208:211], a[64:67], v[120:123]
    ds_read_b64_tr_b16 a[56:57], v39 offset:14592
    ds_read_b64_tr_b16 a[58:59], v39 offset:16384
    v_mfma_f32_16x16x32_bf16 v[124:127], v[208:211], a[68:71], v[124:127]
    ds_read_b64_tr_b16 a[60:61], v39 offset:14624
    ds_read_b64_tr_b16 a[62:63], v39 offset:16416
    v_mfma_f32_16x16x32_bf16 v[128:131], a[88:91], v[152:155], v[128:131]
    ds_read_b64_tr_b16 v[204:205], v39 offset:14656
    ds_read_b64_tr_b16 v[206:207], v39 offset:16448
    v_mfma_f32_16x16x32_bf16 v[132:135], a[92:95], v[152:155], v[132:135]
    s_waitcnt vmcnt(25)
    ds_read_b64_tr_b16 v[168:169], v161 offset:4096
    ds_read_b64_tr_b16 v[170:171], v161 offset:4608
    s_waitcnt vmcnt(24)
    ds_read_b64_tr_b16 v[172:173], v161 offset:5120
    ds_read_b64_tr_b16 v[174:175], v161 offset:5632
    v_mfma_f32_16x16x32_bf16 v[136:139], v[208:211], v[152:155], v[136:139]
    s_waitcnt lgkmcnt(0)
    s_barrier
    v_mfma_f32_16x16x32_bf16 v[44:47], a[96:99], a[96:99], v[44:47]
    s_add_u32 m0, s37, 46080
    s_add_u32 s38, s34, 1152
    buffer_load_dwordx4 v4, s[12:15], s38 offen lds
    s_add_u32 m0, s37, 48128
    s_add_u32 s38, s34, 38016
    buffer_load_dwordx4 v4, s[12:15], s38 offen lds
    v_mfma_f32_16x16x32_bf16 v[48:51], v[156:159], v[156:159], v[48:51]
    s_add_u32 m0, s24, 39936
    s_nop 0
    buffer_load_dwordx4 v6, s[16:19], s25 offen lds
    s_add_u32 m0, s24, 41984
    s_nop 0
    buffer_load_dwordx4 v7, s[16:19], s25 offen lds
    v_mfma_f32_16x16x32_bf16 v[72:75], a[104:107], a[96:99], v[72:75]
    s_add_u32 m0, s24, 44032
    s_nop 0
    buffer_load_dwordx4 v8, s[16:19], s25 offen lds
    s_add_u32 m0, s24, 46080
    s_nop 0
    buffer_load_dwordx4 v9, s[16:19], s25 offen lds
    v_cndmask_b32 v156, v156, v236, s[30:31]
    v_cndmask_b32 v157, v157, v236, s[30:31]
    v_cndmask_b32 v158, v158, v236, s[30:31]
    v_cndmask_b32 v159, v159, v236, s[30:31]
    v_mfma_f32_16x16x32_bf16 v[76:79], a[104:107], a[100:103], v[76:79]
    s_add_u32 m0, s24, 48128
    s_nop 0
    buffer_load_dwordx4 v10, s[16:19], s25 offen lds
    s_add_u32 m0, s24, 50176
    s_nop 0
    buffer_load_dwordx4 v11, s[16:19], s25 offen lds
    v_cndmask_b32 v212, v212, v236, s[32:33]
    v_cndmask_b32 v213, v213, v236, s[32:33]
    v_cndmask_b32 v214, v214, v236, s[32:33]
    v_cndmask_b32 v215, v215, v236, s[32:33]
    v_mfma_f32_16x16x32_bf16 v[80:83], a[108:111], a[96:99], v[80:83]
    s_add_u32 m0, s24, 52224
    s_nop 0
    buffer_load_dwordx4 v12, s[16:19], s25 offen lds
    s_mov_b32 m0, 78848
    s_nop 0
    buffer_load_dwordx4 v13, s[16:19], s25 offen lds
    s_add_u32 s25, s25, 221184
    s_add_u32 s34, s34, 128
    s_cmp_ge_u32 s34, 1152
    s_cselect_b32 s34, 0, s34
    s_cselect_b32 s25, s26, s25
    v_mfma_f32_16x16x32_bf16 v[84:87], a[108:111], a[100:103], v[84:87]
    v_dot2c_f32_bf16 v164, v168, v166
    v_dot2c_f32_bf16 v164, v169, v166
    v_dot2c_f32_bf16 v164, v170, v166
    v_dot2c_f32_bf16 v164, v171, v166
    v_accvgpr_write_b32 a144, v168
    v_accvgpr_write_b32 a145, v169
    v_accvgpr_write_b32 a146, v170
    v_accvgpr_write_b32 a147, v171
    v_dot2c_f32_bf16 v165, v172, v166
    v_dot2c_f32_bf16 v165, v173, v166
    v_dot2c_f32_bf16 v165, v174, v166
    v_dot2c_f32_bf16 v165, v175, v166
    v_accvgpr_write_b32 a148, v172
    v_accvgpr_write_b32 a149, v173
    v_accvgpr_write_b32 a150, v174
    v_accvgpr_write_b32 a151, v175
    v_mfma_f32_16x16x32_bf16 v[88:91], a[112:115], a[96:99], v[88:91]
    s_mul_i32 s42, s4, 276480
    s_add_u32 s42, s42, s5
    s_add_u32 s42, s42, 92160
    s_add_u32 m0, s7, 4096
    s_nop 0
    buffer_load_dwordx4 v160, s[52:55], s42 offen nt lds
    s_mul_i32 s42, s4, 267264
    s_add_u32 s42, s42, s5
    s_add_u32 s42, s42, 101376
    s_add_u32 m0, s7, 5120
    s_nop 0
    buffer_load_dwordx4 v160, s[56:59], s42 offen nt lds
    v_mfma_f32_16x16x32_bf16 v[92:95], a[112:115], a[100:103], v[92:95]
    v_mfma_f32_16x16x32_bf16 v[96:99], a[116:119], a[96:99], v[96:99]
    v_mfma_f32_16x16x32_bf16 v[100:103], a[116:119], a[100:103], v[100:103]
    v_mfma_f32_16x16x32_bf16 v[104:107], a[120:123], a[96:99], v[104:107]
    v_mfma_f32_16x16x32_bf16 v[108:111], a[120:123], a[100:103], v[108:111]
    v_mfma_f32_16x16x32_bf16 v[112:115], a[124:127], a[96:99], v[112:115]
    v_mfma_f32_16x16x32_bf16 v[116:119], a[124:127], a[100:103], v[116:119]
    v_mfma_f32_16x16x32_bf16 v[120:123], v[212:215], a[96:99], v[120:123]
    v_mfma_f32_16x16x32_bf16 v[124:127], v[212:215], a[100:103], v[124:127]
    v_mfma_f32_16x16x32_bf16 v[128:131], a[120:123], v[156:159], v[128:131]
    v_mfma_f32_16x16x32_bf16 v[132:135], a[124:127], v[156:159], v[132:135]
    v_mfma_f32_16x16x32_bf16 v[136:139], v[212:215], v[156:159], v[136:139]
    s_waitcnt vmcnt(26)
    s_barrier
    v_mfma_f32_16x16x32_bf16 v[44:47], a[0:3], a[0:3], v[44:47]
    ds_read_b128 a[64:67], v30
    ds_read_b128 a[68:71], v36
    v_mfma_f32_16x16x32_bf16 v[48:51], v[144:147], v[144:147], v[48:51]
    ds_read_b128 v[152:155], v24
    ds_read_b64_tr_b16 a[72:73], v40 offset:0
    v_mfma_f32_16x16x32_bf16 v[72:75], a[8:11], a[0:3], v[72:75]
    ds_read_b64_tr_b16 a[74:75], v40 offset:1792
    ds_read_b64_tr_b16 a[76:77], v40 offset:32
    v_cndmask_b32 v144, v144, v236, s[30:31]
    v_cndmask_b32 v145, v145, v236, s[30:31]
    v_cndmask_b32 v146, v146, v236, s[30:31]
    v_cndmask_b32 v147, v147, v236, s[30:31]
    v_mfma_f32_16x16x32_bf16 v[76:79], a[8:11], a[4:7], v[76:79]
    ds_read_b64_tr_b16 a[78:79], v40 offset:1824
    ds_read_b64_tr_b16 a[80:81], v40 offset:64
    v_cndmask_b32 v200, v200, v236, s[32:33]
    v_cndmask_b32 v201, v201, v236, s[32:33]
    v_cndmask_b32 v202, v202, v236, s[32:33]
    v_cndmask_b32 v203, v203, v236, s[32:33]
    v_mfma_f32_16x16x32_bf16 v[80:83], a[12:15], a[0:3], v[80:83]
    ds_read_b64_tr_b16 a[82:83], v40 offset:1856
    ds_read_b64_tr_b16 a[84:85], v40 offset:96
    v_mfma_f32_16x16x32_bf16 v[84:87], a[12:15], a[4:7], v[84:87]
    ds_read_b64_tr_b16 a[86:87], v40 offset:1888
    ds_read_b64_tr_b16 a[88:89], v40 offset:128
    v_mfma_f32_16x16x32_bf16 v[88:91], a[16:19], a[0:3], v[88:91]
    ds_read_b64_tr_b16 a[90:91], v40 offset:1920
    ds_read_b64_tr_b16 a[92:93], v40 offset:160
    v_mfma_f32_16x16x32_bf16 v[92:95], a[16:19], a[4:7], v[92:95]
    ds_read_b64_tr_b16 a[94:95], v40 offset:1952
    ds_read_b64_tr_b16 v[208:209], v40 offset:192
    v_mfma_f32_16x16x32_bf16 v[96:99], a[20:23], a[0:3], v[96:99]
    ds_read_b64_tr_b16 v[210:211], v40 offset:1984
    ds_read_b128 a[96:99], v31
    v_mfma_f32_16x16x32_bf16 v[100:103], a[20:23], a[4:7], v[100:103]
    ds_read_b128 a[100:103], v37
    ds_read_b128 v[156:159], v25
    v_mfma_f32_16x16x32_bf16 v[104:107], a[24:27], a[0:3], v[104:107]
    ds_read_b64_tr_b16 a[104:105], v40 offset:14464
    ds_read_b64_tr_b16 a[106:107], v40 offset:16256
    v_mfma_f32_16x16x32_bf16 v[108:111], a[24:27], a[4:7], v[108:111]
    ds_read_b64_tr_b16 a[108:109], v40 offset:14496
    ds_read_b64_tr_b16 a[110:111], v40 offset:16288
    v_mfma_f32_16x16x32_bf16 v[112:115], a[28:31], a[0:3], v[112:115]
    ds_read_b64_tr_b16 a[112:113], v40 offset:14528
    ds_read_b64_tr_b16 a[114:115], v40 offset:16320
    v_mfma_f32_16x16x32_bf16 v[116:119], a[28:31], a[4:7], v[116:119]
    ds_read_b64_tr_b16 a[116:117], v40 offset:14560
    ds_read_b64_tr_b16 a[118:119], v40 offset:16352
    v_mfma_f32_16x16x32_bf16 v[120:123], v[200:203], a[0:3], v[120:123]
    ds_read_b64_tr_b16 a[120:121], v40 offset:14592
    ds_read_b64_tr_b16 a[122:123], v40 offset:16384
    v_mfma_f32_16x16x32_bf16 v[124:127], v[200:203], a[4:7], v[124:127]
    ds_read_b64_tr_b16 a[124:125], v40 offset:14624
    ds_read_b64_tr_b16 a[126:127], v40 offset:16416
    v_mfma_f32_16x16x32_bf16 v[128:131], a[24:27], v[144:147], v[128:131]
    ds_read_b64_tr_b16 v[212:213], v40 offset:14656
    ds_read_b64_tr_b16 v[214:215], v40 offset:16448
    v_mfma_f32_16x16x32_bf16 v[132:135], a[28:31], v[144:147], v[132:135]
    s_waitcnt vmcnt(25)
    ds_read_b64_tr_b16 v[176:177], v161 offset:0
    ds_read_b64_tr_b16 v[178:179], v161 offset:512
    s_waitcnt vmcnt(24)
    ds_read_b64_tr_b16 v[180:181], v161 offset:1024
    ds_read_b64_tr_b16 v[182:183], v161 offset:1536
    v_mfma_f32_16x16x32_bf16 v[136:139], v[200:203], v[144:147], v[136:139]
    s_waitcnt lgkmcnt(0)
    s_barrier
    v_mfma_f32_16x16x32_bf16 v[44:47], a[32:35], a[32:35], v[44:47]
    s_add_u32 m0, s37, 86016
    s_add_u32 s38, s34, 1152
    buffer_load_dwordx4 v4, s[12:15], s38 offen lds
    s_add_u32 m0, s37, 88064
    s_add_u32 s38, s34, 38016
    buffer_load_dwordx4 v4, s[12:15], s38 offen lds
    v_mfma_f32_16x16x32_bf16 v[48:51], v[148:151], v[148:151], v[48:51]
    s_add_u32 m0, s24, 79872
    s_nop 0
    buffer_load_dwordx4 v6, s[16:19], s25 offen lds
    s_add_u32 m0, s24, 81920
    s_nop 0
    buffer_load_dwordx4 v7, s[16:19], s25 offen lds
    v_mfma_f32_16x16x32_bf16 v[72:75], a[40:43], a[32:35], v[72:75]
    s_add_u32 m0, s24, 83968
    s_nop 0
    buffer_load_dwordx4 v8, s[16:19], s25 offen lds
    s_add_u32 m0, s24, 86016
    s_nop 0
    buffer_load_dwordx4 v9, s[16:19], s25 offen lds
    v_cndmask_b32 v148, v148, v236, s[30:31]
    v_cndmask_b32 v149, v149, v236, s[30:31]
    v_cndmask_b32 v150, v150, v236, s[30:31]
    v_cndmask_b32 v151, v151, v236, s[30:31]
    v_mfma_f32_16x16x32_bf16 v[76:79], a[40:43], a[36:39], v[76:79]
    s_add_u32 m0, s24, 88064
    s_nop 0
    buffer_load_dwordx4 v10, s[16:19], s25 offen lds
    s_add_u32 m0, s24, 90112
    s_nop 0
    buffer_load_dwordx4 v11, s[16:19], s25 offen lds
    v_cndmask_b32 v204, v204, v236, s[32:33]
    v_cndmask_b32 v205, v205, v236, s[32:33]
    v_cndmask_b32 v206, v206, v236, s[32:33]
    v_cndmask_b32 v207, v207, v236, s[32:33]
    v_mfma_f32_16x16x32_bf16 v[80:83], a[44:47], a[32:35], v[80:83]
    s_add_u32 m0, s24, 92160
    s_nop 0
    buffer_load_dwordx4 v12, s[16:19], s25 offen lds
    s_mov_b32 m0, 118784
    s_nop 0
    buffer_load_dwordx4 v13, s[16:19], s25 offen lds
    s_add_u32 s25, s25, 221184
    s_add_u32 s34, s34, 128
    s_cmp_ge_u32 s34, 1152
    s_cselect_b32 s34, 0, s34
    s_cselect_b32 s25, s26, s25
    v_mfma_f32_16x16x32_bf16 v[84:87], a[44:47], a[36:39], v[84:87]
    v_dot2c_f32_bf16 v164, v176, v166
    v_dot2c_f32_bf16 v164, v177, v166
    v_dot2c_f32_bf16 v164, v178, v166
    v_dot2c_f32_bf16 v164, v179, v166
    v_accvgpr_write_b32 a152, v176
    v_accvgpr_write_b32 a153, v177
    v_accvgpr_write_b32 a154, v178
    v_accvgpr_write_b32 a155, v179
    v_dot2c_f32_bf16 v165, v180, v166
    v_dot2c_f32_bf16 v165, v181, v166
    v_dot2c_f32_bf16 v165, v182, v166
    v_dot2c_f32_bf16 v165, v183, v166
    v_accvgpr_write_b32 a156, v180
    v_accvgpr_write_b32 a157, v181
    v_accvgpr_write_b32 a158, v182
    v_accvgpr_write_b32 a159, v183
    v_mfma_f32_16x16x32_bf16 v[88:91], a[48:51], a[32:35], v[88:91]
    s_mul_i32 s42, s4, 331776
    s_add_u32 s42, s42, s5
    s_add_u32 s42, s42, 110592
    s_add_u32 m0, s7, 0
    s_nop 0
    buffer_load_dwordx4 v160, s[52:55], s42 offen nt lds
    s_mul_i32 s42, s4, 322560
    s_add_u32 s42, s42, s5
    s_add_u32 s42, s42, 119808
    s_add_u32 m0, s7, 1024
    s_nop 0
    buffer_load_dwordx4 v160, s[56:59], s42 offen nt lds
    v_mfma_f32_16x16x32_bf16 v[92:95], a[48:51], a[36:39], v[92:95]
    v_mfma_f32_16x16x32_bf16 v[96:99], a[52:55], a[32:35], v[96:99]
    v_mfma_f32_16x16x32_bf16 v[100:103], a[52:55], a[36:39], v[100:103]
    v_mfma_f32_16x16x32_bf16 v[104:107], a[56:59], a[32:35], v[104:107]
    v_mfma_f32_16x16x32_bf16 v[108:111], a[56:59], a[36:39], v[108:111]
    v_mfma_f32_16x16x32_bf16 v[112:115], a[60:63], a[32:35], v[112:115]
    v_mfma_f32_16x16x32_bf16 v[116:119], a[60:63], a[36:39], v[116:119]
    v_mfma_f32_16x16x32_bf16 v[120:123], v[204:207], a[32:35], v[120:123]
    v_mfma_f32_16x16x32_bf16 v[124:127], v[204:207], a[36:39], v[124:127]
    v_mfma_f32_16x16x32_bf16 v[128:131], a[56:59], v[148:151], v[128:131]
    v_mfma_f32_16x16x32_bf16 v[132:135], a[60:63], v[148:151], v[132:135]
    v_mfma_f32_16x16x32_bf16 v[136:139], v[204:207], v[148:151], v[136:139]
    s_waitcnt vmcnt(26)
    s_barrier
    v_mfma_f32_16x16x32_bf16 v[44:47], a[64:67], a[64:67], v[44:47]
    ds_read_b128 a[0:3], v26
    ds_read_b128 a[4:7], v32
    v_mfma_f32_16x16x32_bf16 v[48:51], v[152:155], v[152:155], v[48:51]
    ds_read_b128 v[144:147], v20
    ds_read_b64_tr_b16 a[8:9], v38 offset:0
    v_mfma_f32_16x16x32_bf16 v[72:75], a[72:75], a[64:67], v[72:75]
    ds_read_b64_tr_b16 a[10:11], v38 offset:1792
    ds_read_b64_tr_b16 a[12:13], v38 offset:32
    v_cndmask_b32 v152, v152, v236, s[30:31]
    v_cndmask_b32 v153, v153, v236, s[30:31]
    v_cndmask_b32 v154, v154, v236, s[30:31]
    v_cndmask_b32 v155, v155, v236, s[30:31]
    v_mfma_f32_16x16x32_bf16 v[76:79], a[72:75], a[68:71], v[76:79]
    ds_read_b64_tr_b16 a[14:15], v38 offset:1824
    ds_read_b64_tr_b16 a[16:17], v38 offset:64
    v_cndmask_b32 v208, v208, v236, s[32:33]
    v_cndmask_b32 v209, v209, v236, s[32:33]
    v_cndmask_b32 v210, v210, v236, s[32:33]
    v_cndmask_b32 v211, v211, v236, s[32:33]
    v_mfma_f32_16x16x32_bf16 v[80:83], a[76:79], a[64:67], v[80:83]
    ds_read_b64_tr_b16 a[18:19], v38 offset:1856
    ds_read_b64_tr_b16 a[20:21], v38 offset:96
    v_mfma_f32_16x16x32_bf16 v[84:87], a[76:79], a[68:71], v[84:87]
    ds_read_b64_tr_b16 a[22:23], v38 offset:1888
    ds_read_b64_tr_b16 a[24:25], v38 offset:128
    v_mfma_f32_16x16x32_bf16 v[88:91], a[80:83], a[64:67], v[88:91]
    ds_read_b64_tr_b16 a[26:27], v38 offset:1920
    ds_read_b64_tr_b16 a[28:29], v38 offset:160
    v_mfma_f32_16x16x32_bf16 v[92:95], a[80:83], a[68:71], v[92:95]
    ds_read_b64_tr_b16 a[30:31], v38 offset:1952
    ds_read_b64_tr_b16 v[200:201], v38 offset:192
    v_mfma_f32_16x16x32_bf16 v[96:99], a[84:87], a[64:67], v[96:99]
    ds_read_b64_tr_b16 v[202:203], v38 offset:1984
    ds_read_b128 a[32:35], v27
    v_mfma_f32_16x16x32_bf16 v[100:103], a[84:87], a[68:71], v[100:103]
    ds_read_b128 a[36:39], v33
    ds_read_b128 v[148:151], v21
    v_mfma_f32_16x16x32_bf16 v[104:107], a[88:91], a[64:67], v[104:107]
    ds_read_b64_tr_b16 a[40:41], v38 offset:14464
    ds_read_b64_tr_b16 a[42:43], v38 offset:16256
    v_mfma_f32_16x16x32_bf16 v[108:111], a[88:91], a[68:71], v[108:111]
    ds_read_b64_tr_b16 a[44:45], v38 offset:14496
    ds_read_b64_tr_b16 a[46:47], v38 offset:16288
    v_mfma_f32_16x16x32_bf16 v[112:115], a[92:95], a[64:67], v[112:115]
    ds_read_b64_tr_b16 a[48:49], v38 offset:14528
    ds_read_b64_tr_b16 a[50:51], v38 offset:16320
    v_mfma_f32_16x16x32_bf16 v[116:119], a[92:95], a[68:71], v[116:119]
    ds_read_b64_tr_b16 a[52:53], v38 offset:14560
    ds_read_b64_tr_b16 a[54:55], v38 offset:16352
    v_mfma_f32_16x16x32_bf16 v[120:123], v[208:211], a[64:67], v[120:123]
    ds_read_b64_tr_b16 a[56:57], v38 offset:14592
    ds_read_b64_tr_b16 a[58:59], v38 offset:16384
    v_mfma_f32_16x16x32_bf16 v[124:127], v[208:211], a[68:71], v[124:127]
    ds_read_b64_tr_b16 a[60:61], v38 offset:14624
    ds_read_b64_tr_b16 a[62:63], v38 offset:16416
    v_mfma_f32_16x16x32_bf16 v[128:131], a[88:91], v[152:155], v[128:131]
    ds_read_b64_tr_b16 v[204:205], v38 offset:14656
    ds_read_b64_tr_b16 v[206:207], v38 offset:16448
    v_mfma_f32_16x16x32_bf16 v[132:135], a[92:95], v[152:155], v[132:135]
    s_waitcnt vmcnt(25)
    ds_read_b64_tr_b16 v[168:169], v161 offset:2048
    ds_read_b64_tr_b16 v[170:171], v161 offset:2560
    s_waitcnt vmcnt(24)
    ds_read_b64_tr_b16 v[172:173], v161 offset:3072
    ds_read_b64_tr_b16 v[174:175], v161 offset:3584
    v_mfma_f32_16x16x32_bf16 v[136:139], v[208:211], v[152:155], v[136:139]
    s_waitcnt lgkmcnt(0)
    s_barrier
    v_mfma_f32_16x16x32_bf16 v[44:47], a[96:99], a[96:99], v[44:47]
    v_add_u32 v250, 0, v0
    s_lshl_b32 s29, s3, 10
    s_add_u32 m0, s29, 0
    v_mul_u32_u24 v251, 7282, v250
    v_lshrrev_b32 v251, 16, v251
    v_mul_u32_u24 v251, 1008, v251
    v_lshl_add_u32 v251, v250, 4, v251
    buffer_load_dwordx4 v251, s[44:47], s26 offen lds
    v_add_u32 v250, 256, v0
    s_lshl_b32 s29, s3, 10
    s_add_u32 m0, s29, 4096
    v_mul_u32_u24 v251, 7282, v250
    v_lshrrev_b32 v251, 16, v251
    v_mul_u32_u24 v251, 1008, v251
    v_lshl_add_u32 v251, v250, 4, v251
    buffer_load_dwordx4 v251, s[44:47], s26 offen lds
    v_mfma_f32_16x16x32_bf16 v[48:51], v[156:159], v[156:159], v[48:51]
    v_add_u32 v250, 512, v0
    s_lshl_b32 s29, s3, 10
    s_add_u32 m0, s29, 8192
    v_mul_u32_u24 v251, 7282, v250
    v_lshrrev_b32 v251, 16, v251
    v_mul_u32_u24 v251, 1008, v251
    v_lshl_add_u32 v251, v250, 4, v251
    buffer_load_dwordx4 v251, s[44:47], s26 offen lds
    v_add_u32 v250, 768, v0
    s_lshl_b32 s29, s3, 10
    s_add_u32 m0, s29, 12288
    v_mul_u32_u24 v251, 7282, v250
    v_lshrrev_b32 v251, 16, v251
    v_mul_u32_u24 v251, 1008, v251
    v_lshl_add_u32 v251, v250, 4, v251
    buffer_load_dwordx4 v251, s[44:47], s26 offen lds
    v_mfma_f32_16x16x32_bf16 v[72:75], a[104:107], a[96:99], v[72:75]
    v_add_u32 v250, 1024, v0
    s_lshl_b32 s29, s3, 10
    s_add_u32 m0, s29, 16384
    v_mul_u32_u24 v251, 7282, v250
    v_lshrrev_b32 v251, 16, v251
    v_mul_u32_u24 v251, 1008, v251
    v_lshl_add_u32 v251, v250, 4, v251
    buffer_load_dwordx4 v251, s[44:47], s26 offen lds
    v_add_u32 v250, 1280, v0
    s_lshl_b32 s29, s3, 10
    s_add_u32 m0, s29, 20480
    v_mul_u32_u24 v251, 7282, v250
    v_lshrrev_b32 v251, 16, v251
    v_mul_u32_u24 v251, 1008, v251
    v_lshl_add_u32 v251, v250, 4, v251
    buffer_load_dwordx4 v251, s[44:47], s26 offen lds
    v_cndmask_b32 v156, v156, v236, s[30:31]
    v_cndmask_b32 v157, v157, v236, s[30:31]
    v_cndmask_b32 v158, v158, v236, s[30:31]
    v_cndmask_b32 v159, v159, v236, s[30:31]
    v_mfma_f32_16x16x32_bf16 v[76:79], a[104:107], a[100:103], v[76:79]
    v_add_u32 v250, 1536, v0
    s_lshl_b32 s29, s3, 10
    s_add_u32 m0, s29, 24576
    v_mul_u32_u24 v251, 7282, v250
    v_lshrrev_b32 v251, 16, v251
    v_mul_u32_u24 v251, 1008, v251
    v_lshl_add_u32 v251, v250, 4, v251
    buffer_load_dwordx4 v251, s[44:47], s26 offen lds
    v_add_u32 v250, 1792, v0
    s_lshl_b32 s29, s3, 10
    s_add_u32 m0, s29, 28672
    v_mul_u32_u24 v251, 7282, v250
    v_lshrrev_b32 v251, 16, v251
    v_mul_u32_u24 v251, 1008, v251
    v_lshl_add_u32 v251, v250, 4, v251
    buffer_load_dwordx4 v251, s[44:47], s26 offen lds
    v_cndmask_b32 v212, v212, v236, s[32:33]
    v_cndmask_b32 v213, v213, v236, s[32:33]
    v_cndmask_b32 v214, v214, v236, s[32:33]
    v_cndmask_b32 v215, v215, v236, s[32:33]
    v_mfma_f32_16x16x32_bf16 v[80:83], a[108:111], a[96:99], v[80:83]
    v_add_u32 v250, 2048, v0
    s_lshl_b32 s29, s3, 10
    s_add_u32 m0, s29, 32768
    v_mul_u32_u24 v251, 7282, v250
    v_lshrrev_b32 v251, 16, v251
    v_mul_u32_u24 v251, 1008, v251
    v_lshl_add_u32 v251, v250, 4, v251
    buffer_load_dwordx4 v251, s[44:47], s26 offen lds
    s_add_u32 s29, s3, 36
    s_min_u32 s29, s29, 38
    s_add_u32 s29, s29, 0
    s_lshl_b32 m0, s29, 10
    s_lshl_b32 s29, s29, 6
    v_add_u32 v250, s29, v2
    v_mul_u32_u24 v251, 7282, v250
    v_lshrrev_b32 v251, 16, v251
    v_mul_u32_u24 v251, 1008, v251
    v_lshl_add_u32 v251, v250, 4, v251
    buffer_load_dwordx4 v251, s[44:47], s26 offen lds
    v_mfma_f32_16x16x32_bf16 v[84:87], a[108:111], a[100:103], v[84:87]
    v_dot2c_f32_bf16 v164, v168, v166
    v_dot2c_f32_bf16 v164, v169, v166
    v_dot2c_f32_bf16 v164, v170, v166
    v_dot2c_f32_bf16 v164, v171, v166
    v_accvgpr_write_b32 a160, v168
    v_accvgpr_write_b32 a161, v169
    v_accvgpr_write_b32 a162, v170
    v_accvgpr_write_b32 a163, v171
    v_dot2c_f32_bf16 v165, v172, v166
    v_dot2c_f32_bf16 v165, v173, v166
    v_dot2c_f32_bf16 v165, v174, v166
    v_dot2c_f32_bf16 v165, v175, v166
    v_accvgpr_write_b32 a164, v172
    v_accvgpr_write_b32 a165, v173
    v_accvgpr_write_b32 a166, v174
    v_accvgpr_write_b32 a167, v175
    v_mfma_f32_16x16x32_bf16 v[88:91], a[112:115], a[96:99], v[88:91]
    s_mul_i32 s42, s4, 387072
    s_add_u32 s42, s42, s5
    s_add_u32 s42, s42, 129024
    s_add_u32 m0, s7, 2048
    s_nop 0
    buffer_load_dwordx4 v160, s[52:55], s42 offen nt lds
    s_mul_i32 s42, s4, 377856
    s_add_u32 s42, s42, s5
    s_add_u32 s42, s42, 138240
    s_add_u32 m0, s7, 3072
    s_nop 0
    buffer_load_dwordx4 v160, s[56:59], s42 offen nt lds
    v_mfma_f32_16x16x32_bf16 v[92:95], a[112:115], a[100:103], v[92:95]
    v_mfma_f32_16x16x32_bf16 v[96:99], a[116:119], a[96:99], v[96:99]
    v_mfma_f32_16x16x32_bf16 v[100:103], a[116:119], a[100:103], v[100:103]
    v_mfma_f32_16x16x32_bf16 v[104:107], a[120:123], a[96:99], v[104:107]
    v_mfma_f32_16x16x32_bf16 v[108:111], a[120:123], a[100:103], v[108:111]
    v_mfma_f32_16x16x32_bf16 v[112:115], a[124:127], a[96:99], v[112:115]
    v_mfma_f32_16x16x32_bf16 v[116:119], a[124:127], a[100:103], v[116:119]
    v_mfma_f32_16x16x32_bf16 v[120:123], v[212:215], a[96:99], v[120:123]
    v_mfma_f32_16x16x32_bf16 v[124:127], v[212:215], a[100:103], v[124:127]
    v_mfma_f32_16x16x32_bf16 v[128:131], a[120:123], v[156:159], v[128:131]
    v_mfma_f32_16x16x32_bf16 v[132:135], a[124:127], v[156:159], v[132:135]
    v_mfma_f32_16x16x32_bf16 v[136:139], v[212:215], v[156:159], v[136:139]
    s_waitcnt vmcnt(26)
    s_barrier
    v_mfma_f32_16x16x32_bf16 v[44:47], a[0:3], a[0:3], v[44:47]
    ds_read_b128 a[64:67], v28
    ds_read_b128 a[68:71], v34
    v_mfma_f32_16x16x32_bf16 v[48:51], v[144:147], v[144:147], v[48:51]
    ds_read_b128 v[152:155], v22
    ds_read_b64_tr_b16 a[72:73], v39 offset:0
    v_mfma_f32_16x16x32_bf16 v[72:75], a[8:11], a[0:3], v[72:75]
    ds_read_b64_tr_b16 a[74:75], v39 offset:1792
    ds_read_b64_tr_b16 a[76:77], v39 offset:32
    v_cndmask_b32 v144, v144, v236, s[30:31]
    v_cndmask_b32 v145, v145, v236, s[30:31]
    v_cndmask_b32 v146, v146, v236, s[30:31]
    v_cndmask_b32 v147, v147, v236, s[30:31]
    v_mfma_f32_16x16x32_bf16 v[76:79], a[8:11], a[4:7], v[76:79]
    ds_read_b64_tr_b16 a[78:79], v39 offset:1824
    ds_read_b64_tr_b16 a[80:81], v39 offset:64
    v_cndmask_b32 v200, v200, v236, s[32:33]
    v_cndmask_b32 v201, v201, v236, s[32:33]
    v_cndmask_b32 v202, v202, v236, s[32:33]
    v_cndmask_b32 v203, v203, v236, s[32:33]
    v_mfma_f32_16x16x32_bf16 v[80:83], a[12:15], a[0:3], v[80:83]
    ds_read_b64_tr_b16 a[82:83], v39 offset:1856
    ds_read_b64_tr_b16 a[84:85], v39 offset:96
    v_mfma_f32_16x16x32_bf16 v[84:87], a[12:15], a[4:7], v[84:87]
    ds_read_b64_tr_b16 a[86:87], v39 offset:1888
    ds_read_b64_tr_b16 a[88:89], v39 offset:128
    v_mfma_f32_16x16x32_bf16 v[88:91], a[16:19], a[0:3], v[88:91]
    ds_read_b64_tr_b16 a[90:91], v39 offset:1920
    ds_read_b64_tr_b16 a[92:93], v39 offset:160
    v_mfma_f32_16x16x32_bf16 v[92:95], a[16:19], a[4:7], v[92:95]
    ds_read_b64_tr_b16 a[94:95], v39 offset:1952
    ds_read_b64_tr_b16 v[208:209], v39 offset:192
    v_mfma_f32_16x16x32_bf16 v[96:99], a[20:23], a[0:3], v[96:99]
    ds_read_b64_tr_b16 v[210:211], v39 offset:1984
    ds_read_b128 a[96:99], v29
    v_mfma_f32_16x16x32_bf16 v[100:103], a[20:23], a[4:7], v[100:103]
    ds_read_b128 a[100:103], v35
    ds_read_b128 v[156:159], v23
    v_mfma_f32_16x16x32_bf16 v[104:107], a[24:27], a[0:3], v[104:107]
    ds_read_b64_tr_b16 a[104:105], v39 offset:14464
    ds_read_b64_tr_b16 a[106:107], v39 offset:16256
    v_mfma_f32_16x16x32_bf16 v[108:111], a[24:27], a[4:7], v[108:111]
    ds_read_b64_tr_b16 a[108:109], v39 offset:14496
    ds_read_b64_tr_b16 a[110:111], v39 offset:16288
    v_mfma_f32_16x16x32_bf16 v[112:115], a[28:31], a[0:3], v[112:115]
    ds_read_b64_tr_b16 a[112:113], v39 offset:14528
    ds_read_b64_tr_b16 a[114:115], v39 offset:16320
    v_mfma_f32_16x16x32_bf16 v[116:119], a[28:31], a[4:7], v[116:119]
    ds_read_b64_tr_b16 a[116:117], v39 offset:14560
    ds_read_b64_tr_b16 a[118:119], v39 offset:16352
    v_mfma_f32_16x16x32_bf16 v[120:123], v[200:203], a[0:3], v[120:123]
    ds_read_b64_tr_b16 a[120:121], v39 offset:14592
    ds_read_b64_tr_b16 a[122:123], v39 offset:16384
    v_mfma_f32_16x16x32_bf16 v[124:127], v[200:203], a[4:7], v[124:127]
    ds_read_b64_tr_b16 a[124:125], v39 offset:14624
    ds_read_b64_tr_b16 a[126:127], v39 offset:16416
    v_mfma_f32_16x16x32_bf16 v[128:131], a[24:27], v[144:147], v[128:131]
    ds_read_b64_tr_b16 v[212:213], v39 offset:14656
    ds_read_b64_tr_b16 v[214:215], v39 offset:16448
    v_mfma_f32_16x16x32_bf16 v[132:135], a[28:31], v[144:147], v[132:135]
    s_waitcnt vmcnt(25)
    ds_read_b64_tr_b16 v[176:177], v161 offset:4096
    ds_read_b64_tr_b16 v[178:179], v161 offset:4608
    s_waitcnt vmcnt(24)
    ds_read_b64_tr_b16 v[180:181], v161 offset:5120
    ds_read_b64_tr_b16 v[182:183], v161 offset:5632
    v_mfma_f32_16x16x32_bf16 v[136:139], v[200:203], v[144:147], v[136:139]
    s_waitcnt lgkmcnt(0)
    s_barrier
    v_mfma_f32_16x16x32_bf16 v[44:47], a[32:35], a[32:35], v[44:47]
    v_add_u32 v250, 2496, v0
    s_lshl_b32 s29, s3, 10
    s_add_u32 m0, s29, 39936
    v_mul_u32_u24 v251, 7282, v250
    v_lshrrev_b32 v251, 16, v251
    v_mul_u32_u24 v251, 1008, v251
    v_lshl_add_u32 v251, v250, 4, v251
    buffer_load_dwordx4 v251, s[44:47], s26 offen lds
    v_add_u32 v250, 2752, v0
    s_lshl_b32 s29, s3, 10
    s_add_u32 m0, s29, 44032
    v_mul_u32_u24 v251, 7282, v250
    v_lshrrev_b32 v251, 16, v251
    v_mul_u32_u24 v251, 1008, v251
    v_lshl_add_u32 v251, v250, 4, v251
    buffer_load_dwordx4 v251, s[44:47], s26 offen lds
    v_mfma_f32_16x16x32_bf16 v[48:51], v[148:151], v[148:151], v[48:51]
    v_add_u32 v250, 3008, v0
    s_lshl_b32 s29, s3, 10
    s_add_u32 m0, s29, 48128
    v_mul_u32_u24 v251, 7282, v250
    v_lshrrev_b32 v251, 16, v251
    v_mul_u32_u24 v251, 1008, v251
    v_lshl_add_u32 v251, v250, 4, v251
    buffer_load_dwordx4 v251, s[44:47], s26 offen lds
    v_add_u32 v250, 3264, v0
    s_lshl_b32 s29, s3, 10
    s_add_u32 m0, s29, 52224
    v_mul_u32_u24 v251, 7282, v250
    v_lshrrev_b32 v251, 16, v251
    v_mul_u32_u24 v251, 1008, v251
    v_lshl_add_u32 v251, v250, 4, v251
    buffer_load_dwordx4 v251, s[44:47], s26 offen lds
    v_mfma_f32_16x16x32_bf16 v[72:75], a[40:43], a[32:35], v[72:75]
    v_add_u32 v250, 3520, v0
    s_lshl_b32 s29, s3, 10
    s_add_u32 m0, s29, 56320
    v_mul_u32_u24 v251, 7282, v250
    v_lshrrev_b32 v251, 16, v251
    v_mul_u32_u24 v251, 1008, v251
    v_lshl_add_u32 v251, v250, 4, v251
    buffer_load_dwordx4 v251, s[44:47], s26 offen lds
    v_add_u32 v250, 3776, v0
    s_lshl_b32 s29, s3, 10
    s_add_u32 m0, s29, 60416
    v_mul_u32_u24 v251, 7282, v250
    v_lshrrev_b32 v251, 16, v251
    v_mul_u32_u24 v251, 1008, v251
    v_lshl_add_u32 v251, v250, 4, v251
    buffer_load_dwordx4 v251, s[44:47], s26 offen lds
    v_cndmask_b32 v148, v148, v236, s[30:31]
    v_cndmask_b32 v149, v149, v236, s[30:31]
    v_cndmask_b32 v150, v150, v236, s[30:31]
    v_cndmask_b32 v151, v151, v236, s[30:31]
    v_mfma_f32_16x16x32_bf16 v[76:79], a[40:43], a[36:39], v[76:79]
    v_add_u32 v250, 4032, v0
    s_lshl_b32 s29, s3, 10
    s_add_u32 m0, s29, 64512
    v_mul_u32_u24 v251, 7282, v250
    v_lshrrev_b32 v251, 16, v251
    v_mul_u32_u24 v251, 1008, v251
    v_lshl_add_u32 v251, v250, 4, v251
    buffer_load_dwordx4 v251, s[44:47], s26 offen lds
    v_add_u32 v250, 4288, v0
    s_lshl_b32 s29, s3, 10
    s_add_u32 m0, s29, 68608
    v_mul_u32_u24 v251, 7282, v250
    v_lshrrev_b32 v251, 16, v251
    v_mul_u32_u24 v251, 1008, v251
    v_lshl_add_u32 v251, v250, 4, v251
    buffer_load_dwordx4 v251, s[44:47], s26 offen lds
    v_cndmask_b32 v204, v204, v236, s[32:33]
    v_cndmask_b32 v205, v205, v236, s[32:33]
    v_cndmask_b32 v206, v206, v236, s[32:33]
    v_cndmask_b32 v207, v207, v236, s[32:33]
    v_mfma_f32_16x16x32_bf16 v[80:83], a[44:47], a[32:35], v[80:83]
    v_add_u32 v250, 4544, v0
    s_lshl_b32 s29, s3, 10
    s_add_u32 m0, s29, 72704
    v_mul_u32_u24 v251, 7282, v250
    v_lshrrev_b32 v251, 16, v251
    v_mul_u32_u24 v251, 1008, v251
    v_lshl_add_u32 v251, v250, 4, v251
    buffer_load_dwordx4 v251, s[44:47], s26 offen lds
    s_add_u32 s29, s3, 36
    s_min_u32 s29, s29, 38
    s_add_u32 s29, s29, 39
    s_lshl_b32 m0, s29, 10
    s_lshl_b32 s29, s29, 6
    v_add_u32 v250, s29, v2
    v_mul_u32_u24 v251, 7282, v250
    v_lshrrev_b32 v251, 16, v251
    v_mul_u32_u24 v251, 1008, v251
    v_lshl_add_u32 v251, v250, 4, v251
    buffer_load_dwordx4 v251, s[44:47], s26 offen lds
    v_mfma_f32_16x16x32_bf16 v[84:87], a[44:47], a[36:39], v[84:87]
    v_dot2c_f32_bf16 v164, v176, v166
    v_dot2c_f32_bf16 v164, v177, v166
    v_dot2c_f32_bf16 v164, v178, v166
    v_dot2c_f32_bf16 v164, v179, v166
    v_accvgpr_write_b32 a168, v176
    v_accvgpr_write_b32 a169, v177
    v_accvgpr_write_b32 a170, v178
    v_accvgpr_write_b32 a171, v179
    v_dot2c_f32_bf16 v165, v180, v166
    v_dot2c_f32_bf16 v165, v181, v166
    v_dot2c_f32_bf16 v165, v182, v166
    v_dot2c_f32_bf16 v165, v183, v166
    v_accvgpr_write_b32 a172, v180
    v_accvgpr_write_b32 a173, v181
    v_accvgpr_write_b32 a174, v182
    v_accvgpr_write_b32 a175, v183
    v_mfma_f32_16x16x32_bf16 v[88:91], a[48:51], a[32:35], v[88:91]
    v_mfma_f32_16x16x32_bf16 v[92:95], a[48:51], a[36:39], v[92:95]
    v_mfma_f32_16x16x32_bf16 v[96:99], a[52:55], a[32:35], v[96:99]
    v_mfma_f32_16x16x32_bf16 v[100:103], a[52:55], a[36:39], v[100:103]
    v_mfma_f32_16x16x32_bf16 v[104:107], a[56:59], a[32:35], v[104:107]
    v_mfma_f32_16x16x32_bf16 v[108:111], a[56:59], a[36:39], v[108:111]
    v_mfma_f32_16x16x32_bf16 v[112:115], a[60:63], a[32:35], v[112:115]
    v_mfma_f32_16x16x32_bf16 v[116:119], a[60:63], a[36:39], v[116:119]
    v_mfma_f32_16x16x32_bf16 v[120:123], v[204:207], a[32:35], v[120:123]
    v_mfma_f32_16x16x32_bf16 v[124:127], v[204:207], a[36:39], v[124:127]
    v_mfma_f32_16x16x32_bf16 v[128:131], a[56:59], v[148:151], v[128:131]
    v_mfma_f32_16x16x32_bf16 v[132:135], a[60:63], v[148:151], v[132:135]
    v_mfma_f32_16x16x32_bf16 v[136:139], v[204:207], v[148:151], v[136:139]
    s_waitcnt vmcnt(24)
    s_barrier
    v_mfma_f32_16x16x32_bf16 v[44:47], a[64:67], a[64:67], v[44:47]
    ds_read_b128 a[0:3], v30
    ds_read_b128 a[4:7], v36
    v_mfma_f32_16x16x32_bf16 v[48:51], v[152:155], v[152:155], v[48:51]
    ds_read_b128 v[144:147], v24
    ds_read_b64_tr_b16 a[8:9], v40 offset:0
    v_mfma_f32_16x16x32_bf16 v[72:75], a[72:75], a[64:67], v[72:75]
    ds_read_b64_tr_b16 a[10:11], v40 offset:1792
    ds_read_b64_tr_b16 a[12:13], v40 offset:32
    v_cndmask_b32 v152, v152, v236, s[30:31]
    v_cndmask_b32 v153, v153, v236, s[30:31]
    v_cndmask_b32 v154, v154, v236, s[30:31]
    v_cndmask_b32 v155, v155, v236, s[30:31]
    v_mfma_f32_16x16x32_bf16 v[76:79], a[72:75], a[68:71], v[76:79]
    ds_read_b64_tr_b16 a[14:15], v40 offset:1824
    ds_read_b64_tr_b16 a[16:17], v40 offset:64
    v_cndmask_b32 v208, v208, v236, s[32:33]
    v_cndmask_b32 v209, v209, v236, s[32:33]
    v_cndmask_b32 v210, v210, v236, s[32:33]
    v_cndmask_b32 v211, v211, v236, s[32:33]
    v_mfma_f32_16x16x32_bf16 v[80:83], a[76:79], a[64:67], v[80:83]
    ds_read_b64_tr_b16 a[18:19], v40 offset:1856
    ds_read_b64_tr_b16 a[20:21], v40 offset:96
    v_mfma_f32_16x16x32_bf16 v[84:87], a[76:79], a[68:71], v[84:87]
    ds_read_b64_tr_b16 a[22:23], v40 offset:1888
    ds_read_b64_tr_b16 a[24:25], v40 offset:128
    v_mfma_f32_16x16x32_bf16 v[88:91], a[80:83], a[64:67], v[88:91]
    ds_read_b64_tr_b16 a[26:27], v40 offset:1920
    ds_read_b64_tr_b16 a[28:29], v40 offset:160
    v_mfma_f32_16x16x32_bf16 v[92:95], a[80:83], a[68:71], v[92:95]
    ds_read_b64_tr_b16 a[30:31], v40 offset:1952
    ds_read_b64_tr_b16 v[200:201], v40 offset:192
    v_mfma_f32_16x16x32_bf16 v[96:99], a[84:87], a[64:67], v[96:99]
    ds_read_b64_tr_b16 v[202:203], v40 offset:1984
    ds_read_b128 a[32:35], v31
    v_mfma_f32_16x16x32_bf16 v[100:103], a[84:87], a[68:71], v[100:103]
    ds_read_b128 a[36:39], v37
    ds_read_b128 v[148:151], v25
    v_mfma_f32_16x16x32_bf16 v[104:107], a[88:91], a[64:67], v[104:107]
    ds_read_b64_tr_b16 a[40:41], v40 offset:14464
    ds_read_b64_tr_b16 a[42:43], v40 offset:16256
    v_mfma_f32_16x16x32_bf16 v[108:111], a[88:91], a[68:71], v[108:111]
    ds_read_b64_tr_b16 a[44:45], v40 offset:14496
    ds_read_b64_tr_b16 a[46:47], v40 offset:16288
    v_mfma_f32_16x16x32_bf16 v[112:115], a[92:95], a[64:67], v[112:115]
    ds_read_b64_tr_b16 a[48:49], v40 offset:14528
    ds_read_b64_tr_b16 a[50:51], v40 offset:16320
    v_mfma_f32_16x16x32_bf16 v[116:119], a[92:95], a[68:71], v[116:119]
    ds_read_b64_tr_b16 a[52:53], v40 offset:14560
    ds_read_b64_tr_b16 a[54:55], v40 offset:16352
    v_mfma_f32_16x16x32_bf16 v[120:123], v[208:211], a[64:67], v[120:123]
    ds_read_b64_tr_b16 a[56:57], v40 offset:14592
    ds_read_b64_tr_b16 a[58:59], v40 offset:16384
    v_mfma_f32_16x16x32_bf16 v[124:127], v[208:211], a[68:71], v[124:127]
    ds_read_b64_tr_b16 a[60:61], v40 offset:14624
    ds_read_b64_tr_b16 a[62:63], v40 offset:16416
    v_mfma_f32_16x16x32_bf16 v[128:131], a[88:91], v[152:155], v[128:131]
    ds_read_b64_tr_b16 v[204:205], v40 offset:14656
    ds_read_b64_tr_b16 v[206:207], v40 offset:16448
    v_mfma_f32_16x16x32_bf16 v[132:135], a[92:95], v[152:155], v[132:135]
    s_waitcnt vmcnt(23)
    ds_read_b64_tr_b16 v[168:169], v161 offset:0
    ds_read_b64_tr_b16 v[170:171], v161 offset:512
    s_waitcnt vmcnt(22)
    ds_read_b64_tr_b16 v[172:173], v161 offset:1024
    ds_read_b64_tr_b16 v[174:175], v161 offset:1536
    v_mfma_f32_16x16x32_bf16 v[136:139], v[208:211], v[152:155], v[136:139]
    s_waitcnt lgkmcnt(0)
    s_barrier
    v_mfma_f32_16x16x32_bf16 v[44:47], a[96:99], a[96:99], v[44:47]
    v_dot2c_f32_bf16 v164, v168, v166
    v_dot2c_f32_bf16 v164, v169, v166
    v_dot2c_f32_bf16 v164, v170, v166
    v_dot2c_f32_bf16 v164, v171, v166
    v_accvgpr_write_b32 a176, v168
    v_accvgpr_write_b32 a177, v169
    v_accvgpr_write_b32 a178, v170
    v_accvgpr_write_b32 a179, v171
    v_dot2c_f32_bf16 v165, v172, v166
    v_dot2c_f32_bf16 v165, v173, v166
    v_dot2c_f32_bf16 v165, v174, v166
    v_dot2c_f32_bf16 v165, v175, v166
    v_accvgpr_write_b32 a180, v172
    v_accvgpr_write_b32 a181, v173
    v_accvgpr_write_b32 a182, v174
    v_accvgpr_write_b32 a183, v175
    v_mfma_f32_16x16x32_bf16 v[48:51], v[156:159], v[156:159], v[48:51]
    v_mfma_f32_16x16x32_bf16 v[72:75], a[104:107], a[96:99], v[72:75]
    v_cndmask_b32 v156, v156, v236, s[30:31]
    v_cndmask_b32 v157, v157, v236, s[30:31]
    v_cndmask_b32 v158, v158, v236, s[30:31]
    v_cndmask_b32 v159, v159, v236, s[30:31]
    v_mfma_f32_16x16x32_bf16 v[76:79], a[104:107], a[100:103], v[76:79]
    v_cndmask_b32 v212, v212, v236, s[32:33]
    v_cndmask_b32 v213, v213, v236, s[32:33]
    v_cndmask_b32 v214, v214, v236, s[32:33]
    v_cndmask_b32 v215, v215, v236, s[32:33]
    v_mfma_f32_16x16x32_bf16 v[80:83], a[108:111], a[96:99], v[80:83]
    v_mfma_f32_16x16x32_bf16 v[84:87], a[108:111], a[100:103], v[84:87]
    v_mfma_f32_16x16x32_bf16 v[88:91], a[112:115], a[96:99], v[88:91]
    v_mfma_f32_16x16x32_bf16 v[92:95], a[112:115], a[100:103], v[92:95]
    v_mfma_f32_16x16x32_bf16 v[96:99], a[116:119], a[96:99], v[96:99]
    v_mfma_f32_16x16x32_bf16 v[100:103], a[116:119], a[100:103], v[100:103]
    v_mfma_f32_16x16x32_bf16 v[104:107], a[120:123], a[96:99], v[104:107]
    v_mfma_f32_16x16x32_bf16 v[108:111], a[120:123], a[100:103], v[108:111]
    v_mfma_f32_16x16x32_bf16 v[112:115], a[124:127], a[96:99], v[112:115]
    v_mfma_f32_16x16x32_bf16 v[116:119], a[124:127], a[100:103], v[116:119]
    v_mfma_f32_16x16x32_bf16 v[120:123], v[212:215], a[96:99], v[120:123]
    v_mfma_f32_16x16x32_bf16 v[124:127], v[212:215], a[100:103], v[124:127]
    v_mfma_f32_16x16x32_bf16 v[128:131], a[120:123], v[156:159], v[128:131]
    v_mfma_f32_16x16x32_bf16 v[132:135], a[124:127], v[156:159], v[132:135]
    v_mfma_f32_16x16x32_bf16 v[136:139], v[212:215], v[156:159], v[136:139]
    v_mfma_f32_16x16x32_bf16 v[44:47], a[0:3], a[0:3], v[44:47]
    s_waitcnt vmcnt(11)
    ds_read_b64_tr_b16 v[176:177], v161 offset:2048
    ds_read_b64_tr_b16 v[178:179], v161 offset:2560
    v_mfma_f32_16x16x32_bf16 v[48:51], v[144:147], v[144:147], v[48:51]
    s_waitcnt vmcnt(10)
    ds_read_b64_tr_b16 v[180:181], v161 offset:3072
    ds_read_b64_tr_b16 v[182:183], v161 offset:3584
    v_mfma_f32_16x16x32_bf16 v[72:75], a[8:11], a[0:3], v[72:75]
    s_mul_i32 s42, s4, 0
    s_add_u32 s42, s42, s6
    buffer_store_dwordx4 a[128:131], v162, s[8:11], s42 offen sc1
    v_cndmask_b32 v144, v144, v236, s[30:31]
    v_cndmask_b32 v145, v145, v236, s[30:31]
    v_cndmask_b32 v146, v146, v236, s[30:31]
    v_cndmask_b32 v147, v147, v236, s[30:31]
    v_mfma_f32_16x16x32_bf16 v[76:79], a[8:11], a[4:7], v[76:79]
    v_cndmask_b32 v200, v200, v236, s[32:33]
    v_cndmask_b32 v201, v201, v236, s[32:33]
    v_cndmask_b32 v202, v202, v236, s[32:33]
    v_cndmask_b32 v203, v203, v236, s[32:33]
    v_mfma_f32_16x16x32_bf16 v[80:83], a[12:15], a[0:3], v[80:83]
    v_mfma_f32_16x16x32_bf16 v[84:87], a[12:15], a[4:7], v[84:87]
    s_mul_i32 s42, s4, 1792
    s_add_u32 s42, s42, s6
    s_add_u32 s42, s42, 256
    buffer_store_dwordx4 a[132:135], v162, s[8:11], s42 offen sc1
    v_mfma_f32_16x16x32_bf16 v[88:91], a[16:19], a[0:3], v[88:91]
    v_mfma_f32_16x16x32_bf16 v[92:95], a[16:19], a[4:7], v[92:95]
    v_mfma_f32_16x16x32_bf16 v[96:99], a[20:23], a[0:3], v[96:99]
    s_mul_i32 s42, s4, -256
    s_add_u32 s42, s42, s6
    s_add_u32 s42, s42, 512
    buffer_store_dwordx4 a[136:139], v162, s[8:11], s42 offen sc1
    v_mfma_f32_16x16x32_bf16 v[100:103], a[20:23], a[4:7], v[100:103]
    v_mfma_f32_16x16x32_bf16 v[104:107], a[24:27], a[0:3], v[104:107]
    v_mfma_f32_16x16x32_bf16 v[108:111], a[24:27], a[4:7], v[108:111]
    s_mul_i32 s42, s4, 1536
    s_add_u32 s42, s42, s6
    s_add_u32 s42, s42, 768
    buffer_store_dwordx4 a[140:143], v162, s[8:11], s42 offen sc1
    v_mfma_f32_16x16x32_bf16 v[112:115], a[28:31], a[0:3], v[112:115]
    v_mfma_f32_16x16x32_bf16 v[116:119], a[28:31], a[4:7], v[116:119]
    v_mfma_f32_16x16x32_bf16 v[120:123], v[200:203], a[0:3], v[120:123]
    s_mul_i32 s42, s4, -36352
    s_add_u32 s42, s42, s6
    s_add_u32 s42, s42, 36864
    buffer_store_dwordx4 a[144:147], v162, s[8:11], s42 offen sc1
    v_mfma_f32_16x16x32_bf16 v[124:127], v[200:203], a[4:7], v[124:127]
    v_mfma_f32_16x16x32_bf16 v[128:131], a[24:27], v[144:147], v[128:131]
    v_mfma_f32_16x16x32_bf16 v[132:135], a[28:31], v[144:147], v[132:135]
    s_mul_i32 s42, s4, -34560
    s_add_u32 s42, s42, s6
    s_add_u32 s42, s42, 37120
    buffer_store_dwordx4 a[148:151], v162, s[8:11], s42 offen sc1
    v_mfma_f32_16x16x32_bf16 v[136:139], v[200:203], v[144:147], v[136:139]
    v_mfma_f32_16x16x32_bf16 v[44:47], a[32:35], a[32:35], v[44:47]
    s_waitcnt lgkmcnt(3)
    v_dot2c_f32_bf16 v164, v176, v166
    v_dot2c_f32_bf16 v164, v177, v166
    s_waitcnt lgkmcnt(2)
    v_dot2c_f32_bf16 v164, v178, v166
    v_dot2c_f32_bf16 v164, v179, v166
    v_accvgpr_write_b32 a184, v176
    v_accvgpr_write_b32 a185, v177
    v_accvgpr_write_b32 a186, v178
    v_accvgpr_write_b32 a187, v179
    v_mfma_f32_16x16x32_bf16 v[48:51], v[148:151], v[148:151], v[48:51]
    s_waitcnt lgkmcnt(1)
    v_dot2c_f32_bf16 v165, v180, v166
    v_dot2c_f32_bf16 v165, v181, v166
    s_waitcnt lgkmcnt(0)
    v_dot2c_f32_bf16 v165, v182, v166
    v_dot2c_f32_bf16 v165, v183, v166
    v_accvgpr_write_b32 a188, v180
    v_accvgpr_write_b32 a189, v181
    v_accvgpr_write_b32 a190, v182
    v_accvgpr_write_b32 a191, v183
    v_mfma_f32_16x16x32_bf16 v[72:75], a[40:43], a[32:35], v[72:75]
    s_mul_i32 s42, s4, -36608
    s_add_u32 s42, s42, s6
    s_add_u32 s42, s42, 37376
    buffer_store_dwordx4 a[152:155], v162, s[8:11], s42 offen sc1
    v_cndmask_b32 v148, v148, v236, s[30:31]
    v_cndmask_b32 v149, v149, v236, s[30:31]
    v_cndmask_b32 v150, v150, v236, s[30:31]
    v_cndmask_b32 v151, v151, v236, s[30:31]
    v_mfma_f32_16x16x32_bf16 v[76:79], a[40:43], a[36:39], v[76:79]
    v_cndmask_b32 v204, v204, v236, s[32:33]
    v_cndmask_b32 v205, v205, v236, s[32:33]
    v_cndmask_b32 v206, v206, v236, s[32:33]
    v_cndmask_b32 v207, v207, v236, s[32:33]
    v_mfma_f32_16x16x32_bf16 v[80:83], a[44:47], a[32:35], v[80:83]
    v_mfma_f32_16x16x32_bf16 v[84:87], a[44:47], a[36:39], v[84:87]
    s_mul_i32 s42, s4, -34816
    s_add_u32 s42, s42, s6
    s_add_u32 s42, s42, 37632
    buffer_store_dwordx4 a[156:159], v162, s[8:11], s42 offen sc1
    v_mfma_f32_16x16x32_bf16 v[88:91], a[48:51], a[32:35], v[88:91]
    v_mfma_f32_16x16x32_bf16 v[92:95], a[48:51], a[36:39], v[92:95]
    v_mfma_f32_16x16x32_bf16 v[96:99], a[52:55], a[32:35], v[96:99]
    s_mul_i32 s42, s4, -69632
    s_add_u32 s42, s42, s6
    s_add_u32 s42, s42, 73728
    buffer_store_dwordx4 a[160:163], v162, s[8:11], s42 offen sc1
    v_mfma_f32_16x16x32_bf16 v[100:103], a[52:55], a[36:39], v[100:103]
    v_mfma_f32_16x16x32_bf16 v[104:107], a[56:59], a[32:35], v[104:107]
    v_mfma_f32_16x16x32_bf16 v[108:111], a[56:59], a[36:39], v[108:111]
    s_mul_i32 s42, s4, -67840
    s_add_u32 s42, s42, s6
    s_add_u32 s42, s42, 73984
    buffer_store_dwordx4 a[164:167], v162, s[8:11], s42 offen sc1
    v_mfma_f32_16x16x32_bf16 v[112:115], a[60:63], a[32:35], v[112:115]
    v_mfma_f32_16x16x32_bf16 v[116:119], a[60:63], a[36:39], v[116:119]
    v_mfma_f32_16x16x32_bf16 v[120:123], v[204:207], a[32:35], v[120:123]
    s_mul_i32 s42, s4, -69888
    s_add_u32 s42, s42, s6
    s_add_u32 s42, s42, 74240
    buffer_store_dwordx4 a[168:171], v162, s[8:11], s42 offen sc1
    v_mfma_f32_16x16x32_bf16 v[124:127], v[204:207], a[36:39], v[124:127]
    v_mfma_f32_16x16x32_bf16 v[128:131], a[56:59], v[148:151], v[128:131]
    v_mfma_f32_16x16x32_bf16 v[132:135], a[60:63], v[148:151], v[132:135]
    s_mul_i32 s42, s4, -68096
    s_add_u32 s42, s42, s6
    s_add_u32 s42, s42, 74496
    buffer_store_dwordx4 a[172:175], v162, s[8:11], s42 offen sc1
    v_mfma_f32_16x16x32_bf16 v[136:139], v[204:207], v[148:151], v[136:139]
    v_and_b32 v14, 15, v2
    v_lshrrev_b32 v17, 4, v2
    v_lshlrev_b32 v15, 3, v14
    v_add_u32 v15, 119808, v15
    s_lshl_b32 s22, s39, 7
    v_add_u32 v20, s22, v15
    s_lshl_b32 s22, s36, 7
    v_add_u32 v21, s22, v15
    v_and_b32 v18, 3, v14
    v_cmp_eq_u32 vcc, 1, v18
    s_nop 1
    v_cndmask_b32 v44, v44, v45, vcc
    v_cndmask_b32 v48, v48, v49, vcc
    v_cmp_eq_u32 vcc, 2, v18
    s_nop 1
    v_cndmask_b32 v44, v44, v46, vcc
    v_cndmask_b32 v48, v48, v50, vcc
    v_cmp_eq_u32 vcc, 3, v18
    s_nop 1
    v_cndmask_b32 v44, v44, v47, vcc
    v_cndmask_b32 v48, v48, v51, vcc
    v_lshrrev_b32 v18, 2, v14
    v_cmp_eq_u32 s[34:35], v18, v17
    v_lshlrev_b32 v18, 4, v17
    s_mul_i32 s22, s27, 448
    s_add_u32 s22, s22, 120576
    v_add_u32 v18, s22, v18
    s_lshl_b32 s22, s27, 2
    v_add_u32 v25, s22, v17
    v_cmp_eq_u32 s[40:41], 6, v25
    s_lshl_b32 s22, s27, 1
    v_add_u32 v25, s22, v17
    v_cmp_gt_u32 s[32:33], 4, v25
    s_mov_b64 exec, s[34:35]
    ds_write_b32 v20, v44 offset:4
    ds_write_b32 v15, v48 offset:4
    s_mov_b64 exec, s[30:31]
    ds_write_b128 v18, v[128:131] offset:256
    ds_write_b128 v18, v[132:135] offset:320
    ds_write_b128 v18, v[136:139] offset:384
    s_cmp_eq_u32 s27, 0
    s_cbranch_scc1 KAB_G1_NS
    s_mov_b64 exec, s[40:41]
    ds_write_b32 v20, v120
    ds_write_b32 v21, v124
    ds_write_b32 v15, v136
KAB_G1_NS:
    s_mov_b64 exec, -1
    s_add_u32 s29, s3, 0
    s_min_u32 s29, s29, 2
    s_add_u32 s29, s29, 78
    s_lshl_b32 m0, s29, 10
    s_lshl_b32 s29, s29, 6
    v_add_u32 v250, s29, v2
    v_mul_u32_u24 v251, 7282, v250
    v_lshrrev_b32 v251, 16, v251
    v_mul_u32_u24 v251, 1008, v251
    v_lshl_add_u32 v251, v250, 4, v251
    buffer_load_dwordx4 v251, s[44:47], s26 offen lds
    v_mov_b32 v26, 0x3ae38e39
    v_mov_b32 v27, 0x3ae38e39
    v_mul_u32_u24 v22, 440, v14
    v_lshl_add_u32 v22, v17, 3, v22
    s_mul_i32 s22, s27, 224
    s_add_u32 s22, s22, 83968
    v_add_u32 v22, s22, v22
    s_mul_i32 s22, s39, 7040
    v_add_u32 v23, s22, v22
    s_mul_i32 s22, s36, 7040
    v_add_u32 v24, s22, v22
    s_waitcnt lgkmcnt(0)
    s_barrier
    ds_read_b64 v[28:29], v20
    ds_read_b64 v[30:31], v21
    ds_read_b64 v[32:33], v15
    ds_read_b128 v[40:43], v18 offset:0
    ds_read_b128 v[44:47], v18 offset:64
    ds_read_b128 v[48:51], v18 offset:128
    ds_read_b128 v[52:55], v18 offset:192
    ds_read_b128 v[56:59], v18 offset:256
    ds_read_b128 v[60:63], v18 offset:320
    ds_read_b128 v[64:67], v18 offset:384
    s_waitcnt lgkmcnt(9)
    v_pk_mul_f32 v[28:29], v[28:29], v[26:27]
    s_waitcnt lgkmcnt(8)
    v_pk_mul_f32 v[30:31], v[30:31], v[26:27]
    s_waitcnt lgkmcnt(7)
    v_pk_mul_f32 v[32:33], v[32:33], v[26:27]
    v_fma_f32 v29, -v28, v28, v29
    v_fma_f32 v31, -v30, v30, v31
    v_fma_f32 v33, -v32, v32, v33
    v_max_f32 v29, 0, v29
    v_max_f32 v31, 0, v31
    v_max_f32 v33, 0, v33
    v_add_f32 v29, 0x3727c5ac, v29
    v_add_f32 v31, 0x3727c5ac, v31
    v_add_f32 v33, 0x3727c5ac, v33
    v_rsq_f32 v29, v29
    v_rsq_f32 v31, v31
    v_rsq_f32 v33, v33
    v_mul_f32 v28, -v28, v29
    v_mul_f32 v30, -v30, v31
    v_mul_f32 v32, -v32, v33
    v_pk_mul_f32 v[72:73], v[72:73], v[28:29] op_sel:[0,1] op_sel_hi:[1,1]
    v_pk_mul_f32 v[74:75], v[74:75], v[28:29] op_sel:[0,1] op_sel_hi:[1,1]
    s_waitcnt lgkmcnt(6)
    v_pk_fma_f32 v[72:73], v[40:41], v[28:29], v[72:73] op_sel:[0,0,0] op_sel_hi:[1,0,1]
    v_pk_fma_f32 v[74:75], v[42:43], v[28:29], v[74:75] op_sel:[0,0,0] op_sel_hi:[1,0,1]
    v_cvt_pk_bf16_f32 v72, v72, v73
    v_cvt_pk_bf16_f32 v73, v74, v75
    ds_write_b64 v23, v[72:73] offset:0
    v_pk_mul_f32 v[76:77], v[76:77], v[30:31] op_sel:[0,1] op_sel_hi:[1,1]
    v_pk_mul_f32 v[78:79], v[78:79], v[30:31] op_sel:[0,1] op_sel_hi:[1,1]
    v_pk_fma_f32 v[76:77], v[40:41], v[30:31], v[76:77] op_sel:[0,0,0] op_sel_hi:[1,0,1]
    v_pk_fma_f32 v[78:79], v[42:43], v[30:31], v[78:79] op_sel:[0,0,0] op_sel_hi:[1,0,1]
    v_cvt_pk_bf16_f32 v76, v76, v77
    v_cvt_pk_bf16_f32 v77, v78, v79
    ds_write_b64 v24, v[76:77] offset:0
    s_mul_i32 s42, s4, -105984
    s_add_u32 s42, s42, s6
    s_add_u32 s42, s42, 110592
    buffer_store_dwordx4 a[176:179], v162, s[8:11], s42 offen sc1
    v_pk_mul_f32 v[80:81], v[80:81], v[28:29] op_sel:[0,1] op_sel_hi:[1,1]
    v_pk_mul_f32 v[82:83], v[82:83], v[28:29] op_sel:[0,1] op_sel_hi:[1,1]
    s_waitcnt lgkmcnt(7)
    v_pk_fma_f32 v[80:81], v[44:45], v[28:29], v[80:81] op_sel:[0,0,0] op_sel_hi:[1,0,1]
    v_pk_fma_f32 v[82:83], v[46:47], v[28:29], v[82:83] op_sel:[0,0,0] op_sel_hi:[1,0,1]
    v_cvt_pk_bf16_f32 v80, v80, v81
    v_cvt_pk_bf16_f32 v81, v82, v83
    ds_write_b64 v23, v[80:81] offset:32
    v_pk_mul_f32 v[84:85], v[84:85], v[30:31] op_sel:[0,1] op_sel_hi:[1,1]
    v_pk_mul_f32 v[86:87], v[86:87], v[30:31] op_sel:[0,1] op_sel_hi:[1,1]
    v_pk_fma_f32 v[84:85], v[44:45], v[30:31], v[84:85] op_sel:[0,0,0] op_sel_hi:[1,0,1]
    v_pk_fma_f32 v[86:87], v[46:47], v[30:31], v[86:87] op_sel:[0,0,0] op_sel_hi:[1,0,1]
    v_cvt_pk_bf16_f32 v84, v84, v85
    v_cvt_pk_bf16_f32 v85, v86, v87
    ds_write_b64 v24, v[84:85] offset:32
    s_mul_i32 s42, s4, -104192
    s_add_u32 s42, s42, s6
    s_add_u32 s42, s42, 110848
    buffer_store_dwordx4 a[180:183], v162, s[8:11], s42 offen sc1
    v_pk_mul_f32 v[88:89], v[88:89], v[28:29] op_sel:[0,1] op_sel_hi:[1,1]
    v_pk_mul_f32 v[90:91], v[90:91], v[28:29] op_sel:[0,1] op_sel_hi:[1,1]
    s_waitcnt lgkmcnt(8)
    v_pk_fma_f32 v[88:89], v[48:49], v[28:29], v[88:89] op_sel:[0,0,0] op_sel_hi:[1,0,1]
    v_pk_fma_f32 v[90:91], v[50:51], v[28:29], v[90:91] op_sel:[0,0,0] op_sel_hi:[1,0,1]
    v_cvt_pk_bf16_f32 v88, v88, v89
    v_cvt_pk_bf16_f32 v89, v90, v91
    ds_write_b64 v23, v[88:89] offset:64
    v_pk_mul_f32 v[92:93], v[92:93], v[30:31] op_sel:[0,1] op_sel_hi:[1,1]
    v_pk_mul_f32 v[94:95], v[94:95], v[30:31] op_sel:[0,1] op_sel_hi:[1,1]
    v_pk_fma_f32 v[92:93], v[48:49], v[30:31], v[92:93] op_sel:[0,0,0] op_sel_hi:[1,0,1]
    v_pk_fma_f32 v[94:95], v[50:51], v[30:31], v[94:95] op_sel:[0,0,0] op_sel_hi:[1,0,1]
    v_cvt_pk_bf16_f32 v92, v92, v93
    v_cvt_pk_bf16_f32 v93, v94, v95
    ds_write_b64 v24, v[92:93] offset:64
    s_mul_i32 s42, s4, -106240
    s_add_u32 s42, s42, s6
    s_add_u32 s42, s42, 111104
    buffer_store_dwordx4 a[184:187], v162, s[8:11], s42 offen sc1
    v_pk_mul_f32 v[96:97], v[96:97], v[28:29] op_sel:[0,1] op_sel_hi:[1,1]
    v_pk_mul_f32 v[98:99], v[98:99], v[28:29] op_sel:[0,1] op_sel_hi:[1,1]
    s_waitcnt lgkmcnt(9)
    v_pk_fma_f32 v[96:97], v[52:53], v[28:29], v[96:97] op_sel:[0,0,0] op_sel_hi:[1,0,1]
    v_pk_fma_f32 v[98:99], v[54:55], v[28:29], v[98:99] op_sel:[0,0,0] op_sel_hi:[1,0,1]
    v_cvt_pk_bf16_f32 v96, v96, v97
    v_cvt_pk_bf16_f32 v97, v98, v99
    ds_write_b64 v23, v[96:97] offset:96
    v_pk_mul_f32 v[100:101], v[100:101], v[30:31] op_sel:[0,1] op_sel_hi:[1,1]
    v_pk_mul_f32 v[102:103], v[102:103], v[30:31] op_sel:[0,1] op_sel_hi:[1,1]
    v_pk_fma_f32 v[100:101], v[52:53], v[30:31], v[100:101] op_sel:[0,0,0] op_sel_hi:[1,0,1]
    v_pk_fma_f32 v[102:103], v[54:55], v[30:31], v[102:103] op_sel:[0,0,0] op_sel_hi:[1,0,1]
    v_cvt_pk_bf16_f32 v100, v100, v101
    v_cvt_pk_bf16_f32 v101, v102, v103
    ds_write_b64 v24, v[100:101] offset:96
    s_mul_i32 s42, s4, -104448
    s_add_u32 s42, s42, s6
    s_add_u32 s42, s42, 111360
    buffer_store_dwordx4 a[188:191], v162, s[8:11], s42 offen sc1
    v_pk_mul_f32 v[104:105], v[104:105], v[28:29] op_sel:[0,1] op_sel_hi:[1,1]
    v_pk_mul_f32 v[106:107], v[106:107], v[28:29] op_sel:[0,1] op_sel_hi:[1,1]
    s_waitcnt lgkmcnt(10)
    v_pk_fma_f32 v[104:105], v[56:57], v[28:29], v[104:105] op_sel:[0,0,0] op_sel_hi:[1,0,1]
    v_pk_fma_f32 v[106:107], v[58:59], v[28:29], v[106:107] op_sel:[0,0,0] op_sel_hi:[1,0,1]
    v_cvt_pk_bf16_f32 v104, v104, v105
    v_cvt_pk_bf16_f32 v105, v106, v107
    ds_write_b64 v23, v[104:105] offset:128
    v_pk_mul_f32 v[108:109], v[108:109], v[30:31] op_sel:[0,1] op_sel_hi:[1,1]
    v_pk_mul_f32 v[110:111], v[110:111], v[30:31] op_sel:[0,1] op_sel_hi:[1,1]
    v_pk_fma_f32 v[108:109], v[56:57], v[30:31], v[108:109] op_sel:[0,0,0] op_sel_hi:[1,0,1]
    v_pk_fma_f32 v[110:111], v[58:59], v[30:31], v[110:111] op_sel:[0,0,0] op_sel_hi:[1,0,1]
    v_cvt_pk_bf16_f32 v108, v108, v109
    v_cvt_pk_bf16_f32 v109, v110, v111
    ds_write_b64 v24, v[108:109] offset:128
    buffer_store_dword v164, v163, s[8:11], 0 offen offset:0 sc1
    v_pk_mul_f32 v[112:113], v[112:113], v[28:29] op_sel:[0,1] op_sel_hi:[1,1]
    v_pk_mul_f32 v[114:115], v[114:115], v[28:29] op_sel:[0,1] op_sel_hi:[1,1]
    s_waitcnt lgkmcnt(11)
    v_pk_fma_f32 v[112:113], v[60:61], v[28:29], v[112:113] op_sel:[0,0,0] op_sel_hi:[1,0,1]
    v_pk_fma_f32 v[114:115], v[62:63], v[28:29], v[114:115] op_sel:[0,0,0] op_sel_hi:[1,0,1]
    v_cvt_pk_bf16_f32 v112, v112, v113
    v_cvt_pk_bf16_f32 v113, v114, v115
    ds_write_b64 v23, v[112:113] offset:160
    v_pk_mul_f32 v[116:117], v[116:117], v[30:31] op_sel:[0,1] op_sel_hi:[1,1]
    v_pk_mul_f32 v[118:119], v[118:119], v[30:31] op_sel:[0,1] op_sel_hi:[1,1]
    v_pk_fma_f32 v[116:117], v[60:61], v[30:31], v[116:117] op_sel:[0,0,0] op_sel_hi:[1,0,1]
    v_pk_fma_f32 v[118:119], v[62:63], v[30:31], v[118:119] op_sel:[0,0,0] op_sel_hi:[1,0,1]
    v_cvt_pk_bf16_f32 v116, v116, v117
    v_cvt_pk_bf16_f32 v117, v118, v119
    ds_write_b64 v24, v[116:117] offset:160
    buffer_store_dword v165, v163, s[8:11], 0 offen offset:128 sc1
    v_pk_mul_f32 v[120:121], v[120:121], v[28:29] op_sel:[0,1] op_sel_hi:[1,1]
    v_pk_mul_f32 v[122:123], v[122:123], v[28:29] op_sel:[0,1] op_sel_hi:[1,1]
    s_waitcnt lgkmcnt(12)
    v_pk_fma_f32 v[120:121], v[64:65], v[28:29], v[120:121] op_sel:[0,0,0] op_sel_hi:[1,0,1]
    v_pk_fma_f32 v[122:123], v[66:67], v[28:29], v[122:123] op_sel:[0,0,0] op_sel_hi:[1,0,1]
    v_cvt_pk_bf16_f32 v120, v120, v121
    v_cvt_pk_bf16_f32 v121, v122, v123
    s_mov_b64 exec, s[32:33]
    ds_write_b64 v23, v[120:121] offset:192
    s_mov_b64 exec, -1
    v_pk_mul_f32 v[124:125], v[124:125], v[30:31] op_sel:[0,1] op_sel_hi:[1,1]
    v_pk_mul_f32 v[126:127], v[126:127], v[30:31] op_sel:[0,1] op_sel_hi:[1,1]
    v_pk_fma_f32 v[124:125], v[64:65], v[30:31], v[124:125] op_sel:[0,0,0] op_sel_hi:[1,0,1]
    v_pk_fma_f32 v[126:127], v[66:67], v[30:31], v[126:127] op_sel:[0,0,0] op_sel_hi:[1,0,1]
    v_cvt_pk_bf16_f32 v124, v124, v125
    v_cvt_pk_bf16_f32 v125, v126, v127
    s_mov_b64 exec, s[32:33]
    ds_write_b64 v24, v[124:125] offset:192
    s_mov_b64 exec, -1
    v_pk_mul_f32 v[128:129], v[128:129], v[32:33] op_sel:[0,1] op_sel_hi:[1,1]
    v_pk_mul_f32 v[130:131], v[130:131], v[32:33] op_sel:[0,1] op_sel_hi:[1,1]
    v_pk_fma_f32 v[128:129], v[56:57], v[32:33], v[128:129] op_sel:[0,0,0] op_sel_hi:[1,0,1]
    v_pk_fma_f32 v[130:131], v[58:59], v[32:33], v[130:131] op_sel:[0,0,0] op_sel_hi:[1,0,1]
    v_cvt_pk_bf16_f32 v128, v128, v129
    v_cvt_pk_bf16_f32 v129, v130, v131
    ds_write_b64 v22, v[128:129] offset:128
    v_pk_mul_f32 v[132:133], v[132:133], v[32:33] op_sel:[0,1] op_sel_hi:[1,1]
    v_pk_mul_f32 v[134:135], v[134:135], v[32:33] op_sel:[0,1] op_sel_hi:[1,1]
    v_pk_fma_f32 v[132:133], v[60:61], v[32:33], v[132:133] op_sel:[0,0,0] op_sel_hi:[1,0,1]
    v_pk_fma_f32 v[134:135], v[62:63], v[32:33], v[134:135] op_sel:[0,0,0] op_sel_hi:[1,0,1]
    v_cvt_pk_bf16_f32 v132, v132, v133
    v_cvt_pk_bf16_f32 v133, v134, v135
    ds_write_b64 v22, v[132:133] offset:160
    v_pk_mul_f32 v[136:137], v[136:137], v[32:33] op_sel:[0,1] op_sel_hi:[1,1]
    v_pk_mul_f32 v[138:139], v[138:139], v[32:33] op_sel:[0,1] op_sel_hi:[1,1]
    v_pk_fma_f32 v[136:137], v[64:65], v[32:33], v[136:137] op_sel:[0,0,0] op_sel_hi:[1,0,1]
    v_pk_fma_f32 v[138:139], v[66:67], v[32:33], v[138:139] op_sel:[0,0,0] op_sel_hi:[1,0,1]
    v_cvt_pk_bf16_f32 v136, v136, v137
    v_cvt_pk_bf16_f32 v137, v138, v139
    s_mov_b64 exec, s[32:33]
    ds_write_b64 v22, v[136:137] offset:192
    s_mov_b64 exec, -1
KAB_AJ:
    s_waitcnt lgkmcnt(0)
    s_barrier
    s_lshl_b32 s36, s20, 6
    v_and_b32 v12, 7, v2
    v_lshlrev_b32 v12, 3, v12
    buffer_load_dwordx2 v[248:249], v3, s[48:51], 0 offen sc1
    s_add_u32 s36, s36, 0x2c20000
    ds_read_b64 v[20:21], v240 offset:0
    ds_read_b64 v[22:23], v240 offset:8
    ds_read_b64 v[36:37], v242 offset:144
    ds_read_b64 v[38:39], v242 offset:152
    ds_read_b64 v[52:53], v240 offset:144
    ds_read_b64 v[54:55], v240 offset:152
    ds_read_b64 v[24:25], v240 offset:32
    ds_read_b64 v[26:27], v240 offset:40
    ds_read_b64 v[40:41], v242 offset:176
    ds_read_b64 v[42:43], v242 offset:184
    ds_read_b64 v[56:57], v240 offset:176
    ds_read_b64 v[58:59], v240 offset:184
    ds_read_b64 v[28:29], v240 offset:72
    ds_read_b64 v[30:31], v240 offset:80
    ds_read_b64 v[44:45], v242 offset:216
    ds_read_b64 v[46:47], v242 offset:224
    ds_read_b64 v[60:61], v240 offset:216
    ds_read_b64 v[62:63], v240 offset:224
    ds_read_b64 v[32:33], v240 offset:104
    ds_read_b64 v[34:35], v240 offset:112
    ds_read_b64 v[48:49], v242 offset:248
    ds_read_b64 v[50:51], v242 offset:256
    ds_read_b64 v[64:65], v240 offset:248
    ds_read_b64 v[66:67], v240 offset:256
    s_lshl_b32 s22, s20, 2
    s_add_u32 s22, s22, s3
    s_mul_i32 s22, s22, 18432
    s_mul_i32 s23, s21, 2304
    s_add_u32 s22, s22, s23
    s_add_u32 s22, s22, 0x0
    v_cmp_gt_u32 s[40:41], 16, v2
    s_mov_b32 s24, 0x3eae1a93
    s_waitcnt lgkmcnt(15)
    v_and_b32 v20, v228, v20
    v_and_b32 v21, v229, v21
    v_and_b32 v22, v230, v22
    v_and_b32 v23, v231, v23
    s_nop 1
    v_mfma_f32_16x16x32_bf16 v[100:103], v[36:39], v[20:23], v[224:227]
    v_mfma_f32_16x16x32_bf16 v[104:107], v[52:55], v[20:23], v[216:219]
    v_and_b32 v24, v232, v24
    v_and_b32 v25, v233, v25
    v_and_b32 v26, v234, v26
    v_and_b32 v27, v235, v27
    s_waitcnt lgkmcnt(14)
    s_nop 0
    v_mfma_f32_16x16x32_bf16 v[108:111], v[40:43], v[24:27], v[224:227]
    s_waitcnt lgkmcnt(12)
    v_mfma_f32_16x16x32_bf16 v[112:115], v[56:59], v[24:27], v[216:219]
    s_waitcnt lgkmcnt(11)
    v_and_b32 v28, v228, v28
    v_and_b32 v29, v229, v29
    s_waitcnt lgkmcnt(10)
    v_and_b32 v30, v230, v30
    v_and_b32 v31, v231, v31
    s_waitcnt lgkmcnt(8)
    s_nop 0
    v_mfma_f32_16x16x32_bf16 v[116:119], v[44:47], v[28:31], v[224:227]
    s_waitcnt lgkmcnt(6)
    v_mfma_f32_16x16x32_bf16 v[120:123], v[60:63], v[28:31], v[216:219]
    s_waitcnt lgkmcnt(5)
    v_and_b32 v32, v232, v32
    v_and_b32 v33, v233, v33
    s_waitcnt lgkmcnt(4)
    v_and_b32 v34, v234, v34
    v_and_b32 v35, v235, v35
    s_waitcnt lgkmcnt(2)
    s_nop 0
    v_mfma_f32_16x16x32_bf16 v[124:127], v[48:51], v[32:35], v[224:227]
    s_waitcnt lgkmcnt(0)
    v_mfma_f32_16x16x32_bf16 v[128:131], v[64:67], v[32:35], v[216:219]
    ds_read_b64_tr_b16 v[68:69], v243 offset:288
    ds_read_b64_tr_b16 v[70:71], v241 offset:288
    ds_read_b64_tr_b16 v[72:73], v243 offset:320
    ds_read_b64_tr_b16 v[74:75], v241 offset:320
    ds_read_b64_tr_b16 v[76:77], v243 offset:320
    ds_read_b64_tr_b16 v[78:79], v241 offset:320
    ds_read_b64_tr_b16 v[80:81], v243 offset:352
    ds_read_b64_tr_b16 v[82:83], v241 offset:352
    ds_read_b64_tr_b16 v[84:85], v243 offset:360
    ds_read_b64_tr_b16 v[86:87], v241 offset:360
    ds_read_b64_tr_b16 v[88:89], v243 offset:392
    ds_read_b64_tr_b16 v[90:91], v241 offset:392
    ds_read_b64_tr_b16 v[92:93], v243 offset:392
    ds_read_b64_tr_b16 v[94:95], v241 offset:392
    ds_read_b64_tr_b16 v[96:97], v243 offset:424
    ds_read_b64_tr_b16 v[98:99], v241 offset:424
    v_max3_f32 v4, v100, v101, v102
    v_max3_f32 v5, v108, v109, v110
    v_max3_f32 v6, v116, v117, v118
    v_max3_f32 v7, v124, v125, v126
    v_max3_f32 v4, v4, v103, v104
    v_max3_f32 v5, v5, v111, v112
    v_max3_f32 v6, v6, v119, v120
    v_max3_f32 v7, v7, v127, v128
    v_max3_f32 v8, v105, v106, v107
    v_max3_f32 v9, v113, v114, v115
    v_max3_f32 v10, v121, v122, v123
    v_max3_f32 v11, v129, v130, v131
    v_max_f32 v4, v4, v8
    v_max_f32 v5, v5, v9
    v_max_f32 v6, v6, v10
    v_max_f32 v7, v7, v11
    v_mov_b32 v8, v4
    v_mov_b32 v9, v5
    v_mov_b32 v10, v6
    v_mov_b32 v11, v7
    v_permlane32_swap_b32 v4, v8
    v_permlane32_swap_b32 v5, v9
    v_permlane32_swap_b32 v6, v10
    v_permlane32_swap_b32 v7, v11
    v_max_f32 v4, v4, v8
    v_max_f32 v5, v5, v9
    v_max_f32 v6, v6, v10
    v_max_f32 v7, v7, v11
    v_mov_b32 v8, v4
    v_mov_b32 v9, v5
    v_mov_b32 v10, v6
    v_mov_b32 v11, v7
    v_permlane16_swap_b32 v4, v8
    v_permlane16_swap_b32 v5, v9
    v_permlane16_swap_b32 v6, v10
    v_permlane16_swap_b32 v7, v11
    v_max_f32 v4, v4, v8
    v_max_f32 v5, v5, v9
    v_max_f32 v6, v6, v10
    v_max_f32 v7, v7, v11
    v_mul_f32 v4, s24, v4
    v_mul_f32 v5, s24, v5
    v_mul_f32 v6, s24, v6
    v_mul_f32 v7, s24, v7
    v_fma_f32 v100, v100, s24, -v4
    v_fma_f32 v101, v101, s24, -v4
    v_fma_f32 v102, v102, s24, -v4
    v_fma_f32 v103, v103, s24, -v4
    v_fma_f32 v104, v104, s24, -v4
    v_fma_f32 v105, v105, s24, -v4
    v_fma_f32 v106, v106, s24, -v4
    v_fma_f32 v107, v107, s24, -v4
    v_exp_f32 v100, v100
    v_exp_f32 v101, v101
    v_exp_f32 v102, v102
    v_exp_f32 v103, v103
    v_exp_f32 v104, v104
    v_exp_f32 v105, v105
    v_exp_f32 v106, v106
    v_exp_f32 v107, v107
    v_cvt_pk_bf16_f32 v100, v100, v101
    v_cvt_pk_bf16_f32 v101, v102, v103
    v_cvt_pk_bf16_f32 v102, v104, v105
    v_cvt_pk_bf16_f32 v103, v106, v107
    v_fma_f32 v108, v108, s24, -v5
    v_fma_f32 v109, v109, s24, -v5
    v_fma_f32 v110, v110, s24, -v5
    v_fma_f32 v111, v111, s24, -v5
    v_fma_f32 v112, v112, s24, -v5
    v_fma_f32 v113, v113, s24, -v5
    v_fma_f32 v114, v114, s24, -v5
    v_fma_f32 v115, v115, s24, -v5
    v_exp_f32 v108, v108
    v_exp_f32 v109, v109
    v_exp_f32 v110, v110
    v_exp_f32 v111, v111
    v_exp_f32 v112, v112
    v_exp_f32 v113, v113
    v_exp_f32 v114, v114
    v_exp_f32 v115, v115
    v_cvt_pk_bf16_f32 v108, v108, v109
    v_cvt_pk_bf16_f32 v109, v110, v111
    v_cvt_pk_bf16_f32 v110, v112, v113
    v_cvt_pk_bf16_f32 v111, v114, v115
    v_mfma_f32_16x16x32_bf16 v[104:107], v[236:239], v[100:103], 0
    s_waitcnt lgkmcnt(14)
    v_mfma_f32_16x16x32_bf16 v[20:23], v[68:71], v[100:103], 0
    s_waitcnt lgkmcnt(12)
    v_mfma_f32_16x16x32_bf16 v[36:39], v[72:75], v[100:103], 0
    v_fma_f32 v116, v116, s24, -v6
    v_fma_f32 v117, v117, s24, -v6
    v_fma_f32 v118, v118, s24, -v6
    v_fma_f32 v119, v119, s24, -v6
    v_fma_f32 v120, v120, s24, -v6
    v_fma_f32 v121, v121, s24, -v6
    v_fma_f32 v122, v122, s24, -v6
    v_fma_f32 v123, v123, s24, -v6
    v_exp_f32 v116, v116
    v_exp_f32 v117, v117
    v_exp_f32 v118, v118
    v_exp_f32 v119, v119
    v_exp_f32 v120, v120
    v_exp_f32 v121, v121
    v_exp_f32 v122, v122
    v_exp_f32 v123, v123
    v_cvt_pk_bf16_f32 v116, v116, v117
    v_cvt_pk_bf16_f32 v117, v118, v119
    v_cvt_pk_bf16_f32 v118, v120, v121
    v_cvt_pk_bf16_f32 v119, v122, v123
    v_mfma_f32_16x16x32_bf16 v[112:115], v[236:239], v[108:111], 0
    s_waitcnt lgkmcnt(10)
    v_mfma_f32_16x16x32_bf16 v[24:27], v[76:79], v[108:111], 0
    s_waitcnt lgkmcnt(8)
    v_mfma_f32_16x16x32_bf16 v[40:43], v[80:83], v[108:111], 0
    v_fma_f32 v124, v124, s24, -v7
    v_fma_f32 v125, v125, s24, -v7
    v_fma_f32 v126, v126, s24, -v7
    v_fma_f32 v127, v127, s24, -v7
    v_fma_f32 v128, v128, s24, -v7
    v_fma_f32 v129, v129, s24, -v7
    v_fma_f32 v130, v130, s24, -v7
    v_fma_f32 v131, v131, s24, -v7
    v_exp_f32 v124, v124
    v_exp_f32 v125, v125
    v_exp_f32 v126, v126
    v_exp_f32 v127, v127
    v_exp_f32 v128, v128
    v_exp_f32 v129, v129
    v_exp_f32 v130, v130
    v_exp_f32 v131, v131
    v_cvt_pk_bf16_f32 v124, v124, v125
    v_cvt_pk_bf16_f32 v125, v126, v127
    v_cvt_pk_bf16_f32 v126, v128, v129
    v_cvt_pk_bf16_f32 v127, v130, v131
    v_mfma_f32_16x16x32_bf16 v[120:123], v[236:239], v[116:119], 0
    s_waitcnt lgkmcnt(6)
    v_mfma_f32_16x16x32_bf16 v[28:31], v[84:87], v[116:119], 0
    s_waitcnt lgkmcnt(4)
    v_mfma_f32_16x16x32_bf16 v[44:47], v[88:91], v[116:119], 0
    v_mfma_f32_16x16x32_bf16 v[128:131], v[236:239], v[124:127], 0
    s_waitcnt lgkmcnt(2)
    v_mfma_f32_16x16x32_bf16 v[32:35], v[92:95], v[124:127], 0
    s_waitcnt lgkmcnt(0)
    v_mfma_f32_16x16x32_bf16 v[48:51], v[96:99], v[124:127], 0
    v_rcp_f32 v4, v104
    v_rcp_f32 v5, v112
    v_mul_f32 v20, v4, v20
    v_mul_f32 v21, v4, v21
    v_mul_f32 v22, v4, v22
    v_mul_f32 v23, v4, v23
    v_mul_f32 v36, v4, v36
    v_mul_f32 v37, v4, v37
    v_rcp_f32 v6, v120
    v_mul_f32 v24, v5, v24
    v_mul_f32 v25, v5, v25
    v_mul_f32 v26, v5, v26
    v_mul_f32 v27, v5, v27
    v_mul_f32 v40, v5, v40
    v_mul_f32 v41, v5, v41
    v_mul_f32 v42, v5, v42
    v_mul_f32 v43, v5, v43
    v_rcp_f32 v7, v128
    v_mul_f32 v28, v6, v28
    v_mul_f32 v29, v6, v29
    v_mul_f32 v30, v6, v30
    v_mul_f32 v31, v6, v31
    v_mul_f32 v44, v6, v44
    v_mul_f32 v45, v6, v45
    v_mul_f32 v32, v7, v32
    v_mul_f32 v33, v7, v33
    v_mul_f32 v34, v7, v34
    v_mul_f32 v35, v7, v35
    v_mul_f32 v48, v7, v48
    v_mul_f32 v49, v7, v49
    v_mul_f32 v50, v7, v50
    v_mul_f32 v51, v7, v51
    v_cndmask_b32 v24, v24, v36, s[40:41]
    v_cndmask_b32 v25, v25, v37, s[40:41]
    v_cvt_pk_bf16_f32 v20, v20, v21
    v_cvt_pk_bf16_f32 v21, v22, v23
    ds_write_b64 v244, v[20:21] offset:0
    v_cvt_pk_bf16_f32 v24, v24, v25
    v_cvt_pk_bf16_f32 v25, v26, v27
    ds_write_b64 v244, v[24:25] offset:512
    v_cvt_pk_bf16_f32 v40, v40, v41
    v_cvt_pk_bf16_f32 v41, v42, v43
    s_mov_b64 exec, s[40:41]
    ds_write_b64 v244, v[40:41] offset:1024
    s_mov_b64 exec, -1
    v_cndmask_b32 v32, v32, v44, s[40:41]
    v_cndmask_b32 v33, v33, v45, s[40:41]
    v_cvt_pk_bf16_f32 v28, v28, v29
    v_cvt_pk_bf16_f32 v29, v30, v31
    ds_write_b64 v245, v[28:29] offset:1024
    v_cvt_pk_bf16_f32 v32, v32, v33
    v_cvt_pk_bf16_f32 v33, v34, v35
    ds_write_b64 v245, v[32:33] offset:1536
    v_cvt_pk_bf16_f32 v48, v48, v49
    v_cvt_pk_bf16_f32 v49, v50, v51
    s_mov_b64 exec, s[40:41]
    ds_write_b64 v245, v[48:49] offset:2048
    s_mov_b64 exec, -1
    v_lshlrev_b32 v4, 4, v2
    s_mul_i32 s23, s3, 2304
    s_add_u32 s23, s23, 122880
    v_add_u32 v5, s23, v4
    s_waitcnt lgkmcnt(0)
    s_barrier
    ds_read_b128 v[20:23], v5 offset:0
    ds_read_b128 v[24:27], v5 offset:1024
    ds_read_b128 v[28:31], v5 offset:2048
    s_waitcnt lgkmcnt(2)
    buffer_store_dwordx4 v[20:23], v4, s[8:11], s22 offen offset:0 sc1
    s_waitcnt lgkmcnt(1)
    buffer_store_dwordx4 v[24:27], v4, s[8:11], s22 offen offset:1024 sc1
    s_mov_b64 exec, 0xffff
    s_waitcnt lgkmcnt(0)
    buffer_store_dwordx4 v[28:31], v4, s[8:11], s22 offen offset:2048 sc1
    s_mov_b64 exec, -1
    s_waitcnt vmcnt(0)
    s_barrier
    s_mov_b32 s43, 20000
KAB_NL:
    v_readfirstlane_b32 s22, v248
    s_nop 0
    s_cmp_lg_u32 s22, 0
    s_cbranch_scc1 KAB_NOK
    s_sub_u32 s43, s43, 1
    s_cmp_eq_u32 s43, 0
    s_cbranch_scc1 KAB_NOK
    buffer_load_dwordx2 v[248:249], v3, s[48:51], 0 offen sc1
    s_waitcnt vmcnt(0)
    s_branch KAB_NL
KAB_NOK:
    s_cmp_lg_u32 s3, 0
    s_cbranch_scc1 KAB_NF
    s_lshl_b32 s23, s21, 3
    s_add_u32 s23, s23, s36
    buffer_store_dwordx2 v[248:249], v3, s[8:11], s23 offen sc1
KAB_NF:
    s_lshl_b32 s22, s20, 2
    s_add_u32 s22, s22, s3
    v_and_b32 v8, 15, v2
    v_lshrrev_b32 v9, 4, v2
    v_mul_u32_u24 v10, 1152, v8
    v_lshl_add_u32 v10, v9, 3, v10
    s_mul_i32 s23, s22, 18432
    s_add_u32 s23, s23, s26
    buffer_load_dwordx2 v[200:201], v10, s[12:15], s23 offen offset:0
    buffer_load_dwordx2 v[202:203], v10, s[12:15], s23 offen offset:32
    buffer_load_dwordx2 v[204:205], v10, s[12:15], s23 offen offset:64
    buffer_load_dwordx2 v[206:207], v10, s[12:15], s23 offen offset:96
    buffer_load_dwordx2 v[208:209], v10, s[12:15], s23 offen offset:128
    ds_read_b64_tr_b16 a[0:1], v192 offset:0
    ds_read_b64_tr_b16 a[2:3], v192 offset:576
    ds_read_b64_tr_b16 a[4:5], v192 offset:32
    ds_read_b64_tr_b16 a[6:7], v192 offset:608
    ds_read_b64_tr_b16 a[8:9], v192 offset:64
    ds_read_b64_tr_b16 a[10:11], v192 offset:640
    ds_read_b64_tr_b16 a[12:13], v192 offset:96
    ds_read_b64_tr_b16 a[14:15], v192 offset:672
    ds_read_b64_tr_b16 a[16:17], v192 offset:128
    ds_read_b64_tr_b16 a[18:19], v192 offset:704
    ds_read_b64_tr_b16 a[20:21], v192 offset:4608
    ds_read_b64_tr_b16 a[22:23], v192 offset:5184
    ds_read_b64_tr_b16 a[24:25], v192 offset:4640
    ds_read_b64_tr_b16 a[26:27], v192 offset:5216
    ds_read_b64_tr_b16 a[28:29], v192 offset:4672
    ds_read_b64_tr_b16 a[30:31], v192 offset:5248
    ds_read_b64_tr_b16 a[32:33], v192 offset:4704
    ds_read_b64_tr_b16 a[34:35], v192 offset:5280
    ds_read_b64_tr_b16 a[36:37], v192 offset:4736
    ds_read_b64_tr_b16 a[38:39], v192 offset:5312
    ds_read_b64_tr_b16 a[40:41], v192 offset:9216
    ds_read_b64_tr_b16 a[42:43], v192 offset:9792
    ds_read_b64_tr_b16 a[44:45], v192 offset:9248
    ds_read_b64_tr_b16 a[46:47], v192 offset:9824
    ds_read_b64_tr_b16 a[48:49], v192 offset:9280
    ds_read_b64_tr_b16 a[50:51], v192 offset:9856
    ds_read_b64_tr_b16 a[52:53], v192 offset:9312
    ds_read_b64_tr_b16 a[54:55], v192 offset:9888
    ds_read_b64_tr_b16 a[56:57], v192 offset:9344
    ds_read_b64_tr_b16 a[58:59], v192 offset:9920
    ds_read_b64_tr_b16 a[60:61], v192 offset:13824
    ds_read_b64_tr_b16 a[62:63], v192 offset:14400
    ds_read_b64_tr_b16 a[64:65], v192 offset:13856
    ds_read_b64_tr_b16 a[66:67], v192 offset:14432
    ds_read_b64_tr_b16 a[68:69], v192 offset:13888
    ds_read_b64_tr_b16 a[70:71], v192 offset:14464
    ds_read_b64_tr_b16 a[72:73], v192 offset:13920
    ds_read_b64_tr_b16 a[74:75], v192 offset:14496
    ds_read_b64_tr_b16 a[76:77], v192 offset:13952
    ds_read_b64_tr_b16 a[78:79], v192 offset:14528
    ds_read_b64_tr_b16 a[80:81], v192 offset:18432
    ds_read_b64_tr_b16 a[82:83], v192 offset:19008
    ds_read_b64_tr_b16 a[84:85], v192 offset:18464
    ds_read_b64_tr_b16 a[86:87], v192 offset:19040
    ds_read_b64_tr_b16 a[88:89], v192 offset:18496
    ds_read_b64_tr_b16 a[90:91], v192 offset:19072
    ds_read_b64_tr_b16 a[92:93], v192 offset:18528
    ds_read_b64_tr_b16 a[94:95], v192 offset:19104
    ds_read_b64_tr_b16 a[96:97], v192 offset:18560
    ds_read_b64_tr_b16 a[98:99], v192 offset:19136
    ds_read_b64_tr_b16 a[100:101], v192 offset:23040
    ds_read_b64_tr_b16 a[102:103], v192 offset:23616
    ds_read_b64_tr_b16 a[104:105], v192 offset:23072
    ds_read_b64_tr_b16 a[106:107], v192 offset:23648
    ds_read_b64_tr_b16 a[108:109], v192 offset:23104
    ds_read_b64_tr_b16 a[110:111], v192 offset:23680
    ds_read_b64_tr_b16 a[112:113], v192 offset:23136
    ds_read_b64_tr_b16 a[114:115], v192 offset:23712
    ds_read_b64_tr_b16 a[116:117], v192 offset:23168
    ds_read_b64_tr_b16 a[118:119], v192 offset:23744
    ds_read_b64_tr_b16 a[120:121], v192 offset:27648
    ds_read_b64_tr_b16 a[122:123], v192 offset:28224
    ds_read_b64_tr_b16 a[124:125], v192 offset:27680
    ds_read_b64_tr_b16 a[126:127], v192 offset:28256
    ds_read_b64_tr_b16 a[128:129], v192 offset:27712
    ds_read_b64_tr_b16 a[130:131], v192 offset:28288
    ds_read_b64_tr_b16 a[132:133], v192 offset:27744
    ds_read_b64_tr_b16 a[134:135], v192 offset:28320
    ds_read_b64_tr_b16 a[136:137], v192 offset:27776
    ds_read_b64_tr_b16 a[138:139], v192 offset:28352
    ds_read_b64_tr_b16 a[140:141], v192 offset:32256
    ds_read_b64_tr_b16 a[142:143], v192 offset:32832
    ds_read_b64_tr_b16 a[144:145], v192 offset:32288
    ds_read_b64_tr_b16 a[146:147], v192 offset:32864
    ds_read_b64_tr_b16 a[148:149], v192 offset:32320
    ds_read_b64_tr_b16 a[150:151], v192 offset:32896
    ds_read_b64_tr_b16 a[152:153], v192 offset:32352
    ds_read_b64_tr_b16 a[154:155], v192 offset:32928
    ds_read_b64_tr_b16 a[156:157], v192 offset:32384
    ds_read_b64_tr_b16 a[158:159], v192 offset:32960
    ds_read_b64_tr_b16 a[160:161], v192 offset:36864
    ds_read_b64_tr_b16 a[162:163], v192 offset:37440
    ds_read_b64_tr_b16 a[164:165], v192 offset:36896
    ds_read_b64_tr_b16 a[166:167], v192 offset:37472
    ds_read_b64_tr_b16 a[168:169], v192 offset:36928
    ds_read_b64_tr_b16 a[170:171], v192 offset:37504
    ds_read_b64_tr_b16 a[172:173], v192 offset:36960
    ds_read_b64_tr_b16 a[174:175], v192 offset:37536
    ds_read_b64_tr_b16 a[176:177], v192 offset:36992
    ds_read_b64_tr_b16 a[178:179], v192 offset:37568
    ds_read_b64_tr_b16 a[180:181], v193 offset:0
    ds_read_b64_tr_b16 a[182:183], v193 offset:576
    ds_read_b64_tr_b16 a[184:185], v193 offset:32
    ds_read_b64_tr_b16 a[186:187], v193 offset:608
    ds_read_b64_tr_b16 a[188:189], v193 offset:64
    ds_read_b64_tr_b16 a[190:191], v193 offset:640
    ds_read_b64_tr_b16 a[192:193], v193 offset:96
    ds_read_b64_tr_b16 a[194:195], v193 offset:672
    ds_read_b64_tr_b16 a[196:197], v193 offset:128
    ds_read_b64_tr_b16 a[198:199], v193 offset:704
    ds_read_b64_tr_b16 a[200:201], v193 offset:4608
    ds_read_b64_tr_b16 a[202:203], v193 offset:5184
    ds_read_b64_tr_b16 a[204:205], v193 offset:4640
    ds_read_b64_tr_b16 a[206:207], v193 offset:5216
    ds_read_b64_tr_b16 a[208:209], v193 offset:4672
    ds_read_b64_tr_b16 a[210:211], v193 offset:5248
    ds_read_b64_tr_b16 a[212:213], v193 offset:4704
    ds_read_b64_tr_b16 a[214:215], v193 offset:5280
    ds_read_b64_tr_b16 a[216:217], v193 offset:4736
    ds_read_b64_tr_b16 a[218:219], v193 offset:5312
    ds_read_b64_tr_b16 a[220:221], v193 offset:9216
    ds_read_b64_tr_b16 a[222:223], v193 offset:9792
    ds_read_b64_tr_b16 a[224:225], v193 offset:9248
    ds_read_b64_tr_b16 a[226:227], v193 offset:9824
    ds_read_b64_tr_b16 a[228:229], v193 offset:9280
    ds_read_b64_tr_b16 a[230:231], v193 offset:9856
    ds_read_b64_tr_b16 a[232:233], v193 offset:9312
    ds_read_b64_tr_b16 a[234:235], v193 offset:9888
    ds_read_b64_tr_b16 a[236:237], v193 offset:9344
    ds_read_b64_tr_b16 a[238:239], v193 offset:9920
    ds_read_b64_tr_b16 a[240:241], v193 offset:13824
    ds_read_b64_tr_b16 a[242:243], v193 offset:14400
    ds_read_b64_tr_b16 a[244:245], v193 offset:13856
    ds_read_b64_tr_b16 a[246:247], v193 offset:14432
    ds_read_b64_tr_b16 a[248:249], v193 offset:13888
    ds_read_b64_tr_b16 a[250:251], v193 offset:14464
    ds_read_b64_tr_b16 a[252:253], v193 offset:13920
    ds_read_b64_tr_b16 a[254:255], v193 offset:14496
    ds_read_b64_tr_b16 v[88:89], v193 offset:13952
    ds_read_b64_tr_b16 v[90:91], v193 offset:14528
    ds_read_b64_tr_b16 v[92:93], v193 offset:18432
    ds_read_b64_tr_b16 v[94:95], v193 offset:19008
    ds_read_b64_tr_b16 v[96:97], v193 offset:18464
    ds_read_b64_tr_b16 v[98:99], v193 offset:19040
    ds_read_b64_tr_b16 v[100:101], v193 offset:18496
    ds_read_b64_tr_b16 v[102:103], v193 offset:19072
    ds_read_b64_tr_b16 v[104:105], v193 offset:18528
    ds_read_b64_tr_b16 v[106:107], v193 offset:19104
    ds_read_b64_tr_b16 v[108:109], v193 offset:18560
    ds_read_b64_tr_b16 v[110:111], v193 offset:19136
    ds_read_b64_tr_b16 v[112:113], v193 offset:23040
    ds_read_b64_tr_b16 v[114:115], v193 offset:23616
    ds_read_b64_tr_b16 v[116:117], v193 offset:23072
    ds_read_b64_tr_b16 v[118:119], v193 offset:23648
    ds_read_b64_tr_b16 v[120:121], v193 offset:23104
    ds_read_b64_tr_b16 v[122:123], v193 offset:23680
    ds_read_b64_tr_b16 v[124:125], v193 offset:23136
    ds_read_b64_tr_b16 v[126:127], v193 offset:23712
    ds_read_b64_tr_b16 v[128:129], v193 offset:23168
    ds_read_b64_tr_b16 v[130:131], v193 offset:23744
    ds_read_b64_tr_b16 v[132:133], v193 offset:27648
    ds_read_b64_tr_b16 v[134:135], v193 offset:28224
    ds_read_b64_tr_b16 v[136:137], v193 offset:27680
    ds_read_b64_tr_b16 v[138:139], v193 offset:28256
    ds_read_b64_tr_b16 v[140:141], v193 offset:27712
    ds_read_b64_tr_b16 v[142:143], v193 offset:28288
    ds_read_b64_tr_b16 v[144:145], v193 offset:27744
    ds_read_b64_tr_b16 v[146:147], v193 offset:28320
    ds_read_b64_tr_b16 v[148:149], v193 offset:27776
    ds_read_b64_tr_b16 v[150:151], v193 offset:28352
    ds_read_b64_tr_b16 v[152:153], v193 offset:32256
    ds_read_b64_tr_b16 v[154:155], v193 offset:32832
    ds_read_b64_tr_b16 v[156:157], v193 offset:32288
    ds_read_b64_tr_b16 v[158:159], v193 offset:32864
    ds_read_b64_tr_b16 v[168:169], v193 offset:32320
    ds_read_b64_tr_b16 v[170:171], v193 offset:32896
    ds_read_b64_tr_b16 v[172:173], v193 offset:32352
    ds_read_b64_tr_b16 v[174:175], v193 offset:32928
    ds_read_b64_tr_b16 v[176:177], v193 offset:32384
    ds_read_b64_tr_b16 v[178:179], v193 offset:32960
    ds_read_b64_tr_b16 v[180:181], v193 offset:36864
    ds_read_b64_tr_b16 v[182:183], v193 offset:37440
    ds_read_b64_tr_b16 v[232:233], v193 offset:36896
    ds_read_b64_tr_b16 v[234:235], v193 offset:37472
    ds_read_b64_tr_b16 v[236:237], v193 offset:36928
    ds_read_b64_tr_b16 v[238:239], v193 offset:37504
    ds_read_b64_tr_b16 v[240:241], v193 offset:36960
    ds_read_b64_tr_b16 v[242:243], v193 offset:37536
    ds_read_b64_tr_b16 v[244:245], v193 offset:36992
    ds_read_b64_tr_b16 v[246:247], v193 offset:37568
    s_mul_i32 s38, s22, 18432
    s_add_u32 s38, s38, 0x0
    s_mov_b32 s33, 40000
KAB_PLf:
    buffer_load_dwordx2 v[6:7], v12, s[8:11], s36 offen sc1
    s_waitcnt vmcnt(0)
    v_cmp_eq_u64 vcc, v[248:249], v[6:7]
    s_nop 0
    s_cmp_eq_u64 vcc, -1
    s_cbranch_scc1 KAB_POKf
    s_sub_u32 s33, s33, 1
    s_cmp_eq_u32 s33, 0
    s_cbranch_scc1 KAB_POKf
    s_branch KAB_PLf
KAB_POKf:
    v_lshlrev_b32 v13, 4, v2
    s_mov_b32 s33, 2000
KAB_BL:
    s_mov_b32 s24, s38
    buffer_load_dwordx4 v[16:19], v13, s[8:11], s24 offen offset:0 sc1
    buffer_load_dwordx4 v[20:23], v13, s[8:11], s24 offen offset:1024 sc1
    buffer_load_dwordx4 v[24:27], v13, s[8:11], s24 offen offset:2048 sc1
    buffer_load_dwordx4 v[28:31], v13, s[8:11], s24 offen offset:3072 sc1
    s_add_u32 s24, s24, 4096
    buffer_load_dwordx4 v[32:35], v13, s[8:11], s24 offen offset:0 sc1
    buffer_load_dwordx4 v[36:39], v13, s[8:11], s24 offen offset:1024 sc1
    buffer_load_dwordx4 v[40:43], v13, s[8:11], s24 offen offset:2048 sc1
    buffer_load_dwordx4 v[44:47], v13, s[8:11], s24 offen offset:3072 sc1
    s_add_u32 s24, s24, 4096
    buffer_load_dwordx4 v[48:51], v13, s[8:11], s24 offen offset:0 sc1
    buffer_load_dwordx4 v[52:55], v13, s[8:11], s24 offen offset:1024 sc1
    buffer_load_dwordx4 v[56:59], v13, s[8:11], s24 offen offset:2048 sc1
    buffer_load_dwordx4 v[60:63], v13, s[8:11], s24 offen offset:3072 sc1
    s_add_u32 s24, s24, 4096
    buffer_load_dwordx4 v[64:67], v13, s[8:11], s24 offen offset:0 sc1
    buffer_load_dwordx4 v[68:71], v13, s[8:11], s24 offen offset:1024 sc1
    buffer_load_dwordx4 v[72:75], v13, s[8:11], s24 offen offset:2048 sc1
    buffer_load_dwordx4 v[76:79], v13, s[8:11], s24 offen offset:3072 sc1
    s_add_u32 s24, s24, 4096
    buffer_load_dwordx4 v[80:83], v13, s[8:11], s24 offen offset:0 sc1
    buffer_load_dwordx4 v[84:87], v13, s[8:11], s24 offen offset:1024 sc1
    v_lshlrev_b32 v10, 4, v8
    v_lshrrev_b32 v11, 1, v9
    v_lshl_add_u32 v10, v11, 8, v10
    v_and_b32 v11, 1, v9
    v_lshl_add_u32 v10, v11, 3, v10
    s_mul_i32 s23, s3, 2304
    s_add_u32 s23, s23, 132096
    v_add_u32 v10, s23, v10
    v_lshlrev_b32 v14, 4, v2
    v_add_u32 v15, s23, v14
    s_mul_i32 s23, s22, 18432
    s_mul_i32 s24, s21, 2304
    s_add_u32 s23, s23, s24
    s_add_u32 s23, s23, 0x240000
    v_cmp_gt_u32 s[40:41], 32, v2
    v_mov_b32 v4, 0
    v_mov_b32 v5, 0
    v_mov_b32 v6, 0x3f803f80
    s_waitcnt vmcnt(17) lgkmcnt(15)
    v_mfma_f32_16x16x32_bf16 v[212:215], a[0:3], v[16:19], 0
    v_mfma_f32_16x16x32_bf16 v[216:219], a[4:7], v[16:19], 0
    v_mfma_f32_16x16x32_bf16 v[220:223], a[8:11], v[16:19], 0
    v_mfma_f32_16x16x32_bf16 v[224:227], a[12:15], v[16:19], 0
    v_mfma_f32_16x16x32_bf16 v[228:231], a[16:19], v[16:19], 0
    s_waitcnt vmcnt(16)
    v_mfma_f32_16x16x32_bf16 v[212:215], a[20:23], v[20:23], v[212:215]
    v_mfma_f32_16x16x32_bf16 v[216:219], a[24:27], v[20:23], v[216:219]
    v_mfma_f32_16x16x32_bf16 v[220:223], a[28:31], v[20:23], v[220:223]
    v_mfma_f32_16x16x32_bf16 v[224:227], a[32:35], v[20:23], v[224:227]
    v_mfma_f32_16x16x32_bf16 v[228:231], a[36:39], v[20:23], v[228:231]
    s_waitcnt vmcnt(15)
    v_mfma_f32_16x16x32_bf16 v[212:215], a[40:43], v[24:27], v[212:215]
    v_mfma_f32_16x16x32_bf16 v[216:219], a[44:47], v[24:27], v[216:219]
    v_mfma_f32_16x16x32_bf16 v[220:223], a[48:51], v[24:27], v[220:223]
    v_mfma_f32_16x16x32_bf16 v[224:227], a[52:55], v[24:27], v[224:227]
    v_mfma_f32_16x16x32_bf16 v[228:231], a[56:59], v[24:27], v[228:231]
    s_waitcnt vmcnt(14)
    v_mfma_f32_16x16x32_bf16 v[212:215], a[60:63], v[28:31], v[212:215]
    v_mfma_f32_16x16x32_bf16 v[216:219], a[64:67], v[28:31], v[216:219]
    v_mfma_f32_16x16x32_bf16 v[220:223], a[68:71], v[28:31], v[220:223]
    v_mfma_f32_16x16x32_bf16 v[224:227], a[72:75], v[28:31], v[224:227]
    v_mfma_f32_16x16x32_bf16 v[228:231], a[76:79], v[28:31], v[228:231]
    s_waitcnt vmcnt(13)
    v_mfma_f32_16x16x32_bf16 v[212:215], a[80:83], v[32:35], v[212:215]
    v_mfma_f32_16x16x32_bf16 v[216:219], a[84:87], v[32:35], v[216:219]
    v_mfma_f32_16x16x32_bf16 v[220:223], a[88:91], v[32:35], v[220:223]
    v_mfma_f32_16x16x32_bf16 v[224:227], a[92:95], v[32:35], v[224:227]
    v_mfma_f32_16x16x32_bf16 v[228:231], a[96:99], v[32:35], v[228:231]
    s_waitcnt vmcnt(12)
    v_mfma_f32_16x16x32_bf16 v[212:215], a[100:103], v[36:39], v[212:215]
    v_mfma_f32_16x16x32_bf16 v[216:219], a[104:107], v[36:39], v[216:219]
    v_mfma_f32_16x16x32_bf16 v[220:223], a[108:111], v[36:39], v[220:223]
    v_mfma_f32_16x16x32_bf16 v[224:227], a[112:115], v[36:39], v[224:227]
    v_mfma_f32_16x16x32_bf16 v[228:231], a[116:119], v[36:39], v[228:231]
    s_waitcnt vmcnt(11)
    v_mfma_f32_16x16x32_bf16 v[212:215], a[120:123], v[40:43], v[212:215]
    v_mfma_f32_16x16x32_bf16 v[216:219], a[124:127], v[40:43], v[216:219]
    v_mfma_f32_16x16x32_bf16 v[220:223], a[128:131], v[40:43], v[220:223]
    v_mfma_f32_16x16x32_bf16 v[224:227], a[132:135], v[40:43], v[224:227]
    v_mfma_f32_16x16x32_bf16 v[228:231], a[136:139], v[40:43], v[228:231]
    s_waitcnt vmcnt(10)
    v_mfma_f32_16x16x32_bf16 v[212:215], a[140:143], v[44:47], v[212:215]
    v_mfma_f32_16x16x32_bf16 v[216:219], a[144:147], v[44:47], v[216:219]
    v_mfma_f32_16x16x32_bf16 v[220:223], a[148:151], v[44:47], v[220:223]
    v_mfma_f32_16x16x32_bf16 v[224:227], a[152:155], v[44:47], v[224:227]
    v_mfma_f32_16x16x32_bf16 v[228:231], a[156:159], v[44:47], v[228:231]
    s_waitcnt vmcnt(9)
    v_mfma_f32_16x16x32_bf16 v[212:215], a[160:163], v[48:51], v[212:215]
    v_mfma_f32_16x16x32_bf16 v[216:219], a[164:167], v[48:51], v[216:219]
    v_mfma_f32_16x16x32_bf16 v[220:223], a[168:171], v[48:51], v[220:223]
    v_mfma_f32_16x16x32_bf16 v[224:227], a[172:175], v[48:51], v[224:227]
    v_mfma_f32_16x16x32_bf16 v[228:231], a[176:179], v[48:51], v[228:231]
    s_waitcnt vmcnt(8)
    v_mfma_f32_16x16x32_bf16 v[212:215], a[180:183], v[52:55], v[212:215]
    v_mfma_f32_16x16x32_bf16 v[216:219], a[184:187], v[52:55], v[216:219]
    v_mfma_f32_16x16x32_bf16 v[220:223], a[188:191], v[52:55], v[220:223]
    v_mfma_f32_16x16x32_bf16 v[224:227], a[192:195], v[52:55], v[224:227]
    v_mfma_f32_16x16x32_bf16 v[228:231], a[196:199], v[52:55], v[228:231]
    s_waitcnt vmcnt(7)
    v_mfma_f32_16x16x32_bf16 v[212:215], a[200:203], v[56:59], v[212:215]
    v_mfma_f32_16x16x32_bf16 v[216:219], a[204:207], v[56:59], v[216:219]
    v_mfma_f32_16x16x32_bf16 v[220:223], a[208:211], v[56:59], v[220:223]
    v_mfma_f32_16x16x32_bf16 v[224:227], a[212:215], v[56:59], v[224:227]
    v_mfma_f32_16x16x32_bf16 v[228:231], a[216:219], v[56:59], v[228:231]
    s_waitcnt vmcnt(6)
    v_mfma_f32_16x16x32_bf16 v[212:215], a[220:223], v[60:63], v[212:215]
    v_mfma_f32_16x16x32_bf16 v[216:219], a[224:227], v[60:63], v[216:219]
    v_mfma_f32_16x16x32_bf16 v[220:223], a[228:231], v[60:63], v[220:223]
    v_mfma_f32_16x16x32_bf16 v[224:227], a[232:235], v[60:63], v[224:227]
    v_mfma_f32_16x16x32_bf16 v[228:231], a[236:239], v[60:63], v[228:231]
    v_lshlrev_b32 v7, 5, v2
    s_mov_b32 s25, 0x2c20000
    buffer_load_dwordx4 v[192:195], v7, s[8:11], s25 offen offset:0 sc1
    buffer_load_dwordx4 v[196:199], v7, s[8:11], s25 offen offset:16 sc1
    s_waitcnt vmcnt(7)
    v_mfma_f32_16x16x32_bf16 v[212:215], a[240:243], v[64:67], v[212:215]
    v_mfma_f32_16x16x32_bf16 v[216:219], a[244:247], v[64:67], v[216:219]
    v_mfma_f32_16x16x32_bf16 v[220:223], a[248:251], v[64:67], v[220:223]
    v_mfma_f32_16x16x32_bf16 v[224:227], a[252:255], v[64:67], v[224:227]
    v_mfma_f32_16x16x32_bf16 v[228:231], v[88:91], v[64:67], v[228:231]
    s_waitcnt vmcnt(6)
    v_mfma_f32_16x16x32_bf16 v[212:215], v[92:95], v[68:71], v[212:215]
    v_mfma_f32_16x16x32_bf16 v[216:219], v[96:99], v[68:71], v[216:219]
    v_mfma_f32_16x16x32_bf16 v[220:223], v[100:103], v[68:71], v[220:223]
    v_mfma_f32_16x16x32_bf16 v[224:227], v[104:107], v[68:71], v[224:227]
    v_mfma_f32_16x16x32_bf16 v[228:231], v[108:111], v[68:71], v[228:231]
    s_waitcnt vmcnt(5)
    v_mfma_f32_16x16x32_bf16 v[212:215], v[112:115], v[72:75], v[212:215]
    v_mfma_f32_16x16x32_bf16 v[216:219], v[116:119], v[72:75], v[216:219]
    v_mfma_f32_16x16x32_bf16 v[220:223], v[120:123], v[72:75], v[220:223]
    v_mfma_f32_16x16x32_bf16 v[224:227], v[124:127], v[72:75], v[224:227]
    v_mfma_f32_16x16x32_bf16 v[228:231], v[128:131], v[72:75], v[228:231]
    s_waitcnt vmcnt(4)
    v_mfma_f32_16x16x32_bf16 v[212:215], v[132:135], v[76:79], v[212:215]
    v_mfma_f32_16x16x32_bf16 v[216:219], v[136:139], v[76:79], v[216:219]
    v_mfma_f32_16x16x32_bf16 v[220:223], v[140:143], v[76:79], v[220:223]
    v_mfma_f32_16x16x32_bf16 v[224:227], v[144:147], v[76:79], v[224:227]
    v_mfma_f32_16x16x32_bf16 v[228:231], v[148:151], v[76:79], v[228:231]
    s_waitcnt vmcnt(3)
    v_mfma_f32_16x16x32_bf16 v[212:215], v[152:155], v[80:83], v[212:215]
    v_mfma_f32_16x16x32_bf16 v[216:219], v[156:159], v[80:83], v[216:219]
    s_waitcnt lgkmcnt(14)
    v_mfma_f32_16x16x32_bf16 v[220:223], v[168:171], v[80:83], v[220:223]
    s_waitcnt lgkmcnt(12)
    v_mfma_f32_16x16x32_bf16 v[224:227], v[172:175], v[80:83], v[224:227]
    s_waitcnt lgkmcnt(10)
    v_mfma_f32_16x16x32_bf16 v[228:231], v[176:179], v[80:83], v[228:231]
    s_waitcnt vmcnt(2) lgkmcnt(8)
    v_mfma_f32_16x16x32_bf16 v[212:215], v[180:183], v[84:87], v[212:215]
    s_waitcnt lgkmcnt(6)
    v_mfma_f32_16x16x32_bf16 v[216:219], v[232:235], v[84:87], v[216:219]
    s_waitcnt lgkmcnt(4)
    v_mfma_f32_16x16x32_bf16 v[220:223], v[236:239], v[84:87], v[220:223]
    s_waitcnt lgkmcnt(2)
    v_mfma_f32_16x16x32_bf16 v[224:227], v[240:243], v[84:87], v[224:227]
    s_waitcnt lgkmcnt(0)
    v_mfma_f32_16x16x32_bf16 v[228:231], v[244:247], v[84:87], v[228:231]
    v_lshlrev_b32 v16, 16, v200
    v_and_b32 v17, 0xffff0000, v200
    v_lshlrev_b32 v18, 16, v201
    v_and_b32 v19, 0xffff0000, v201
    v_add_f32 v212, v212, v16
    v_add_f32 v213, v213, v17
    v_add_f32 v214, v214, v18
    v_add_f32 v215, v215, v19
    v_cvt_pk_bf16_f32 v212, v212, v213
    v_cvt_pk_bf16_f32 v213, v214, v215
    ds_write_b64 v10, v[212:213] offset:0
    v_dot2c_f32_bf16 v4, v212, v6
    v_dot2c_f32_bf16 v5, v212, v212
    v_dot2c_f32_bf16 v4, v213, v6
    v_dot2c_f32_bf16 v5, v213, v213
    v_lshlrev_b32 v20, 16, v202
    v_and_b32 v21, 0xffff0000, v202
    v_lshlrev_b32 v22, 16, v203
    v_and_b32 v23, 0xffff0000, v203
    v_add_f32 v216, v216, v20
    v_add_f32 v217, v217, v21
    v_add_f32 v218, v218, v22
    v_add_f32 v219, v219, v23
    v_cvt_pk_bf16_f32 v216, v216, v217
    v_cvt_pk_bf16_f32 v217, v218, v219
    ds_write_b64 v10, v[216:217] offset:512
    v_dot2c_f32_bf16 v4, v216, v6
    v_dot2c_f32_bf16 v5, v216, v216
    v_dot2c_f32_bf16 v4, v217, v6
    v_dot2c_f32_bf16 v5, v217, v217
    v_lshlrev_b32 v16, 16, v204
    v_and_b32 v17, 0xffff0000, v204
    v_lshlrev_b32 v18, 16, v205
    v_and_b32 v19, 0xffff0000, v205
    v_add_f32 v220, v220, v16
    v_add_f32 v221, v221, v17
    v_add_f32 v222, v222, v18
    v_add_f32 v223, v223, v19
    v_cvt_pk_bf16_f32 v220, v220, v221
    v_cvt_pk_bf16_f32 v221, v222, v223
    ds_write_b64 v10, v[220:221] offset:1024
    v_dot2c_f32_bf16 v4, v220, v6
    v_dot2c_f32_bf16 v5, v220, v220
    v_dot2c_f32_bf16 v4, v221, v6
    v_dot2c_f32_bf16 v5, v221, v221
    v_lshlrev_b32 v20, 16, v206
    v_and_b32 v21, 0xffff0000, v206
    v_lshlrev_b32 v22, 16, v207
    v_and_b32 v23, 0xffff0000, v207
    v_add_f32 v224, v224, v20
    v_add_f32 v225, v225, v21
    v_add_f32 v226, v226, v22
    v_add_f32 v227, v227, v23
    v_cvt_pk_bf16_f32 v224, v224, v225
    v_cvt_pk_bf16_f32 v225, v226, v227
    ds_write_b64 v10, v[224:225] offset:1536
    v_dot2c_f32_bf16 v4, v224, v6
    v_dot2c_f32_bf16 v5, v224, v224
    v_dot2c_f32_bf16 v4, v225, v6
    v_dot2c_f32_bf16 v5, v225, v225
    v_lshlrev_b32 v16, 16, v208
    v_and_b32 v17, 0xffff0000, v208
    v_lshlrev_b32 v18, 16, v209
    v_and_b32 v19, 0xffff0000, v209
    v_add_f32 v228, v228, v16
    v_add_f32 v229, v229, v17
    v_add_f32 v230, v230, v18
    v_add_f32 v231, v231, v19
    v_cvt_pk_bf16_f32 v228, v228, v229
    v_cvt_pk_bf16_f32 v229, v230, v231
    s_mov_b64 exec, s[40:41]
    ds_write_b64 v10, v[228:229] offset:2048
    v_dot2c_f32_bf16 v4, v228, v6
    v_dot2c_f32_bf16 v5, v228, v228
    v_dot2c_f32_bf16 v4, v229, v6
    v_dot2c_f32_bf16 v5, v229, v229
    s_mov_b64 exec, -1
    ds_read_b128 v[28:31], v15 offset:0
    ds_read_b128 v[32:35], v15 offset:1024
    ds_read_b128 v[36:39], v15 offset:2048
    s_waitcnt lgkmcnt(2)
    buffer_store_dwordx4 v[28:31], v14, s[8:11], s23 offen offset:0 sc1
    s_waitcnt lgkmcnt(1)
    buffer_store_dwordx4 v[32:35], v14, s[8:11], s23 offen offset:1024 sc1
    s_mov_b64 exec, 0xffff
    s_waitcnt lgkmcnt(0)
    buffer_store_dwordx4 v[36:39], v14, s[8:11], s23 offen offset:2048 sc1
    s_mov_b64 exec, -1
    v_mov_b32 v24, v4
    v_mov_b32 v25, v5
    s_nop 0
    v_permlane32_swap_b32 v4, v24
    v_permlane32_swap_b32 v5, v25
    v_add_f32 v4, v4, v24
    v_add_f32 v5, v5, v25
    v_mov_b32 v24, v4
    v_mov_b32 v25, v5
    s_nop 0
    v_permlane16_swap_b32 v4, v24
    v_permlane16_swap_b32 v5, v25
    v_add_f32 v4, v4, v24
    v_add_f32 v5, v5, v25
    v_lshlrev_b32 v10, 6, v8
    s_lshl_b32 s23, s22, 10
    s_lshl_b32 s24, s21, 3
    s_add_u32 s23, s23, s24
    s_add_u32 s23, s23, 0x2a00000
    buffer_store_dwordx2 v[4:5], v10, s[8:11], s23 offen sc1
    s_lshl_b32 s62, s20, 6
    s_lshl_b32 s63, s21, 3
    s_add_u32 s62, s62, s63
    s_add_u32 s62, s62, 0x2c30000
    s_load_dwordx2 s[6:7], s[0:1], 56
    s_bfe_u32 s16, s2, 0x20001
    s_bfe_u32 s17, s2, 0x20003
    s_and_b32 s21, s2, 1
    s_lshl_b32 s21, s21, 3
    s_lshr_b32 s20, s2, 5
    s_add_u32 s21, s21, s20
    s_lshl_b32 s20, s16, 2
    s_add_u32 s20, s20, s17
    v_lshlrev_b32 v3, 4, v2
    s_lshl_b32 s22, s21, 3
    s_lshl_b32 s23, s3, 1
    s_add_u32 s22, s22, s23
    s_mul_i32 s24, s20, 663552
    s_add_u32 s24, s24, 0x1e00000
    s_lshl_b32 s25, s3, 12
    s_add_u32 s30, s24, s25
    s_add_u32 s30, s30, 294912
    s_mul_i32 s31, s3, 73728
    s_add_u32 s24, s24, s31
    s_mul_i32 s26, s22, 18432
    s_add_u32 s26, s26, 0x240000
    s_add_u32 s27, s26, 18432
    s_waitcnt lgkmcnt(0)
    s_mov_b32 s12, s6
    s_and_b32 s13, s7, 0xffff
    s_mov_b32 s14, 0x240000
    s_mov_b32 s15, 0x00020000
    v_lshlrev_b32 v4, 5, v2
    s_mov_b32 s59, 0x2c20000
    s_waitcnt vmcnt(0)
    s_barrier
    s_cmp_lg_u32 s3, 0
    s_cbranch_scc1 KF_NH
    v_mov_b32 v15, 0
    buffer_store_dwordx2 v[248:249], v15, s[8:11], s62 offen sc1
KF_NH:
    s_mov_b32 s60, 40000
    v_cmp_eq_u64 vcc, v[248:249], v[192:193]
    v_cmp_eq_u64 s[56:57], v[248:249], v[194:195]
    s_nop 0
    s_and_b64 vcc, vcc, s[56:57]
    v_cmp_eq_u64 s[56:57], v[248:249], v[196:197]
    s_nop 0
    s_and_b64 vcc, vcc, s[56:57]
    v_cmp_eq_u64 s[56:57], v[248:249], v[198:199]
    s_nop 0
    s_and_b64 vcc, vcc, s[56:57]
    s_cmp_eq_u64 vcc, -1
    s_cbranch_scc1 KCD_Ra
KCD_Qa:
    buffer_load_dwordx4 v[192:195], v4, s[8:11], s59 offen offset:0 sc1
    buffer_load_dwordx4 v[196:199], v4, s[8:11], s59 offen offset:16 sc1
    s_waitcnt vmcnt(0)
    v_cmp_eq_u64 vcc, v[248:249], v[192:193]
    v_cmp_eq_u64 s[56:57], v[248:249], v[194:195]
    s_nop 0
    s_and_b64 vcc, vcc, s[56:57]
    v_cmp_eq_u64 s[56:57], v[248:249], v[196:197]
    s_nop 0
    s_and_b64 vcc, vcc, s[56:57]
    v_cmp_eq_u64 s[56:57], v[248:249], v[198:199]
    s_nop 0
    s_and_b64 vcc, vcc, s[56:57]
    s_cmp_eq_u64 vcc, -1
    s_cbranch_scc1 KCD_Ra
    s_sub_u32 s60, s60, 1
    s_cmp_eq_u32 s60, 0
    s_cbranch_scc1 KCD_Ra
    s_branch KCD_Qa
KCD_Ra:
    s_add_u32 m0, s25, 0
    s_nop 0
    buffer_load_dwordx4 v3, s[8:11], s24 offen offset:0 sc1 lds
    buffer_load_dwordx4 v3, s[8:11], s24 offen offset:1024 sc1 lds
    buffer_load_dwordx4 v3, s[8:11], s24 offen offset:2048 sc1 lds
    buffer_load_dwordx4 v3, s[8:11], s24 offen offset:3072 sc1 lds
    s_add_u32 s24, s24, 4096
    s_add_u32 m0, s25, 16384
    s_nop 0
    buffer_load_dwordx4 v3, s[8:11], s24 offen offset:0 sc1 lds
    buffer_load_dwordx4 v3, s[8:11], s24 offen offset:1024 sc1 lds
    buffer_load_dwordx4 v3, s[8:11], s24 offen offset:2048 sc1 lds
    buffer_load_dwordx4 v3, s[8:11], s24 offen offset:3072 sc1 lds
    s_add_u32 s24, s24, 4096
    s_add_u32 m0, s25, 32768
    s_nop 0
    buffer_load_dwordx4 v3, s[8:11], s24 offen offset:0 sc1 lds
    buffer_load_dwordx4 v3, s[8:11], s24 offen offset:1024 sc1 lds
    buffer_load_dwordx4 v3, s[8:11], s24 offen offset:2048 sc1 lds
    buffer_load_dwordx4 v3, s[8:11], s24 offen offset:3072 sc1 lds
    s_add_u32 s24, s24, 4096
    v_and_b32 v4, 7, v2
    v_lshlrev_b32 v4, 4, v4
    s_lshl_b32 s59, s21, 7
    s_add_u32 s59, s59, 0x2c30000
    s_mov_b32 s60, 40000
KCD_Qb:
    buffer_load_dwordx4 v[28:31], v4, s[8:11], s59 offen offset:0 sc1
    s_waitcnt vmcnt(0)
    v_cmp_eq_u64 vcc, v[248:249], v[28:29]
    v_cmp_eq_u64 s[56:57], v[248:249], v[30:31]
    s_nop 0
    s_and_b64 vcc, vcc, s[56:57]
    s_cmp_eq_u64 vcc, -1
    s_cbranch_scc1 KCD_Rb
    s_sub_u32 s60, s60, 1
    s_cmp_eq_u32 s60, 0
    s_cbranch_scc1 KCD_Rb
    s_branch KCD_Qb
KCD_Rb:
    buffer_load_dwordx4 a[0:3], v3, s[8:11], s26 offen offset:0 sc1
    buffer_load_dwordx4 a[4:7], v3, s[8:11], s27 offen offset:0 sc1
    buffer_load_dwordx4 a[8:11], v3, s[8:11], s26 offen offset:1024 sc1
    buffer_load_dwordx4 a[12:15], v3, s[8:11], s27 offen offset:1024 sc1
    buffer_load_dwordx4 a[16:19], v3, s[8:11], s26 offen offset:2048 sc1
    buffer_load_dwordx4 a[20:23], v3, s[8:11], s27 offen offset:2048 sc1
    v_add_u32 v4, 49152, v3
    s_mul_i32 s61, s3, 19456
    s_add_u32 s61, s61, 81920
    v_add_u32 v5, s61, v3
    v_add_u32 v14, 147456, v3
    v_mov_b32 v15, 0
    s_mul_i32 s28, s22, 147456
    s_mul_i32 s29, s20, 9216
    s_add_u32 s28, s28, s29
    s_add_u32 s28, s28, 0x480000
    s_mul_i32 s53, s16, 36
    s_mul_i32 s54, s3, 9
    s_add_u32 s53, s53, s54
    s_mul_i32 s32, s53, 36864
    s_mul_i32 s54, s17, 9216
    s_add_u32 s32, s32, s54
    s_add_u32 s32, s32, 0x1800000
    s_lshl_b32 s54, s21, 2
    s_add_u32 s55, s54, s16
    s_lshl_b32 s55, s55, 2
    s_add_u32 s40, s55, s3
    s_lshl_b32 s40, s40, 7
    s_add_u32 s40, s40, 0x2c00000
    s_add_u32 s44, s55, s17
    s_lshl_b32 s44, s44, 7
    s_lshl_b32 s56, s3, 2
    s_add_u32 s44, s44, s56
    s_add_u32 s44, s44, 0x2c00000
    s_add_u32 s55, s54, s17
    s_lshl_b32 s55, s55, 2
    s_add_u32 s56, s16, 1
    s_and_b32 s56, s56, 3
    s_lshl_b32 s57, s21, 2
    s_add_u32 s57, s57, s56
    s_mul_i32 s57, s57, 288
    s_add_u32 s57, s57, s53
    s_lshl_b32 s57, s57, 10
    s_add_u32 s36, s57, 0x480000
    s_add_u32 s57, s55, s56
    s_lshl_b32 s58, s57, 2
    s_add_u32 s58, s58, s16
    s_mul_i32 s58, s58, 18432
    s_add_u32 s45, s58, 0x2d00000
    s_lshl_b32 s58, s57, 5
    s_lshl_b32 s59, s3, 2
    s_add_u32 s58, s58, s59
    s_add_u32 s58, s58, s16
    s_lshl_b32 s58, s58, 2
    s_add_u32 s48, s58, 0x2c10000
    s_add_u32 s56, s16, 2
    s_and_b32 s56, s56, 3
    s_lshl_b32 s57, s21, 2
    s_add_u32 s57, s57, s56
    s_mul_i32 s57, s57, 288
    s_add_u32 s57, s57, s53
    s_lshl_b32 s57, s57, 10
    s_add_u32 s37, s57, 0x480000
    s_add_u32 s57, s55, s56
    s_lshl_b32 s58, s57, 2
    s_add_u32 s58, s58, s16
    s_mul_i32 s58, s58, 18432
    s_add_u32 s46, s58, 0x2d00000
    s_lshl_b32 s58, s57, 5
    s_lshl_b32 s59, s3, 2
    s_add_u32 s58, s58, s59
    s_add_u32 s58, s58, s16
    s_lshl_b32 s58, s58, 2
    s_add_u32 s49, s58, 0x2c10000
    s_add_u32 s56, s16, 3
    s_and_b32 s56, s56, 3
    s_lshl_b32 s57, s21, 2
    s_add_u32 s57, s57, s56
    s_mul_i32 s57, s57, 288
    s_add_u32 s57, s57, s53
    s_lshl_b32 s57, s57, 10
    s_add_u32 s38, s57, 0x480000
    s_add_u32 s57, s55, s56
    s_lshl_b32 s58, s57, 2
    s_add_u32 s58, s58, s16
    s_mul_i32 s58, s58, 18432
    s_add_u32 s47, s58, 0x2d00000
    s_lshl_b32 s58, s57, 5
    s_lshl_b32 s59, s3, 2
    s_add_u32 s58, s58, s59
    s_add_u32 s58, s58, s16
    s_lshl_b32 s58, s58, 2
    s_add_u32 s50, s58, 0x2c10000
    s_add_u32 s56, s16, 4
    s_and_b32 s56, s56, 3
    s_lshl_b32 s57, s21, 2
    s_add_u32 s57, s57, s56
    s_mul_i32 s57, s57, 288
    s_add_u32 s57, s57, s53
    s_lshl_b32 s57, s57, 10
    s_add_u32 s39, s57, 0x480000
    s_add_u32 s57, s55, s56
    s_mul_i32 s51, s57, 73728
    s_add_u32 s51, s51, 0x2d00000
    s_lshl_b32 s52, s57, 7
    s_lshl_b32 s59, s3, 4
    s_add_u32 s52, s52, s59
    s_add_u32 s52, s52, 0x2c10000
    v_and_b32 v7, 15, v2
    v_lshlrev_b32 v7, 6, v7
    s_lshl_b32 s23, s22, 10
    s_add_u32 s23, s23, 0x2a00000
    v_min_u32 v24, 143, v0
    v_lshlrev_b32 v24, 4, v24
    s_mul_i32 s31, s20, 2304
    s_add_u32 s31, s31, 0x2900000
    v_lshrrev_b32 v6, 4, v2
    v_lshlrev_b32 v6, 4, v6
    v_add_u32 v6, 159744, v6
    s_barrier
    ds_read_b128 a[144:147], v3 offset:0
    ds_read_b128 a[148:151], v3 offset:1024
    ds_read_b128 a[152:155], v3 offset:2048
    ds_read_b128 a[156:159], v3 offset:3072
    ds_read_b128 a[160:163], v3 offset:4096
    ds_read_b128 a[164:167], v3 offset:5120
    ds_read_b128 a[168:171], v3 offset:6144
    ds_read_b128 a[172:175], v3 offset:7168
    s_waitcnt lgkmcnt(4)
    s_waitcnt vmcnt(5)
    v_mfma_f32_16x16x32_bf16 v[28:31], a[144:147], a[0:3], 0
    ds_read_b128 a[176:179], v3 offset:8192
    s_waitcnt vmcnt(4)
    v_mfma_f32_16x16x32_bf16 v[32:35], a[144:147], a[4:7], 0
    s_add_u32 m0, s25, 49152
    s_nop 0
    buffer_load_dwordx4 v3, s[8:11], s24 offen offset:0 sc1 lds
    v_mfma_f32_16x16x32_bf16 v[36:39], a[148:151], a[0:3], 0
    ds_read_b128 a[180:183], v3 offset:9216
    v_mfma_f32_16x16x32_bf16 v[40:43], a[148:151], a[4:7], 0
    buffer_load_dwordx4 v3, s[8:11], s24 offen offset:1024 sc1 lds
    v_mfma_f32_16x16x32_bf16 v[44:47], a[152:155], a[0:3], 0
    ds_read_b128 a[184:187], v3 offset:10240
    v_mfma_f32_16x16x32_bf16 v[48:51], a[152:155], a[4:7], 0
    buffer_load_dwordx4 v3, s[8:11], s24 offen offset:2048 sc1 lds
    v_mfma_f32_16x16x32_bf16 v[52:55], a[156:159], a[0:3], 0
    ds_read_b128 a[188:191], v3 offset:11264
    v_mfma_f32_16x16x32_bf16 v[56:59], a[156:159], a[4:7], 0
    buffer_load_dwordx4 v3, s[8:11], s24 offen offset:3072 sc1 lds
    s_add_u32 s24, s24, 4096
    s_waitcnt lgkmcnt(4)
    v_mfma_f32_16x16x32_bf16 v[60:63], a[160:163], a[0:3], 0
    ds_read_b128 a[144:147], v3 offset:12288
    v_mfma_f32_16x16x32_bf16 v[64:67], a[160:163], a[4:7], 0
    buffer_load_dwordx4 a[24:27], v3, s[8:11], s26 offen offset:3072 sc1
    v_mfma_f32_16x16x32_bf16 v[68:71], a[164:167], a[0:3], 0
    ds_read_b128 a[148:151], v3 offset:13312
    v_mfma_f32_16x16x32_bf16 v[72:75], a[164:167], a[4:7], 0
    buffer_load_dwordx4 a[28:31], v3, s[8:11], s27 offen offset:3072 sc1
    v_mfma_f32_16x16x32_bf16 v[76:79], a[168:171], a[0:3], 0
    ds_read_b128 a[152:155], v3 offset:14336
    v_mfma_f32_16x16x32_bf16 v[80:83], a[168:171], a[4:7], 0
    v_mfma_f32_16x16x32_bf16 v[84:87], a[172:175], a[0:3], 0
    ds_read_b128 a[156:159], v3 offset:15360
    v_mfma_f32_16x16x32_bf16 v[88:91], a[172:175], a[4:7], 0
    s_waitcnt lgkmcnt(4)
    v_mfma_f32_16x16x32_bf16 v[92:95], a[176:179], a[0:3], 0
    s_barrier
    ds_read_b128 a[160:163], v3 offset:16384
    v_mfma_f32_16x16x32_bf16 v[96:99], a[176:179], a[4:7], 0
    s_add_u32 m0, s25, 65536
    s_nop 0
    buffer_load_dwordx4 v3, s[8:11], s24 offen offset:0 sc1 lds
    v_mfma_f32_16x16x32_bf16 v[100:103], a[180:183], a[0:3], 0
    ds_read_b128 a[164:167], v3 offset:17408
    v_mfma_f32_16x16x32_bf16 v[104:107], a[180:183], a[4:7], 0
    buffer_load_dwordx4 v3, s[8:11], s24 offen offset:1024 sc1 lds
    v_mfma_f32_16x16x32_bf16 v[108:111], a[184:187], a[0:3], 0
    ds_read_b128 a[168:171], v3 offset:18432
    v_mfma_f32_16x16x32_bf16 v[112:115], a[184:187], a[4:7], 0
    buffer_load_dwordx4 v3, s[8:11], s24 offen offset:2048 sc1 lds
    v_mfma_f32_16x16x32_bf16 v[116:119], a[188:191], a[0:3], 0
    ds_read_b128 a[172:175], v3 offset:19456
    v_mfma_f32_16x16x32_bf16 v[120:123], a[188:191], a[4:7], 0
    buffer_load_dwordx4 v3, s[8:11], s24 offen offset:3072 sc1 lds
    s_add_u32 s24, s24, 4096
    s_waitcnt lgkmcnt(4)
    v_mfma_f32_16x16x32_bf16 v[124:127], a[144:147], a[0:3], 0
    ds_read_b128 a[176:179], v3 offset:20480
    v_mfma_f32_16x16x32_bf16 v[128:131], a[144:147], a[4:7], 0
    s_add_u32 s26, s26, 4096
    buffer_load_dwordx4 a[32:35], v3, s[8:11], s26 offen offset:0 sc1
    v_mfma_f32_16x16x32_bf16 v[132:135], a[148:151], a[0:3], 0
    ds_read_b128 a[180:183], v3 offset:21504
    v_mfma_f32_16x16x32_bf16 v[136:139], a[148:151], a[4:7], 0
    s_add_u32 s27, s27, 4096
    buffer_load_dwordx4 a[36:39], v3, s[8:11], s27 offen offset:0 sc1
    v_mfma_f32_16x16x32_bf16 v[140:143], a[152:155], a[0:3], 0
    ds_read_b128 a[184:187], v3 offset:22528
    v_mfma_f32_16x16x32_bf16 v[144:147], a[152:155], a[4:7], 0
    v_mfma_f32_16x16x32_bf16 v[148:151], a[156:159], a[0:3], 0
    ds_read_b128 a[188:191], v3 offset:23552
    v_mfma_f32_16x16x32_bf16 v[152:155], a[156:159], a[4:7], 0
    s_waitcnt lgkmcnt(4)
    s_waitcnt vmcnt(15)
    v_mfma_f32_16x16x32_bf16 v[28:31], a[160:163], a[8:11], v[28:31]
    ds_read_b128 a[144:147], v3 offset:24576
    s_waitcnt vmcnt(14)
    v_mfma_f32_16x16x32_bf16 v[32:35], a[160:163], a[12:15], v[32:35]
    v_mfma_f32_16x16x32_bf16 v[36:39], a[164:167], a[8:11], v[36:39]
    ds_read_b128 a[148:151], v3 offset:25600
    v_mfma_f32_16x16x32_bf16 v[40:43], a[164:167], a[12:15], v[40:43]
    v_mfma_f32_16x16x32_bf16 v[44:47], a[168:171], a[8:11], v[44:47]
    ds_read_b128 a[152:155], v3 offset:26624
    v_mfma_f32_16x16x32_bf16 v[48:51], a[168:171], a[12:15], v[48:51]
    v_mfma_f32_16x16x32_bf16 v[52:55], a[172:175], a[8:11], v[52:55]
    ds_read_b128 a[156:159], v3 offset:27648
    v_mfma_f32_16x16x32_bf16 v[56:59], a[172:175], a[12:15], v[56:59]
    s_waitcnt lgkmcnt(4)
    v_mfma_f32_16x16x32_bf16 v[60:63], a[176:179], a[8:11], v[60:63]
    ds_read_b128 a[160:163], v3 offset:28672
    v_mfma_f32_16x16x32_bf16 v[64:67], a[176:179], a[12:15], v[64:67]
    v_mfma_f32_16x16x32_bf16 v[68:71], a[180:183], a[8:11], v[68:71]
    ds_read_b128 a[164:167], v3 offset:29696
    v_mfma_f32_16x16x32_bf16 v[72:75], a[180:183], a[12:15], v[72:75]
    v_mfma_f32_16x16x32_bf16 v[76:79], a[184:187], a[8:11], v[76:79]
    ds_read_b128 a[168:171], v3 offset:30720
    v_mfma_f32_16x16x32_bf16 v[80:83], a[184:187], a[12:15], v[80:83]
    v_mfma_f32_16x16x32_bf16 v[84:87], a[188:191], a[8:11], v[84:87]
    ds_read_b128 a[172:175], v3 offset:31744
    v_mfma_f32_16x16x32_bf16 v[88:91], a[188:191], a[12:15], v[88:91]
    s_waitcnt lgkmcnt(4)
    v_mfma_f32_16x16x32_bf16 v[92:95], a[144:147], a[8:11], v[92:95]
    s_barrier
    ds_read_b128 a[176:179], v3 offset:32768
    v_mfma_f32_16x16x32_bf16 v[96:99], a[144:147], a[12:15], v[96:99]
    s_add_u32 m0, s25, 0
    s_nop 0
    buffer_load_dwordx4 v3, s[8:11], s24 offen offset:0 sc1 lds
    v_mfma_f32_16x16x32_bf16 v[100:103], a[148:151], a[8:11], v[100:103]
    ds_read_b128 a[180:183], v3 offset:33792
    v_mfma_f32_16x16x32_bf16 v[104:107], a[148:151], a[12:15], v[104:107]
    buffer_load_dwordx4 v3, s[8:11], s24 offen offset:1024 sc1 lds
    v_mfma_f32_16x16x32_bf16 v[108:111], a[152:155], a[8:11], v[108:111]
    ds_read_b128 a[184:187], v3 offset:34816
    v_mfma_f32_16x16x32_bf16 v[112:115], a[152:155], a[12:15], v[112:115]
    buffer_load_dwordx4 v3, s[8:11], s24 offen offset:2048 sc1 lds
    v_mfma_f32_16x16x32_bf16 v[116:119], a[156:159], a[8:11], v[116:119]
    ds_read_b128 a[188:191], v3 offset:35840
    v_mfma_f32_16x16x32_bf16 v[120:123], a[156:159], a[12:15], v[120:123]
    buffer_load_dwordx4 v3, s[8:11], s24 offen offset:3072 sc1 lds
    s_add_u32 s24, s24, 4096
    s_waitcnt lgkmcnt(4)
    v_mfma_f32_16x16x32_bf16 v[124:127], a[160:163], a[8:11], v[124:127]
    ds_read_b128 a[144:147], v3 offset:36864
    v_mfma_f32_16x16x32_bf16 v[128:131], a[160:163], a[12:15], v[128:131]
    buffer_load_dwordx4 a[40:43], v3, s[8:11], s26 offen offset:1024 sc1
    v_mfma_f32_16x16x32_bf16 v[132:135], a[164:167], a[8:11], v[132:135]
    ds_read_b128 a[148:151], v3 offset:37888
    v_mfma_f32_16x16x32_bf16 v[136:139], a[164:167], a[12:15], v[136:139]
    buffer_load_dwordx4 a[44:47], v3, s[8:11], s27 offen offset:1024 sc1
    v_mfma_f32_16x16x32_bf16 v[140:143], a[168:171], a[8:11], v[140:143]
    ds_read_b128 a[152:155], v3 offset:38912
    v_mfma_f32_16x16x32_bf16 v[144:147], a[168:171], a[12:15], v[144:147]
    v_mfma_f32_16x16x32_bf16 v[148:151], a[172:175], a[8:11], v[148:151]
    ds_read_b128 a[156:159], v3 offset:39936
    v_mfma_f32_16x16x32_bf16 v[152:155], a[172:175], a[12:15], v[152:155]
    s_waitcnt lgkmcnt(4)
    s_waitcnt vmcnt(19)
    v_mfma_f32_16x16x32_bf16 v[28:31], a[176:179], a[16:19], v[28:31]
    ds_read_b128 a[160:163], v3 offset:40960
    s_waitcnt vmcnt(18)
    v_mfma_f32_16x16x32_bf16 v[32:35], a[176:179], a[20:23], v[32:35]
    v_mfma_f32_16x16x32_bf16 v[36:39], a[180:183], a[16:19], v[36:39]
    ds_read_b128 a[164:167], v3 offset:41984
    v_mfma_f32_16x16x32_bf16 v[40:43], a[180:183], a[20:23], v[40:43]
    v_mfma_f32_16x16x32_bf16 v[44:47], a[184:187], a[16:19], v[44:47]
    ds_read_b128 a[168:171], v3 offset:43008
    v_mfma_f32_16x16x32_bf16 v[48:51], a[184:187], a[20:23], v[48:51]
    v_mfma_f32_16x16x32_bf16 v[52:55], a[188:191], a[16:19], v[52:55]
    ds_read_b128 a[172:175], v3 offset:44032
    v_mfma_f32_16x16x32_bf16 v[56:59], a[188:191], a[20:23], v[56:59]
    s_waitcnt lgkmcnt(4)
    v_mfma_f32_16x16x32_bf16 v[60:63], a[144:147], a[16:19], v[60:63]
    ds_read_b128 a[176:179], v3 offset:45056
    v_mfma_f32_16x16x32_bf16 v[64:67], a[144:147], a[20:23], v[64:67]
    v_mfma_f32_16x16x32_bf16 v[68:71], a[148:151], a[16:19], v[68:71]
    ds_read_b128 a[180:183], v3 offset:46080
    v_mfma_f32_16x16x32_bf16 v[72:75], a[148:151], a[20:23], v[72:75]
    v_mfma_f32_16x16x32_bf16 v[76:79], a[152:155], a[16:19], v[76:79]
    ds_read_b128 a[184:187], v3 offset:47104
    v_mfma_f32_16x16x32_bf16 v[80:83], a[152:155], a[20:23], v[80:83]
    v_mfma_f32_16x16x32_bf16 v[84:87], a[156:159], a[16:19], v[84:87]
    ds_read_b128 a[188:191], v3 offset:48128
    v_mfma_f32_16x16x32_bf16 v[88:91], a[156:159], a[20:23], v[88:91]
    s_waitcnt lgkmcnt(4)
    v_mfma_f32_16x16x32_bf16 v[92:95], a[160:163], a[16:19], v[92:95]
    s_waitcnt vmcnt(14)
    s_barrier
    ds_read_b128 a[144:147], v4 offset:0
    v_mfma_f32_16x16x32_bf16 v[96:99], a[160:163], a[20:23], v[96:99]
    s_add_u32 m0, s25, 16384
    s_nop 0
    buffer_load_dwordx4 v3, s[8:11], s24 offen offset:0 sc1 lds
    v_mfma_f32_16x16x32_bf16 v[100:103], a[164:167], a[16:19], v[100:103]
    ds_read_b128 a[148:151], v4 offset:1024
    v_mfma_f32_16x16x32_bf16 v[104:107], a[164:167], a[20:23], v[104:107]
    buffer_load_dwordx4 v3, s[8:11], s24 offen offset:1024 sc1 lds
    v_mfma_f32_16x16x32_bf16 v[108:111], a[168:171], a[16:19], v[108:111]
    ds_read_b128 a[152:155], v4 offset:2048
    v_mfma_f32_16x16x32_bf16 v[112:115], a[168:171], a[20:23], v[112:115]
    buffer_load_dwordx4 v3, s[8:11], s24 offen offset:2048 sc1 lds
    v_mfma_f32_16x16x32_bf16 v[116:119], a[172:175], a[16:19], v[116:119]
    ds_read_b128 a[156:159], v4 offset:3072
    v_mfma_f32_16x16x32_bf16 v[120:123], a[172:175], a[20:23], v[120:123]
    buffer_load_dwordx4 v3, s[8:11], s24 offen offset:3072 sc1 lds
    s_add_u32 s24, s24, 4096
    s_waitcnt lgkmcnt(4)
    v_mfma_f32_16x16x32_bf16 v[124:127], a[176:179], a[16:19], v[124:127]
    ds_read_b128 a[160:163], v4 offset:4096
    v_mfma_f32_16x16x32_bf16 v[128:131], a[176:179], a[20:23], v[128:131]
    buffer_load_dwordx4 a[48:51], v3, s[8:11], s26 offen offset:2048 sc1
    v_mfma_f32_16x16x32_bf16 v[132:135], a[180:183], a[16:19], v[132:135]
    ds_read_b128 a[164:167], v4 offset:5120
    v_mfma_f32_16x16x32_bf16 v[136:139], a[180:183], a[20:23], v[136:139]
    buffer_load_dwordx4 a[52:55], v3, s[8:11], s27 offen offset:2048 sc1
    v_mfma_f32_16x16x32_bf16 v[140:143], a[184:187], a[16:19], v[140:143]
    ds_read_b128 a[168:171], v4 offset:6144
    v_mfma_f32_16x16x32_bf16 v[144:147], a[184:187], a[20:23], v[144:147]
    v_mfma_f32_16x16x32_bf16 v[148:151], a[188:191], a[16:19], v[148:151]
    ds_read_b128 a[172:175], v4 offset:7168
    v_mfma_f32_16x16x32_bf16 v[152:155], a[188:191], a[20:23], v[152:155]
    s_waitcnt lgkmcnt(4)
    s_waitcnt vmcnt(19)
    v_mfma_f32_16x16x32_bf16 v[28:31], a[144:147], a[24:27], v[28:31]
    ds_read_b128 a[176:179], v4 offset:8192
    s_waitcnt vmcnt(18)
    v_mfma_f32_16x16x32_bf16 v[32:35], a[144:147], a[28:31], v[32:35]
    v_mfma_f32_16x16x32_bf16 v[36:39], a[148:151], a[24:27], v[36:39]
    ds_read_b128 a[180:183], v4 offset:9216
    v_mfma_f32_16x16x32_bf16 v[40:43], a[148:151], a[28:31], v[40:43]
    v_mfma_f32_16x16x32_bf16 v[44:47], a[152:155], a[24:27], v[44:47]
    ds_read_b128 a[184:187], v4 offset:10240
    v_mfma_f32_16x16x32_bf16 v[48:51], a[152:155], a[28:31], v[48:51]
    v_mfma_f32_16x16x32_bf16 v[52:55], a[156:159], a[24:27], v[52:55]
    ds_read_b128 a[188:191], v4 offset:11264
    v_mfma_f32_16x16x32_bf16 v[56:59], a[156:159], a[28:31], v[56:59]
    s_waitcnt lgkmcnt(4)
    v_mfma_f32_16x16x32_bf16 v[60:63], a[160:163], a[24:27], v[60:63]
    ds_read_b128 a[144:147], v4 offset:12288
    v_mfma_f32_16x16x32_bf16 v[64:67], a[160:163], a[28:31], v[64:67]
    v_mfma_f32_16x16x32_bf16 v[68:71], a[164:167], a[24:27], v[68:71]
    ds_read_b128 a[148:151], v4 offset:13312
    v_mfma_f32_16x16x32_bf16 v[72:75], a[164:167], a[28:31], v[72:75]
    v_mfma_f32_16x16x32_bf16 v[76:79], a[168:171], a[24:27], v[76:79]
    ds_read_b128 a[152:155], v4 offset:14336
    v_mfma_f32_16x16x32_bf16 v[80:83], a[168:171], a[28:31], v[80:83]
    v_mfma_f32_16x16x32_bf16 v[84:87], a[172:175], a[24:27], v[84:87]
    ds_read_b128 a[156:159], v4 offset:15360
    v_mfma_f32_16x16x32_bf16 v[88:91], a[172:175], a[28:31], v[88:91]
    s_waitcnt lgkmcnt(4)
    v_mfma_f32_16x16x32_bf16 v[92:95], a[176:179], a[24:27], v[92:95]
    s_waitcnt vmcnt(14)
    s_barrier
    ds_read_b128 a[160:163], v4 offset:16384
    v_mfma_f32_16x16x32_bf16 v[96:99], a[176:179], a[28:31], v[96:99]
    s_add_u32 m0, s25, 32768
    s_nop 0
    buffer_load_dwordx4 v3, s[8:11], s24 offen offset:0 sc1 lds
    v_mfma_f32_16x16x32_bf16 v[100:103], a[180:183], a[24:27], v[100:103]
    ds_read_b128 a[164:167], v4 offset:17408
    v_mfma_f32_16x16x32_bf16 v[104:107], a[180:183], a[28:31], v[104:107]
    buffer_load_dwordx4 v3, s[8:11], s24 offen offset:1024 sc1 lds
    v_mfma_f32_16x16x32_bf16 v[108:111], a[184:187], a[24:27], v[108:111]
    ds_read_b128 a[168:171], v4 offset:18432
    v_mfma_f32_16x16x32_bf16 v[112:115], a[184:187], a[28:31], v[112:115]
    buffer_load_dwordx4 v3, s[8:11], s24 offen offset:2048 sc1 lds
    v_mfma_f32_16x16x32_bf16 v[116:119], a[188:191], a[24:27], v[116:119]
    ds_read_b128 a[172:175], v4 offset:19456
    v_mfma_f32_16x16x32_bf16 v[120:123], a[188:191], a[28:31], v[120:123]
    buffer_load_dwordx4 v3, s[8:11], s24 offen offset:3072 sc1 lds
    s_add_u32 s24, s24, 4096
    s_waitcnt lgkmcnt(4)
    v_mfma_f32_16x16x32_bf16 v[124:127], a[144:147], a[24:27], v[124:127]
    ds_read_b128 a[176:179], v4 offset:20480
    v_mfma_f32_16x16x32_bf16 v[128:131], a[144:147], a[28:31], v[128:131]
    buffer_load_dwordx4 a[56:59], v3, s[8:11], s26 offen offset:3072 sc1
    v_mfma_f32_16x16x32_bf16 v[132:135], a[148:151], a[24:27], v[132:135]
    ds_read_b128 a[180:183], v4 offset:21504
    v_mfma_f32_16x16x32_bf16 v[136:139], a[148:151], a[28:31], v[136:139]
    buffer_load_dwordx4 a[60:63], v3, s[8:11], s27 offen offset:3072 sc1
    v_mfma_f32_16x16x32_bf16 v[140:143], a[152:155], a[24:27], v[140:143]
    ds_read_b128 a[184:187], v4 offset:22528
    v_mfma_f32_16x16x32_bf16 v[144:147], a[152:155], a[28:31], v[144:147]
    v_mfma_f32_16x16x32_bf16 v[148:151], a[156:159], a[24:27], v[148:151]
    ds_read_b128 a[188:191], v4 offset:23552
    v_mfma_f32_16x16x32_bf16 v[152:155], a[156:159], a[28:31], v[152:155]
    s_waitcnt lgkmcnt(4)
    s_waitcnt vmcnt(19)
    v_mfma_f32_16x16x32_bf16 v[28:31], a[160:163], a[32:35], v[28:31]
    ds_read_b128 a[144:147], v4 offset:24576
    s_waitcnt vmcnt(18)
    v_mfma_f32_16x16x32_bf16 v[32:35], a[160:163], a[36:39], v[32:35]
    v_mfma_f32_16x16x32_bf16 v[36:39], a[164:167], a[32:35], v[36:39]
    ds_read_b128 a[148:151], v4 offset:25600
    v_mfma_f32_16x16x32_bf16 v[40:43], a[164:167], a[36:39], v[40:43]
    v_mfma_f32_16x16x32_bf16 v[44:47], a[168:171], a[32:35], v[44:47]
    ds_read_b128 a[152:155], v4 offset:26624
    v_mfma_f32_16x16x32_bf16 v[48:51], a[168:171], a[36:39], v[48:51]
    v_mfma_f32_16x16x32_bf16 v[52:55], a[172:175], a[32:35], v[52:55]
    ds_read_b128 a[156:159], v4 offset:27648
    v_mfma_f32_16x16x32_bf16 v[56:59], a[172:175], a[36:39], v[56:59]
    s_waitcnt lgkmcnt(4)
    v_mfma_f32_16x16x32_bf16 v[60:63], a[176:179], a[32:35], v[60:63]
    ds_read_b128 a[160:163], v4 offset:28672
    v_mfma_f32_16x16x32_bf16 v[64:67], a[176:179], a[36:39], v[64:67]
    v_mfma_f32_16x16x32_bf16 v[68:71], a[180:183], a[32:35], v[68:71]
    ds_read_b128 a[164:167], v4 offset:29696
    v_mfma_f32_16x16x32_bf16 v[72:75], a[180:183], a[36:39], v[72:75]
    v_mfma_f32_16x16x32_bf16 v[76:79], a[184:187], a[32:35], v[76:79]
    ds_read_b128 a[168:171], v4 offset:30720
    v_mfma_f32_16x16x32_bf16 v[80:83], a[184:187], a[36:39], v[80:83]
    v_mfma_f32_16x16x32_bf16 v[84:87], a[188:191], a[32:35], v[84:87]
    ds_read_b128 a[172:175], v4 offset:31744
    v_mfma_f32_16x16x32_bf16 v[88:91], a[188:191], a[36:39], v[88:91]
    s_waitcnt lgkmcnt(4)
    v_mfma_f32_16x16x32_bf16 v[92:95], a[144:147], a[32:35], v[92:95]
    s_waitcnt vmcnt(14)
    s_barrier
    ds_read_b128 a[176:179], v3 offset:0
    v_mfma_f32_16x16x32_bf16 v[96:99], a[144:147], a[36:39], v[96:99]
    s_add_u32 m0, s25, 49152
    s_nop 0
    buffer_load_dwordx4 v3, s[8:11], s24 offen offset:0 sc1 lds
    v_mfma_f32_16x16x32_bf16 v[100:103], a[148:151], a[32:35], v[100:103]
    ds_read_b128 a[180:183], v3 offset:1024
    v_mfma_f32_16x16x32_bf16 v[104:107], a[148:151], a[36:39], v[104:107]
    buffer_load_dwordx4 v3, s[8:11], s24 offen offset:1024 sc1 lds
    v_mfma_f32_16x16x32_bf16 v[108:111], a[152:155], a[32:35], v[108:111]
    ds_read_b128 a[184:187], v3 offset:2048
    v_mfma_f32_16x16x32_bf16 v[112:115], a[152:155], a[36:39], v[112:115]
    buffer_load_dwordx4 v3, s[8:11], s24 offen offset:2048 sc1 lds
    v_mfma_f32_16x16x32_bf16 v[116:119], a[156:159], a[32:35], v[116:119]
    ds_read_b128 a[188:191], v3 offset:3072
    v_mfma_f32_16x16x32_bf16 v[120:123], a[156:159], a[36:39], v[120:123]
    buffer_load_dwordx4 v3, s[8:11], s24 offen offset:3072 sc1 lds
    s_add_u32 s24, s24, 4096
    s_waitcnt lgkmcnt(4)
    v_mfma_f32_16x16x32_bf16 v[124:127], a[160:163], a[32:35], v[124:127]
    ds_read_b128 a[144:147], v3 offset:4096
    v_mfma_f32_16x16x32_bf16 v[128:131], a[160:163], a[36:39], v[128:131]
    s_add_u32 s26, s26, 4096
    buffer_load_dwordx4 a[64:67], v3, s[8:11], s26 offen offset:0 sc1
    v_mfma_f32_16x16x32_bf16 v[132:135], a[164:167], a[32:35], v[132:135]
    ds_read_b128 a[148:151], v3 offset:5120
    v_mfma_f32_16x16x32_bf16 v[136:139], a[164:167], a[36:39], v[136:139]
    s_add_u32 s27, s27, 4096
    buffer_load_dwordx4 a[68:71], v3, s[8:11], s27 offen offset:0 sc1
    v_mfma_f32_16x16x32_bf16 v[140:143], a[168:171], a[32:35], v[140:143]
    ds_read_b128 a[152:155], v3 offset:6144
    v_mfma_f32_16x16x32_bf16 v[144:147], a[168:171], a[36:39], v[144:147]
    v_mfma_f32_16x16x32_bf16 v[148:151], a[172:175], a[32:35], v[148:151]
    ds_read_b128 a[156:159], v3 offset:7168
    v_mfma_f32_16x16x32_bf16 v[152:155], a[172:175], a[36:39], v[152:155]
    s_waitcnt lgkmcnt(4)
    s_waitcnt vmcnt(19)
    v_mfma_f32_16x16x32_bf16 v[28:31], a[176:179], a[40:43], v[28:31]
    ds_read_b128 a[160:163], v3 offset:8192
    s_waitcnt vmcnt(18)
    v_mfma_f32_16x16x32_bf16 v[32:35], a[176:179], a[44:47], v[32:35]
    v_mfma_f32_16x16x32_bf16 v[36:39], a[180:183], a[40:43], v[36:39]
    ds_read_b128 a[164:167], v3 offset:9216
    v_mfma_f32_16x16x32_bf16 v[40:43], a[180:183], a[44:47], v[40:43]
    v_mfma_f32_16x16x32_bf16 v[44:47], a[184:187], a[40:43], v[44:47]
    ds_read_b128 a[168:171], v3 offset:10240
    v_mfma_f32_16x16x32_bf16 v[48:51], a[184:187], a[44:47], v[48:51]
    v_mfma_f32_16x16x32_bf16 v[52:55], a[188:191], a[40:43], v[52:55]
    ds_read_b128 a[172:175], v3 offset:11264
    v_mfma_f32_16x16x32_bf16 v[56:59], a[188:191], a[44:47], v[56:59]
    s_waitcnt lgkmcnt(4)
    v_mfma_f32_16x16x32_bf16 v[60:63], a[144:147], a[40:43], v[60:63]
    ds_read_b128 a[176:179], v3 offset:12288
    v_mfma_f32_16x16x32_bf16 v[64:67], a[144:147], a[44:47], v[64:67]
    v_mfma_f32_16x16x32_bf16 v[68:71], a[148:151], a[40:43], v[68:71]
    ds_read_b128 a[180:183], v3 offset:13312
    v_mfma_f32_16x16x32_bf16 v[72:75], a[148:151], a[44:47], v[72:75]
    v_mfma_f32_16x16x32_bf16 v[76:79], a[152:155], a[40:43], v[76:79]
    ds_read_b128 a[184:187], v3 offset:14336
    v_mfma_f32_16x16x32_bf16 v[80:83], a[152:155], a[44:47], v[80:83]
    v_mfma_f32_16x16x32_bf16 v[84:87], a[156:159], a[40:43], v[84:87]
    ds_read_b128 a[188:191], v3 offset:15360
    v_mfma_f32_16x16x32_bf16 v[88:91], a[156:159], a[44:47], v[88:91]
    s_waitcnt lgkmcnt(4)
    v_mfma_f32_16x16x32_bf16 v[92:95], a[160:163], a[40:43], v[92:95]
    s_waitcnt vmcnt(14)
    s_barrier
    ds_read_b128 a[144:147], v3 offset:16384
    v_mfma_f32_16x16x32_bf16 v[96:99], a[160:163], a[44:47], v[96:99]
    s_add_u32 m0, s25, 65536
    s_nop 0
    buffer_load_dwordx4 v3, s[8:11], s24 offen offset:0 sc1 lds
    v_mfma_f32_16x16x32_bf16 v[100:103], a[164:167], a[40:43], v[100:103]
    ds_read_b128 a[148:151], v3 offset:17408
    v_mfma_f32_16x16x32_bf16 v[104:107], a[164:167], a[44:47], v[104:107]
    buffer_load_dwordx4 v3, s[8:11], s24 offen offset:1024 sc1 lds
    v_mfma_f32_16x16x32_bf16 v[108:111], a[168:171], a[40:43], v[108:111]
    ds_read_b128 a[152:155], v3 offset:18432
    v_mfma_f32_16x16x32_bf16 v[112:115], a[168:171], a[44:47], v[112:115]
    buffer_load_dwordx4 v3, s[8:11], s24 offen offset:2048 sc1 lds
    v_mfma_f32_16x16x32_bf16 v[116:119], a[172:175], a[40:43], v[116:119]
    ds_read_b128 a[156:159], v3 offset:19456
    v_mfma_f32_16x16x32_bf16 v[120:123], a[172:175], a[44:47], v[120:123]
    buffer_load_dwordx4 v3, s[8:11], s24 offen offset:3072 sc1 lds
    s_add_u32 s24, s24, 4096
    s_waitcnt lgkmcnt(4)
    v_mfma_f32_16x16x32_bf16 v[124:127], a[176:179], a[40:43], v[124:127]
    ds_read_b128 a[160:163], v3 offset:20480
    v_mfma_f32_16x16x32_bf16 v[128:131], a[176:179], a[44:47], v[128:131]
    buffer_load_dwordx4 a[72:75], v3, s[8:11], s26 offen offset:1024 sc1
    v_mfma_f32_16x16x32_bf16 v[132:135], a[180:183], a[40:43], v[132:135]
    ds_read_b128 a[164:167], v3 offset:21504
    v_mfma_f32_16x16x32_bf16 v[136:139], a[180:183], a[44:47], v[136:139]
    buffer_load_dwordx4 a[76:79], v3, s[8:11], s27 offen offset:1024 sc1
    v_mfma_f32_16x16x32_bf16 v[140:143], a[184:187], a[40:43], v[140:143]
    ds_read_b128 a[168:171], v3 offset:22528
    v_mfma_f32_16x16x32_bf16 v[144:147], a[184:187], a[44:47], v[144:147]
    v_mfma_f32_16x16x32_bf16 v[148:151], a[188:191], a[40:43], v[148:151]
    ds_read_b128 a[172:175], v3 offset:23552
    v_mfma_f32_16x16x32_bf16 v[152:155], a[188:191], a[44:47], v[152:155]
    s_waitcnt lgkmcnt(4)
    s_waitcnt vmcnt(19)
    v_mfma_f32_16x16x32_bf16 v[28:31], a[144:147], a[48:51], v[28:31]
    ds_read_b128 a[176:179], v3 offset:24576
    s_waitcnt vmcnt(18)
    v_mfma_f32_16x16x32_bf16 v[32:35], a[144:147], a[52:55], v[32:35]
    buffer_load_dwordx4 v[172:175], v7, s[8:11], s23 offen offset:0 sc1
    v_mfma_f32_16x16x32_bf16 v[36:39], a[148:151], a[48:51], v[36:39]
    ds_read_b128 a[180:183], v3 offset:25600
    v_mfma_f32_16x16x32_bf16 v[40:43], a[148:151], a[52:55], v[40:43]
    buffer_load_dwordx4 v[176:179], v7, s[8:11], s23 offen offset:16 sc1
    v_mfma_f32_16x16x32_bf16 v[44:47], a[152:155], a[48:51], v[44:47]
    ds_read_b128 a[184:187], v3 offset:26624
    v_mfma_f32_16x16x32_bf16 v[48:51], a[152:155], a[52:55], v[48:51]
    buffer_load_dwordx4 v[180:183], v7, s[8:11], s23 offen offset:32 sc1
    v_mfma_f32_16x16x32_bf16 v[52:55], a[156:159], a[48:51], v[52:55]
    ds_read_b128 a[188:191], v3 offset:27648
    v_mfma_f32_16x16x32_bf16 v[56:59], a[156:159], a[52:55], v[56:59]
    buffer_load_dwordx4 v[184:187], v7, s[8:11], s23 offen offset:48 sc1
    s_waitcnt lgkmcnt(4)
    v_mfma_f32_16x16x32_bf16 v[60:63], a[160:163], a[48:51], v[60:63]
    ds_read_b128 a[144:147], v3 offset:28672
    v_mfma_f32_16x16x32_bf16 v[64:67], a[160:163], a[52:55], v[64:67]
    buffer_load_dwordx4 v[188:191], v7, s[8:11], s23 offen offset:1024 sc1
    v_mfma_f32_16x16x32_bf16 v[68:71], a[164:167], a[48:51], v[68:71]
    ds_read_b128 a[148:151], v3 offset:29696
    v_mfma_f32_16x16x32_bf16 v[72:75], a[164:167], a[52:55], v[72:75]
    buffer_load_dwordx4 v[192:195], v7, s[8:11], s23 offen offset:1040 sc1
    v_mfma_f32_16x16x32_bf16 v[76:79], a[168:171], a[48:51], v[76:79]
    ds_read_b128 a[152:155], v3 offset:30720
    v_mfma_f32_16x16x32_bf16 v[80:83], a[168:171], a[52:55], v[80:83]
    buffer_load_dwordx4 v[196:199], v7, s[8:11], s23 offen offset:1056 sc1
    v_mfma_f32_16x16x32_bf16 v[84:87], a[172:175], a[48:51], v[84:87]
    ds_read_b128 a[156:159], v3 offset:31744
    v_mfma_f32_16x16x32_bf16 v[88:91], a[172:175], a[52:55], v[88:91]
    buffer_load_dwordx4 v[200:203], v7, s[8:11], s23 offen offset:1072 sc1
    s_waitcnt lgkmcnt(4)
    v_mfma_f32_16x16x32_bf16 v[92:95], a[176:179], a[48:51], v[92:95]
    s_waitcnt vmcnt(22)
    s_barrier
    ds_read_b128 a[160:163], v3 offset:32768
    v_mfma_f32_16x16x32_bf16 v[96:99], a[176:179], a[52:55], v[96:99]
    buffer_load_dwordx4 v[204:207], v24, s[8:11], s31 offen sc1
    s_add_u32 s31, s31, 36864
    v_mfma_f32_16x16x32_bf16 v[100:103], a[180:183], a[48:51], v[100:103]
    ds_read_b128 a[164:167], v3 offset:33792
    v_mfma_f32_16x16x32_bf16 v[104:107], a[180:183], a[52:55], v[104:107]
    buffer_load_dwordx4 v[208:211], v24, s[8:11], s31 offen sc1
    s_add_u32 s31, s31, 36864
    v_mfma_f32_16x16x32_bf16 v[108:111], a[184:187], a[48:51], v[108:111]
    ds_read_b128 a[168:171], v3 offset:34816
    v_mfma_f32_16x16x32_bf16 v[112:115], a[184:187], a[52:55], v[112:115]
    buffer_load_dwordx4 v[212:215], v24, s[8:11], s31 offen sc1
    s_add_u32 s31, s31, 36864
    v_mfma_f32_16x16x32_bf16 v[116:119], a[188:191], a[48:51], v[116:119]
    ds_read_b128 a[172:175], v3 offset:35840
    v_mfma_f32_16x16x32_bf16 v[120:123], a[188:191], a[52:55], v[120:123]
    buffer_load_dwordx4 v[216:219], v24, s[8:11], s31 offen sc1
    s_add_u32 s31, s31, 36864
    s_waitcnt lgkmcnt(4)
    v_mfma_f32_16x16x32_bf16 v[124:127], a[144:147], a[48:51], v[124:127]
    ds_read_b128 a[176:179], v3 offset:36864
    v_mfma_f32_16x16x32_bf16 v[128:131], a[144:147], a[52:55], v[128:131]
    buffer_load_dwordx4 v[220:223], v24, s[8:11], s31 offen sc1
    s_add_u32 s31, s31, 36864
    v_mfma_f32_16x16x32_bf16 v[132:135], a[148:151], a[48:51], v[132:135]
    ds_read_b128 a[180:183], v3 offset:37888
    v_mfma_f32_16x16x32_bf16 v[136:139], a[148:151], a[52:55], v[136:139]
    buffer_load_dwordx4 v[224:227], v24, s[8:11], s31 offen sc1
    s_add_u32 s31, s31, 36864
    v_mfma_f32_16x16x32_bf16 v[140:143], a[152:155], a[48:51], v[140:143]
    ds_read_b128 a[184:187], v3 offset:38912
    v_mfma_f32_16x16x32_bf16 v[144:147], a[152:155], a[52:55], v[144:147]
    buffer_load_dwordx4 v[228:231], v24, s[8:11], s31 offen sc1
    s_add_u32 s31, s31, 36864
    v_mfma_f32_16x16x32_bf16 v[148:151], a[156:159], a[48:51], v[148:151]
    ds_read_b128 a[188:191], v3 offset:39936
    v_mfma_f32_16x16x32_bf16 v[152:155], a[156:159], a[52:55], v[152:155]
    buffer_load_dwordx4 v[232:235], v24, s[8:11], s31 offen sc1
    s_add_u32 s31, s31, 36864
    s_waitcnt lgkmcnt(4)
    s_waitcnt vmcnt(29)
    v_mfma_f32_16x16x32_bf16 v[28:31], a[160:163], a[56:59], v[28:31]
    ds_read_b128 a[144:147], v3 offset:40960
    s_waitcnt vmcnt(28)
    v_mfma_f32_16x16x32_bf16 v[32:35], a[160:163], a[60:63], v[32:35]
    buffer_load_dwordx4 v[236:239], v24, s[8:11], s31 offen sc1
    v_mfma_f32_16x16x32_bf16 v[36:39], a[164:167], a[56:59], v[36:39]
    ds_read_b128 a[148:151], v3 offset:41984
    v_mfma_f32_16x16x32_bf16 v[40:43], a[164:167], a[60:63], v[40:43]
    s_add_u32 m0, s25, 0
    s_nop 0
    buffer_load_dwordx4 v3, s[8:11], s24 offen offset:0 sc1 lds
    v_mfma_f32_16x16x32_bf16 v[44:47], a[168:171], a[56:59], v[44:47]
    ds_read_b128 a[152:155], v3 offset:43008
    v_mfma_f32_16x16x32_bf16 v[48:51], a[168:171], a[60:63], v[48:51]
    buffer_load_dwordx4 v3, s[8:11], s24 offen offset:1024 sc1 lds
    v_mfma_f32_16x16x32_bf16 v[52:55], a[172:175], a[56:59], v[52:55]
    ds_read_b128 a[156:159], v3 offset:44032
    v_mfma_f32_16x16x32_bf16 v[56:59], a[172:175], a[60:63], v[56:59]
    buffer_load_dwordx4 v3, s[8:11], s24 offen offset:2048 sc1 lds
    s_waitcnt lgkmcnt(4)
    v_mfma_f32_16x16x32_bf16 v[60:63], a[176:179], a[56:59], v[60:63]
    ds_read_b128 a[160:163], v3 offset:45056
    v_mfma_f32_16x16x32_bf16 v[64:67], a[176:179], a[60:63], v[64:67]
    buffer_load_dwordx4 v3, s[8:11], s24 offen offset:3072 sc1 lds
    s_add_u32 s24, s24, 4096
    v_mfma_f32_16x16x32_bf16 v[68:71], a[180:183], a[56:59], v[68:71]
    ds_read_b128 a[164:167], v3 offset:46080
    v_mfma_f32_16x16x32_bf16 v[72:75], a[180:183], a[60:63], v[72:75]
    buffer_load_dwordx4 a[80:83], v3, s[8:11], s26 offen offset:2048 sc1
    v_mfma_f32_16x16x32_bf16 v[76:79], a[184:187], a[56:59], v[76:79]
    ds_read_b128 a[168:171], v3 offset:47104
    v_mfma_f32_16x16x32_bf16 v[80:83], a[184:187], a[60:63], v[80:83]
    buffer_load_dwordx4 a[84:87], v3, s[8:11], s27 offen offset:2048 sc1
    v_mfma_f32_16x16x32_bf16 v[84:87], a[188:191], a[56:59], v[84:87]
    ds_read_b128 a[172:175], v3 offset:48128
    v_mfma_f32_16x16x32_bf16 v[88:91], a[188:191], a[60:63], v[88:91]
    s_waitcnt lgkmcnt(4)
    v_mfma_f32_16x16x32_bf16 v[92:95], a[144:147], a[56:59], v[92:95]
    s_waitcnt vmcnt(31)
    s_barrier
    ds_read_b128 a[176:179], v4 offset:0
    v_mfma_f32_16x16x32_bf16 v[96:99], a[144:147], a[60:63], v[96:99]
    s_add_u32 m0, s25, 16384
    s_nop 0
    buffer_load_dwordx4 v3, s[8:11], s24 offen offset:0 sc1 lds
    v_mfma_f32_16x16x32_bf16 v[100:103], a[148:151], a[56:59], v[100:103]
    ds_read_b128 a[180:183], v4 offset:1024
    v_mfma_f32_16x16x32_bf16 v[104:107], a[148:151], a[60:63], v[104:107]
    buffer_load_dwordx4 v3, s[8:11], s24 offen offset:1024 sc1 lds
    v_mfma_f32_16x16x32_bf16 v[108:111], a[152:155], a[56:59], v[108:111]
    ds_read_b128 a[184:187], v4 offset:2048
    v_mfma_f32_16x16x32_bf16 v[112:115], a[152:155], a[60:63], v[112:115]
    buffer_load_dwordx4 v3, s[8:11], s24 offen offset:2048 sc1 lds
    v_mfma_f32_16x16x32_bf16 v[116:119], a[156:159], a[56:59], v[116:119]
    ds_read_b128 a[188:191], v4 offset:3072
    v_mfma_f32_16x16x32_bf16 v[120:123], a[156:159], a[60:63], v[120:123]
    buffer_load_dwordx4 v3, s[8:11], s24 offen offset:3072 sc1 lds
    s_add_u32 s24, s24, 4096
    s_waitcnt lgkmcnt(4)
    v_mfma_f32_16x16x32_bf16 v[124:127], a[160:163], a[56:59], v[124:127]
    ds_read_b128 a[144:147], v4 offset:4096
    v_mfma_f32_16x16x32_bf16 v[128:131], a[160:163], a[60:63], v[128:131]
    buffer_load_dwordx4 a[88:91], v3, s[8:11], s26 offen offset:3072 sc1
    v_mfma_f32_16x16x32_bf16 v[132:135], a[164:167], a[56:59], v[132:135]
    ds_read_b128 a[148:151], v4 offset:5120
    v_mfma_f32_16x16x32_bf16 v[136:139], a[164:167], a[60:63], v[136:139]
    buffer_load_dwordx4 a[92:95], v3, s[8:11], s27 offen offset:3072 sc1
    v_mfma_f32_16x16x32_bf16 v[140:143], a[168:171], a[56:59], v[140:143]
    ds_read_b128 a[152:155], v4 offset:6144
    v_mfma_f32_16x16x32_bf16 v[144:147], a[168:171], a[60:63], v[144:147]
    v_mfma_f32_16x16x32_bf16 v[148:151], a[172:175], a[56:59], v[148:151]
    ds_read_b128 a[156:159], v4 offset:7168
    v_mfma_f32_16x16x32_bf16 v[152:155], a[172:175], a[60:63], v[152:155]
    s_waitcnt lgkmcnt(4)
    s_waitcnt vmcnt(36)
    v_mfma_f32_16x16x32_bf16 v[28:31], a[176:179], a[64:67], v[28:31]
    ds_read_b128 a[160:163], v4 offset:8192
    s_waitcnt vmcnt(35)
    v_mfma_f32_16x16x32_bf16 v[32:35], a[176:179], a[68:71], v[32:35]
    v_mfma_f32_16x16x32_bf16 v[36:39], a[180:183], a[64:67], v[36:39]
    ds_read_b128 a[164:167], v4 offset:9216
    v_mfma_f32_16x16x32_bf16 v[40:43], a[180:183], a[68:71], v[40:43]
    v_mfma_f32_16x16x32_bf16 v[44:47], a[184:187], a[64:67], v[44:47]
    ds_read_b128 a[168:171], v4 offset:10240
    v_mfma_f32_16x16x32_bf16 v[48:51], a[184:187], a[68:71], v[48:51]
    v_mfma_f32_16x16x32_bf16 v[52:55], a[188:191], a[64:67], v[52:55]
    ds_read_b128 a[172:175], v4 offset:11264
    v_mfma_f32_16x16x32_bf16 v[56:59], a[188:191], a[68:71], v[56:59]
    s_waitcnt lgkmcnt(4)
    v_mfma_f32_16x16x32_bf16 v[60:63], a[144:147], a[64:67], v[60:63]
    ds_read_b128 a[176:179], v4 offset:12288
    v_mfma_f32_16x16x32_bf16 v[64:67], a[144:147], a[68:71], v[64:67]
    v_mfma_f32_16x16x32_bf16 v[68:71], a[148:151], a[64:67], v[68:71]
    ds_read_b128 a[180:183], v4 offset:13312
    v_mfma_f32_16x16x32_bf16 v[72:75], a[148:151], a[68:71], v[72:75]
    v_mfma_f32_16x16x32_bf16 v[76:79], a[152:155], a[64:67], v[76:79]
    ds_read_b128 a[184:187], v4 offset:14336
    v_mfma_f32_16x16x32_bf16 v[80:83], a[152:155], a[68:71], v[80:83]
    v_mfma_f32_16x16x32_bf16 v[84:87], a[156:159], a[64:67], v[84:87]
    ds_read_b128 a[188:191], v4 offset:15360
    v_mfma_f32_16x16x32_bf16 v[88:91], a[156:159], a[68:71], v[88:91]
    s_waitcnt lgkmcnt(4)
    v_mfma_f32_16x16x32_bf16 v[92:95], a[160:163], a[64:67], v[92:95]
    s_waitcnt vmcnt(31)
    s_barrier
    ds_read_b128 a[144:147], v4 offset:16384
    v_mfma_f32_16x16x32_bf16 v[96:99], a[160:163], a[68:71], v[96:99]
    s_add_u32 m0, s25, 32768
    s_nop 0
    buffer_load_dwordx4 v3, s[8:11], s24 offen offset:0 sc1 lds
    v_mfma_f32_16x16x32_bf16 v[100:103], a[164:167], a[64:67], v[100:103]
    ds_read_b128 a[148:151], v4 offset:17408
    v_mfma_f32_16x16x32_bf16 v[104:107], a[164:167], a[68:71], v[104:107]
    buffer_load_dwordx4 v3, s[8:11], s24 offen offset:1024 sc1 lds
    v_mfma_f32_16x16x32_bf16 v[108:111], a[168:171], a[64:67], v[108:111]
    ds_read_b128 a[152:155], v4 offset:18432
    v_mfma_f32_16x16x32_bf16 v[112:115], a[168:171], a[68:71], v[112:115]
    buffer_load_dwordx4 v3, s[8:11], s24 offen offset:2048 sc1 lds
    v_mfma_f32_16x16x32_bf16 v[116:119], a[172:175], a[64:67], v[116:119]
    ds_read_b128 a[156:159], v4 offset:19456
    v_mfma_f32_16x16x32_bf16 v[120:123], a[172:175], a[68:71], v[120:123]
    buffer_load_dwordx4 v3, s[8:11], s24 offen offset:3072 sc1 lds
    s_add_u32 s24, s24, 4096
    s_waitcnt lgkmcnt(4)
    v_mfma_f32_16x16x32_bf16 v[124:127], a[176:179], a[64:67], v[124:127]
    ds_read_b128 a[160:163], v4 offset:20480
    v_mfma_f32_16x16x32_bf16 v[128:131], a[176:179], a[68:71], v[128:131]
    s_add_u32 s26, s26, 4096
    buffer_load_dwordx4 a[96:99], v3, s[8:11], s26 offen offset:0 sc1
    v_mfma_f32_16x16x32_bf16 v[132:135], a[180:183], a[64:67], v[132:135]
    ds_read_b128 a[164:167], v4 offset:21504
    v_mfma_f32_16x16x32_bf16 v[136:139], a[180:183], a[68:71], v[136:139]
    s_add_u32 s27, s27, 4096
    buffer_load_dwordx4 a[100:103], v3, s[8:11], s27 offen offset:0 sc1
    v_mfma_f32_16x16x32_bf16 v[140:143], a[184:187], a[64:67], v[140:143]
    ds_read_b128 a[168:171], v4 offset:22528
    v_mfma_f32_16x16x32_bf16 v[144:147], a[184:187], a[68:71], v[144:147]
    v_mfma_f32_16x16x32_bf16 v[148:151], a[188:191], a[64:67], v[148:151]
    ds_read_b128 a[172:175], v4 offset:23552
    v_mfma_f32_16x16x32_bf16 v[152:155], a[188:191], a[68:71], v[152:155]
    s_waitcnt lgkmcnt(4)
    s_waitcnt vmcnt(36)
    v_mfma_f32_16x16x32_bf16 v[28:31], a[144:147], a[72:75], v[28:31]
    ds_read_b128 a[176:179], v4 offset:24576
    s_waitcnt vmcnt(35)
    v_mfma_f32_16x16x32_bf16 v[32:35], a[144:147], a[76:79], v[32:35]
    v_mfma_f32_16x16x32_bf16 v[36:39], a[148:151], a[72:75], v[36:39]
    ds_read_b128 a[180:183], v4 offset:25600
    v_mfma_f32_16x16x32_bf16 v[40:43], a[148:151], a[76:79], v[40:43]
    v_mfma_f32_16x16x32_bf16 v[44:47], a[152:155], a[72:75], v[44:47]
    ds_read_b128 a[184:187], v4 offset:26624
    v_mfma_f32_16x16x32_bf16 v[48:51], a[152:155], a[76:79], v[48:51]
    v_mfma_f32_16x16x32_bf16 v[52:55], a[156:159], a[72:75], v[52:55]
    ds_read_b128 a[188:191], v4 offset:27648
    v_mfma_f32_16x16x32_bf16 v[56:59], a[156:159], a[76:79], v[56:59]
    s_waitcnt lgkmcnt(4)
    v_mfma_f32_16x16x32_bf16 v[60:63], a[160:163], a[72:75], v[60:63]
    ds_read_b128 a[144:147], v4 offset:28672
    v_mfma_f32_16x16x32_bf16 v[64:67], a[160:163], a[76:79], v[64:67]
    v_mfma_f32_16x16x32_bf16 v[68:71], a[164:167], a[72:75], v[68:71]
    ds_read_b128 a[148:151], v4 offset:29696
    v_mfma_f32_16x16x32_bf16 v[72:75], a[164:167], a[76:79], v[72:75]
    v_mfma_f32_16x16x32_bf16 v[76:79], a[168:171], a[72:75], v[76:79]
    ds_read_b128 a[152:155], v4 offset:30720
    v_mfma_f32_16x16x32_bf16 v[80:83], a[168:171], a[76:79], v[80:83]
    v_mfma_f32_16x16x32_bf16 v[84:87], a[172:175], a[72:75], v[84:87]
    ds_read_b128 a[156:159], v4 offset:31744
    v_mfma_f32_16x16x32_bf16 v[88:91], a[172:175], a[76:79], v[88:91]
    s_waitcnt lgkmcnt(4)
    v_mfma_f32_16x16x32_bf16 v[92:95], a[176:179], a[72:75], v[92:95]
    s_waitcnt vmcnt(14)
    s_barrier
    ds_read_b128 a[160:163], v3 offset:0
    v_mfma_f32_16x16x32_bf16 v[96:99], a[176:179], a[76:79], v[96:99]
    s_add_u32 m0, s25, 49152
    s_nop 0
    buffer_load_dwordx4 v3, s[8:11], s24 offen offset:0 sc1 lds
    v_mfma_f32_16x16x32_bf16 v[100:103], a[180:183], a[72:75], v[100:103]
    ds_read_b128 a[164:167], v3 offset:1024
    v_mfma_f32_16x16x32_bf16 v[104:107], a[180:183], a[76:79], v[104:107]
    buffer_load_dwordx4 v3, s[8:11], s24 offen offset:1024 sc1 lds
    v_mfma_f32_16x16x32_bf16 v[108:111], a[184:187], a[72:75], v[108:111]
    ds_read_b128 a[168:171], v3 offset:2048
    v_mfma_f32_16x16x32_bf16 v[112:115], a[184:187], a[76:79], v[112:115]
    buffer_load_dwordx4 v3, s[8:11], s24 offen offset:2048 sc1 lds
    v_mfma_f32_16x16x32_bf16 v[116:119], a[188:191], a[72:75], v[116:119]
    ds_read_b128 a[172:175], v3 offset:3072
    v_mfma_f32_16x16x32_bf16 v[120:123], a[188:191], a[76:79], v[120:123]
    buffer_load_dwordx4 v3, s[8:11], s24 offen offset:3072 sc1 lds
    s_add_u32 s24, s24, 4096
    s_waitcnt lgkmcnt(4)
    v_mfma_f32_16x16x32_bf16 v[124:127], a[144:147], a[72:75], v[124:127]
    ds_read_b128 a[176:179], v3 offset:4096
    v_mfma_f32_16x16x32_bf16 v[128:131], a[144:147], a[76:79], v[128:131]
    buffer_load_dwordx4 a[104:107], v3, s[8:11], s26 offen offset:1024 sc1
    v_mfma_f32_16x16x32_bf16 v[132:135], a[148:151], a[72:75], v[132:135]
    ds_read_b128 a[180:183], v3 offset:5120
    v_mfma_f32_16x16x32_bf16 v[136:139], a[148:151], a[76:79], v[136:139]
    buffer_load_dwordx4 a[108:111], v3, s[8:11], s27 offen offset:1024 sc1
    v_mfma_f32_16x16x32_bf16 v[140:143], a[152:155], a[72:75], v[140:143]
    ds_read_b128 a[184:187], v3 offset:6144
    v_mfma_f32_16x16x32_bf16 v[144:147], a[152:155], a[76:79], v[144:147]
    v_mfma_f32_16x16x32_bf16 v[148:151], a[156:159], a[72:75], v[148:151]
    ds_read_b128 a[188:191], v3 offset:7168
    v_mfma_f32_16x16x32_bf16 v[152:155], a[156:159], a[76:79], v[152:155]
    s_waitcnt lgkmcnt(4)
    s_waitcnt vmcnt(19)
    v_mfma_f32_16x16x32_bf16 v[28:31], a[160:163], a[80:83], v[28:31]
    ds_read_b128 a[144:147], v3 offset:8192
    s_waitcnt vmcnt(18)
    v_mfma_f32_16x16x32_bf16 v[32:35], a[160:163], a[84:87], v[32:35]
    v_lshl_add_u32 v26, v1, 10, v3
    v_and_b32 v27, 1, v1
    v_lshl_add_u32 v27, v27, 10, v3
    v_add_u32 v27, 16384, v27
    v_mov_b32 v16, -1
    v_mov_b32 v17, -1
    v_mov_b32 v18, -1
    v_mov_b32 v19, -1
    v_mfma_f32_16x16x32_bf16 v[36:39], a[164:167], a[80:83], v[36:39]
    ds_read_b128 a[148:151], v3 offset:9216
    v_mfma_f32_16x16x32_bf16 v[40:43], a[164:167], a[84:87], v[40:43]
    buffer_store_dwordx4 v[16:19], v26, s[8:11], s47 offen sc1
    v_mfma_f32_16x16x32_bf16 v[44:47], a[168:171], a[80:83], v[44:47]
    ds_read_b128 a[152:155], v3 offset:10240
    v_mfma_f32_16x16x32_bf16 v[48:51], a[168:171], a[84:87], v[48:51]
    s_add_u32 s59, s47, 4096
    buffer_store_dwordx4 v[16:19], v26, s[8:11], s59 offen sc1
    v_mfma_f32_16x16x32_bf16 v[52:55], a[172:175], a[80:83], v[52:55]
    ds_read_b128 a[156:159], v3 offset:11264
    v_mfma_f32_16x16x32_bf16 v[56:59], a[172:175], a[84:87], v[56:59]
    s_add_u32 s59, s47, 8192
    buffer_store_dwordx4 v[16:19], v26, s[8:11], s59 offen sc1
    s_waitcnt lgkmcnt(4)
    v_mfma_f32_16x16x32_bf16 v[60:63], a[176:179], a[80:83], v[60:63]
    ds_read_b128 a[160:163], v3 offset:12288
    v_mfma_f32_16x16x32_bf16 v[64:67], a[176:179], a[84:87], v[64:67]
    s_add_u32 s59, s47, 12288
    buffer_store_dwordx4 v[16:19], v26, s[8:11], s59 offen sc1
    v_mfma_f32_16x16x32_bf16 v[68:71], a[180:183], a[80:83], v[68:71]
    ds_read_b128 a[164:167], v3 offset:13312
    v_mfma_f32_16x16x32_bf16 v[72:75], a[180:183], a[84:87], v[72:75]
    buffer_store_dwordx4 v[16:19], v27, s[8:11], s47 offen sc1
    v_mfma_f32_16x16x32_bf16 v[76:79], a[184:187], a[80:83], v[76:79]
    ds_read_b128 a[168:171], v3 offset:14336
    v_mfma_f32_16x16x32_bf16 v[80:83], a[184:187], a[84:87], v[80:83]
    v_mfma_f32_16x16x32_bf16 v[84:87], a[188:191], a[80:83], v[84:87]
    ds_read_b128 a[172:175], v3 offset:15360
    v_mfma_f32_16x16x32_bf16 v[88:91], a[188:191], a[84:87], v[88:91]
    s_waitcnt lgkmcnt(4)
    v_mfma_f32_16x16x32_bf16 v[92:95], a[144:147], a[80:83], v[92:95]
    s_waitcnt vmcnt(19)
    s_barrier
    ds_read_b128 a[176:179], v3 offset:16384
    v_mfma_f32_16x16x32_bf16 v[96:99], a[144:147], a[84:87], v[96:99]
    s_add_u32 m0, s25, 65536
    s_nop 0
    buffer_load_dwordx4 v3, s[8:11], s24 offen offset:0 sc1 lds
    v_mfma_f32_16x16x32_bf16 v[100:103], a[148:151], a[80:83], v[100:103]
    ds_read_b128 a[180:183], v3 offset:17408
    v_mfma_f32_16x16x32_bf16 v[104:107], a[148:151], a[84:87], v[104:107]
    buffer_load_dwordx4 v3, s[8:11], s24 offen offset:1024 sc1 lds
    v_mfma_f32_16x16x32_bf16 v[108:111], a[152:155], a[80:83], v[108:111]
    ds_read_b128 a[184:187], v3 offset:18432
    v_mfma_f32_16x16x32_bf16 v[112:115], a[152:155], a[84:87], v[112:115]
    buffer_load_dwordx4 v3, s[8:11], s24 offen offset:2048 sc1 lds
    v_mfma_f32_16x16x32_bf16 v[116:119], a[156:159], a[80:83], v[116:119]
    ds_read_b128 a[188:191], v3 offset:19456
    v_mfma_f32_16x16x32_bf16 v[120:123], a[156:159], a[84:87], v[120:123]
    buffer_load_dwordx4 v3, s[8:11], s24 offen offset:3072 sc1 lds
    s_add_u32 s24, s24, 4096
    s_waitcnt lgkmcnt(4)
    v_mfma_f32_16x16x32_bf16 v[124:127], a[160:163], a[80:83], v[124:127]
    ds_read_b128 a[144:147], v3 offset:20480
    v_mfma_f32_16x16x32_bf16 v[128:131], a[160:163], a[84:87], v[128:131]
    buffer_load_dwordx4 a[112:115], v3, s[8:11], s26 offen offset:2048 sc1
    v_mfma_f32_16x16x32_bf16 v[132:135], a[164:167], a[80:83], v[132:135]
    ds_read_b128 a[148:151], v3 offset:21504
    v_mfma_f32_16x16x32_bf16 v[136:139], a[164:167], a[84:87], v[136:139]
    buffer_load_dwordx4 a[116:119], v3, s[8:11], s27 offen offset:2048 sc1
    v_mfma_f32_16x16x32_bf16 v[140:143], a[168:171], a[80:83], v[140:143]
    ds_read_b128 a[152:155], v3 offset:22528
    v_mfma_f32_16x16x32_bf16 v[144:147], a[168:171], a[84:87], v[144:147]
    v_mfma_f32_16x16x32_bf16 v[148:151], a[172:175], a[80:83], v[148:151]
    ds_read_b128 a[156:159], v3 offset:23552
    v_mfma_f32_16x16x32_bf16 v[152:155], a[172:175], a[84:87], v[152:155]
    s_waitcnt lgkmcnt(4)
    s_waitcnt vmcnt(24)
    v_mfma_f32_16x16x32_bf16 v[28:31], a[176:179], a[88:91], v[28:31]
    ds_read_b128 a[160:163], v3 offset:24576
    s_waitcnt vmcnt(23)
    v_mfma_f32_16x16x32_bf16 v[32:35], a[176:179], a[92:95], v[32:35]
    v_mfma_f32_16x16x32_bf16 v[36:39], a[180:183], a[88:91], v[36:39]
    ds_read_b128 a[164:167], v3 offset:25600
    v_mfma_f32_16x16x32_bf16 v[40:43], a[180:183], a[92:95], v[40:43]
    v_mfma_f32_16x16x32_bf16 v[44:47], a[184:187], a[88:91], v[44:47]
    ds_read_b128 a[168:171], v3 offset:26624
    v_mfma_f32_16x16x32_bf16 v[48:51], a[184:187], a[92:95], v[48:51]
    v_mfma_f32_16x16x32_bf16 v[52:55], a[188:191], a[88:91], v[52:55]
    ds_read_b128 a[172:175], v3 offset:27648
    v_mfma_f32_16x16x32_bf16 v[56:59], a[188:191], a[92:95], v[56:59]
    s_waitcnt lgkmcnt(4)
    v_mfma_f32_16x16x32_bf16 v[60:63], a[144:147], a[88:91], v[60:63]
    ds_read_b128 a[176:179], v3 offset:28672
    v_mfma_f32_16x16x32_bf16 v[64:67], a[144:147], a[92:95], v[64:67]
    v_mfma_f32_16x16x32_bf16 v[68:71], a[148:151], a[88:91], v[68:71]
    ds_read_b128 a[180:183], v3 offset:29696
    v_mfma_f32_16x16x32_bf16 v[72:75], a[148:151], a[92:95], v[72:75]
    v_mfma_f32_16x16x32_bf16 v[76:79], a[152:155], a[88:91], v[76:79]
    ds_read_b128 a[184:187], v3 offset:30720
    v_mfma_f32_16x16x32_bf16 v[80:83], a[152:155], a[92:95], v[80:83]
    v_mfma_f32_16x16x32_bf16 v[84:87], a[156:159], a[88:91], v[84:87]
    ds_read_b128 a[188:191], v3 offset:31744
    v_mfma_f32_16x16x32_bf16 v[88:91], a[156:159], a[92:95], v[88:91]
    s_waitcnt lgkmcnt(4)
    v_mfma_f32_16x16x32_bf16 v[92:95], a[160:163], a[88:91], v[92:95]
    s_waitcnt vmcnt(19)
    s_barrier
    ds_read_b128 a[144:147], v3 offset:32768
    v_mfma_f32_16x16x32_bf16 v[96:99], a[160:163], a[92:95], v[96:99]
    s_add_u32 m0, s25, 0
    s_nop 0
    buffer_load_dwordx4 v3, s[8:11], s24 offen offset:0 sc1 lds
    v_mfma_f32_16x16x32_bf16 v[100:103], a[164:167], a[88:91], v[100:103]
    ds_read_b128 a[148:151], v3 offset:33792
    v_mfma_f32_16x16x32_bf16 v[104:107], a[164:167], a[92:95], v[104:107]
    buffer_load_dwordx4 v3, s[8:11], s24 offen offset:1024 sc1 lds
    v_mfma_f32_16x16x32_bf16 v[108:111], a[168:171], a[88:91], v[108:111]
    ds_read_b128 a[152:155], v3 offset:34816
    v_mfma_f32_16x16x32_bf16 v[112:115], a[168:171], a[92:95], v[112:115]
    buffer_load_dwordx4 v3, s[8:11], s24 offen offset:2048 sc1 lds
    v_mfma_f32_16x16x32_bf16 v[116:119], a[172:175], a[88:91], v[116:119]
    ds_read_b128 a[156:159], v3 offset:35840
    v_mfma_f32_16x16x32_bf16 v[120:123], a[172:175], a[92:95], v[120:123]
    buffer_load_dwordx4 v3, s[8:11], s24 offen offset:3072 sc1 lds
    s_add_u32 s24, s24, 4096
    s_waitcnt lgkmcnt(4)
    v_mfma_f32_16x16x32_bf16 v[124:127], a[176:179], a[88:91], v[124:127]
    ds_read_b128 a[160:163], v3 offset:36864
    v_mfma_f32_16x16x32_bf16 v[128:131], a[176:179], a[92:95], v[128:131]
    buffer_load_dwordx4 a[120:123], v3, s[8:11], s26 offen offset:3072 sc1
    v_mfma_f32_16x16x32_bf16 v[132:135], a[180:183], a[88:91], v[132:135]
    ds_read_b128 a[164:167], v3 offset:37888
    v_mfma_f32_16x16x32_bf16 v[136:139], a[180:183], a[92:95], v[136:139]
    buffer_load_dwordx4 a[124:127], v3, s[8:11], s27 offen offset:3072 sc1
    v_mfma_f32_16x16x32_bf16 v[140:143], a[184:187], a[88:91], v[140:143]
    ds_read_b128 a[168:171], v3 offset:38912
    v_mfma_f32_16x16x32_bf16 v[144:147], a[184:187], a[92:95], v[144:147]
    v_mfma_f32_16x16x32_bf16 v[148:151], a[188:191], a[88:91], v[148:151]
    ds_read_b128 a[172:175], v3 offset:39936
    v_mfma_f32_16x16x32_bf16 v[152:155], a[188:191], a[92:95], v[152:155]
    s_waitcnt lgkmcnt(4)
    s_waitcnt vmcnt(24)
    v_mfma_f32_16x16x32_bf16 v[28:31], a[144:147], a[96:99], v[28:31]
    ds_read_b128 a[176:179], v3 offset:40960
    v_add_f32 v172, v172, v176
    s_waitcnt vmcnt(23)
    v_mfma_f32_16x16x32_bf16 v[32:35], a[144:147], a[100:103], v[32:35]
    v_add_f32 v173, v173, v177
    v_mfma_f32_16x16x32_bf16 v[36:39], a[148:151], a[96:99], v[36:39]
    ds_read_b128 a[180:183], v3 offset:41984
    v_add_f32 v174, v174, v178
    v_mfma_f32_16x16x32_bf16 v[40:43], a[148:151], a[100:103], v[40:43]
    v_add_f32 v175, v175, v179
    v_mfma_f32_16x16x32_bf16 v[44:47], a[152:155], a[96:99], v[44:47]
    ds_read_b128 a[184:187], v3 offset:43008
    v_add_f32 v180, v180, v184
    v_mfma_f32_16x16x32_bf16 v[48:51], a[152:155], a[100:103], v[48:51]
    v_add_f32 v181, v181, v185
    v_mfma_f32_16x16x32_bf16 v[52:55], a[156:159], a[96:99], v[52:55]
    ds_read_b128 a[188:191], v3 offset:44032
    v_add_f32 v182, v182, v186
    v_mfma_f32_16x16x32_bf16 v[56:59], a[156:159], a[100:103], v[56:59]
    v_add_f32 v183, v183, v187
    s_waitcnt lgkmcnt(4)
    v_mfma_f32_16x16x32_bf16 v[60:63], a[160:163], a[96:99], v[60:63]
    ds_read_b128 a[144:147], v3 offset:45056
    v_add_f32 v172, v172, v180
    v_mfma_f32_16x16x32_bf16 v[64:67], a[160:163], a[100:103], v[64:67]
    v_add_f32 v173, v173, v181
    v_mfma_f32_16x16x32_bf16 v[68:71], a[164:167], a[96:99], v[68:71]
    ds_read_b128 a[148:151], v3 offset:46080
    v_add_f32 v174, v174, v182
    v_mfma_f32_16x16x32_bf16 v[72:75], a[164:167], a[100:103], v[72:75]
    v_add_f32 v175, v175, v183
    v_mfma_f32_16x16x32_bf16 v[76:79], a[168:171], a[96:99], v[76:79]
    ds_read_b128 a[152:155], v3 offset:47104
    v_add_f32 v172, v172, v174
    v_mfma_f32_16x16x32_bf16 v[80:83], a[168:171], a[100:103], v[80:83]
    v_add_f32 v173, v173, v175
    v_mfma_f32_16x16x32_bf16 v[84:87], a[172:175], a[96:99], v[84:87]
    ds_read_b128 a[156:159], v3 offset:48128
    v_mul_f32 v172, 0xbae38e39, v172
    v_mfma_f32_16x16x32_bf16 v[88:91], a[172:175], a[100:103], v[88:91]
    v_mul_f32 v173, 0x3ae38e39, v173
    s_waitcnt lgkmcnt(4)
    v_mfma_f32_16x16x32_bf16 v[92:95], a[176:179], a[96:99], v[92:95]
    s_waitcnt vmcnt(19)
    s_barrier
    ds_read_b128 a[160:163], v4 offset:0
    v_fma_f32 v173, -v172, v172, v173
    v_mfma_f32_16x16x32_bf16 v[96:99], a[176:179], a[100:103], v[96:99]
    s_add_u32 m0, s25, 16384
    s_nop 0
    buffer_load_dwordx4 v3, s[8:11], s24 offen offset:0 sc1 lds
    v_max_f32 v173, 0, v173
    v_mfma_f32_16x16x32_bf16 v[100:103], a[180:183], a[96:99], v[100:103]
    ds_read_b128 a[164:167], v4 offset:1024
    v_add_f32 v173, 0x3727c5ac, v173
    v_mfma_f32_16x16x32_bf16 v[104:107], a[180:183], a[100:103], v[104:107]
    buffer_load_dwordx4 v3, s[8:11], s24 offen offset:1024 sc1 lds
    v_rsq_f32 v10, v173
    v_mfma_f32_16x16x32_bf16 v[108:111], a[184:187], a[96:99], v[108:111]
    ds_read_b128 a[168:171], v4 offset:2048
    v_mov_b32 v8, v172
    v_mfma_f32_16x16x32_bf16 v[112:115], a[184:187], a[100:103], v[112:115]
    buffer_load_dwordx4 v3, s[8:11], s24 offen offset:2048 sc1 lds
    v_mul_f32 v10, 0xbfb8aa3b, v10
    v_mfma_f32_16x16x32_bf16 v[116:119], a[188:191], a[96:99], v[116:119]
    ds_read_b128 a[172:175], v4 offset:3072
    v_mul_f32 v12, v10, v8
    v_mfma_f32_16x16x32_bf16 v[120:123], a[188:191], a[100:103], v[120:123]
    buffer_load_dwordx4 v3, s[8:11], s24 offen offset:3072 sc1 lds
    s_add_u32 s24, s24, 4096
    v_add_f32 v188, v188, v192
    s_waitcnt lgkmcnt(4)
    v_mfma_f32_16x16x32_bf16 v[124:127], a[144:147], a[96:99], v[124:127]
    ds_read_b128 a[176:179], v4 offset:4096
    v_add_f32 v189, v189, v193
    v_mfma_f32_16x16x32_bf16 v[128:131], a[144:147], a[100:103], v[128:131]
    s_add_u32 s26, s26, 4096
    buffer_load_dwordx4 a[128:131], v3, s[8:11], s26 offen offset:0 sc1
    v_add_f32 v190, v190, v194
    v_mfma_f32_16x16x32_bf16 v[132:135], a[148:151], a[96:99], v[132:135]
    ds_read_b128 a[180:183], v4 offset:5120
    v_add_f32 v191, v191, v195
    v_mfma_f32_16x16x32_bf16 v[136:139], a[148:151], a[100:103], v[136:139]
    s_add_u32 s27, s27, 4096
    buffer_load_dwordx4 a[132:135], v3, s[8:11], s27 offen offset:0 sc1
    v_add_f32 v196, v196, v200
    v_mfma_f32_16x16x32_bf16 v[140:143], a[152:155], a[96:99], v[140:143]
    ds_read_b128 a[184:187], v4 offset:6144
    v_add_f32 v197, v197, v201
    v_mfma_f32_16x16x32_bf16 v[144:147], a[152:155], a[100:103], v[144:147]
    v_add_f32 v198, v198, v202
    v_mfma_f32_16x16x32_bf16 v[148:151], a[156:159], a[96:99], v[148:151]
    ds_read_b128 a[188:191], v4 offset:7168
    v_add_f32 v199, v199, v203
    v_mfma_f32_16x16x32_bf16 v[152:155], a[156:159], a[100:103], v[152:155]
    v_add_f32 v188, v188, v196
    s_waitcnt lgkmcnt(4)
    s_waitcnt vmcnt(24)
    v_mfma_f32_16x16x32_bf16 v[28:31], a[160:163], a[104:107], v[28:31]
    ds_read_b128 a[144:147], v4 offset:8192
    v_add_f32 v189, v189, v197
    s_waitcnt vmcnt(23)
    v_mfma_f32_16x16x32_bf16 v[32:35], a[160:163], a[108:111], v[32:35]
    v_add_f32 v190, v190, v198
    v_mfma_f32_16x16x32_bf16 v[36:39], a[164:167], a[104:107], v[36:39]
    ds_read_b128 a[148:151], v4 offset:9216
    v_add_f32 v191, v191, v199
    v_mfma_f32_16x16x32_bf16 v[40:43], a[164:167], a[108:111], v[40:43]
    v_add_f32 v188, v188, v190
    v_mfma_f32_16x16x32_bf16 v[44:47], a[168:171], a[104:107], v[44:47]
    ds_read_b128 a[152:155], v4 offset:10240
    v_add_f32 v189, v189, v191
    v_mfma_f32_16x16x32_bf16 v[48:51], a[168:171], a[108:111], v[48:51]
    v_mul_f32 v188, 0xbae38e39, v188
    v_mfma_f32_16x16x32_bf16 v[52:55], a[172:175], a[104:107], v[52:55]
    ds_read_b128 a[156:159], v4 offset:11264
    v_mul_f32 v189, 0x3ae38e39, v189
    v_mfma_f32_16x16x32_bf16 v[56:59], a[172:175], a[108:111], v[56:59]
    v_fma_f32 v189, -v188, v188, v189
    s_waitcnt lgkmcnt(4)
    v_mfma_f32_16x16x32_bf16 v[60:63], a[176:179], a[104:107], v[60:63]
    ds_read_b128 a[160:163], v4 offset:12288
    v_max_f32 v189, 0, v189
    v_mfma_f32_16x16x32_bf16 v[64:67], a[176:179], a[108:111], v[64:67]
    v_add_f32 v189, 0x3727c5ac, v189
    v_mfma_f32_16x16x32_bf16 v[68:71], a[180:183], a[104:107], v[68:71]
    ds_read_b128 a[164:167], v4 offset:13312
    v_rsq_f32 v11, v189
    v_mfma_f32_16x16x32_bf16 v[72:75], a[180:183], a[108:111], v[72:75]
    v_mov_b32 v9, v188
    v_mfma_f32_16x16x32_bf16 v[76:79], a[184:187], a[104:107], v[76:79]
    ds_read_b128 a[168:171], v4 offset:14336
    v_mul_f32 v11, 0xbfb8aa3b, v11
    v_mfma_f32_16x16x32_bf16 v[80:83], a[184:187], a[108:111], v[80:83]
    v_mul_f32 v13, v11, v9
    v_mfma_f32_16x16x32_bf16 v[84:87], a[188:191], a[104:107], v[84:87]
    ds_read_b128 a[172:175], v4 offset:15360
    v_add_f32 v204, v204, v208
    v_mfma_f32_16x16x32_bf16 v[88:91], a[188:191], a[108:111], v[88:91]
    v_add_f32 v205, v205, v209
    s_waitcnt lgkmcnt(4)
    v_mfma_f32_16x16x32_bf16 v[92:95], a[144:147], a[104:107], v[92:95]
    s_waitcnt vmcnt(14)
    s_barrier
    ds_read_b128 a[176:179], v4 offset:16384
    v_add_f32 v206, v206, v210
    v_mfma_f32_16x16x32_bf16 v[96:99], a[144:147], a[108:111], v[96:99]
    s_add_u32 m0, s25, 32768
    s_nop 0
    buffer_load_dwordx4 v3, s[8:11], s24 offen offset:0 sc1 lds
    v_add_f32 v207, v207, v211
    v_mfma_f32_16x16x32_bf16 v[100:103], a[148:151], a[104:107], v[100:103]
    ds_read_b128 a[180:183], v4 offset:17408
    v_add_f32 v204, v204, v212
    v_mfma_f32_16x16x32_bf16 v[104:107], a[148:151], a[108:111], v[104:107]
    buffer_load_dwordx4 v3, s[8:11], s24 offen offset:1024 sc1 lds
    v_add_f32 v205, v205, v213
    v_mfma_f32_16x16x32_bf16 v[108:111], a[152:155], a[104:107], v[108:111]
    ds_read_b128 a[184:187], v4 offset:18432
    v_add_f32 v206, v206, v214
    v_mfma_f32_16x16x32_bf16 v[112:115], a[152:155], a[108:111], v[112:115]
    buffer_load_dwordx4 v3, s[8:11], s24 offen offset:2048 sc1 lds
    v_add_f32 v207, v207, v215
    v_mfma_f32_16x16x32_bf16 v[116:119], a[156:159], a[104:107], v[116:119]
    ds_read_b128 a[188:191], v4 offset:19456
    v_add_f32 v204, v204, v216
    v_mfma_f32_16x16x32_bf16 v[120:123], a[156:159], a[108:111], v[120:123]
    buffer_load_dwordx4 v3, s[8:11], s24 offen offset:3072 sc1 lds
    s_add_u32 s24, s24, 4096
    v_add_f32 v205, v205, v217
    s_waitcnt lgkmcnt(4)
    v_mfma_f32_16x16x32_bf16 v[124:127], a[160:163], a[104:107], v[124:127]
    ds_read_b128 a[144:147], v4 offset:20480
    v_add_f32 v206, v206, v218
    v_mfma_f32_16x16x32_bf16 v[128:131], a[160:163], a[108:111], v[128:131]
    buffer_load_dwordx4 a[136:139], v3, s[8:11], s26 offen offset:1024 sc1
    v_add_f32 v207, v207, v219
    v_mfma_f32_16x16x32_bf16 v[132:135], a[164:167], a[104:107], v[132:135]
    ds_read_b128 a[148:151], v4 offset:21504
    v_add_f32 v204, v204, v220
    v_mfma_f32_16x16x32_bf16 v[136:139], a[164:167], a[108:111], v[136:139]
    buffer_load_dwordx4 a[140:143], v3, s[8:11], s27 offen offset:1024 sc1
    v_add_f32 v205, v205, v221
    v_mfma_f32_16x16x32_bf16 v[140:143], a[168:171], a[104:107], v[140:143]
    ds_read_b128 a[152:155], v4 offset:22528
    v_add_f32 v206, v206, v222
    v_mfma_f32_16x16x32_bf16 v[144:147], a[168:171], a[108:111], v[144:147]
    v_add_f32 v207, v207, v223
    v_mfma_f32_16x16x32_bf16 v[148:151], a[172:175], a[104:107], v[148:151]
    ds_read_b128 a[156:159], v4 offset:23552
    v_add_f32 v204, v204, v224
    v_mfma_f32_16x16x32_bf16 v[152:155], a[172:175], a[108:111], v[152:155]
    v_add_f32 v205, v205, v225
    s_waitcnt lgkmcnt(4)
    s_waitcnt vmcnt(19)
    v_mfma_f32_16x16x32_bf16 v[28:31], a[176:179], a[112:115], v[28:31]
    ds_read_b128 a[160:163], v4 offset:24576
    v_add_f32 v206, v206, v226
    s_waitcnt vmcnt(18)
    v_mfma_f32_16x16x32_bf16 v[32:35], a[176:179], a[116:119], v[32:35]
    v_add_f32 v207, v207, v227
    v_mfma_f32_16x16x32_bf16 v[36:39], a[180:183], a[112:115], v[36:39]
    ds_read_b128 a[164:167], v4 offset:25600
    v_add_f32 v204, v204, v228
    v_mfma_f32_16x16x32_bf16 v[40:43], a[180:183], a[116:119], v[40:43]
    v_add_f32 v205, v205, v229
    v_mfma_f32_16x16x32_bf16 v[44:47], a[184:187], a[112:115], v[44:47]
    ds_read_b128 a[168:171], v4 offset:26624
    v_add_f32 v206, v206, v230
    v_mfma_f32_16x16x32_bf16 v[48:51], a[184:187], a[116:119], v[48:51]
    v_add_f32 v207, v207, v231
    v_mfma_f32_16x16x32_bf16 v[52:55], a[188:191], a[112:115], v[52:55]
    ds_read_b128 a[172:175], v4 offset:27648
    v_add_f32 v204, v204, v232
    v_mfma_f32_16x16x32_bf16 v[56:59], a[188:191], a[116:119], v[56:59]
    v_add_f32 v205, v205, v233
    s_waitcnt lgkmcnt(4)
    v_mfma_f32_16x16x32_bf16 v[60:63], a[144:147], a[112:115], v[60:63]
    ds_read_b128 a[176:179], v4 offset:28672
    v_add_f32 v206, v206, v234
    v_mfma_f32_16x16x32_bf16 v[64:67], a[144:147], a[116:119], v[64:67]
    v_add_f32 v207, v207, v235
    v_mfma_f32_16x16x32_bf16 v[68:71], a[148:151], a[112:115], v[68:71]
    ds_read_b128 a[180:183], v4 offset:29696
    v_add_f32 v204, v204, v236
    v_mfma_f32_16x16x32_bf16 v[72:75], a[148:151], a[116:119], v[72:75]
    v_add_f32 v205, v205, v237
    v_mfma_f32_16x16x32_bf16 v[76:79], a[152:155], a[112:115], v[76:79]
    ds_read_b128 a[184:187], v4 offset:30720
    v_add_f32 v206, v206, v238
    v_mfma_f32_16x16x32_bf16 v[80:83], a[152:155], a[116:119], v[80:83]
    v_add_f32 v207, v207, v239
    v_mfma_f32_16x16x32_bf16 v[84:87], a[156:159], a[112:115], v[84:87]
    ds_read_b128 a[188:191], v4 offset:31744
    v_add_u32 v24, 159744, v24
    v_mfma_f32_16x16x32_bf16 v[88:91], a[156:159], a[116:119], v[88:91]
    ds_write_b128 v24, v[204:207]
    s_waitcnt lgkmcnt(5)
    v_mfma_f32_16x16x32_bf16 v[92:95], a[160:163], a[112:115], v[92:95]
    s_waitcnt vmcnt(14)
    s_barrier
    ds_read_b128 a[144:147], v3 offset:0
    v_mfma_f32_16x16x32_bf16 v[96:99], a[160:163], a[116:119], v[96:99]
    s_add_u32 m0, s25, 49152
    s_nop 0
    buffer_load_dwordx4 v3, s[8:11], s30 offen offset:0 sc1 lds
    v_mfma_f32_16x16x32_bf16 v[100:103], a[164:167], a[112:115], v[100:103]
    ds_read_b128 a[148:151], v3 offset:1024
    v_mfma_f32_16x16x32_bf16 v[104:107], a[164:167], a[116:119], v[104:107]
    buffer_load_dwordx4 v3, s[8:11], s30 offen offset:1024 sc1 lds
    v_mfma_f32_16x16x32_bf16 v[108:111], a[168:171], a[112:115], v[108:111]
    ds_read_b128 a[152:155], v3 offset:2048
    v_mfma_f32_16x16x32_bf16 v[112:115], a[168:171], a[116:119], v[112:115]
    buffer_load_dwordx4 v3, s[8:11], s30 offen offset:2048 sc1 lds
    v_mfma_f32_16x16x32_bf16 v[116:119], a[172:175], a[112:115], v[116:119]
    ds_read_b128 a[156:159], v3 offset:3072
    v_mfma_f32_16x16x32_bf16 v[120:123], a[172:175], a[116:119], v[120:123]
    buffer_load_dwordx4 v3, s[8:11], s30 offen offset:3072 sc1 lds
    s_add_u32 s30, s30, 16384
    s_waitcnt lgkmcnt(5)
    v_mfma_f32_16x16x32_bf16 v[124:127], a[176:179], a[112:115], v[124:127]
    ds_read_b128 a[160:163], v3 offset:4096
    v_mfma_f32_16x16x32_bf16 v[128:131], a[176:179], a[116:119], v[128:131]
    v_mfma_f32_16x16x32_bf16 v[132:135], a[180:183], a[112:115], v[132:135]
    ds_read_b128 a[164:167], v3 offset:5120
    v_mfma_f32_16x16x32_bf16 v[136:139], a[180:183], a[116:119], v[136:139]
    v_mfma_f32_16x16x32_bf16 v[140:143], a[184:187], a[112:115], v[140:143]
    ds_read_b128 a[168:171], v3 offset:6144
    v_mfma_f32_16x16x32_bf16 v[144:147], a[184:187], a[116:119], v[144:147]
    v_mfma_f32_16x16x32_bf16 v[148:151], a[188:191], a[112:115], v[148:151]
    ds_read_b128 a[172:175], v3 offset:7168
    v_mfma_f32_16x16x32_bf16 v[152:155], a[188:191], a[116:119], v[152:155]
    s_waitcnt lgkmcnt(4)
    s_waitcnt vmcnt(17)
    v_mfma_f32_16x16x32_bf16 v[28:31], a[144:147], a[120:123], v[28:31]
    ds_read_b128 a[176:179], v3 offset:8192
    s_waitcnt vmcnt(16)
    v_mfma_f32_16x16x32_bf16 v[32:35], a[144:147], a[124:127], v[32:35]
    v_mfma_f32_16x16x32_bf16 v[36:39], a[148:151], a[120:123], v[36:39]
    ds_read_b128 a[180:183], v3 offset:9216
    v_mfma_f32_16x16x32_bf16 v[40:43], a[148:151], a[124:127], v[40:43]
    v_mfma_f32_16x16x32_bf16 v[44:47], a[152:155], a[120:123], v[44:47]
    ds_read_b128 a[184:187], v3 offset:10240
    v_mfma_f32_16x16x32_bf16 v[48:51], a[152:155], a[124:127], v[48:51]
    v_mfma_f32_16x16x32_bf16 v[52:55], a[156:159], a[120:123], v[52:55]
    ds_read_b128 a[188:191], v3 offset:11264
    v_mfma_f32_16x16x32_bf16 v[56:59], a[156:159], a[124:127], v[56:59]
    s_waitcnt lgkmcnt(4)
    v_mfma_f32_16x16x32_bf16 v[60:63], a[160:163], a[120:123], v[60:63]
    ds_read_b128 a[144:147], v3 offset:12288
    v_mfma_f32_16x16x32_bf16 v[64:67], a[160:163], a[124:127], v[64:67]
    v_mfma_f32_16x16x32_bf16 v[68:71], a[164:167], a[120:123], v[68:71]
    ds_read_b128 a[148:151], v3 offset:13312
    v_mfma_f32_16x16x32_bf16 v[72:75], a[164:167], a[124:127], v[72:75]
    v_mfma_f32_16x16x32_bf16 v[76:79], a[168:171], a[120:123], v[76:79]
    ds_read_b128 a[152:155], v3 offset:14336
    v_mfma_f32_16x16x32_bf16 v[80:83], a[168:171], a[124:127], v[80:83]
    v_mfma_f32_16x16x32_bf16 v[84:87], a[172:175], a[120:123], v[84:87]
    ds_read_b128 a[156:159], v3 offset:15360
    v_mfma_f32_16x16x32_bf16 v[88:91], a[172:175], a[124:127], v[88:91]
    s_waitcnt lgkmcnt(4)
    v_mfma_f32_16x16x32_bf16 v[92:95], a[176:179], a[120:123], v[92:95]
    s_waitcnt vmcnt(12)
    s_barrier
    ds_read_b128 a[160:163], v3 offset:16384
    v_mfma_f32_16x16x32_bf16 v[96:99], a[176:179], a[124:127], v[96:99]
    s_add_u32 m0, s25, 65536
    s_nop 0
    buffer_load_dwordx4 v3, s[8:11], s30 offen offset:0 sc1 lds
    v_mfma_f32_16x16x32_bf16 v[100:103], a[180:183], a[120:123], v[100:103]
    ds_read_b128 a[164:167], v3 offset:17408
    v_mfma_f32_16x16x32_bf16 v[104:107], a[180:183], a[124:127], v[104:107]
    buffer_load_dwordx4 v3, s[8:11], s30 offen offset:1024 sc1 lds
    v_mfma_f32_16x16x32_bf16 v[108:111], a[184:187], a[120:123], v[108:111]
    ds_read_b128 a[168:171], v3 offset:18432
    v_mfma_f32_16x16x32_bf16 v[112:115], a[184:187], a[124:127], v[112:115]
    buffer_load_dwordx4 v3, s[8:11], s30 offen offset:2048 sc1 lds
    v_mfma_f32_16x16x32_bf16 v[116:119], a[188:191], a[120:123], v[116:119]
    ds_read_b128 a[172:175], v3 offset:19456
    v_mfma_f32_16x16x32_bf16 v[120:123], a[188:191], a[124:127], v[120:123]
    buffer_load_dwordx4 v3, s[8:11], s30 offen offset:3072 sc1 lds
    s_add_u32 s30, s30, 16384
    s_waitcnt lgkmcnt(4)
    v_mfma_f32_16x16x32_bf16 v[124:127], a[144:147], a[120:123], v[124:127]
    ds_read_b128 a[176:179], v3 offset:20480
    v_mfma_f32_16x16x32_bf16 v[128:131], a[144:147], a[124:127], v[128:131]
    v_mfma_f32_16x16x32_bf16 v[132:135], a[148:151], a[120:123], v[132:135]
    ds_read_b128 a[180:183], v3 offset:21504
    v_mfma_f32_16x16x32_bf16 v[136:139], a[148:151], a[124:127], v[136:139]
    v_mfma_f32_16x16x32_bf16 v[140:143], a[152:155], a[120:123], v[140:143]
    ds_read_b128 a[184:187], v3 offset:22528
    v_mfma_f32_16x16x32_bf16 v[144:147], a[152:155], a[124:127], v[144:147]
    v_mfma_f32_16x16x32_bf16 v[148:151], a[156:159], a[120:123], v[148:151]
    ds_read_b128 a[188:191], v3 offset:23552
    v_mfma_f32_16x16x32_bf16 v[152:155], a[156:159], a[124:127], v[152:155]
    s_waitcnt lgkmcnt(4)
    s_waitcnt vmcnt(15)
    v_mfma_f32_16x16x32_bf16 v[28:31], a[160:163], a[128:131], v[28:31]
    ds_read_b128 a[144:147], v3 offset:24576
    s_waitcnt vmcnt(14)
    v_mfma_f32_16x16x32_bf16 v[32:35], a[160:163], a[132:135], v[32:35]
    v_mfma_f32_16x16x32_bf16 v[36:39], a[164:167], a[128:131], v[36:39]
    ds_read_b128 a[148:151], v3 offset:25600
    v_mfma_f32_16x16x32_bf16 v[40:43], a[164:167], a[132:135], v[40:43]
    v_mfma_f32_16x16x32_bf16 v[44:47], a[168:171], a[128:131], v[44:47]
    ds_read_b128 a[152:155], v3 offset:26624
    v_mfma_f32_16x16x32_bf16 v[48:51], a[168:171], a[132:135], v[48:51]
    v_mfma_f32_16x16x32_bf16 v[52:55], a[172:175], a[128:131], v[52:55]
    ds_read_b128 a[156:159], v3 offset:27648
    v_mfma_f32_16x16x32_bf16 v[56:59], a[172:175], a[132:135], v[56:59]
    s_waitcnt lgkmcnt(4)
    v_mfma_f32_16x16x32_bf16 v[60:63], a[176:179], a[128:131], v[60:63]
    ds_read_b128 a[160:163], v3 offset:28672
    v_mfma_f32_16x16x32_bf16 v[64:67], a[176:179], a[132:135], v[64:67]
    v_mfma_f32_16x16x32_bf16 v[68:71], a[180:183], a[128:131], v[68:71]
    ds_read_b128 a[164:167], v3 offset:29696
    v_mfma_f32_16x16x32_bf16 v[72:75], a[180:183], a[132:135], v[72:75]
    v_mfma_f32_16x16x32_bf16 v[76:79], a[184:187], a[128:131], v[76:79]
    ds_read_b128 a[168:171], v3 offset:30720
    v_mfma_f32_16x16x32_bf16 v[80:83], a[184:187], a[132:135], v[80:83]
    v_mfma_f32_16x16x32_bf16 v[84:87], a[188:191], a[128:131], v[84:87]
    ds_read_b128 a[172:175], v3 offset:31744
    v_mfma_f32_16x16x32_bf16 v[88:91], a[188:191], a[132:135], v[88:91]
    s_waitcnt lgkmcnt(4)
    v_mfma_f32_16x16x32_bf16 v[92:95], a[144:147], a[128:131], v[92:95]
    s_waitcnt lgkmcnt(0)
    s_waitcnt vmcnt(10)
    s_barrier
    ds_read_b128 a[176:179], v3 offset:32768
    v_mfma_f32_16x16x32_bf16 v[96:99], a[144:147], a[132:135], v[96:99]
    s_add_u32 m0, s25, 0
    s_nop 0
    buffer_load_dwordx4 v3, s[8:11], s30 offen offset:0 sc1 lds
    v_mfma_f32_16x16x32_bf16 v[100:103], a[148:151], a[128:131], v[100:103]
    ds_read_b128 a[180:183], v3 offset:33792
    v_mfma_f32_16x16x32_bf16 v[104:107], a[148:151], a[132:135], v[104:107]
    buffer_load_dwordx4 v3, s[8:11], s30 offen offset:1024 sc1 lds
    v_mfma_f32_16x16x32_bf16 v[108:111], a[152:155], a[128:131], v[108:111]
    ds_read_b128 a[184:187], v3 offset:34816
    v_mfma_f32_16x16x32_bf16 v[112:115], a[152:155], a[132:135], v[112:115]
    buffer_load_dwordx4 v3, s[8:11], s30 offen offset:2048 sc1 lds
    v_mfma_f32_16x16x32_bf16 v[116:119], a[156:159], a[128:131], v[116:119]
    ds_read_b128 a[188:191], v3 offset:35840
    v_mfma_f32_16x16x32_bf16 v[120:123], a[156:159], a[132:135], v[120:123]
    buffer_load_dwordx4 v3, s[8:11], s30 offen offset:3072 sc1 lds
    s_add_u32 s30, s30, 16384
    v_mfma_f32_16x16x32_bf16 v[124:127], a[160:163], a[128:131], v[124:127]
    ds_read_b128 a[144:147], v3 offset:36864
    v_mfma_f32_16x16x32_bf16 v[128:131], a[160:163], a[132:135], v[128:131]
    v_mfma_f32_16x16x32_bf16 v[132:135], a[164:167], a[128:131], v[132:135]
    ds_read_b128 a[148:151], v3 offset:37888
    v_mfma_f32_16x16x32_bf16 v[136:139], a[164:167], a[132:135], v[136:139]
    v_mfma_f32_16x16x32_bf16 v[140:143], a[168:171], a[128:131], v[140:143]
    ds_read_b128 a[152:155], v3 offset:38912
    v_mfma_f32_16x16x32_bf16 v[144:147], a[168:171], a[132:135], v[144:147]
    v_mfma_f32_16x16x32_bf16 v[148:151], a[172:175], a[128:131], v[148:151]
    ds_read_b128 a[156:159], v3 offset:39936
    v_mfma_f32_16x16x32_bf16 v[152:155], a[172:175], a[132:135], v[152:155]
    v_mov_b32 v25, 1
    buffer_store_dword v25, v15, s[8:11], s50 offen sc1
    s_waitcnt lgkmcnt(4)
    s_waitcnt vmcnt(14)
    v_mfma_f32_16x16x32_bf16 v[28:31], a[176:179], a[136:139], v[28:31]
    ds_read_b128 a[160:163], v3 offset:40960
    s_waitcnt vmcnt(13)
    v_mfma_f32_16x16x32_bf16 v[32:35], a[176:179], a[140:143], v[32:35]
    v_mfma_f32_16x16x32_bf16 v[36:39], a[180:183], a[136:139], v[36:39]
    ds_read_b128 a[164:167], v3 offset:41984
    v_mfma_f32_16x16x32_bf16 v[40:43], a[180:183], a[140:143], v[40:43]
    v_mfma_f32_16x16x32_bf16 v[44:47], a[184:187], a[136:139], v[44:47]
    ds_read_b128 a[168:171], v3 offset:43008
    v_mfma_f32_16x16x32_bf16 v[48:51], a[184:187], a[140:143], v[48:51]
    v_mfma_f32_16x16x32_bf16 v[52:55], a[188:191], a[136:139], v[52:55]
    ds_read_b128 a[172:175], v3 offset:44032
    v_mfma_f32_16x16x32_bf16 v[56:59], a[188:191], a[140:143], v[56:59]
    s_waitcnt lgkmcnt(4)
    v_mfma_f32_16x16x32_bf16 v[60:63], a[144:147], a[136:139], v[60:63]
    ds_read_b128 a[176:179], v3 offset:45056
    v_mfma_f32_16x16x32_bf16 v[64:67], a[144:147], a[140:143], v[64:67]
    v_mfma_f32_16x16x32_bf16 v[68:71], a[148:151], a[136:139], v[68:71]
    ds_read_b128 a[180:183], v3 offset:46080
    v_mfma_f32_16x16x32_bf16 v[72:75], a[148:151], a[140:143], v[72:75]
    v_mfma_f32_16x16x32_bf16 v[76:79], a[152:155], a[136:139], v[76:79]
    ds_read_b128 a[184:187], v3 offset:47104
    v_mfma_f32_16x16x32_bf16 v[80:83], a[152:155], a[140:143], v[80:83]
    v_mfma_f32_16x16x32_bf16 v[84:87], a[156:159], a[136:139], v[84:87]
    ds_read_b128 a[188:191], v3 offset:48128
    v_mfma_f32_16x16x32_bf16 v[88:91], a[156:159], a[140:143], v[88:91]
    s_waitcnt lgkmcnt(4)
    v_mfma_f32_16x16x32_bf16 v[92:95], a[160:163], a[136:139], v[92:95]
    s_waitcnt vmcnt(9)
    s_barrier
    ds_read_b128 a[144:147], v4 offset:0
    v_mfma_f32_16x16x32_bf16 v[96:99], a[160:163], a[140:143], v[96:99]
    s_add_u32 m0, s25, 16384
    s_nop 0
    buffer_load_dwordx4 v3, s[8:11], s30 offen offset:0 sc1 lds
    v_mfma_f32_16x16x32_bf16 v[100:103], a[164:167], a[136:139], v[100:103]
    ds_read_b128 a[148:151], v4 offset:1024
    v_mfma_f32_16x16x32_bf16 v[104:107], a[164:167], a[140:143], v[104:107]
    buffer_load_dwordx4 v3, s[8:11], s30 offen offset:1024 sc1 lds
    v_mfma_f32_16x16x32_bf16 v[108:111], a[168:171], a[136:139], v[108:111]
    ds_read_b128 a[152:155], v4 offset:2048
    v_mfma_f32_16x16x32_bf16 v[112:115], a[168:171], a[140:143], v[112:115]
    buffer_load_dwordx4 v3, s[8:11], s30 offen offset:2048 sc1 lds
    v_mfma_f32_16x16x32_bf16 v[116:119], a[172:175], a[136:139], v[116:119]
    ds_read_b128 a[156:159], v4 offset:3072
    v_mfma_f32_16x16x32_bf16 v[120:123], a[172:175], a[140:143], v[120:123]
    buffer_load_dwordx4 v3, s[8:11], s30 offen offset:3072 sc1 lds
    s_add_u32 s30, s30, 16384
    s_waitcnt lgkmcnt(4)
    v_mfma_f32_16x16x32_bf16 v[124:127], a[176:179], a[136:139], v[124:127]
    ds_read_b128 a[160:163], v4 offset:4096
    v_mfma_f32_16x16x32_bf16 v[128:131], a[176:179], a[140:143], v[128:131]
    v_mfma_f32_16x16x32_bf16 v[132:135], a[180:183], a[136:139], v[132:135]
    ds_read_b128 a[164:167], v4 offset:5120
    v_mfma_f32_16x16x32_bf16 v[136:139], a[180:183], a[140:143], v[136:139]
    v_mfma_f32_16x16x32_bf16 v[140:143], a[184:187], a[136:139], v[140:143]
    ds_read_b128 a[168:171], v4 offset:6144
    v_mfma_f32_16x16x32_bf16 v[144:147], a[184:187], a[140:143], v[144:147]
    v_mfma_f32_16x16x32_bf16 v[148:151], a[188:191], a[136:139], v[148:151]
    ds_read_b128 a[172:175], v4 offset:7168
    v_mfma_f32_16x16x32_bf16 v[152:155], a[188:191], a[140:143], v[152:155]
    s_waitcnt lgkmcnt(4)
    v_mfma_f32_16x16x32_bf16 v[240:243], a[144:147], a[0:3], 0
    ds_read_b128 a[176:179], v4 offset:8192
    v_mfma_f32_16x16x32_bf16 v[244:247], a[144:147], a[4:7], 0
    v_mfma_f32_16x16x32_bf16 v[248:251], a[148:151], a[0:3], 0
    ds_read_b128 a[180:183], v4 offset:9216
    v_mfma_f32_16x16x32_bf16 v[252:255], a[148:151], a[4:7], 0
    s_add_u32 m0, s61, 0
    s_add_u32 s59, s32, 184320
    buffer_load_dwordx4 v3, s[8:11], s59 offen sc1 lds
    ds_read_b128 v[156:159], v6 offset:0
    v_mfma_f32_16x16x32_bf16 v[172:175], a[152:155], a[0:3], 0
    ds_read_b128 a[184:187], v4 offset:10240
    ds_read_b128 v[160:163], v6 offset:64
    ds_read_b128 v[164:167], v6 offset:128
    v_mfma_f32_16x16x32_bf16 v[176:179], a[152:155], a[4:7], 0
    s_add_u32 s59, s32, 0
    buffer_load_dwordx4 a[192:195], v3, s[8:11], s59 offen offset:0 sc1
    ds_read_b128 v[168:171], v6 offset:192
    v_mul_f32 v28, v10, v28
    v_mfma_f32_16x16x32_bf16 v[180:183], a[156:159], a[0:3], 0
    ds_read_b128 a[188:191], v4 offset:11264
    v_mul_f32 v29, v10, v29
    v_mul_f32 v30, v10, v30
    v_mfma_f32_16x16x32_bf16 v[184:187], a[156:159], a[4:7], 0
    v_mul_f32 v31, v10, v31
    v_mul_f32 v36, v10, v36
    s_waitcnt lgkmcnt(8)
    v_mfma_f32_16x16x32_bf16 v[240:243], a[160:163], a[8:11], v[240:243]
    ds_read_b128 a[144:147], v4 offset:12288
    v_mul_f32 v37, v10, v37
    v_mul_f32 v38, v10, v38
    v_mfma_f32_16x16x32_bf16 v[244:247], a[160:163], a[12:15], v[244:247]
    v_mul_f32 v39, v10, v39
    s_waitcnt lgkmcnt(6)
    v_fmac_f32 v28, v12, v156
    v_mfma_f32_16x16x32_bf16 v[248:251], a[164:167], a[8:11], v[248:251]
    ds_read_b128 a[148:151], v4 offset:13312
    v_fmac_f32 v29, v12, v157
    v_fmac_f32 v30, v12, v158
    v_mfma_f32_16x16x32_bf16 v[252:255], a[164:167], a[12:15], v[252:255]
    s_add_u32 m0, s61, 1024
    s_add_u32 s59, s32, 221184
    buffer_load_dwordx4 v3, s[8:11], s59 offen sc1 lds
    v_fmac_f32 v31, v12, v159
    s_waitcnt lgkmcnt(5)
    v_fmac_f32 v36, v12, v160
    v_mfma_f32_16x16x32_bf16 v[172:175], a[168:171], a[8:11], v[172:175]
    ds_read_b128 a[152:155], v4 offset:14336
    v_fmac_f32 v37, v12, v161
    v_fmac_f32 v38, v12, v162
    v_mfma_f32_16x16x32_bf16 v[176:179], a[168:171], a[12:15], v[176:179]
    s_add_u32 s59, s32, 36864
    buffer_load_dwordx4 a[196:199], v3, s[8:11], s59 offen offset:0 sc1
    v_fmac_f32 v39, v12, v163
    v_exp_f32 v28, v28
    v_mfma_f32_16x16x32_bf16 v[180:183], a[172:175], a[8:11], v[180:183]
    ds_read_b128 a[156:159], v4 offset:15360
    s_waitcnt lgkmcnt(6)
    v_fmac_f32 v44, v8, v164
    v_exp_f32 v29, v29
    v_mfma_f32_16x16x32_bf16 v[184:187], a[172:175], a[12:15], v[184:187]
    v_fmac_f32 v45, v8, v165
    v_exp_f32 v30, v30
    s_waitcnt lgkmcnt(4)
    v_mfma_f32_16x16x32_bf16 v[240:243], a[176:179], a[16:19], v[240:243]
    s_waitcnt vmcnt(13)
    s_barrier
    ds_read_b128 a[160:163], v4 offset:16384
    v_fmac_f32 v46, v8, v166
    v_exp_f32 v31, v31
    v_mfma_f32_16x16x32_bf16 v[244:247], a[176:179], a[20:23], v[244:247]
    s_add_u32 m0, s25, 32768
    s_nop 0
    buffer_load_dwordx4 v3, s[8:11], s30 offen offset:0 sc1 lds
    v_fmac_f32 v47, v8, v167
    v_exp_f32 v36, v36
    v_mfma_f32_16x16x32_bf16 v[248:251], a[180:183], a[16:19], v[248:251]
    ds_read_b128 a[164:167], v4 offset:17408
    v_fmac_f32 v52, v8, v168
    v_exp_f32 v37, v37
    v_mfma_f32_16x16x32_bf16 v[252:255], a[180:183], a[20:23], v[252:255]
    buffer_load_dwordx4 v3, s[8:11], s30 offen offset:1024 sc1 lds
    v_fmac_f32 v53, v8, v169
    v_exp_f32 v38, v38
    v_mfma_f32_16x16x32_bf16 v[172:175], a[184:187], a[16:19], v[172:175]
    ds_read_b128 a[168:171], v4 offset:18432
    v_fmac_f32 v54, v8, v170
    v_exp_f32 v39, v39
    v_mfma_f32_16x16x32_bf16 v[176:179], a[184:187], a[20:23], v[176:179]
    buffer_load_dwordx4 v3, s[8:11], s30 offen offset:2048 sc1 lds
    v_fmac_f32 v55, v8, v171
    v_add_f32 v28, 1.0, v28
    v_mfma_f32_16x16x32_bf16 v[180:183], a[188:191], a[16:19], v[180:183]
    ds_read_b128 a[172:175], v4 offset:19456
    v_add_f32 v29, 1.0, v29
    v_add_f32 v30, 1.0, v30
    v_mfma_f32_16x16x32_bf16 v[184:187], a[188:191], a[20:23], v[184:187]
    buffer_load_dwordx4 v3, s[8:11], s30 offen offset:3072 sc1 lds
    s_add_u32 s30, s30, 16384
    v_add_f32 v31, 1.0, v31
    v_add_f32 v36, 1.0, v36
    s_waitcnt lgkmcnt(4)
    v_mfma_f32_16x16x32_bf16 v[240:243], a[144:147], a[24:27], v[240:243]
    ds_read_b128 a[176:179], v4 offset:20480
    v_add_f32 v37, 1.0, v37
    v_mfma_f32_16x16x32_bf16 v[244:247], a[144:147], a[28:31], v[244:247]
    v_add_f32 v38, 1.0, v38
    v_add_f32 v39, 1.0, v39
    v_mfma_f32_16x16x32_bf16 v[248:251], a[148:151], a[24:27], v[248:251]
    ds_read_b128 a[180:183], v4 offset:21504
    v_rcp_f32 v28, v28
    v_rcp_f32 v29, v29
    v_mfma_f32_16x16x32_bf16 v[252:255], a[148:151], a[28:31], v[252:255]
    s_add_u32 m0, s61, 2048
    s_add_u32 s59, s32, 258048
    buffer_load_dwordx4 v3, s[8:11], s59 offen sc1 lds
    v_rcp_f32 v30, v30
    v_rcp_f32 v31, v31
    v_mfma_f32_16x16x32_bf16 v[172:175], a[152:155], a[24:27], v[172:175]
    ds_read_b128 a[184:187], v4 offset:22528
    v_rcp_f32 v36, v36
    v_rcp_f32 v37, v37
    v_mfma_f32_16x16x32_bf16 v[176:179], a[152:155], a[28:31], v[176:179]
    s_add_u32 s59, s32, 73728
    buffer_load_dwordx4 a[200:203], v3, s[8:11], s59 offen offset:0 sc1
    v_rcp_f32 v38, v38
    v_rcp_f32 v39, v39
    v_mfma_f32_16x16x32_bf16 v[180:183], a[156:159], a[24:27], v[180:183]
    ds_read_b128 a[188:191], v4 offset:23552
    v_mul_f32 v44, v28, v44
    v_mul_f32 v45, v29, v45
    v_mfma_f32_16x16x32_bf16 v[184:187], a[156:159], a[28:31], v[184:187]
    v_mul_f32 v46, v30, v46
    v_mul_f32 v47, v31, v47
    s_waitcnt lgkmcnt(4)
    v_mfma_f32_16x16x32_bf16 v[240:243], a[160:163], a[32:35], v[240:243]
    ds_read_b128 a[144:147], v4 offset:24576
    v_mul_f32 v52, v36, v52
    v_mul_f32 v53, v37, v53
    v_mfma_f32_16x16x32_bf16 v[244:247], a[160:163], a[36:39], v[244:247]
    v_mul_f32 v54, v38, v54
    v_mul_f32 v55, v39, v55
    v_mfma_f32_16x16x32_bf16 v[248:251], a[164:167], a[32:35], v[248:251]
    ds_read_b128 a[148:151], v4 offset:25600
    v_cvt_pk_bf16_f32 v16, v44, v45
    v_cvt_pk_bf16_f32 v17, v46, v47
    v_mfma_f32_16x16x32_bf16 v[252:255], a[164:167], a[36:39], v[252:255]
    s_add_u32 m0, s61, 3072
    s_add_u32 s59, s32, 185344
    buffer_load_dwordx4 v3, s[8:11], s59 offen sc1 lds
    v_cvt_pk_bf16_f32 v18, v52, v53
    v_cvt_pk_bf16_f32 v19, v54, v55
    v_mfma_f32_16x16x32_bf16 v[172:175], a[168:171], a[32:35], v[172:175]
    ds_read_b128 a[152:155], v4 offset:26624
    buffer_store_dwordx4 v[16:19], v3, s[8:11], s28 offen offset:0 sc1
    v_mul_f32 v32, v11, v32
    v_mfma_f32_16x16x32_bf16 v[176:179], a[168:171], a[36:39], v[176:179]
    s_add_u32 s59, s32, 110592
    buffer_load_dwordx4 a[204:207], v3, s[8:11], s59 offen offset:0 sc1
    v_mul_f32 v33, v11, v33
    v_mul_f32 v34, v11, v34
    v_mfma_f32_16x16x32_bf16 v[180:183], a[172:175], a[32:35], v[180:183]
    ds_read_b128 a[156:159], v4 offset:27648
    v_mul_f32 v35, v11, v35
    v_mul_f32 v40, v11, v40
    v_mfma_f32_16x16x32_bf16 v[184:187], a[172:175], a[36:39], v[184:187]
    v_mul_f32 v41, v11, v41
    v_mul_f32 v42, v11, v42
    s_waitcnt lgkmcnt(4)
    v_mfma_f32_16x16x32_bf16 v[240:243], a[176:179], a[40:43], v[240:243]
    ds_read_b128 a[160:163], v4 offset:28672
    v_mul_f32 v43, v11, v43
    v_fmac_f32 v32, v13, v156
    v_mfma_f32_16x16x32_bf16 v[244:247], a[176:179], a[44:47], v[244:247]
    v_fmac_f32 v33, v13, v157
    v_fmac_f32 v34, v13, v158
    v_mfma_f32_16x16x32_bf16 v[248:251], a[180:183], a[40:43], v[248:251]
    ds_read_b128 a[164:167], v4 offset:29696
    v_fmac_f32 v35, v13, v159
    v_fmac_f32 v40, v13, v160
    v_mfma_f32_16x16x32_bf16 v[252:255], a[180:183], a[44:47], v[252:255]
    s_add_u32 m0, s61, 4096
    s_add_u32 s59, s32, 222208
    buffer_load_dwordx4 v3, s[8:11], s59 offen sc1 lds
    v_fmac_f32 v41, v13, v161
    v_fmac_f32 v42, v13, v162
    v_mfma_f32_16x16x32_bf16 v[172:175], a[184:187], a[40:43], v[172:175]
    ds_read_b128 a[168:171], v4 offset:30720
    v_fmac_f32 v43, v13, v163
    v_exp_f32 v32, v32
    v_mfma_f32_16x16x32_bf16 v[176:179], a[184:187], a[44:47], v[176:179]
    s_add_u32 s59, s32, 147456
    buffer_load_dwordx4 a[208:211], v3, s[8:11], s59 offen offset:0 sc1
    v_fmac_f32 v48, v9, v164
    v_exp_f32 v33, v33
    v_mfma_f32_16x16x32_bf16 v[180:183], a[188:191], a[40:43], v[180:183]
    ds_read_b128 a[172:175], v4 offset:31744
    v_fmac_f32 v49, v9, v165
    v_mfma_f32_16x16x32_bf16 v[184:187], a[188:191], a[44:47], v[184:187]
    v_exp_f32 v34, v34
    v_fmac_f32 v50, v9, v166
    s_waitcnt lgkmcnt(4)
    v_mfma_f32_16x16x32_bf16 v[240:243], a[144:147], a[48:51], v[240:243]
    s_waitcnt vmcnt(20)
    s_barrier
    ds_read_b128 a[176:179], v3 offset:0
    v_exp_f32 v35, v35
    v_fmac_f32 v51, v9, v167
    v_mfma_f32_16x16x32_bf16 v[244:247], a[144:147], a[52:55], v[244:247]
    s_add_u32 m0, s25, 49152
    s_nop 0
    buffer_load_dwordx4 v3, s[8:11], s30 offen offset:0 sc1 lds
    v_exp_f32 v40, v40
    v_fmac_f32 v56, v9, v168
    v_mfma_f32_16x16x32_bf16 v[248:251], a[148:151], a[48:51], v[248:251]
    ds_read_b128 a[180:183], v3 offset:1024
    v_exp_f32 v41, v41
    v_fmac_f32 v57, v9, v169
    v_mfma_f32_16x16x32_bf16 v[252:255], a[148:151], a[52:55], v[252:255]
    buffer_load_dwordx4 v3, s[8:11], s30 offen offset:1024 sc1 lds
    v_exp_f32 v42, v42
    v_fmac_f32 v58, v9, v170
    v_mfma_f32_16x16x32_bf16 v[172:175], a[152:155], a[48:51], v[172:175]
    ds_read_b128 a[184:187], v3 offset:2048
    v_exp_f32 v43, v43
    v_fmac_f32 v59, v9, v171
    v_mfma_f32_16x16x32_bf16 v[176:179], a[152:155], a[52:55], v[176:179]
    buffer_load_dwordx4 v3, s[8:11], s30 offen offset:2048 sc1 lds
    v_add_f32 v32, 1.0, v32
    v_add_f32 v33, 1.0, v33
    v_mfma_f32_16x16x32_bf16 v[180:183], a[156:159], a[48:51], v[180:183]
    ds_read_b128 a[188:191], v3 offset:3072
    v_add_f32 v34, 1.0, v34
    v_add_f32 v35, 1.0, v35
    v_mfma_f32_16x16x32_bf16 v[184:187], a[156:159], a[52:55], v[184:187]
    buffer_load_dwordx4 v3, s[8:11], s30 offen offset:3072 sc1 lds
    s_add_u32 s30, s30, 16384
    v_add_f32 v40, 1.0, v40
    v_add_f32 v41, 1.0, v41
    s_waitcnt lgkmcnt(4)
    v_mfma_f32_16x16x32_bf16 v[240:243], a[160:163], a[56:59], v[240:243]
    ds_read_b128 a[144:147], v3 offset:4096
    v_add_f32 v42, 1.0, v42
    v_add_f32 v43, 1.0, v43
    v_mfma_f32_16x16x32_bf16 v[244:247], a[160:163], a[60:63], v[244:247]
    v_rcp_f32 v32, v32
    v_rcp_f32 v33, v33
    v_mfma_f32_16x16x32_bf16 v[248:251], a[164:167], a[56:59], v[248:251]
    ds_read_b128 a[148:151], v3 offset:5120
    v_rcp_f32 v34, v34
    v_rcp_f32 v35, v35
    v_mfma_f32_16x16x32_bf16 v[252:255], a[164:167], a[60:63], v[252:255]
    s_add_u32 m0, s61, 5120
    s_add_u32 s59, s32, 186368
    buffer_load_dwordx4 v3, s[8:11], s59 offen sc1 lds
    v_rcp_f32 v40, v40
    v_rcp_f32 v41, v41
    v_mfma_f32_16x16x32_bf16 v[172:175], a[168:171], a[56:59], v[172:175]
    ds_read_b128 a[152:155], v3 offset:6144
    v_rcp_f32 v42, v42
    v_rcp_f32 v43, v43
    v_mfma_f32_16x16x32_bf16 v[176:179], a[168:171], a[60:63], v[176:179]
    s_add_u32 s59, s32, 0
    buffer_load_dwordx4 a[212:215], v3, s[8:11], s59 offen offset:1024 sc1
    v_mul_f32 v48, v32, v48
    v_mul_f32 v49, v33, v49
    v_mfma_f32_16x16x32_bf16 v[180:183], a[172:175], a[56:59], v[180:183]
    ds_read_b128 a[156:159], v3 offset:7168
    v_mul_f32 v50, v34, v50
    v_mul_f32 v51, v35, v51
    v_mfma_f32_16x16x32_bf16 v[184:187], a[172:175], a[60:63], v[184:187]
    v_mul_f32 v56, v40, v56
    v_mul_f32 v57, v41, v57
    s_waitcnt lgkmcnt(4)
    v_mfma_f32_16x16x32_bf16 v[240:243], a[176:179], a[64:67], v[240:243]
    ds_read_b128 a[160:163], v3 offset:8192
    v_mul_f32 v58, v42, v58
    v_mul_f32 v59, v43, v59
    v_mfma_f32_16x16x32_bf16 v[244:247], a[176:179], a[68:71], v[244:247]
    v_cvt_pk_bf16_f32 v20, v48, v49
    v_cvt_pk_bf16_f32 v21, v50, v51
    v_mfma_f32_16x16x32_bf16 v[248:251], a[180:183], a[64:67], v[248:251]
    ds_read_b128 a[164:167], v3 offset:9216
    v_cvt_pk_bf16_f32 v22, v56, v57
    v_cvt_pk_bf16_f32 v23, v58, v59
    v_mfma_f32_16x16x32_bf16 v[252:255], a[180:183], a[68:71], v[252:255]
    s_add_u32 m0, s61, 6144
    s_add_u32 s59, s32, 223232
    buffer_load_dwordx4 v3, s[8:11], s59 offen sc1 lds
    buffer_store_dwordx4 v[20:23], v14, s[8:11], s28 offen offset:0 sc1
    v_mfma_f32_16x16x32_bf16 v[172:175], a[184:187], a[64:67], v[172:175]
    ds_read_b128 a[168:171], v3 offset:10240
    ds_read_b128 v[156:159], v6 offset:256
    v_mfma_f32_16x16x32_bf16 v[176:179], a[184:187], a[68:71], v[176:179]
    s_add_u32 s59, s32, 36864
    buffer_load_dwordx4 a[216:219], v3, s[8:11], s59 offen offset:1024 sc1
    ds_read_b128 v[160:163], v6 offset:320
    ds_read_b128 v[164:167], v6 offset:384
    v_mfma_f32_16x16x32_bf16 v[180:183], a[188:191], a[64:67], v[180:183]
    ds_read_b128 a[172:175], v3 offset:11264
    ds_read_b128 v[168:171], v6 offset:448
    v_mul_f32 v60, v10, v60
    v_mfma_f32_16x16x32_bf16 v[184:187], a[188:191], a[68:71], v[184:187]
    v_mul_f32 v61, v10, v61
    v_mul_f32 v62, v10, v62
    s_waitcnt lgkmcnt(8)
    v_mfma_f32_16x16x32_bf16 v[240:243], a[144:147], a[72:75], v[240:243]
    ds_read_b128 a[176:179], v3 offset:12288
    v_mul_f32 v63, v10, v63
    v_mul_f32 v68, v10, v68
    v_mfma_f32_16x16x32_bf16 v[244:247], a[144:147], a[76:79], v[244:247]
    v_mul_f32 v69, v10, v69
    v_mul_f32 v70, v10, v70
    v_mfma_f32_16x16x32_bf16 v[248:251], a[148:151], a[72:75], v[248:251]
    ds_read_b128 a[180:183], v3 offset:13312
    v_mul_f32 v71, v10, v71
    s_waitcnt lgkmcnt(6)
    v_fmac_f32 v60, v12, v156
    v_mfma_f32_16x16x32_bf16 v[252:255], a[148:151], a[76:79], v[252:255]
    s_add_u32 m0, s61, 7168
    s_add_u32 s59, s32, 187392
    buffer_load_dwordx4 v3, s[8:11], s59 offen sc1 lds
    v_fmac_f32 v61, v12, v157
    v_fmac_f32 v62, v12, v158
    v_mfma_f32_16x16x32_bf16 v[172:175], a[152:155], a[72:75], v[172:175]
    ds_read_b128 a[184:187], v3 offset:14336
    v_fmac_f32 v63, v12, v159
    s_waitcnt lgkmcnt(6)
    v_fmac_f32 v68, v12, v160
    v_mfma_f32_16x16x32_bf16 v[176:179], a[152:155], a[76:79], v[176:179]
    s_add_u32 s59, s32, 73728
    buffer_load_dwordx4 a[220:223], v3, s[8:11], s59 offen offset:1024 sc1
    v_fmac_f32 v69, v12, v161
    v_fmac_f32 v70, v12, v162
    v_mfma_f32_16x16x32_bf16 v[180:183], a[156:159], a[72:75], v[180:183]
    ds_read_b128 a[188:191], v3 offset:15360
    v_fmac_f32 v71, v12, v163
    v_exp_f32 v60, v60
    v_mfma_f32_16x16x32_bf16 v[184:187], a[156:159], a[76:79], v[184:187]
    s_waitcnt lgkmcnt(6)
    v_fmac_f32 v76, v8, v164
    v_exp_f32 v61, v61
    s_waitcnt lgkmcnt(5)
    v_mfma_f32_16x16x32_bf16 v[240:243], a[160:163], a[80:83], v[240:243]
    s_waitcnt vmcnt(26)
    s_barrier
    ds_read_b128 a[144:147], v3 offset:16384
    v_fmac_f32 v77, v8, v165
    v_exp_f32 v62, v62
    v_mfma_f32_16x16x32_bf16 v[244:247], a[160:163], a[84:87], v[244:247]
    s_add_u32 m0, s25, 65536
    s_nop 0
    buffer_load_dwordx4 v3, s[8:11], s30 offen offset:0 sc1 lds
    v_fmac_f32 v78, v8, v166
    v_exp_f32 v63, v63
    v_mfma_f32_16x16x32_bf16 v[248:251], a[164:167], a[80:83], v[248:251]
    ds_read_b128 a[148:151], v3 offset:17408
    v_fmac_f32 v79, v8, v167
    v_exp_f32 v68, v68
    v_mfma_f32_16x16x32_bf16 v[252:255], a[164:167], a[84:87], v[252:255]
    buffer_load_dwordx4 v3, s[8:11], s30 offen offset:1024 sc1 lds
    s_waitcnt lgkmcnt(6)
    v_fmac_f32 v84, v8, v168
    v_exp_f32 v69, v69
    v_mfma_f32_16x16x32_bf16 v[172:175], a[168:171], a[80:83], v[172:175]
    ds_read_b128 a[152:155], v3 offset:18432
    v_fmac_f32 v85, v8, v169
    v_exp_f32 v70, v70
    v_mfma_f32_16x16x32_bf16 v[176:179], a[168:171], a[84:87], v[176:179]
    buffer_load_dwordx4 v3, s[8:11], s30 offen offset:2048 sc1 lds
    v_fmac_f32 v86, v8, v170
    v_exp_f32 v71, v71
    v_mfma_f32_16x16x32_bf16 v[180:183], a[172:175], a[80:83], v[180:183]
    ds_read_b128 a[156:159], v3 offset:19456
    v_fmac_f32 v87, v8, v171
    v_add_f32 v60, 1.0, v60
    v_mfma_f32_16x16x32_bf16 v[184:187], a[172:175], a[84:87], v[184:187]
    buffer_load_dwordx4 v3, s[8:11], s30 offen offset:3072 sc1 lds
    s_add_u32 s30, s30, 16384
    v_add_f32 v61, 1.0, v61
    v_add_f32 v62, 1.0, v62
    s_waitcnt lgkmcnt(4)
    v_mfma_f32_16x16x32_bf16 v[240:243], a[176:179], a[88:91], v[240:243]
    ds_read_b128 a[160:163], v3 offset:20480
    v_add_f32 v63, 1.0, v63
    v_add_f32 v68, 1.0, v68
    v_mfma_f32_16x16x32_bf16 v[244:247], a[176:179], a[92:95], v[244:247]
    v_add_f32 v69, 1.0, v69
    v_mfma_f32_16x16x32_bf16 v[248:251], a[180:183], a[88:91], v[248:251]
    ds_read_b128 a[164:167], v3 offset:21504
    v_add_f32 v70, 1.0, v70
    v_add_f32 v71, 1.0, v71
    v_mfma_f32_16x16x32_bf16 v[252:255], a[180:183], a[92:95], v[252:255]
    s_add_u32 m0, s61, 8192
    s_add_u32 s59, s32, 224256
    buffer_load_dwordx4 v3, s[8:11], s59 offen sc1 lds
    v_rcp_f32 v60, v60
    v_rcp_f32 v61, v61
    v_mfma_f32_16x16x32_bf16 v[172:175], a[184:187], a[88:91], v[172:175]
    ds_read_b128 a[168:171], v3 offset:22528
    v_rcp_f32 v62, v62
    v_rcp_f32 v63, v63
    v_mfma_f32_16x16x32_bf16 v[176:179], a[184:187], a[92:95], v[176:179]
    s_add_u32 s59, s32, 110592
    buffer_load_dwordx4 a[224:227], v3, s[8:11], s59 offen offset:1024 sc1
    v_rcp_f32 v68, v68
    v_rcp_f32 v69, v69
    v_mfma_f32_16x16x32_bf16 v[180:183], a[188:191], a[88:91], v[180:183]
    ds_read_b128 a[172:175], v3 offset:23552
    v_rcp_f32 v70, v70
    v_rcp_f32 v71, v71
    v_mfma_f32_16x16x32_bf16 v[184:187], a[188:191], a[92:95], v[184:187]
    v_mul_f32 v76, v60, v76
    v_mul_f32 v77, v61, v77
    s_waitcnt lgkmcnt(4)
    v_mfma_f32_16x16x32_bf16 v[240:243], a[144:147], a[96:99], v[240:243]
    ds_read_b128 a[176:179], v3 offset:24576
    v_mul_f32 v78, v62, v78
    v_mul_f32 v79, v63, v79
    v_mfma_f32_16x16x32_bf16 v[244:247], a[144:147], a[100:103], v[244:247]
    v_mul_f32 v84, v68, v84
    v_mul_f32 v85, v69, v85
    v_mfma_f32_16x16x32_bf16 v[248:251], a[148:151], a[96:99], v[248:251]
    ds_read_b128 a[180:183], v3 offset:25600
    v_mul_f32 v86, v70, v86
    v_mul_f32 v87, v71, v87
    v_mfma_f32_16x16x32_bf16 v[252:255], a[148:151], a[100:103], v[252:255]
    s_add_u32 m0, s61, 9216
    s_add_u32 s59, s32, 188416
    buffer_load_dwordx4 v3, s[8:11], s59 offen sc1 lds
    v_cvt_pk_bf16_f32 v16, v76, v77
    v_cvt_pk_bf16_f32 v17, v78, v79
    v_mfma_f32_16x16x32_bf16 v[172:175], a[152:155], a[96:99], v[172:175]
    ds_read_b128 a[184:187], v3 offset:26624
    v_cvt_pk_bf16_f32 v18, v84, v85
    v_cvt_pk_bf16_f32 v19, v86, v87
    v_mfma_f32_16x16x32_bf16 v[176:179], a[152:155], a[100:103], v[176:179]
    s_add_u32 s59, s32, 147456
    buffer_load_dwordx4 a[228:231], v3, s[8:11], s59 offen offset:1024 sc1
    buffer_store_dwordx4 v[16:19], v3, s[8:11], s28 offen offset:1024 sc1
    v_mul_f32 v64, v11, v64
    v_mfma_f32_16x16x32_bf16 v[180:183], a[156:159], a[96:99], v[180:183]
    ds_read_b128 a[188:191], v3 offset:27648
    v_mul_f32 v65, v11, v65
    v_mul_f32 v66, v11, v66
    v_mfma_f32_16x16x32_bf16 v[184:187], a[156:159], a[100:103], v[184:187]
    v_mul_f32 v67, v11, v67
    v_mul_f32 v72, v11, v72
    s_waitcnt lgkmcnt(4)
    v_mfma_f32_16x16x32_bf16 v[240:243], a[160:163], a[104:107], v[240:243]
    ds_read_b128 a[144:147], v3 offset:28672
    v_mul_f32 v73, v11, v73
    v_mul_f32 v74, v11, v74
    v_mfma_f32_16x16x32_bf16 v[244:247], a[160:163], a[108:111], v[244:247]
    v_mul_f32 v75, v11, v75
    v_fmac_f32 v64, v13, v156
    v_mfma_f32_16x16x32_bf16 v[248:251], a[164:167], a[104:107], v[248:251]
    ds_read_b128 a[148:151], v3 offset:29696
    v_fmac_f32 v65, v13, v157
    v_fmac_f32 v66, v13, v158
    v_mfma_f32_16x16x32_bf16 v[252:255], a[164:167], a[108:111], v[252:255]
    s_add_u32 m0, s61, 10240
    s_add_u32 s59, s32, 225280
    buffer_load_dwordx4 v3, s[8:11], s59 offen sc1 lds
    v_fmac_f32 v67, v13, v159
    v_fmac_f32 v72, v13, v160
    v_mfma_f32_16x16x32_bf16 v[172:175], a[168:171], a[104:107], v[172:175]
    ds_read_b128 a[152:155], v3 offset:30720
    v_fmac_f32 v73, v13, v161
    v_fmac_f32 v74, v13, v162
    v_mfma_f32_16x16x32_bf16 v[176:179], a[168:171], a[108:111], v[176:179]
    s_add_u32 s59, s32, 0
    buffer_load_dwordx4 a[232:235], v3, s[8:11], s59 offen offset:2048 sc1
    v_fmac_f32 v75, v13, v163
    v_exp_f32 v64, v64
    v_mfma_f32_16x16x32_bf16 v[180:183], a[172:175], a[104:107], v[180:183]
    ds_read_b128 a[156:159], v3 offset:31744
    v_fmac_f32 v80, v9, v164
    v_exp_f32 v65, v65
    v_mfma_f32_16x16x32_bf16 v[184:187], a[172:175], a[108:111], v[184:187]
    v_fmac_f32 v81, v9, v165
    s_waitcnt lgkmcnt(4)
    v_mfma_f32_16x16x32_bf16 v[240:243], a[176:179], a[112:115], v[240:243]
    s_waitcnt vmcnt(29)
    s_barrier
    ds_read_b128 a[160:163], v3 offset:32768
    v_exp_f32 v66, v66
    v_fmac_f32 v82, v9, v166
    v_mfma_f32_16x16x32_bf16 v[244:247], a[176:179], a[116:119], v[244:247]
    s_add_u32 m0, s25, 0
    s_nop 0
    buffer_load_dwordx4 v3, s[8:11], s30 offen offset:0 sc1 lds
    v_exp_f32 v67, v67
    v_fmac_f32 v83, v9, v167
    v_mfma_f32_16x16x32_bf16 v[248:251], a[180:183], a[112:115], v[248:251]
    ds_read_b128 a[164:167], v3 offset:33792
    v_exp_f32 v72, v72
    v_fmac_f32 v88, v9, v168
    v_mfma_f32_16x16x32_bf16 v[252:255], a[180:183], a[116:119], v[252:255]
    buffer_load_dwordx4 v3, s[8:11], s30 offen offset:1024 sc1 lds
    v_exp_f32 v73, v73
    v_fmac_f32 v89, v9, v169
    v_mfma_f32_16x16x32_bf16 v[172:175], a[184:187], a[112:115], v[172:175]
    ds_read_b128 a[168:171], v3 offset:34816
    v_exp_f32 v74, v74
    v_fmac_f32 v90, v9, v170
    v_mfma_f32_16x16x32_bf16 v[176:179], a[184:187], a[116:119], v[176:179]
    buffer_load_dwordx4 v3, s[8:11], s30 offen offset:2048 sc1 lds
    v_exp_f32 v75, v75
    v_fmac_f32 v91, v9, v171
    v_mfma_f32_16x16x32_bf16 v[180:183], a[188:191], a[112:115], v[180:183]
    ds_read_b128 a[172:175], v3 offset:35840
    v_add_f32 v64, 1.0, v64
    v_add_f32 v65, 1.0, v65
    v_mfma_f32_16x16x32_bf16 v[184:187], a[188:191], a[116:119], v[184:187]
    buffer_load_dwordx4 v3, s[8:11], s30 offen offset:3072 sc1 lds
    s_add_u32 s30, s30, 16384
    v_add_f32 v66, 1.0, v66
    v_add_f32 v67, 1.0, v67
    s_waitcnt lgkmcnt(4)
    v_mfma_f32_16x16x32_bf16 v[240:243], a[144:147], a[120:123], v[240:243]
    ds_read_b128 a[176:179], v3 offset:36864
    v_add_f32 v72, 1.0, v72
    v_add_f32 v73, 1.0, v73
    v_mfma_f32_16x16x32_bf16 v[244:247], a[144:147], a[124:127], v[244:247]
    v_add_f32 v74, 1.0, v74
    v_add_f32 v75, 1.0, v75
    v_mfma_f32_16x16x32_bf16 v[248:251], a[148:151], a[120:123], v[248:251]
    ds_read_b128 a[180:183], v3 offset:37888
    v_rcp_f32 v64, v64
    v_rcp_f32 v65, v65
    v_mfma_f32_16x16x32_bf16 v[252:255], a[148:151], a[124:127], v[252:255]
    s_add_u32 m0, s61, 11264
    s_add_u32 s59, s32, 189440
    buffer_load_dwordx4 v3, s[8:11], s59 offen sc1 lds
    v_rcp_f32 v66, v66
    v_rcp_f32 v67, v67
    v_mfma_f32_16x16x32_bf16 v[172:175], a[152:155], a[120:123], v[172:175]
    ds_read_b128 a[184:187], v3 offset:38912
    v_rcp_f32 v72, v72
    v_rcp_f32 v73, v73
    v_mfma_f32_16x16x32_bf16 v[176:179], a[152:155], a[124:127], v[176:179]
    s_add_u32 s59, s32, 36864
    buffer_load_dwordx4 a[236:239], v3, s[8:11], s59 offen offset:2048 sc1
    v_rcp_f32 v74, v74
    v_rcp_f32 v75, v75
    v_mfma_f32_16x16x32_bf16 v[180:183], a[156:159], a[120:123], v[180:183]
    ds_read_b128 a[188:191], v3 offset:39936
    v_mul_f32 v80, v64, v80
    v_mul_f32 v81, v65, v81
    v_mfma_f32_16x16x32_bf16 v[184:187], a[156:159], a[124:127], v[184:187]
    v_mul_f32 v82, v66, v82
    v_mul_f32 v83, v67, v83
    s_waitcnt lgkmcnt(4)
    v_mfma_f32_16x16x32_bf16 v[240:243], a[160:163], a[128:131], v[240:243]
    ds_read_b128 a[144:147], v3 offset:40960
    v_mul_f32 v88, v72, v88
    v_mul_f32 v89, v73, v89
    v_mfma_f32_16x16x32_bf16 v[244:247], a[160:163], a[132:135], v[244:247]
    v_mul_f32 v90, v74, v90
    v_mul_f32 v91, v75, v91
    v_mfma_f32_16x16x32_bf16 v[248:251], a[164:167], a[128:131], v[248:251]
    ds_read_b128 a[148:151], v3 offset:41984
    v_cvt_pk_bf16_f32 v20, v80, v81
    v_cvt_pk_bf16_f32 v21, v82, v83
    v_mfma_f32_16x16x32_bf16 v[252:255], a[164:167], a[132:135], v[252:255]
    s_add_u32 m0, s61, 12288
    s_add_u32 s59, s32, 226304
    buffer_load_dwordx4 v3, s[8:11], s59 offen sc1 lds
    v_cvt_pk_bf16_f32 v22, v88, v89
    v_cvt_pk_bf16_f32 v23, v90, v91
    v_mfma_f32_16x16x32_bf16 v[172:175], a[168:171], a[128:131], v[172:175]
    ds_read_b128 a[152:155], v3 offset:43008
    buffer_store_dwordx4 v[20:23], v14, s[8:11], s28 offen offset:1024 sc1
    v_mfma_f32_16x16x32_bf16 v[176:179], a[168:171], a[132:135], v[176:179]
    s_add_u32 s59, s32, 73728
    buffer_load_dwordx4 a[240:243], v3, s[8:11], s59 offen offset:2048 sc1
    v_mfma_f32_16x16x32_bf16 v[180:183], a[172:175], a[128:131], v[180:183]
    ds_read_b128 a[156:159], v3 offset:44032
    v_mfma_f32_16x16x32_bf16 v[184:187], a[172:175], a[132:135], v[184:187]
    s_waitcnt lgkmcnt(4)
    v_mfma_f32_16x16x32_bf16 v[240:243], a[176:179], a[136:139], v[240:243]
    ds_read_b128 a[160:163], v3 offset:45056
    v_mfma_f32_16x16x32_bf16 v[244:247], a[176:179], a[140:143], v[244:247]
    v_mfma_f32_16x16x32_bf16 v[248:251], a[180:183], a[136:139], v[248:251]
    ds_read_b128 a[164:167], v3 offset:46080
    v_mfma_f32_16x16x32_bf16 v[252:255], a[180:183], a[140:143], v[252:255]
    s_add_u32 m0, s61, 13312
    s_add_u32 s59, s32, 190464
    buffer_load_dwordx4 v3, s[8:11], s59 offen sc1 lds
    v_mfma_f32_16x16x32_bf16 v[172:175], a[184:187], a[136:139], v[172:175]
    ds_read_b128 a[168:171], v3 offset:47104
    v_mfma_f32_16x16x32_bf16 v[176:179], a[184:187], a[140:143], v[176:179]
    s_add_u32 s59, s32, 110592
    buffer_load_dwordx4 a[244:247], v3, s[8:11], s59 offen offset:2048 sc1
    v_mfma_f32_16x16x32_bf16 v[180:183], a[188:191], a[136:139], v[180:183]
    ds_read_b128 a[172:175], v3 offset:48128
    v_mfma_f32_16x16x32_bf16 v[184:187], a[188:191], a[140:143], v[184:187]
    s_waitcnt lgkmcnt(4)
    v_mfma_f32_16x16x32_bf16 v[188:191], a[144:147], a[0:3], 0
    s_waitcnt vmcnt(29)
    s_barrier
    ds_read_b128 a[176:179], v4 offset:0
    v_mfma_f32_16x16x32_bf16 v[192:195], a[144:147], a[4:7], 0
    s_add_u32 m0, s25, 16384
    s_nop 0
    buffer_load_dwordx4 v3, s[8:11], s30 offen offset:0 sc1 lds
    v_mfma_f32_16x16x32_bf16 v[196:199], a[148:151], a[0:3], 0
    ds_read_b128 a[180:183], v4 offset:1024
    v_mfma_f32_16x16x32_bf16 v[200:203], a[148:151], a[4:7], 0
    buffer_load_dwordx4 v3, s[8:11], s30 offen offset:1024 sc1 lds
    ds_read_b128 v[156:159], v6 offset:512
    v_mfma_f32_16x16x32_bf16 v[204:207], a[152:155], a[0:3], 0
    ds_read_b128 a[184:187], v4 offset:2048
    ds_read_b128 v[160:163], v6 offset:576
    ds_read_b128 v[164:167], v6 offset:640
    v_mfma_f32_16x16x32_bf16 v[208:211], a[152:155], a[4:7], 0
    buffer_load_dwordx4 v3, s[8:11], s30 offen offset:2048 sc1 lds
    ds_read_b128 v[168:171], v6 offset:704
    v_mul_f32 v92, v10, v92
    v_mfma_f32_16x16x32_bf16 v[212:215], a[156:159], a[0:3], 0
    ds_read_b128 a[188:191], v4 offset:3072
    v_mul_f32 v93, v10, v93
    v_mul_f32 v94, v10, v94
    v_mfma_f32_16x16x32_bf16 v[216:219], a[156:159], a[4:7], 0
    buffer_load_dwordx4 v3, s[8:11], s30 offen offset:3072 sc1 lds
    s_add_u32 s30, s30, 16384
    v_mul_f32 v95, v10, v95
    v_mul_f32 v100, v10, v100
    s_waitcnt lgkmcnt(8)
    v_mfma_f32_16x16x32_bf16 v[188:191], a[160:163], a[8:11], v[188:191]
    ds_read_b128 a[144:147], v4 offset:4096
    v_mul_f32 v101, v10, v101
    v_mul_f32 v102, v10, v102
    v_mfma_f32_16x16x32_bf16 v[192:195], a[160:163], a[12:15], v[192:195]
    v_mul_f32 v103, v10, v103
    s_waitcnt lgkmcnt(6)
    v_fmac_f32 v92, v12, v156
    v_mfma_f32_16x16x32_bf16 v[196:199], a[164:167], a[8:11], v[196:199]
    ds_read_b128 a[148:151], v4 offset:5120
    v_fmac_f32 v93, v12, v157
    v_fmac_f32 v94, v12, v158
    v_mfma_f32_16x16x32_bf16 v[200:203], a[164:167], a[12:15], v[200:203]
    s_add_u32 m0, s61, 14336
    s_add_u32 s59, s32, 227328
    buffer_load_dwordx4 v3, s[8:11], s59 offen sc1 lds
    v_fmac_f32 v95, v12, v159
    s_waitcnt lgkmcnt(5)
    v_fmac_f32 v100, v12, v160
    v_mfma_f32_16x16x32_bf16 v[204:207], a[168:171], a[8:11], v[204:207]
    ds_read_b128 a[152:155], v4 offset:6144
    v_fmac_f32 v101, v12, v161
    v_fmac_f32 v102, v12, v162
    v_mfma_f32_16x16x32_bf16 v[208:211], a[168:171], a[12:15], v[208:211]
    s_add_u32 s59, s32, 147456
    buffer_load_dwordx4 a[248:251], v3, s[8:11], s59 offen offset:2048 sc1
    v_fmac_f32 v103, v12, v163
    v_exp_f32 v92, v92
    v_mfma_f32_16x16x32_bf16 v[212:215], a[172:175], a[8:11], v[212:215]
    ds_read_b128 a[156:159], v4 offset:7168
    s_waitcnt lgkmcnt(6)
    v_fmac_f32 v108, v8, v164
    v_exp_f32 v93, v93
    v_mfma_f32_16x16x32_bf16 v[216:219], a[172:175], a[12:15], v[216:219]
    v_fmac_f32 v109, v8, v165
    v_exp_f32 v94, v94
    s_waitcnt lgkmcnt(4)
    v_mfma_f32_16x16x32_bf16 v[188:191], a[176:179], a[16:19], v[188:191]
    ds_read_b128 a[160:163], v4 offset:8192
    v_fmac_f32 v110, v8, v166
    v_exp_f32 v95, v95
    v_mfma_f32_16x16x32_bf16 v[192:195], a[176:179], a[20:23], v[192:195]
    v_fmac_f32 v111, v8, v167
    v_exp_f32 v100, v100
    v_mfma_f32_16x16x32_bf16 v[196:199], a[180:183], a[16:19], v[196:199]
    ds_read_b128 a[164:167], v4 offset:9216
    v_fmac_f32 v116, v8, v168
    v_exp_f32 v101, v101
    v_mfma_f32_16x16x32_bf16 v[200:203], a[180:183], a[20:23], v[200:203]
    s_add_u32 m0, s61, 15360
    s_add_u32 s59, s32, 191488
    buffer_load_dwordx4 v3, s[8:11], s59 offen sc1 lds
    v_fmac_f32 v117, v8, v169
    v_exp_f32 v102, v102
    v_mfma_f32_16x16x32_bf16 v[204:207], a[184:187], a[16:19], v[204:207]
    ds_read_b128 a[168:171], v4 offset:10240
    v_fmac_f32 v118, v8, v170
    v_exp_f32 v103, v103
    v_mfma_f32_16x16x32_bf16 v[208:211], a[184:187], a[20:23], v[208:211]
    s_add_u32 s59, s32, 0
    buffer_load_dwordx4 a[252:255], v3, s[8:11], s59 offen offset:3072 sc1
    v_fmac_f32 v119, v8, v171
    v_add_f32 v92, 1.0, v92
    v_mfma_f32_16x16x32_bf16 v[212:215], a[188:191], a[16:19], v[212:215]
    ds_read_b128 a[172:175], v4 offset:11264
    v_add_f32 v93, 1.0, v93
    v_add_f32 v94, 1.0, v94
    v_mfma_f32_16x16x32_bf16 v[216:219], a[188:191], a[20:23], v[216:219]
    v_add_f32 v95, 1.0, v95
    v_add_f32 v100, 1.0, v100
    s_waitcnt lgkmcnt(4)
    v_mfma_f32_16x16x32_bf16 v[188:191], a[144:147], a[24:27], v[188:191]
    ds_read_b128 a[176:179], v4 offset:12288
    v_add_f32 v101, 1.0, v101
    v_mfma_f32_16x16x32_bf16 v[192:195], a[144:147], a[28:31], v[192:195]
    v_add_f32 v102, 1.0, v102
    v_add_f32 v103, 1.0, v103
    v_mfma_f32_16x16x32_bf16 v[196:199], a[148:151], a[24:27], v[196:199]
    ds_read_b128 a[180:183], v4 offset:13312
    v_rcp_f32 v92, v92
    v_rcp_f32 v93, v93
    v_mfma_f32_16x16x32_bf16 v[200:203], a[148:151], a[28:31], v[200:203]
    s_add_u32 m0, s61, 16384
    s_add_u32 s59, s32, 228352
    buffer_load_dwordx4 v3, s[8:11], s59 offen sc1 lds
    v_rcp_f32 v94, v94
    v_rcp_f32 v95, v95
    v_mfma_f32_16x16x32_bf16 v[204:207], a[152:155], a[24:27], v[204:207]
    ds_read_b128 a[184:187], v4 offset:14336
    v_rcp_f32 v100, v100
    v_rcp_f32 v101, v101
    v_mfma_f32_16x16x32_bf16 v[208:211], a[152:155], a[28:31], v[208:211]
    s_add_u32 s59, s32, 36864
    buffer_load_dwordx4 v[220:223], v3, s[8:11], s59 offen offset:3072 sc1
    v_rcp_f32 v102, v102
    v_rcp_f32 v103, v103
    v_mfma_f32_16x16x32_bf16 v[212:215], a[156:159], a[24:27], v[212:215]
    ds_read_b128 a[188:191], v4 offset:15360
    v_mul_f32 v108, v92, v108
    v_mul_f32 v109, v93, v109
    v_mfma_f32_16x16x32_bf16 v[216:219], a[156:159], a[28:31], v[216:219]
    v_mul_f32 v110, v94, v110
    v_mul_f32 v111, v95, v111
    s_waitcnt lgkmcnt(4)
    v_mfma_f32_16x16x32_bf16 v[188:191], a[160:163], a[32:35], v[188:191]
    s_waitcnt vmcnt(28)
    s_barrier
    ds_read_b128 a[144:147], v4 offset:16384
    v_mul_f32 v116, v100, v116
    v_mul_f32 v117, v101, v117
    v_mfma_f32_16x16x32_bf16 v[192:195], a[160:163], a[36:39], v[192:195]
    s_add_u32 m0, s25, 32768
    s_nop 0
    buffer_load_dwordx4 v3, s[8:11], s30 offen offset:0 sc1 lds
    v_mul_f32 v118, v102, v118
    v_mul_f32 v119, v103, v119
    v_mfma_f32_16x16x32_bf16 v[196:199], a[164:167], a[32:35], v[196:199]
    ds_read_b128 a[148:151], v4 offset:17408
    v_cvt_pk_bf16_f32 v16, v108, v109
    v_cvt_pk_bf16_f32 v17, v110, v111
    v_mfma_f32_16x16x32_bf16 v[200:203], a[164:167], a[36:39], v[200:203]
    buffer_load_dwordx4 v3, s[8:11], s30 offen offset:1024 sc1 lds
    v_cvt_pk_bf16_f32 v18, v116, v117
    v_cvt_pk_bf16_f32 v19, v118, v119
    v_mfma_f32_16x16x32_bf16 v[204:207], a[168:171], a[32:35], v[204:207]
    ds_read_b128 a[152:155], v4 offset:18432
    buffer_store_dwordx4 v[16:19], v3, s[8:11], s28 offen offset:2048 sc1
    v_mul_f32 v96, v11, v96
    v_mfma_f32_16x16x32_bf16 v[208:211], a[168:171], a[36:39], v[208:211]
    buffer_load_dwordx4 v3, s[8:11], s30 offen offset:2048 sc1 lds
    v_mul_f32 v97, v11, v97
    v_mul_f32 v98, v11, v98
    v_mfma_f32_16x16x32_bf16 v[212:215], a[172:175], a[32:35], v[212:215]
    ds_read_b128 a[156:159], v4 offset:19456
    v_mul_f32 v99, v11, v99
    v_mul_f32 v104, v11, v104
    v_mfma_f32_16x16x32_bf16 v[216:219], a[172:175], a[36:39], v[216:219]
    buffer_load_dwordx4 v3, s[8:11], s30 offen offset:3072 sc1 lds
    s_add_u32 s30, s30, 16384
    v_mul_f32 v105, v11, v105
    v_mul_f32 v106, v11, v106
    s_waitcnt lgkmcnt(4)
    v_mfma_f32_16x16x32_bf16 v[188:191], a[176:179], a[40:43], v[188:191]
    ds_read_b128 a[160:163], v4 offset:20480
    v_mul_f32 v107, v11, v107
    v_fmac_f32 v96, v13, v156
    v_mfma_f32_16x16x32_bf16 v[192:195], a[176:179], a[44:47], v[192:195]
    v_fmac_f32 v97, v13, v157
    v_fmac_f32 v98, v13, v158
    v_mfma_f32_16x16x32_bf16 v[196:199], a[180:183], a[40:43], v[196:199]
    ds_read_b128 a[164:167], v4 offset:21504
    v_fmac_f32 v99, v13, v159
    v_fmac_f32 v104, v13, v160
    v_mfma_f32_16x16x32_bf16 v[200:203], a[180:183], a[44:47], v[200:203]
    s_add_u32 m0, s61, 17408
    s_add_u32 s59, s32, 192512
    buffer_load_dwordx4 v3, s[8:11], s59 offen sc1 lds
    v_fmac_f32 v105, v13, v161
    v_fmac_f32 v106, v13, v162
    v_mfma_f32_16x16x32_bf16 v[204:207], a[184:187], a[40:43], v[204:207]
    ds_read_b128 a[168:171], v4 offset:22528
    v_fmac_f32 v107, v13, v163
    v_exp_f32 v96, v96
    v_mfma_f32_16x16x32_bf16 v[208:211], a[184:187], a[44:47], v[208:211]
    s_add_u32 s59, s32, 73728
    buffer_load_dwordx4 v[224:227], v3, s[8:11], s59 offen offset:3072 sc1
    v_fmac_f32 v112, v9, v164
    v_exp_f32 v97, v97
    v_mfma_f32_16x16x32_bf16 v[212:215], a[188:191], a[40:43], v[212:215]
    ds_read_b128 a[172:175], v4 offset:23552
    v_fmac_f32 v113, v9, v165
    v_mfma_f32_16x16x32_bf16 v[216:219], a[188:191], a[44:47], v[216:219]
    v_exp_f32 v98, v98
    v_fmac_f32 v114, v9, v166
    s_waitcnt lgkmcnt(4)
    v_mfma_f32_16x16x32_bf16 v[188:191], a[144:147], a[48:51], v[188:191]
    ds_read_b128 a[176:179], v4 offset:24576
    v_exp_f32 v99, v99
    v_fmac_f32 v115, v9, v167
    v_mfma_f32_16x16x32_bf16 v[192:195], a[144:147], a[52:55], v[192:195]
    v_exp_f32 v104, v104
    v_fmac_f32 v120, v9, v168
    v_mfma_f32_16x16x32_bf16 v[196:199], a[148:151], a[48:51], v[196:199]
    ds_read_b128 a[180:183], v4 offset:25600
    v_exp_f32 v105, v105
    v_fmac_f32 v121, v9, v169
    v_mfma_f32_16x16x32_bf16 v[200:203], a[148:151], a[52:55], v[200:203]
    s_add_u32 m0, s61, 18432
    s_add_u32 s59, s32, 229376
    buffer_load_dwordx4 v3, s[8:11], s59 offen sc1 lds
    v_exp_f32 v106, v106
    v_fmac_f32 v122, v9, v170
    v_mfma_f32_16x16x32_bf16 v[204:207], a[152:155], a[48:51], v[204:207]
    ds_read_b128 a[184:187], v4 offset:26624
    v_exp_f32 v107, v107
    v_fmac_f32 v123, v9, v171
    v_mfma_f32_16x16x32_bf16 v[208:211], a[152:155], a[52:55], v[208:211]
    s_add_u32 s59, s32, 110592
    buffer_load_dwordx4 v[228:231], v3, s[8:11], s59 offen offset:3072 sc1
    v_add_f32 v96, 1.0, v96
    v_add_f32 v97, 1.0, v97
    v_mfma_f32_16x16x32_bf16 v[212:215], a[156:159], a[48:51], v[212:215]
    ds_read_b128 a[188:191], v4 offset:27648
    v_add_f32 v98, 1.0, v98
    v_add_f32 v99, 1.0, v99
    v_mfma_f32_16x16x32_bf16 v[216:219], a[156:159], a[52:55], v[216:219]
    v_add_f32 v104, 1.0, v104
    v_add_f32 v105, 1.0, v105
    s_waitcnt lgkmcnt(4)
    v_mfma_f32_16x16x32_bf16 v[188:191], a[160:163], a[56:59], v[188:191]
    ds_read_b128 a[144:147], v4 offset:28672
    v_add_f32 v106, 1.0, v106
    v_add_f32 v107, 1.0, v107
    v_mfma_f32_16x16x32_bf16 v[192:195], a[160:163], a[60:63], v[192:195]
    v_rcp_f32 v96, v96
    v_rcp_f32 v97, v97
    v_mfma_f32_16x16x32_bf16 v[196:199], a[164:167], a[56:59], v[196:199]
    ds_read_b128 a[148:151], v4 offset:29696
    v_rcp_f32 v98, v98
    v_rcp_f32 v99, v99
    v_mfma_f32_16x16x32_bf16 v[200:203], a[164:167], a[60:63], v[200:203]
    v_rcp_f32 v104, v104
    v_rcp_f32 v105, v105
    v_mfma_f32_16x16x32_bf16 v[204:207], a[168:171], a[56:59], v[204:207]
    ds_read_b128 a[152:155], v4 offset:30720
    v_rcp_f32 v106, v106
    v_rcp_f32 v107, v107
    v_mfma_f32_16x16x32_bf16 v[208:211], a[168:171], a[60:63], v[208:211]
    s_add_u32 s59, s32, 147456
    buffer_load_dwordx4 v[232:235], v3, s[8:11], s59 offen offset:3072 sc1
    v_mul_f32 v112, v96, v112
    v_mul_f32 v113, v97, v113
    v_mfma_f32_16x16x32_bf16 v[212:215], a[172:175], a[56:59], v[212:215]
    ds_read_b128 a[156:159], v4 offset:31744
    v_mul_f32 v114, v98, v114
    v_mul_f32 v115, v99, v115
    v_mfma_f32_16x16x32_bf16 v[216:219], a[172:175], a[60:63], v[216:219]
    v_mul_f32 v120, v104, v120
    v_mul_f32 v121, v105, v121
    s_waitcnt lgkmcnt(4)
    v_mfma_f32_16x16x32_bf16 v[188:191], a[176:179], a[64:67], v[188:191]
    s_waitcnt vmcnt(27)
    s_barrier
    ds_read_b128 a[160:163], v3 offset:0
    v_mul_f32 v122, v106, v122
    v_mul_f32 v123, v107, v123
    v_mfma_f32_16x16x32_bf16 v[192:195], a[176:179], a[68:71], v[192:195]
    s_add_u32 m0, s25, 49152
    s_nop 0
    buffer_load_dwordx4 v3, s[8:11], s30 offen offset:0 sc1 lds
    v_cvt_pk_bf16_f32 v20, v112, v113
    v_cvt_pk_bf16_f32 v21, v114, v115
    v_mfma_f32_16x16x32_bf16 v[196:199], a[180:183], a[64:67], v[196:199]
    ds_read_b128 a[164:167], v3 offset:1024
    v_cvt_pk_bf16_f32 v22, v120, v121
    v_cvt_pk_bf16_f32 v23, v122, v123
    v_mfma_f32_16x16x32_bf16 v[200:203], a[180:183], a[68:71], v[200:203]
    buffer_load_dwordx4 v3, s[8:11], s30 offen offset:1024 sc1 lds
    buffer_store_dwordx4 v[20:23], v14, s[8:11], s28 offen offset:2048 sc1
    v_mfma_f32_16x16x32_bf16 v[204:207], a[184:187], a[64:67], v[204:207]
    ds_read_b128 a[168:171], v3 offset:2048
    ds_read_b128 v[156:159], v6 offset:768
    v_mfma_f32_16x16x32_bf16 v[208:211], a[184:187], a[68:71], v[208:211]
    buffer_load_dwordx4 v3, s[8:11], s30 offen offset:2048 sc1 lds
    ds_read_b128 v[160:163], v6 offset:832
    ds_read_b128 v[164:167], v6 offset:896
    v_mfma_f32_16x16x32_bf16 v[212:215], a[188:191], a[64:67], v[212:215]
    ds_read_b128 a[172:175], v3 offset:3072
    ds_read_b128 v[168:171], v6 offset:960
    v_mul_f32 v124, v10, v124
    v_mfma_f32_16x16x32_bf16 v[216:219], a[188:191], a[68:71], v[216:219]
    buffer_load_dwordx4 v3, s[8:11], s30 offen offset:3072 sc1 lds
    s_add_u32 s30, s30, 16384
    v_mul_f32 v125, v10, v125
    v_mul_f32 v126, v10, v126
    s_waitcnt lgkmcnt(8)
    v_mfma_f32_16x16x32_bf16 v[188:191], a[144:147], a[72:75], v[188:191]
    ds_read_b128 a[176:179], v3 offset:4096
    v_mul_f32 v127, v10, v127
    v_mul_f32 v132, v10, v132
    v_mfma_f32_16x16x32_bf16 v[192:195], a[144:147], a[76:79], v[192:195]
    v_mul_f32 v133, v10, v133
    v_mul_f32 v134, v10, v134
    v_mfma_f32_16x16x32_bf16 v[196:199], a[148:151], a[72:75], v[196:199]
    ds_read_b128 a[180:183], v3 offset:5120
    v_mul_f32 v135, v10, v135
    s_waitcnt lgkmcnt(6)
    v_fmac_f32 v124, v12, v156
    v_mfma_f32_16x16x32_bf16 v[200:203], a[148:151], a[76:79], v[200:203]
    v_fmac_f32 v125, v12, v157
    v_fmac_f32 v126, v12, v158
    v_mfma_f32_16x16x32_bf16 v[204:207], a[152:155], a[72:75], v[204:207]
    ds_read_b128 a[184:187], v3 offset:6144
    v_fmac_f32 v127, v12, v159
    s_waitcnt lgkmcnt(6)
    v_fmac_f32 v132, v12, v160
    v_mfma_f32_16x16x32_bf16 v[208:211], a[152:155], a[76:79], v[208:211]
    s_add_u32 s59, s32, 4096
    buffer_load_dwordx4 v[236:239], v3, s[8:11], s59 offen offset:0 sc1
    v_fmac_f32 v133, v12, v161
    v_fmac_f32 v134, v12, v162
    v_mfma_f32_16x16x32_bf16 v[212:215], a[156:159], a[72:75], v[212:215]
    ds_read_b128 a[188:191], v3 offset:7168
    v_fmac_f32 v135, v12, v163
    v_exp_f32 v124, v124
    v_mfma_f32_16x16x32_bf16 v[216:219], a[156:159], a[76:79], v[216:219]
    s_waitcnt lgkmcnt(6)
    v_fmac_f32 v140, v8, v164
    v_exp_f32 v125, v125
    s_waitcnt lgkmcnt(5)
    v_mfma_f32_16x16x32_bf16 v[188:191], a[160:163], a[80:83], v[188:191]
    ds_read_b128 a[144:147], v3 offset:8192
    v_fmac_f32 v141, v8, v165
    v_exp_f32 v126, v126
    v_mfma_f32_16x16x32_bf16 v[192:195], a[160:163], a[84:87], v[192:195]
    v_fmac_f32 v142, v8, v166
    v_exp_f32 v127, v127
    v_mfma_f32_16x16x32_bf16 v[196:199], a[164:167], a[80:83], v[196:199]
    ds_read_b128 a[148:151], v3 offset:9216
    v_fmac_f32 v143, v8, v167
    v_exp_f32 v132, v132
    v_mfma_f32_16x16x32_bf16 v[200:203], a[164:167], a[84:87], v[200:203]
    s_waitcnt lgkmcnt(6)
    v_fmac_f32 v148, v8, v168
    v_exp_f32 v133, v133
    v_mfma_f32_16x16x32_bf16 v[204:207], a[168:171], a[80:83], v[204:207]
    ds_read_b128 a[152:155], v3 offset:10240
    v_fmac_f32 v149, v8, v169
    v_exp_f32 v134, v134
    v_mfma_f32_16x16x32_bf16 v[208:211], a[168:171], a[84:87], v[208:211]
    s_add_u32 s59, s32, 40960
    buffer_load_dwordx4 v[28:31], v3, s[8:11], s59 offen offset:0 sc1
    v_fmac_f32 v150, v8, v170
    v_exp_f32 v135, v135
    v_mfma_f32_16x16x32_bf16 v[212:215], a[172:175], a[80:83], v[212:215]
    ds_read_b128 a[156:159], v3 offset:11264
    v_fmac_f32 v151, v8, v171
    v_add_f32 v124, 1.0, v124
    v_mfma_f32_16x16x32_bf16 v[216:219], a[172:175], a[84:87], v[216:219]
    v_add_f32 v125, 1.0, v125
    v_add_f32 v126, 1.0, v126
    s_waitcnt lgkmcnt(4)
    v_mfma_f32_16x16x32_bf16 v[188:191], a[176:179], a[88:91], v[188:191]
    ds_read_b128 a[160:163], v3 offset:12288
    v_add_f32 v127, 1.0, v127
    v_add_f32 v132, 1.0, v132
    v_mfma_f32_16x16x32_bf16 v[192:195], a[176:179], a[92:95], v[192:195]
    v_add_f32 v133, 1.0, v133
    v_mfma_f32_16x16x32_bf16 v[196:199], a[180:183], a[88:91], v[196:199]
    ds_read_b128 a[164:167], v3 offset:13312
    v_add_f32 v134, 1.0, v134
    v_add_f32 v135, 1.0, v135
    v_mfma_f32_16x16x32_bf16 v[200:203], a[180:183], a[92:95], v[200:203]
    v_rcp_f32 v124, v124
    v_rcp_f32 v125, v125
    v_mfma_f32_16x16x32_bf16 v[204:207], a[184:187], a[88:91], v[204:207]
    ds_read_b128 a[168:171], v3 offset:14336
    v_rcp_f32 v126, v126
    v_rcp_f32 v127, v127
    v_mfma_f32_16x16x32_bf16 v[208:211], a[184:187], a[92:95], v[208:211]
    s_add_u32 s59, s32, 77824
    buffer_load_dwordx4 v[32:35], v3, s[8:11], s59 offen offset:0 sc1
    v_rcp_f32 v132, v132
    v_rcp_f32 v133, v133
    v_mfma_f32_16x16x32_bf16 v[212:215], a[188:191], a[88:91], v[212:215]
    ds_read_b128 a[172:175], v3 offset:15360
    v_rcp_f32 v134, v134
    v_rcp_f32 v135, v135
    v_mfma_f32_16x16x32_bf16 v[216:219], a[188:191], a[92:95], v[216:219]
    v_mul_f32 v140, v124, v140
    v_mul_f32 v141, v125, v141
    s_waitcnt lgkmcnt(4)
    v_mfma_f32_16x16x32_bf16 v[188:191], a[144:147], a[96:99], v[188:191]
    s_waitcnt vmcnt(24)
    s_barrier
    ds_read_b128 a[176:179], v3 offset:16384
    v_mul_f32 v142, v126, v142
    v_mul_f32 v143, v127, v143
    v_mfma_f32_16x16x32_bf16 v[192:195], a[144:147], a[100:103], v[192:195]
    s_add_u32 m0, s25, 65536
    s_nop 0
    buffer_load_dwordx4 v3, s[8:11], s30 offen offset:0 sc1 lds
    v_mul_f32 v148, v132, v148
    v_mul_f32 v149, v133, v149
    v_mfma_f32_16x16x32_bf16 v[196:199], a[148:151], a[96:99], v[196:199]
    ds_read_b128 a[180:183], v3 offset:17408
    v_mul_f32 v150, v134, v150
    v_mul_f32 v151, v135, v151
    v_mfma_f32_16x16x32_bf16 v[200:203], a[148:151], a[100:103], v[200:203]
    buffer_load_dwordx4 v3, s[8:11], s30 offen offset:1024 sc1 lds
    v_cvt_pk_bf16_f32 v16, v140, v141
    v_cvt_pk_bf16_f32 v17, v142, v143
    v_mfma_f32_16x16x32_bf16 v[204:207], a[152:155], a[96:99], v[204:207]
    ds_read_b128 a[184:187], v3 offset:18432
    v_cvt_pk_bf16_f32 v18, v148, v149
    v_cvt_pk_bf16_f32 v19, v150, v151
    v_mfma_f32_16x16x32_bf16 v[208:211], a[152:155], a[100:103], v[208:211]
    buffer_load_dwordx4 v3, s[8:11], s30 offen offset:2048 sc1 lds
    buffer_store_dwordx4 v[16:19], v3, s[8:11], s28 offen offset:3072 sc1
    v_mul_f32 v128, v11, v128
    v_mfma_f32_16x16x32_bf16 v[212:215], a[156:159], a[96:99], v[212:215]
    ds_read_b128 a[188:191], v3 offset:19456
    v_mul_f32 v129, v11, v129
    v_mul_f32 v130, v11, v130
    v_mfma_f32_16x16x32_bf16 v[216:219], a[156:159], a[100:103], v[216:219]
    buffer_load_dwordx4 v3, s[8:11], s30 offen offset:3072 sc1 lds
    s_add_u32 s30, s30, 16384
    v_mul_f32 v131, v11, v131
    v_mul_f32 v136, v11, v136
    s_waitcnt lgkmcnt(4)
    v_mfma_f32_16x16x32_bf16 v[188:191], a[160:163], a[104:107], v[188:191]
    ds_read_b128 a[144:147], v3 offset:20480
    v_mul_f32 v137, v11, v137
    v_mul_f32 v138, v11, v138
    v_mfma_f32_16x16x32_bf16 v[192:195], a[160:163], a[108:111], v[192:195]
    v_mul_f32 v139, v11, v139
    v_fmac_f32 v128, v13, v156
    v_mfma_f32_16x16x32_bf16 v[196:199], a[164:167], a[104:107], v[196:199]
    ds_read_b128 a[148:151], v3 offset:21504
    v_fmac_f32 v129, v13, v157
    v_fmac_f32 v130, v13, v158
    v_mfma_f32_16x16x32_bf16 v[200:203], a[164:167], a[108:111], v[200:203]
    v_fmac_f32 v131, v13, v159
    v_fmac_f32 v136, v13, v160
    v_mfma_f32_16x16x32_bf16 v[204:207], a[168:171], a[104:107], v[204:207]
    ds_read_b128 a[152:155], v3 offset:22528
    v_fmac_f32 v137, v13, v161
    v_fmac_f32 v138, v13, v162
    v_mfma_f32_16x16x32_bf16 v[208:211], a[168:171], a[108:111], v[208:211]
    s_add_u32 s59, s32, 114688
    buffer_load_dwordx4 v[36:39], v3, s[8:11], s59 offen offset:0 sc1
    v_fmac_f32 v139, v13, v163
    v_exp_f32 v128, v128
    v_mfma_f32_16x16x32_bf16 v[212:215], a[172:175], a[104:107], v[212:215]
    ds_read_b128 a[156:159], v3 offset:23552
    v_fmac_f32 v144, v9, v164
    v_exp_f32 v129, v129
    v_mfma_f32_16x16x32_bf16 v[216:219], a[172:175], a[108:111], v[216:219]
    v_fmac_f32 v145, v9, v165
    s_waitcnt lgkmcnt(4)
    v_mfma_f32_16x16x32_bf16 v[188:191], a[176:179], a[112:115], v[188:191]
    ds_read_b128 a[160:163], v3 offset:24576
    v_exp_f32 v130, v130
    v_fmac_f32 v146, v9, v166
    v_mfma_f32_16x16x32_bf16 v[192:195], a[176:179], a[116:119], v[192:195]
    v_exp_f32 v131, v131
    v_fmac_f32 v147, v9, v167
    v_mfma_f32_16x16x32_bf16 v[196:199], a[180:183], a[112:115], v[196:199]
    ds_read_b128 a[164:167], v3 offset:25600
    v_exp_f32 v136, v136
    v_fmac_f32 v152, v9, v168
    v_mfma_f32_16x16x32_bf16 v[200:203], a[180:183], a[116:119], v[200:203]
    v_exp_f32 v137, v137
    v_fmac_f32 v153, v9, v169
    v_mfma_f32_16x16x32_bf16 v[204:207], a[184:187], a[112:115], v[204:207]
    ds_read_b128 a[168:171], v3 offset:26624
    v_exp_f32 v138, v138
    v_fmac_f32 v154, v9, v170
    v_mfma_f32_16x16x32_bf16 v[208:211], a[184:187], a[116:119], v[208:211]
    s_add_u32 s59, s32, 151552
    buffer_load_dwordx4 v[40:43], v3, s[8:11], s59 offen offset:0 sc1
    v_exp_f32 v139, v139
    v_fmac_f32 v155, v9, v171
    v_mfma_f32_16x16x32_bf16 v[212:215], a[188:191], a[112:115], v[212:215]
    ds_read_b128 a[172:175], v3 offset:27648
    v_add_f32 v128, 1.0, v128
    v_add_f32 v129, 1.0, v129
    v_mfma_f32_16x16x32_bf16 v[216:219], a[188:191], a[116:119], v[216:219]
    v_add_f32 v130, 1.0, v130
    v_add_f32 v131, 1.0, v131
    s_waitcnt lgkmcnt(4)
    v_mfma_f32_16x16x32_bf16 v[188:191], a[144:147], a[120:123], v[188:191]
    ds_read_b128 a[176:179], v3 offset:28672
    v_add_f32 v136, 1.0, v136
    v_add_f32 v137, 1.0, v137
    v_mfma_f32_16x16x32_bf16 v[192:195], a[144:147], a[124:127], v[192:195]
    v_add_f32 v138, 1.0, v138
    v_add_f32 v139, 1.0, v139
    v_mfma_f32_16x16x32_bf16 v[196:199], a[148:151], a[120:123], v[196:199]
    ds_read_b128 a[180:183], v3 offset:29696
    v_rcp_f32 v128, v128
    v_rcp_f32 v129, v129
    v_mfma_f32_16x16x32_bf16 v[200:203], a[148:151], a[124:127], v[200:203]
    v_rcp_f32 v130, v130
    v_rcp_f32 v131, v131
    v_mfma_f32_16x16x32_bf16 v[204:207], a[152:155], a[120:123], v[204:207]
    ds_read_b128 a[184:187], v3 offset:30720
    v_rcp_f32 v136, v136
    v_rcp_f32 v137, v137
    v_mfma_f32_16x16x32_bf16 v[208:211], a[152:155], a[124:127], v[208:211]
    s_add_u32 s59, s32, 4096
    buffer_load_dwordx4 v[44:47], v3, s[8:11], s59 offen offset:1024 sc1
    v_rcp_f32 v138, v138
    v_rcp_f32 v139, v139
    v_mfma_f32_16x16x32_bf16 v[212:215], a[156:159], a[120:123], v[212:215]
    ds_read_b128 a[188:191], v3 offset:31744
    v_mul_f32 v144, v128, v144
    v_mul_f32 v145, v129, v145
    v_mfma_f32_16x16x32_bf16 v[216:219], a[156:159], a[124:127], v[216:219]
    v_mul_f32 v146, v130, v146
    v_mul_f32 v147, v131, v147
    s_waitcnt lgkmcnt(4)
    v_mfma_f32_16x16x32_bf16 v[188:191], a[160:163], a[128:131], v[188:191]
    s_waitcnt vmcnt(21)
    s_barrier
    ds_read_b128 a[144:147], v3 offset:32768
    v_mul_f32 v152, v136, v152
    v_mul_f32 v153, v137, v153
    v_mfma_f32_16x16x32_bf16 v[192:195], a[160:163], a[132:135], v[192:195]
    s_add_u32 m0, s25, 0
    s_nop 0
    buffer_load_dwordx4 v3, s[8:11], s30 offen offset:0 sc1 lds
    v_mul_f32 v154, v138, v154
    v_mul_f32 v155, v139, v155
    v_mfma_f32_16x16x32_bf16 v[196:199], a[164:167], a[128:131], v[196:199]
    ds_read_b128 a[148:151], v3 offset:33792
    v_cvt_pk_bf16_f32 v20, v144, v145
    v_cvt_pk_bf16_f32 v21, v146, v147
    v_mfma_f32_16x16x32_bf16 v[200:203], a[164:167], a[132:135], v[200:203]
    buffer_load_dwordx4 v3, s[8:11], s30 offen offset:1024 sc1 lds
    v_cvt_pk_bf16_f32 v22, v152, v153
    v_cvt_pk_bf16_f32 v23, v154, v155
    v_mfma_f32_16x16x32_bf16 v[204:207], a[168:171], a[128:131], v[204:207]
    ds_read_b128 a[152:155], v3 offset:34816
    buffer_store_dwordx4 v[20:23], v14, s[8:11], s28 offen offset:3072 sc1
    v_mfma_f32_16x16x32_bf16 v[208:211], a[168:171], a[132:135], v[208:211]
    buffer_load_dwordx4 v3, s[8:11], s30 offen offset:2048 sc1 lds
    v_mfma_f32_16x16x32_bf16 v[212:215], a[172:175], a[128:131], v[212:215]
    ds_read_b128 a[156:159], v3 offset:35840
    v_mfma_f32_16x16x32_bf16 v[216:219], a[172:175], a[132:135], v[216:219]
    buffer_load_dwordx4 v3, s[8:11], s30 offen offset:3072 sc1 lds
    s_add_u32 s30, s30, 16384
    s_waitcnt lgkmcnt(4)
    v_mfma_f32_16x16x32_bf16 v[188:191], a[176:179], a[136:139], v[188:191]
    ds_read_b128 a[160:163], v3 offset:36864
    v_mfma_f32_16x16x32_bf16 v[192:195], a[176:179], a[140:143], v[192:195]
    v_mfma_f32_16x16x32_bf16 v[196:199], a[180:183], a[136:139], v[196:199]
    ds_read_b128 a[164:167], v3 offset:37888
    v_mfma_f32_16x16x32_bf16 v[200:203], a[180:183], a[140:143], v[200:203]
    v_mfma_f32_16x16x32_bf16 v[204:207], a[184:187], a[136:139], v[204:207]
    ds_read_b128 a[168:171], v3 offset:38912
    v_mfma_f32_16x16x32_bf16 v[208:211], a[184:187], a[140:143], v[208:211]
    s_add_u32 s59, s32, 40960
    buffer_load_dwordx4 v[48:51], v3, s[8:11], s59 offen offset:1024 sc1
    v_mfma_f32_16x16x32_bf16 v[212:215], a[188:191], a[136:139], v[212:215]
    ds_read_b128 a[172:175], v3 offset:39936
    v_mfma_f32_16x16x32_bf16 v[216:219], a[188:191], a[140:143], v[216:219]
    s_waitcnt lgkmcnt(4)
    v_mfma_f32_16x16x32_bf16 v[52:55], a[144:147], a[0:3], 0
    ds_read_b128 a[176:179], v3 offset:40960
    v_mfma_f32_16x16x32_bf16 v[56:59], a[144:147], a[4:7], 0
    v_mfma_f32_16x16x32_bf16 v[60:63], a[148:151], a[0:3], 0
    ds_read_b128 a[180:183], v3 offset:41984
    v_mfma_f32_16x16x32_bf16 v[64:67], a[148:151], a[4:7], 0
    ds_read_b128 v[156:159], v6 offset:1024
    v_mfma_f32_16x16x32_bf16 v[68:71], a[152:155], a[0:3], 0
    ds_read_b128 a[184:187], v3 offset:43008
    ds_read_b128 v[160:163], v6 offset:1088
    ds_read_b128 v[164:167], v6 offset:1152
    v_mfma_f32_16x16x32_bf16 v[72:75], a[152:155], a[4:7], 0
    s_add_u32 s59, s32, 77824
    buffer_load_dwordx4 v[84:87], v3, s[8:11], s59 offen offset:1024 sc1
    ds_read_b128 v[168:171], v6 offset:1216
    v_mul_f32 v240, v10, v240
    v_mfma_f32_16x16x32_bf16 v[76:79], a[156:159], a[0:3], 0
    ds_read_b128 a[188:191], v3 offset:44032
    v_mul_f32 v241, v10, v241
    v_mul_f32 v242, v10, v242
    v_mfma_f32_16x16x32_bf16 v[80:83], a[156:159], a[4:7], 0
    v_mul_f32 v243, v10, v243
    v_mul_f32 v248, v10, v248
    s_waitcnt lgkmcnt(8)
    v_mfma_f32_16x16x32_bf16 v[52:55], a[160:163], a[8:11], v[52:55]
    ds_read_b128 a[144:147], v3 offset:45056
    v_mul_f32 v249, v10, v249
    v_mul_f32 v250, v10, v250
    v_mfma_f32_16x16x32_bf16 v[56:59], a[160:163], a[12:15], v[56:59]
    v_mul_f32 v251, v10, v251
    s_waitcnt lgkmcnt(6)
    v_fmac_f32 v240, v12, v156
    v_mfma_f32_16x16x32_bf16 v[60:63], a[164:167], a[8:11], v[60:63]
    ds_read_b128 a[148:151], v3 offset:46080
    v_fmac_f32 v241, v12, v157
    v_fmac_f32 v242, v12, v158
    v_mfma_f32_16x16x32_bf16 v[64:67], a[164:167], a[12:15], v[64:67]
    v_fmac_f32 v243, v12, v159
    s_waitcnt lgkmcnt(5)
    v_fmac_f32 v248, v12, v160
    v_mfma_f32_16x16x32_bf16 v[68:71], a[168:171], a[8:11], v[68:71]
    ds_read_b128 a[152:155], v3 offset:47104
    v_fmac_f32 v249, v12, v161
    v_fmac_f32 v250, v12, v162
    v_mfma_f32_16x16x32_bf16 v[72:75], a[168:171], a[12:15], v[72:75]
    s_add_u32 s59, s32, 114688
    buffer_load_dwordx4 v[88:91], v3, s[8:11], s59 offen offset:1024 sc1
    v_fmac_f32 v251, v12, v163
    v_exp_f32 v240, v240
    v_mfma_f32_16x16x32_bf16 v[76:79], a[172:175], a[8:11], v[76:79]
    ds_read_b128 a[156:159], v3 offset:48128
    s_waitcnt lgkmcnt(6)
    v_fmac_f32 v172, v8, v164
    v_exp_f32 v241, v241
    v_mfma_f32_16x16x32_bf16 v[80:83], a[172:175], a[12:15], v[80:83]
    v_fmac_f32 v173, v8, v165
    v_exp_f32 v242, v242
    s_waitcnt lgkmcnt(4)
    v_mfma_f32_16x16x32_bf16 v[52:55], a[176:179], a[16:19], v[52:55]
    s_waitcnt vmcnt(19)
    s_barrier
    ds_read_b128 a[160:163], v4 offset:0
    v_fmac_f32 v174, v8, v166
    v_exp_f32 v243, v243
    v_mfma_f32_16x16x32_bf16 v[56:59], a[176:179], a[20:23], v[56:59]
    s_add_u32 m0, s25, 16384
    s_nop 0
    buffer_load_dwordx4 v3, s[8:11], s30 offen offset:0 sc1 lds
    v_fmac_f32 v175, v8, v167
    v_exp_f32 v248, v248
    v_mfma_f32_16x16x32_bf16 v[60:63], a[180:183], a[16:19], v[60:63]
    ds_read_b128 a[164:167], v4 offset:1024
    v_fmac_f32 v180, v8, v168
    v_exp_f32 v249, v249
    v_mfma_f32_16x16x32_bf16 v[64:67], a[180:183], a[20:23], v[64:67]
    buffer_load_dwordx4 v3, s[8:11], s30 offen offset:1024 sc1 lds
    v_fmac_f32 v181, v8, v169
    v_exp_f32 v250, v250
    v_mfma_f32_16x16x32_bf16 v[68:71], a[184:187], a[16:19], v[68:71]
    ds_read_b128 a[168:171], v4 offset:2048
    v_fmac_f32 v182, v8, v170
    v_exp_f32 v251, v251
    v_mfma_f32_16x16x32_bf16 v[72:75], a[184:187], a[20:23], v[72:75]
    buffer_load_dwordx4 v3, s[8:11], s30 offen offset:2048 sc1 lds
    v_fmac_f32 v183, v8, v171
    v_add_f32 v240, 1.0, v240
    v_mfma_f32_16x16x32_bf16 v[76:79], a[188:191], a[16:19], v[76:79]
    ds_read_b128 a[172:175], v4 offset:3072
    v_add_f32 v241, 1.0, v241
    v_add_f32 v242, 1.0, v242
    v_mfma_f32_16x16x32_bf16 v[80:83], a[188:191], a[20:23], v[80:83]
    buffer_load_dwordx4 v3, s[8:11], s30 offen offset:3072 sc1 lds
    s_add_u32 s30, s30, 16384
    v_add_f32 v243, 1.0, v243
    v_add_f32 v248, 1.0, v248
    s_waitcnt lgkmcnt(4)
    v_mfma_f32_16x16x32_bf16 v[52:55], a[144:147], a[24:27], v[52:55]
    ds_read_b128 a[176:179], v4 offset:4096
    v_add_f32 v249, 1.0, v249
    v_mfma_f32_16x16x32_bf16 v[56:59], a[144:147], a[28:31], v[56:59]
    v_add_f32 v250, 1.0, v250
    v_add_f32 v251, 1.0, v251
    v_mfma_f32_16x16x32_bf16 v[60:63], a[148:151], a[24:27], v[60:63]
    ds_read_b128 a[180:183], v4 offset:5120
    v_rcp_f32 v240, v240
    v_rcp_f32 v241, v241
    v_mfma_f32_16x16x32_bf16 v[64:67], a[148:151], a[28:31], v[64:67]
    v_rcp_f32 v242, v242
    v_rcp_f32 v243, v243
    v_mfma_f32_16x16x32_bf16 v[68:71], a[152:155], a[24:27], v[68:71]
    ds_read_b128 a[184:187], v4 offset:6144
    v_rcp_f32 v248, v248
    v_rcp_f32 v249, v249
    v_mfma_f32_16x16x32_bf16 v[72:75], a[152:155], a[28:31], v[72:75]
    s_add_u32 s59, s32, 151552
    buffer_load_dwordx4 v[92:95], v3, s[8:11], s59 offen offset:1024 sc1
    v_rcp_f32 v250, v250
    v_rcp_f32 v251, v251
    v_mfma_f32_16x16x32_bf16 v[76:79], a[156:159], a[24:27], v[76:79]
    ds_read_b128 a[188:191], v4 offset:7168
    v_mul_f32 v172, v240, v172
    v_mul_f32 v173, v241, v173
    v_mfma_f32_16x16x32_bf16 v[80:83], a[156:159], a[28:31], v[80:83]
    v_mul_f32 v174, v242, v174
    v_mul_f32 v175, v243, v175
    s_waitcnt lgkmcnt(4)
    v_mfma_f32_16x16x32_bf16 v[52:55], a[160:163], a[32:35], v[52:55]
    ds_read_b128 a[144:147], v4 offset:8192
    v_mul_f32 v180, v248, v180
    v_mul_f32 v181, v249, v181
    v_mfma_f32_16x16x32_bf16 v[56:59], a[160:163], a[36:39], v[56:59]
    v_mul_f32 v182, v250, v182
    v_mul_f32 v183, v251, v183
    v_mfma_f32_16x16x32_bf16 v[60:63], a[164:167], a[32:35], v[60:63]
    ds_read_b128 a[148:151], v4 offset:9216
    v_cvt_pk_bf16_f32 v16, v172, v173
    v_cvt_pk_bf16_f32 v17, v174, v175
    v_mfma_f32_16x16x32_bf16 v[64:67], a[164:167], a[36:39], v[64:67]
    v_cvt_pk_bf16_f32 v18, v180, v181
    v_cvt_pk_bf16_f32 v19, v182, v183
    v_mfma_f32_16x16x32_bf16 v[68:71], a[168:171], a[32:35], v[68:71]
    ds_read_b128 a[152:155], v4 offset:10240
    s_add_u32 s28, s28, 4096
    buffer_store_dwordx4 v[16:19], v3, s[8:11], s28 offen offset:0 sc1
    v_mul_f32 v244, v11, v244
    v_mfma_f32_16x16x32_bf16 v[72:75], a[168:171], a[36:39], v[72:75]
    s_add_u32 s59, s32, 4096
    buffer_load_dwordx4 v[96:99], v3, s[8:11], s59 offen offset:2048 sc1
    v_mul_f32 v245, v11, v245
    v_mul_f32 v246, v11, v246
    v_mfma_f32_16x16x32_bf16 v[76:79], a[172:175], a[32:35], v[76:79]
    ds_read_b128 a[156:159], v4 offset:11264
    v_mul_f32 v247, v11, v247
    v_mul_f32 v252, v11, v252
    v_mfma_f32_16x16x32_bf16 v[80:83], a[172:175], a[36:39], v[80:83]
    v_mul_f32 v253, v11, v253
    v_mul_f32 v254, v11, v254
    s_waitcnt lgkmcnt(4)
    v_mfma_f32_16x16x32_bf16 v[52:55], a[176:179], a[40:43], v[52:55]
    ds_read_b128 a[160:163], v4 offset:12288
    v_mul_f32 v255, v11, v255
    v_fmac_f32 v244, v13, v156
    v_mfma_f32_16x16x32_bf16 v[56:59], a[176:179], a[44:47], v[56:59]
    v_fmac_f32 v245, v13, v157
    v_fmac_f32 v246, v13, v158
    v_mfma_f32_16x16x32_bf16 v[60:63], a[180:183], a[40:43], v[60:63]
    ds_read_b128 a[164:167], v4 offset:13312
    v_fmac_f32 v247, v13, v159
    v_fmac_f32 v252, v13, v160
    v_mfma_f32_16x16x32_bf16 v[64:67], a[180:183], a[44:47], v[64:67]
    v_fmac_f32 v253, v13, v161
    v_fmac_f32 v254, v13, v162
    v_mfma_f32_16x16x32_bf16 v[68:71], a[184:187], a[40:43], v[68:71]
    ds_read_b128 a[168:171], v4 offset:14336
    v_fmac_f32 v255, v13, v163
    v_exp_f32 v244, v244
    v_mfma_f32_16x16x32_bf16 v[72:75], a[184:187], a[44:47], v[72:75]
    s_add_u32 s59, s32, 40960
    buffer_load_dwordx4 v[100:103], v3, s[8:11], s59 offen offset:2048 sc1
    v_fmac_f32 v176, v9, v164
    v_exp_f32 v245, v245
    v_mfma_f32_16x16x32_bf16 v[76:79], a[188:191], a[40:43], v[76:79]
    ds_read_b128 a[172:175], v4 offset:15360
    v_fmac_f32 v177, v9, v165
    v_mfma_f32_16x16x32_bf16 v[80:83], a[188:191], a[44:47], v[80:83]
    v_exp_f32 v246, v246
    v_fmac_f32 v178, v9, v166
    s_waitcnt lgkmcnt(4)
    v_mfma_f32_16x16x32_bf16 v[52:55], a[144:147], a[48:51], v[52:55]
    s_waitcnt vmcnt(19)
    s_barrier
    ds_read_b128 a[176:179], v4 offset:16384
    v_exp_f32 v247, v247
    v_fmac_f32 v179, v9, v167
    v_mfma_f32_16x16x32_bf16 v[56:59], a[144:147], a[52:55], v[56:59]
    s_add_u32 m0, s25, 32768
    s_nop 0
    buffer_load_dwordx4 v3, s[8:11], s30 offen offset:0 sc1 lds
    v_exp_f32 v252, v252
    v_fmac_f32 v184, v9, v168
    v_mfma_f32_16x16x32_bf16 v[60:63], a[148:151], a[48:51], v[60:63]
    ds_read_b128 a[180:183], v4 offset:17408
    v_exp_f32 v253, v253
    v_fmac_f32 v185, v9, v169
    v_mfma_f32_16x16x32_bf16 v[64:67], a[148:151], a[52:55], v[64:67]
    buffer_load_dwordx4 v3, s[8:11], s30 offen offset:1024 sc1 lds
    v_exp_f32 v254, v254
    v_fmac_f32 v186, v9, v170
    v_mfma_f32_16x16x32_bf16 v[68:71], a[152:155], a[48:51], v[68:71]
    ds_read_b128 a[184:187], v4 offset:18432
    v_exp_f32 v255, v255
    v_fmac_f32 v187, v9, v171
    v_mfma_f32_16x16x32_bf16 v[72:75], a[152:155], a[52:55], v[72:75]
    buffer_load_dwordx4 v3, s[8:11], s30 offen offset:2048 sc1 lds
    v_add_f32 v244, 1.0, v244
    v_add_f32 v245, 1.0, v245
    v_mfma_f32_16x16x32_bf16 v[76:79], a[156:159], a[48:51], v[76:79]
    ds_read_b128 a[188:191], v4 offset:19456
    v_add_f32 v246, 1.0, v246
    v_add_f32 v247, 1.0, v247
    v_mfma_f32_16x16x32_bf16 v[80:83], a[156:159], a[52:55], v[80:83]
    buffer_load_dwordx4 v3, s[8:11], s30 offen offset:3072 sc1 lds
    s_add_u32 s30, s30, 16384
    v_add_f32 v252, 1.0, v252
    v_add_f32 v253, 1.0, v253
    s_waitcnt lgkmcnt(4)
    v_mfma_f32_16x16x32_bf16 v[52:55], a[160:163], a[56:59], v[52:55]
    ds_read_b128 a[144:147], v4 offset:20480
    v_add_f32 v254, 1.0, v254
    v_add_f32 v255, 1.0, v255
    v_mfma_f32_16x16x32_bf16 v[56:59], a[160:163], a[60:63], v[56:59]
    v_rcp_f32 v244, v244
    v_rcp_f32 v245, v245
    v_mfma_f32_16x16x32_bf16 v[60:63], a[164:167], a[56:59], v[60:63]
    ds_read_b128 a[148:151], v4 offset:21504
    v_rcp_f32 v246, v246
    v_rcp_f32 v247, v247
    v_mfma_f32_16x16x32_bf16 v[64:67], a[164:167], a[60:63], v[64:67]
    v_rcp_f32 v252, v252
    v_rcp_f32 v253, v253
    v_mfma_f32_16x16x32_bf16 v[68:71], a[168:171], a[56:59], v[68:71]
    ds_read_b128 a[152:155], v4 offset:22528
    v_rcp_f32 v254, v254
    v_rcp_f32 v255, v255
    v_mfma_f32_16x16x32_bf16 v[72:75], a[168:171], a[60:63], v[72:75]
    s_add_u32 s59, s32, 77824
    buffer_load_dwordx4 v[104:107], v3, s[8:11], s59 offen offset:2048 sc1
    v_mul_f32 v176, v244, v176
    v_mul_f32 v177, v245, v177
    v_mfma_f32_16x16x32_bf16 v[76:79], a[172:175], a[56:59], v[76:79]
    ds_read_b128 a[156:159], v4 offset:23552
    v_mul_f32 v178, v246, v178
    v_mul_f32 v179, v247, v179
    v_mfma_f32_16x16x32_bf16 v[80:83], a[172:175], a[60:63], v[80:83]
    v_mul_f32 v184, v252, v184
    v_mul_f32 v185, v253, v185
    s_waitcnt lgkmcnt(4)
    v_mfma_f32_16x16x32_bf16 v[52:55], a[176:179], a[64:67], v[52:55]
    ds_read_b128 a[160:163], v4 offset:24576
    v_mul_f32 v186, v254, v186
    v_mul_f32 v187, v255, v187
    v_mfma_f32_16x16x32_bf16 v[56:59], a[176:179], a[68:71], v[56:59]
    v_cvt_pk_bf16_f32 v20, v176, v177
    v_cvt_pk_bf16_f32 v21, v178, v179
    v_mfma_f32_16x16x32_bf16 v[60:63], a[180:183], a[64:67], v[60:63]
    ds_read_b128 a[164:167], v4 offset:25600
    v_cvt_pk_bf16_f32 v22, v184, v185
    v_cvt_pk_bf16_f32 v23, v186, v187
    v_mfma_f32_16x16x32_bf16 v[64:67], a[180:183], a[68:71], v[64:67]
    buffer_store_dwordx4 v[20:23], v14, s[8:11], s28 offen offset:0 sc1
    v_mfma_f32_16x16x32_bf16 v[68:71], a[184:187], a[64:67], v[68:71]
    ds_read_b128 a[168:171], v4 offset:26624
    ds_read_b128 v[156:159], v6 offset:1280
    v_mfma_f32_16x16x32_bf16 v[72:75], a[184:187], a[68:71], v[72:75]
    s_add_u32 s59, s32, 114688
    buffer_load_dwordx4 v[108:111], v3, s[8:11], s59 offen offset:2048 sc1
    ds_read_b128 v[160:163], v6 offset:1344
    ds_read_b128 v[164:167], v6 offset:1408
    v_mfma_f32_16x16x32_bf16 v[76:79], a[188:191], a[64:67], v[76:79]
    ds_read_b128 a[172:175], v4 offset:27648
    ds_read_b128 v[168:171], v6 offset:1472
    v_mul_f32 v188, v10, v188
    v_mfma_f32_16x16x32_bf16 v[80:83], a[188:191], a[68:71], v[80:83]
    v_mul_f32 v189, v10, v189
    v_mul_f32 v190, v10, v190
    s_waitcnt lgkmcnt(8)
    v_mfma_f32_16x16x32_bf16 v[52:55], a[144:147], a[72:75], v[52:55]
    ds_read_b128 a[176:179], v4 offset:28672
    v_mul_f32 v191, v10, v191
    v_mul_f32 v196, v10, v196
    v_mfma_f32_16x16x32_bf16 v[56:59], a[144:147], a[76:79], v[56:59]
    v_mul_f32 v197, v10, v197
    v_mul_f32 v198, v10, v198
    v_mfma_f32_16x16x32_bf16 v[60:63], a[148:151], a[72:75], v[60:63]
    ds_read_b128 a[180:183], v4 offset:29696
    v_mul_f32 v199, v10, v199
    s_waitcnt lgkmcnt(6)
    v_fmac_f32 v188, v12, v156
    v_mfma_f32_16x16x32_bf16 v[64:67], a[148:151], a[76:79], v[64:67]
    v_fmac_f32 v189, v12, v157
    v_fmac_f32 v190, v12, v158
    v_mfma_f32_16x16x32_bf16 v[68:71], a[152:155], a[72:75], v[68:71]
    ds_read_b128 a[184:187], v4 offset:30720
    v_fmac_f32 v191, v12, v159
    s_waitcnt lgkmcnt(6)
    v_fmac_f32 v196, v12, v160
    v_mfma_f32_16x16x32_bf16 v[72:75], a[152:155], a[76:79], v[72:75]
    s_add_u32 s59, s32, 151552
    buffer_load_dwordx4 v[112:115], v3, s[8:11], s59 offen offset:2048 sc1
    v_fmac_f32 v197, v12, v161
    v_fmac_f32 v198, v12, v162
    v_mfma_f32_16x16x32_bf16 v[76:79], a[156:159], a[72:75], v[76:79]
    ds_read_b128 a[188:191], v4 offset:31744
    v_fmac_f32 v199, v12, v163
    v_exp_f32 v188, v188
    v_mfma_f32_16x16x32_bf16 v[80:83], a[156:159], a[76:79], v[80:83]
    s_waitcnt lgkmcnt(6)
    v_fmac_f32 v204, v8, v164
    v_exp_f32 v189, v189
    s_waitcnt lgkmcnt(5)
    v_mfma_f32_16x16x32_bf16 v[52:55], a[160:163], a[80:83], v[52:55]
    s_waitcnt vmcnt(19)
    s_barrier
    ds_read_b128 a[144:147], v3 offset:0
    v_fmac_f32 v205, v8, v165
    v_exp_f32 v190, v190
    v_mfma_f32_16x16x32_bf16 v[56:59], a[160:163], a[84:87], v[56:59]
    s_add_u32 m0, s25, 49152
    s_nop 0
    buffer_load_dwordx4 v3, s[8:11], s30 offen offset:0 sc1 lds
    v_fmac_f32 v206, v8, v166
    v_exp_f32 v191, v191
    v_mfma_f32_16x16x32_bf16 v[60:63], a[164:167], a[80:83], v[60:63]
    ds_read_b128 a[148:151], v3 offset:1024
    v_fmac_f32 v207, v8, v167
    v_exp_f32 v196, v196
    v_mfma_f32_16x16x32_bf16 v[64:67], a[164:167], a[84:87], v[64:67]
    buffer_load_dwordx4 v3, s[8:11], s30 offen offset:1024 sc1 lds
    s_waitcnt lgkmcnt(6)
    v_fmac_f32 v212, v8, v168
    v_exp_f32 v197, v197
    v_mfma_f32_16x16x32_bf16 v[68:71], a[168:171], a[80:83], v[68:71]
    ds_read_b128 a[152:155], v3 offset:2048
    v_fmac_f32 v213, v8, v169
    v_exp_f32 v198, v198
    v_mfma_f32_16x16x32_bf16 v[72:75], a[168:171], a[84:87], v[72:75]
    buffer_load_dwordx4 v3, s[8:11], s30 offen offset:2048 sc1 lds
    v_fmac_f32 v214, v8, v170
    v_exp_f32 v199, v199
    v_mfma_f32_16x16x32_bf16 v[76:79], a[172:175], a[80:83], v[76:79]
    ds_read_b128 a[156:159], v3 offset:3072
    v_fmac_f32 v215, v8, v171
    v_add_f32 v188, 1.0, v188
    v_mfma_f32_16x16x32_bf16 v[80:83], a[172:175], a[84:87], v[80:83]
    buffer_load_dwordx4 v3, s[8:11], s30 offen offset:3072 sc1 lds
    s_add_u32 s30, s30, 16384
    v_add_f32 v189, 1.0, v189
    v_add_f32 v190, 1.0, v190
    s_waitcnt lgkmcnt(4)
    v_mfma_f32_16x16x32_bf16 v[52:55], a[176:179], a[88:91], v[52:55]
    ds_read_b128 a[160:163], v3 offset:4096
    v_add_f32 v191, 1.0, v191
    v_add_f32 v196, 1.0, v196
    v_mfma_f32_16x16x32_bf16 v[56:59], a[176:179], a[92:95], v[56:59]
    v_add_f32 v197, 1.0, v197
    v_mfma_f32_16x16x32_bf16 v[60:63], a[180:183], a[88:91], v[60:63]
    ds_read_b128 a[164:167], v3 offset:5120
    v_add_f32 v198, 1.0, v198
    v_add_f32 v199, 1.0, v199
    v_mfma_f32_16x16x32_bf16 v[64:67], a[180:183], a[92:95], v[64:67]
    v_rcp_f32 v188, v188
    v_rcp_f32 v189, v189
    v_mfma_f32_16x16x32_bf16 v[68:71], a[184:187], a[88:91], v[68:71]
    ds_read_b128 a[168:171], v3 offset:6144
    v_rcp_f32 v190, v190
    v_rcp_f32 v191, v191
    v_mfma_f32_16x16x32_bf16 v[72:75], a[184:187], a[92:95], v[72:75]
    s_add_u32 s59, s32, 4096
    buffer_load_dwordx4 v[116:119], v3, s[8:11], s59 offen offset:3072 sc1
    v_rcp_f32 v196, v196
    v_rcp_f32 v197, v197
    v_mfma_f32_16x16x32_bf16 v[76:79], a[188:191], a[88:91], v[76:79]
    ds_read_b128 a[172:175], v3 offset:7168
    v_rcp_f32 v198, v198
    v_rcp_f32 v199, v199
    v_mfma_f32_16x16x32_bf16 v[80:83], a[188:191], a[92:95], v[80:83]
    v_mul_f32 v204, v188, v204
    v_mul_f32 v205, v189, v205
    s_waitcnt lgkmcnt(4)
    v_mfma_f32_16x16x32_bf16 v[52:55], a[144:147], a[96:99], v[52:55]
    ds_read_b128 a[176:179], v3 offset:8192
    v_mul_f32 v206, v190, v206
    v_mul_f32 v207, v191, v207
    v_mfma_f32_16x16x32_bf16 v[56:59], a[144:147], a[100:103], v[56:59]
    v_mul_f32 v212, v196, v212
    v_mul_f32 v213, v197, v213
    v_mfma_f32_16x16x32_bf16 v[60:63], a[148:151], a[96:99], v[60:63]
    ds_read_b128 a[180:183], v3 offset:9216
    v_mul_f32 v214, v198, v214
    v_mul_f32 v215, v199, v215
    v_mfma_f32_16x16x32_bf16 v[64:67], a[148:151], a[100:103], v[64:67]
    v_cvt_pk_bf16_f32 v16, v204, v205
    v_cvt_pk_bf16_f32 v17, v206, v207
    v_mfma_f32_16x16x32_bf16 v[68:71], a[152:155], a[96:99], v[68:71]
    ds_read_b128 a[184:187], v3 offset:10240
    v_cvt_pk_bf16_f32 v18, v212, v213
    v_cvt_pk_bf16_f32 v19, v214, v215
    v_mfma_f32_16x16x32_bf16 v[72:75], a[152:155], a[100:103], v[72:75]
    s_add_u32 s59, s32, 40960
    buffer_load_dwordx4 v[120:123], v3, s[8:11], s59 offen offset:3072 sc1
    buffer_store_dwordx4 v[16:19], v3, s[8:11], s28 offen offset:1024 sc1
    v_mul_f32 v192, v11, v192
    v_mfma_f32_16x16x32_bf16 v[76:79], a[156:159], a[96:99], v[76:79]
    ds_read_b128 a[188:191], v3 offset:11264
    v_mul_f32 v193, v11, v193
    v_mul_f32 v194, v11, v194
    v_mfma_f32_16x16x32_bf16 v[80:83], a[156:159], a[100:103], v[80:83]
    v_mul_f32 v195, v11, v195
    v_mul_f32 v200, v11, v200
    s_waitcnt lgkmcnt(4)
    v_mfma_f32_16x16x32_bf16 v[52:55], a[160:163], a[104:107], v[52:55]
    ds_read_b128 a[144:147], v3 offset:12288
    v_mul_f32 v201, v11, v201
    v_mul_f32 v202, v11, v202
    v_mfma_f32_16x16x32_bf16 v[56:59], a[160:163], a[108:111], v[56:59]
    v_mul_f32 v203, v11, v203
    v_fmac_f32 v192, v13, v156
    v_mfma_f32_16x16x32_bf16 v[60:63], a[164:167], a[104:107], v[60:63]
    ds_read_b128 a[148:151], v3 offset:13312
    v_fmac_f32 v193, v13, v157
    v_fmac_f32 v194, v13, v158
    v_mfma_f32_16x16x32_bf16 v[64:67], a[164:167], a[108:111], v[64:67]
    v_fmac_f32 v195, v13, v159
    v_fmac_f32 v200, v13, v160
    v_mfma_f32_16x16x32_bf16 v[68:71], a[168:171], a[104:107], v[68:71]
    ds_read_b128 a[152:155], v3 offset:14336
    v_fmac_f32 v201, v13, v161
    v_fmac_f32 v202, v13, v162
    v_mfma_f32_16x16x32_bf16 v[72:75], a[168:171], a[108:111], v[72:75]
    s_add_u32 s59, s32, 77824
    buffer_load_dwordx4 v[124:127], v3, s[8:11], s59 offen offset:3072 sc1
    v_fmac_f32 v203, v13, v163
    v_exp_f32 v192, v192
    v_mfma_f32_16x16x32_bf16 v[76:79], a[172:175], a[104:107], v[76:79]
    ds_read_b128 a[156:159], v3 offset:15360
    v_fmac_f32 v208, v9, v164
    v_exp_f32 v193, v193
    v_mfma_f32_16x16x32_bf16 v[80:83], a[172:175], a[108:111], v[80:83]
    v_fmac_f32 v209, v9, v165
    s_waitcnt lgkmcnt(4)
    v_mfma_f32_16x16x32_bf16 v[52:55], a[176:179], a[112:115], v[52:55]
    s_waitcnt vmcnt(20)
    s_barrier
    ds_read_b128 a[160:163], v3 offset:16384
    v_exp_f32 v194, v194
    v_fmac_f32 v210, v9, v166
    v_mfma_f32_16x16x32_bf16 v[56:59], a[176:179], a[116:119], v[56:59]
    s_add_u32 m0, s25, 65536
    s_nop 0
    buffer_load_dwordx4 v3, s[8:11], s30 offen offset:0 sc1 lds
    v_exp_f32 v195, v195
    v_fmac_f32 v211, v9, v167
    v_mfma_f32_16x16x32_bf16 v[60:63], a[180:183], a[112:115], v[60:63]
    ds_read_b128 a[164:167], v3 offset:17408
    v_exp_f32 v200, v200
    v_fmac_f32 v216, v9, v168
    v_mfma_f32_16x16x32_bf16 v[64:67], a[180:183], a[116:119], v[64:67]
    buffer_load_dwordx4 v3, s[8:11], s30 offen offset:1024 sc1 lds
    v_exp_f32 v201, v201
    v_fmac_f32 v217, v9, v169
    v_mfma_f32_16x16x32_bf16 v[68:71], a[184:187], a[112:115], v[68:71]
    ds_read_b128 a[168:171], v3 offset:18432
    v_exp_f32 v202, v202
    v_fmac_f32 v218, v9, v170
    v_mfma_f32_16x16x32_bf16 v[72:75], a[184:187], a[116:119], v[72:75]
    buffer_load_dwordx4 v3, s[8:11], s30 offen offset:2048 sc1 lds
    v_exp_f32 v203, v203
    v_fmac_f32 v219, v9, v171
    v_mfma_f32_16x16x32_bf16 v[76:79], a[188:191], a[112:115], v[76:79]
    ds_read_b128 a[172:175], v3 offset:19456
    v_add_f32 v192, 1.0, v192
    v_add_f32 v193, 1.0, v193
    v_mfma_f32_16x16x32_bf16 v[80:83], a[188:191], a[116:119], v[80:83]
    buffer_load_dwordx4 v3, s[8:11], s30 offen offset:3072 sc1 lds
    s_add_u32 s30, s30, 16384
    v_add_f32 v194, 1.0, v194
    v_add_f32 v195, 1.0, v195
    s_waitcnt lgkmcnt(4)
    v_mfma_f32_16x16x32_bf16 v[52:55], a[144:147], a[120:123], v[52:55]
    ds_read_b128 a[176:179], v3 offset:20480
    v_add_f32 v200, 1.0, v200
    v_add_f32 v201, 1.0, v201
    v_mfma_f32_16x16x32_bf16 v[56:59], a[144:147], a[124:127], v[56:59]
    v_add_f32 v202, 1.0, v202
    v_add_f32 v203, 1.0, v203
    v_mfma_f32_16x16x32_bf16 v[60:63], a[148:151], a[120:123], v[60:63]
    ds_read_b128 a[180:183], v3 offset:21504
    v_rcp_f32 v192, v192
    v_rcp_f32 v193, v193
    v_mfma_f32_16x16x32_bf16 v[64:67], a[148:151], a[124:127], v[64:67]
    v_rcp_f32 v194, v194
    v_rcp_f32 v195, v195
    v_mfma_f32_16x16x32_bf16 v[68:71], a[152:155], a[120:123], v[68:71]
    ds_read_b128 a[184:187], v3 offset:22528
    v_rcp_f32 v200, v200
    v_rcp_f32 v201, v201
    v_mfma_f32_16x16x32_bf16 v[72:75], a[152:155], a[124:127], v[72:75]
    s_add_u32 s59, s32, 114688
    buffer_load_dwordx4 v[128:131], v3, s[8:11], s59 offen offset:3072 sc1
    v_rcp_f32 v202, v202
    v_rcp_f32 v203, v203
    v_mfma_f32_16x16x32_bf16 v[76:79], a[156:159], a[120:123], v[76:79]
    ds_read_b128 a[188:191], v3 offset:23552
    v_mul_f32 v208, v192, v208
    v_mul_f32 v209, v193, v209
    v_mfma_f32_16x16x32_bf16 v[80:83], a[156:159], a[124:127], v[80:83]
    v_mul_f32 v210, v194, v210
    v_mul_f32 v211, v195, v211
    s_waitcnt lgkmcnt(4)
    v_mfma_f32_16x16x32_bf16 v[52:55], a[160:163], a[128:131], v[52:55]
    ds_read_b128 a[144:147], v3 offset:24576
    v_mul_f32 v216, v200, v216
    v_mul_f32 v217, v201, v217
    v_mfma_f32_16x16x32_bf16 v[56:59], a[160:163], a[132:135], v[56:59]
    v_mul_f32 v218, v202, v218
    v_mul_f32 v219, v203, v219
    v_mfma_f32_16x16x32_bf16 v[60:63], a[164:167], a[128:131], v[60:63]
    ds_read_b128 a[148:151], v3 offset:25600
    v_cvt_pk_bf16_f32 v20, v208, v209
    v_cvt_pk_bf16_f32 v21, v210, v211
    v_mfma_f32_16x16x32_bf16 v[64:67], a[164:167], a[132:135], v[64:67]
    v_cvt_pk_bf16_f32 v22, v216, v217
    v_cvt_pk_bf16_f32 v23, v218, v219
    v_mfma_f32_16x16x32_bf16 v[68:71], a[168:171], a[128:131], v[68:71]
    ds_read_b128 a[152:155], v3 offset:26624
    buffer_store_dwordx4 v[20:23], v14, s[8:11], s28 offen offset:1024 sc1
    v_mfma_f32_16x16x32_bf16 v[72:75], a[168:171], a[132:135], v[72:75]
    s_add_u32 s59, s32, 151552
    buffer_load_dwordx4 v[132:135], v3, s[8:11], s59 offen offset:3072 sc1
    v_mfma_f32_16x16x32_bf16 v[76:79], a[172:175], a[128:131], v[76:79]
    ds_read_b128 a[156:159], v3 offset:27648
    v_mfma_f32_16x16x32_bf16 v[80:83], a[172:175], a[132:135], v[80:83]
    s_waitcnt lgkmcnt(4)
    v_mfma_f32_16x16x32_bf16 v[52:55], a[176:179], a[136:139], v[52:55]
    ds_read_b128 a[160:163], v3 offset:28672
    v_mfma_f32_16x16x32_bf16 v[56:59], a[176:179], a[140:143], v[56:59]
    v_mfma_f32_16x16x32_bf16 v[60:63], a[180:183], a[136:139], v[60:63]
    ds_read_b128 a[164:167], v3 offset:29696
    v_mfma_f32_16x16x32_bf16 v[64:67], a[180:183], a[140:143], v[64:67]
    v_mfma_f32_16x16x32_bf16 v[68:71], a[184:187], a[136:139], v[68:71]
    ds_read_b128 a[168:171], v3 offset:30720
    v_mfma_f32_16x16x32_bf16 v[72:75], a[184:187], a[140:143], v[72:75]
    s_add_u32 s59, s32, 8192
    buffer_load_dwordx4 v[136:139], v3, s[8:11], s59 offen offset:0 sc1
    v_mfma_f32_16x16x32_bf16 v[76:79], a[188:191], a[136:139], v[76:79]
    ds_read_b128 a[172:175], v3 offset:31744
    v_mfma_f32_16x16x32_bf16 v[80:83], a[188:191], a[140:143], v[80:83]
    s_waitcnt lgkmcnt(4)
    v_mfma_f32_16x16x32_bf16 v[140:143], a[144:147], a[0:3], 0
    s_waitcnt vmcnt(20)
    s_barrier
    ds_read_b128 a[176:179], v3 offset:32768
    v_mfma_f32_16x16x32_bf16 v[144:147], a[144:147], a[4:7], 0
    s_add_u32 m0, s25, 0
    s_nop 0
    buffer_load_dwordx4 v3, s[8:11], s30 offen offset:0 sc1 lds
    v_mfma_f32_16x16x32_bf16 v[148:151], a[148:151], a[0:3], 0
    ds_read_b128 a[180:183], v3 offset:33792
    v_mfma_f32_16x16x32_bf16 v[152:155], a[148:151], a[4:7], 0
    buffer_load_dwordx4 v3, s[8:11], s30 offen offset:1024 sc1 lds
    ds_read_b128 v[156:159], v6 offset:1536
    v_mfma_f32_16x16x32_bf16 v[240:243], a[152:155], a[0:3], 0
    ds_read_b128 a[184:187], v3 offset:34816
    ds_read_b128 v[160:163], v6 offset:1600
    v_mfma_f32_16x16x32_bf16 v[244:247], a[152:155], a[4:7], 0
    buffer_load_dwordx4 v3, s[8:11], s30 offen offset:2048 sc1 lds
    ds_read_b128 v[164:167], v6 offset:1664
    ds_read_b128 v[168:171], v6 offset:1728
    v_mfma_f32_16x16x32_bf16 v[248:251], a[156:159], a[0:3], 0
    ds_read_b128 a[188:191], v3 offset:35840
    v_mul_f32 v52, v10, v52
    v_mfma_f32_16x16x32_bf16 v[252:255], a[156:159], a[4:7], 0
    buffer_load_dwordx4 v3, s[8:11], s30 offen offset:3072 sc1 lds
    s_add_u32 s30, s30, 16384
    v_mul_f32 v53, v10, v53
    v_mul_f32 v54, v10, v54
    s_waitcnt lgkmcnt(8)
    v_mfma_f32_16x16x32_bf16 v[140:143], a[160:163], a[8:11], v[140:143]
    ds_read_b128 a[144:147], v3 offset:36864
    v_mul_f32 v55, v10, v55
    v_mfma_f32_16x16x32_bf16 v[144:147], a[160:163], a[12:15], v[144:147]
    v_mul_f32 v60, v10, v60
    v_mfma_f32_16x16x32_bf16 v[148:151], a[164:167], a[8:11], v[148:151]
    ds_read_b128 a[148:151], v3 offset:37888
    v_mul_f32 v61, v10, v61
    v_mul_f32 v62, v10, v62
    v_mfma_f32_16x16x32_bf16 v[152:155], a[164:167], a[12:15], v[152:155]
    v_mul_f32 v63, v10, v63
    v_mfma_f32_16x16x32_bf16 v[240:243], a[168:171], a[8:11], v[240:243]
    ds_read_b128 a[152:155], v3 offset:38912
    s_waitcnt lgkmcnt(8)
    v_fmac_f32 v52, v12, v156
    v_fmac_f32 v53, v12, v157
    v_mfma_f32_16x16x32_bf16 v[244:247], a[168:171], a[12:15], v[244:247]
    s_add_u32 s59, s32, 45056
    buffer_load_dwordx4 v[172:175], v3, s[8:11], s59 offen offset:0 sc1
    v_fmac_f32 v54, v12, v158
    v_mfma_f32_16x16x32_bf16 v[248:251], a[172:175], a[8:11], v[248:251]
    ds_read_b128 a[156:159], v3 offset:39936
    v_fmac_f32 v55, v12, v159
    v_mfma_f32_16x16x32_bf16 v[252:255], a[172:175], a[12:15], v[252:255]
    s_waitcnt lgkmcnt(7)
    v_fmac_f32 v60, v12, v160
    v_fmac_f32 v61, v12, v161
    s_waitcnt lgkmcnt(4)
    v_mfma_f32_16x16x32_bf16 v[140:143], a[176:179], a[16:19], v[140:143]
    ds_read_b128 a[160:163], v3 offset:40960
    v_fmac_f32 v62, v12, v162
    v_mfma_f32_16x16x32_bf16 v[144:147], a[176:179], a[20:23], v[144:147]
    v_fmac_f32 v63, v12, v163
    v_exp_f32 v52, v52
    v_mfma_f32_16x16x32_bf16 v[148:151], a[180:183], a[16:19], v[148:151]
    ds_read_b128 a[164:167], v3 offset:41984
    v_fmac_f32 v68, v8, v164
    v_mfma_f32_16x16x32_bf16 v[152:155], a[180:183], a[20:23], v[152:155]
    v_exp_f32 v53, v53
    v_mfma_f32_16x16x32_bf16 v[240:243], a[184:187], a[16:19], v[240:243]
    ds_read_b128 a[168:171], v3 offset:43008
    v_fmac_f32 v69, v8, v165
    v_exp_f32 v54, v54
    v_mfma_f32_16x16x32_bf16 v[244:247], a[184:187], a[20:23], v[244:247]
    s_add_u32 s59, s32, 81920
    buffer_load_dwordx4 v[176:179], v3, s[8:11], s59 offen offset:0 sc1
    v_fmac_f32 v70, v8, v166
    v_mfma_f32_16x16x32_bf16 v[248:251], a[188:191], a[16:19], v[248:251]
    ds_read_b128 a[172:175], v3 offset:44032
    v_exp_f32 v55, v55
    v_fmac_f32 v71, v8, v167
    v_mfma_f32_16x16x32_bf16 v[252:255], a[188:191], a[20:23], v[252:255]
    v_exp_f32 v60, v60
    s_waitcnt lgkmcnt(4)
    v_mfma_f32_16x16x32_bf16 v[140:143], a[144:147], a[24:27], v[140:143]
    ds_read_b128 a[176:179], v3 offset:45056
    v_fmac_f32 v76, v8, v168
    v_exp_f32 v61, v61
    v_mfma_f32_16x16x32_bf16 v[144:147], a[144:147], a[28:31], v[144:147]
    v_fmac_f32 v77, v8, v169
    v_mfma_f32_16x16x32_bf16 v[148:151], a[148:151], a[24:27], v[148:151]
    ds_read_b128 a[180:183], v3 offset:46080
    v_exp_f32 v62, v62
    v_mfma_f32_16x16x32_bf16 v[152:155], a[148:151], a[28:31], v[152:155]
    v_fmac_f32 v78, v8, v170
    v_exp_f32 v63, v63
    v_mfma_f32_16x16x32_bf16 v[240:243], a[152:155], a[24:27], v[240:243]
    ds_read_b128 a[184:187], v3 offset:47104
    v_fmac_f32 v79, v8, v171
    v_mfma_f32_16x16x32_bf16 v[244:247], a[152:155], a[28:31], v[244:247]
    s_add_u32 s59, s32, 118784
    buffer_load_dwordx4 v[180:183], v3, s[8:11], s59 offen offset:0 sc1
    v_add_f32 v52, 1.0, v52
    v_add_f32 v53, 1.0, v53
    v_mfma_f32_16x16x32_bf16 v[248:251], a[156:159], a[24:27], v[248:251]
    ds_read_b128 a[188:191], v3 offset:48128
    v_add_f32 v54, 1.0, v54
    v_mfma_f32_16x16x32_bf16 v[252:255], a[156:159], a[28:31], v[252:255]
    v_add_f32 v55, 1.0, v55
    s_waitcnt lgkmcnt(4)
    v_mfma_f32_16x16x32_bf16 v[140:143], a[160:163], a[32:35], v[140:143]
    s_waitcnt vmcnt(19)
    s_barrier
    ds_read_b128 a[144:147], v4 offset:0
    v_add_f32 v60, 1.0, v60
    v_add_f32 v61, 1.0, v61
    v_mfma_f32_16x16x32_bf16 v[144:147], a[160:163], a[36:39], v[144:147]
    s_add_u32 m0, s25, 16384
    s_nop 0
    buffer_load_dwordx4 v3, s[8:11], s30 offen offset:0 sc1 lds
    v_add_f32 v62, 1.0, v62
    v_mfma_f32_16x16x32_bf16 v[148:151], a[164:167], a[32:35], v[148:151]
    ds_read_b128 a[148:151], v4 offset:1024
    v_add_f32 v63, 1.0, v63
    v_rcp_f32 v52, v52
    v_mfma_f32_16x16x32_bf16 v[152:155], a[164:167], a[36:39], v[152:155]
    buffer_load_dwordx4 v3, s[8:11], s30 offen offset:1024 sc1 lds
    v_rcp_f32 v53, v53
    v_mfma_f32_16x16x32_bf16 v[240:243], a[168:171], a[32:35], v[240:243]
    ds_read_b128 a[152:155], v4 offset:2048
    v_rcp_f32 v54, v54
    v_mfma_f32_16x16x32_bf16 v[244:247], a[168:171], a[36:39], v[244:247]
    buffer_load_dwordx4 v3, s[8:11], s30 offen offset:2048 sc1 lds
    v_rcp_f32 v55, v55
    v_rcp_f32 v60, v60
    v_mfma_f32_16x16x32_bf16 v[248:251], a[172:175], a[32:35], v[248:251]
    ds_read_b128 a[156:159], v4 offset:3072
    v_rcp_f32 v61, v61
    v_mfma_f32_16x16x32_bf16 v[252:255], a[172:175], a[36:39], v[252:255]
    buffer_load_dwordx4 v3, s[8:11], s30 offen offset:3072 sc1 lds
    s_add_u32 s30, s30, 16384
    v_rcp_f32 v62, v62
    v_rcp_f32 v63, v63
    s_waitcnt lgkmcnt(4)
    v_mfma_f32_16x16x32_bf16 v[140:143], a[176:179], a[40:43], v[140:143]
    ds_read_b128 a[160:163], v4 offset:4096
    v_mul_f32 v68, v52, v68
    v_mfma_f32_16x16x32_bf16 v[144:147], a[176:179], a[44:47], v[144:147]
    v_mul_f32 v69, v53, v69
    v_mul_f32 v70, v54, v70
    v_mfma_f32_16x16x32_bf16 v[148:151], a[180:183], a[40:43], v[148:151]
    ds_read_b128 a[164:167], v4 offset:5120
    v_mul_f32 v71, v55, v71
    v_mfma_f32_16x16x32_bf16 v[152:155], a[180:183], a[44:47], v[152:155]
    v_mul_f32 v76, v60, v76
    v_mfma_f32_16x16x32_bf16 v[240:243], a[184:187], a[40:43], v[240:243]
    ds_read_b128 a[168:171], v4 offset:6144
    v_mul_f32 v77, v61, v77
    v_mul_f32 v78, v62, v78
    v_mfma_f32_16x16x32_bf16 v[244:247], a[184:187], a[44:47], v[244:247]
    v_mul_f32 v79, v63, v79
    v_mfma_f32_16x16x32_bf16 v[248:251], a[188:191], a[40:43], v[248:251]
    ds_read_b128 a[172:175], v4 offset:7168
    v_cvt_pk_bf16_f32 v16, v68, v69
    v_cvt_pk_bf16_f32 v17, v70, v71
    v_mfma_f32_16x16x32_bf16 v[252:255], a[188:191], a[44:47], v[252:255]
    v_cvt_pk_bf16_f32 v18, v76, v77
    s_waitcnt lgkmcnt(4)
    v_mfma_f32_16x16x32_bf16 v[140:143], a[144:147], a[48:51], v[140:143]
    ds_read_b128 a[176:179], v4 offset:8192
    v_cvt_pk_bf16_f32 v19, v78, v79
    v_mfma_f32_16x16x32_bf16 v[144:147], a[144:147], a[52:55], v[144:147]
    buffer_store_dwordx4 v[16:19], v3, s[8:11], s28 offen offset:2048 sc1
    v_mul_f32 v56, v11, v56
    v_mfma_f32_16x16x32_bf16 v[148:151], a[148:151], a[48:51], v[148:151]
    ds_read_b128 a[180:183], v4 offset:9216
    v_mul_f32 v57, v11, v57
    v_mfma_f32_16x16x32_bf16 v[152:155], a[148:151], a[52:55], v[152:155]
    v_mul_f32 v58, v11, v58
    v_mul_f32 v59, v11, v59
    v_mfma_f32_16x16x32_bf16 v[240:243], a[152:155], a[48:51], v[240:243]
    ds_read_b128 a[184:187], v4 offset:10240
    v_mul_f32 v64, v11, v64
    v_mfma_f32_16x16x32_bf16 v[244:247], a[152:155], a[52:55], v[244:247]
    v_mul_f32 v65, v11, v65
    v_mfma_f32_16x16x32_bf16 v[248:251], a[156:159], a[48:51], v[248:251]
    ds_read_b128 a[188:191], v4 offset:11264
    v_mul_f32 v66, v11, v66
    v_mul_f32 v67, v11, v67
    v_mfma_f32_16x16x32_bf16 v[252:255], a[156:159], a[52:55], v[252:255]
    v_fmac_f32 v56, v13, v156
    s_waitcnt lgkmcnt(4)
    v_mfma_f32_16x16x32_bf16 v[140:143], a[160:163], a[56:59], v[140:143]
    ds_read_b128 a[144:147], v4 offset:12288
    v_fmac_f32 v57, v13, v157
    v_fmac_f32 v58, v13, v158
    v_mfma_f32_16x16x32_bf16 v[144:147], a[160:163], a[60:63], v[144:147]
    v_fmac_f32 v59, v13, v159
    v_mfma_f32_16x16x32_bf16 v[148:151], a[164:167], a[56:59], v[148:151]
    ds_read_b128 a[148:151], v4 offset:13312
    v_fmac_f32 v64, v13, v160
    v_fmac_f32 v65, v13, v161
    v_mfma_f32_16x16x32_bf16 v[152:155], a[164:167], a[60:63], v[152:155]
    v_fmac_f32 v66, v13, v162
    v_mfma_f32_16x16x32_bf16 v[240:243], a[168:171], a[56:59], v[240:243]
    ds_read_b128 a[152:155], v4 offset:14336
    v_fmac_f32 v67, v13, v163
    v_mfma_f32_16x16x32_bf16 v[244:247], a[168:171], a[60:63], v[244:247]
    v_exp_f32 v56, v56
    v_fmac_f32 v72, v9, v164
    v_mfma_f32_16x16x32_bf16 v[248:251], a[172:175], a[56:59], v[248:251]
    ds_read_b128 a[156:159], v4 offset:15360
    v_exp_f32 v57, v57
    v_mfma_f32_16x16x32_bf16 v[252:255], a[172:175], a[60:63], v[252:255]
    v_fmac_f32 v73, v9, v165
    v_exp_f32 v58, v58
    s_waitcnt lgkmcnt(4)
    v_mfma_f32_16x16x32_bf16 v[140:143], a[176:179], a[64:67], v[140:143]
    s_waitcnt vmcnt(16)
    s_barrier
    ds_read_b128 a[160:163], v4 offset:16384
    v_fmac_f32 v74, v9, v166
    v_mfma_f32_16x16x32_bf16 v[144:147], a[176:179], a[68:71], v[144:147]
    s_add_u32 m0, s25, 32768
    s_nop 0
    buffer_load_dwordx4 v3, s[8:11], s30 offen offset:0 sc1 lds
    v_exp_f32 v59, v59
    v_mfma_f32_16x16x32_bf16 v[148:151], a[180:183], a[64:67], v[148:151]
    ds_read_b128 a[164:167], v4 offset:17408
    v_fmac_f32 v75, v9, v167
    v_exp_f32 v64, v64
    v_mfma_f32_16x16x32_bf16 v[152:155], a[180:183], a[68:71], v[152:155]
    buffer_load_dwordx4 v3, s[8:11], s30 offen offset:1024 sc1 lds
    v_fmac_f32 v80, v9, v168
    v_mfma_f32_16x16x32_bf16 v[240:243], a[184:187], a[64:67], v[240:243]
    ds_read_b128 a[168:171], v4 offset:18432
    v_exp_f32 v65, v65
    v_fmac_f32 v81, v9, v169
    v_mfma_f32_16x16x32_bf16 v[244:247], a[184:187], a[68:71], v[244:247]
    buffer_load_dwordx4 v3, s[8:11], s30 offen offset:2048 sc1 lds
    v_exp_f32 v66, v66
    v_mfma_f32_16x16x32_bf16 v[248:251], a[188:191], a[64:67], v[248:251]
    ds_read_b128 a[172:175], v4 offset:19456
    v_fmac_f32 v82, v9, v170
    v_mfma_f32_16x16x32_bf16 v[252:255], a[188:191], a[68:71], v[252:255]
    buffer_load_dwordx4 v3, s[8:11], s30 offen offset:3072 sc1 lds
    s_add_u32 s30, s30, 16384
    v_exp_f32 v67, v67
    v_fmac_f32 v83, v9, v171
    s_waitcnt lgkmcnt(4)
    v_mfma_f32_16x16x32_bf16 v[140:143], a[144:147], a[72:75], v[140:143]
    ds_read_b128 a[176:179], v4 offset:20480
    v_add_f32 v56, 1.0, v56
    v_mfma_f32_16x16x32_bf16 v[144:147], a[144:147], a[76:79], v[144:147]
    v_add_f32 v57, 1.0, v57
    v_add_f32 v58, 1.0, v58
    v_mfma_f32_16x16x32_bf16 v[148:151], a[148:151], a[72:75], v[148:151]
    ds_read_b128 a[180:183], v4 offset:21504
    v_add_f32 v59, 1.0, v59
    v_mfma_f32_16x16x32_bf16 v[152:155], a[148:151], a[76:79], v[152:155]
    v_add_f32 v64, 1.0, v64
    v_add_f32 v65, 1.0, v65
    v_mfma_f32_16x16x32_bf16 v[240:243], a[152:155], a[72:75], v[240:243]
    ds_read_b128 a[184:187], v4 offset:22528
    v_add_f32 v66, 1.0, v66
    v_mfma_f32_16x16x32_bf16 v[244:247], a[152:155], a[76:79], v[244:247]
    v_add_f32 v67, 1.0, v67
    v_mfma_f32_16x16x32_bf16 v[248:251], a[156:159], a[72:75], v[248:251]
    ds_read_b128 a[188:191], v4 offset:23552
    v_rcp_f32 v56, v56
    v_rcp_f32 v57, v57
    v_mfma_f32_16x16x32_bf16 v[252:255], a[156:159], a[76:79], v[252:255]
    v_rcp_f32 v58, v58
    s_waitcnt lgkmcnt(4)
    v_mfma_f32_16x16x32_bf16 v[140:143], a[160:163], a[80:83], v[140:143]
    ds_read_b128 a[144:147], v4 offset:24576
    v_rcp_f32 v59, v59
    v_rcp_f32 v64, v64
    v_mfma_f32_16x16x32_bf16 v[144:147], a[160:163], a[84:87], v[144:147]
    v_rcp_f32 v65, v65
    v_mfma_f32_16x16x32_bf16 v[148:151], a[164:167], a[80:83], v[148:151]
    ds_read_b128 a[148:151], v4 offset:25600
    v_rcp_f32 v66, v66
    v_mfma_f32_16x16x32_bf16 v[152:155], a[164:167], a[84:87], v[152:155]
    v_rcp_f32 v67, v67
    v_mul_f32 v72, v56, v72
    v_mfma_f32_16x16x32_bf16 v[240:243], a[168:171], a[80:83], v[240:243]
    ds_read_b128 a[152:155], v4 offset:26624
    v_mul_f32 v73, v57, v73
    v_mfma_f32_16x16x32_bf16 v[244:247], a[168:171], a[84:87], v[244:247]
    v_mul_f32 v74, v58, v74
    v_mul_f32 v75, v59, v75
    v_mfma_f32_16x16x32_bf16 v[248:251], a[172:175], a[80:83], v[248:251]
    ds_read_b128 a[156:159], v4 offset:27648
    v_mul_f32 v80, v64, v80
    v_mfma_f32_16x16x32_bf16 v[252:255], a[172:175], a[84:87], v[252:255]
    v_mul_f32 v81, v65, v81
    s_waitcnt lgkmcnt(4)
    v_mfma_f32_16x16x32_bf16 v[140:143], a[176:179], a[88:91], v[140:143]
    ds_read_b128 a[160:163], v4 offset:28672
    v_mul_f32 v82, v66, v82
    v_mul_f32 v83, v67, v83
    v_mfma_f32_16x16x32_bf16 v[144:147], a[176:179], a[92:95], v[144:147]
    v_cvt_pk_bf16_f32 v20, v72, v73
    v_mfma_f32_16x16x32_bf16 v[148:151], a[180:183], a[88:91], v[148:151]
    ds_read_b128 a[164:167], v4 offset:29696
    v_cvt_pk_bf16_f32 v21, v74, v75
    v_cvt_pk_bf16_f32 v22, v80, v81
    v_mfma_f32_16x16x32_bf16 v[152:155], a[180:183], a[92:95], v[152:155]
    v_cvt_pk_bf16_f32 v23, v82, v83
    v_mfma_f32_16x16x32_bf16 v[240:243], a[184:187], a[88:91], v[240:243]
    ds_read_b128 a[168:171], v4 offset:30720
    buffer_store_dwordx4 v[20:23], v14, s[8:11], s28 offen offset:2048 sc1
    v_mfma_f32_16x16x32_bf16 v[244:247], a[184:187], a[92:95], v[244:247]
    s_add_u32 s59, s32, 155648
    buffer_load_dwordx4 v[184:187], v3, s[8:11], s59 offen offset:0 sc1
    v_mfma_f32_16x16x32_bf16 v[248:251], a[188:191], a[88:91], v[248:251]
    ds_read_b128 a[172:175], v4 offset:31744
    v_mfma_f32_16x16x32_bf16 v[252:255], a[188:191], a[92:95], v[252:255]
    s_waitcnt lgkmcnt(4)
    v_mfma_f32_16x16x32_bf16 v[140:143], a[144:147], a[96:99], v[140:143]
    s_waitcnt vmcnt(14)
    s_barrier
    ds_read_b128 a[176:179], v3 offset:0
    v_mfma_f32_16x16x32_bf16 v[144:147], a[144:147], a[100:103], v[144:147]
    s_add_u32 m0, s25, 49152
    s_nop 0
    buffer_load_dwordx4 v3, s[8:11], s30 offen offset:0 sc1 lds
    v_mfma_f32_16x16x32_bf16 v[148:151], a[148:151], a[96:99], v[148:151]
    ds_read_b128 a[180:183], v3 offset:1024
    v_mfma_f32_16x16x32_bf16 v[152:155], a[148:151], a[100:103], v[152:155]
    buffer_load_dwordx4 v3, s[8:11], s30 offen offset:1024 sc1 lds
    v_mfma_f32_16x16x32_bf16 v[240:243], a[152:155], a[96:99], v[240:243]
    ds_read_b128 a[184:187], v3 offset:2048
    v_mfma_f32_16x16x32_bf16 v[244:247], a[152:155], a[100:103], v[244:247]
    buffer_load_dwordx4 v3, s[8:11], s30 offen offset:2048 sc1 lds
    v_mfma_f32_16x16x32_bf16 v[248:251], a[156:159], a[96:99], v[248:251]
    ds_read_b128 a[188:191], v3 offset:3072
    v_mfma_f32_16x16x32_bf16 v[252:255], a[156:159], a[100:103], v[252:255]
    buffer_load_dwordx4 v3, s[8:11], s30 offen offset:3072 sc1 lds
    s_add_u32 s30, s30, 16384
    s_waitcnt lgkmcnt(4)
    v_mfma_f32_16x16x32_bf16 v[140:143], a[160:163], a[104:107], v[140:143]
    ds_read_b128 a[144:147], v3 offset:4096
    v_mfma_f32_16x16x32_bf16 v[144:147], a[160:163], a[108:111], v[144:147]
    v_mfma_f32_16x16x32_bf16 v[148:151], a[164:167], a[104:107], v[148:151]
    ds_read_b128 a[148:151], v3 offset:5120
    v_mfma_f32_16x16x32_bf16 v[152:155], a[164:167], a[108:111], v[152:155]
    v_mfma_f32_16x16x32_bf16 v[240:243], a[168:171], a[104:107], v[240:243]
    ds_read_b128 a[152:155], v3 offset:6144
    v_mfma_f32_16x16x32_bf16 v[244:247], a[168:171], a[108:111], v[244:247]
    v_mfma_f32_16x16x32_bf16 v[248:251], a[172:175], a[104:107], v[248:251]
    ds_read_b128 a[156:159], v3 offset:7168
    v_mfma_f32_16x16x32_bf16 v[252:255], a[172:175], a[108:111], v[252:255]
    s_waitcnt lgkmcnt(4)
    v_mfma_f32_16x16x32_bf16 v[140:143], a[176:179], a[112:115], v[140:143]
    ds_read_b128 a[160:163], v3 offset:8192
    v_mfma_f32_16x16x32_bf16 v[144:147], a[176:179], a[116:119], v[144:147]
    v_mfma_f32_16x16x32_bf16 v[148:151], a[180:183], a[112:115], v[148:151]
    ds_read_b128 a[164:167], v3 offset:9216
    v_mfma_f32_16x16x32_bf16 v[152:155], a[180:183], a[116:119], v[152:155]
    v_mfma_f32_16x16x32_bf16 v[240:243], a[184:187], a[112:115], v[240:243]
    ds_read_b128 a[168:171], v3 offset:10240
    v_mfma_f32_16x16x32_bf16 v[244:247], a[184:187], a[116:119], v[244:247]
    v_mfma_f32_16x16x32_bf16 v[248:251], a[188:191], a[112:115], v[248:251]
    ds_read_b128 a[172:175], v3 offset:11264
    v_mfma_f32_16x16x32_bf16 v[252:255], a[188:191], a[116:119], v[252:255]
    s_waitcnt lgkmcnt(4)
    v_mfma_f32_16x16x32_bf16 v[140:143], a[144:147], a[120:123], v[140:143]
    ds_read_b128 a[176:179], v3 offset:12288
    v_mfma_f32_16x16x32_bf16 v[144:147], a[144:147], a[124:127], v[144:147]
    v_mfma_f32_16x16x32_bf16 v[148:151], a[148:151], a[120:123], v[148:151]
    ds_read_b128 a[180:183], v3 offset:13312
    v_mfma_f32_16x16x32_bf16 v[152:155], a[148:151], a[124:127], v[152:155]
    v_mfma_f32_16x16x32_bf16 v[240:243], a[152:155], a[120:123], v[240:243]
    ds_read_b128 a[184:187], v3 offset:14336
    v_mfma_f32_16x16x32_bf16 v[244:247], a[152:155], a[124:127], v[244:247]
    v_mfma_f32_16x16x32_bf16 v[248:251], a[156:159], a[120:123], v[248:251]
    ds_read_b128 a[188:191], v3 offset:15360
    v_mfma_f32_16x16x32_bf16 v[252:255], a[156:159], a[124:127], v[252:255]
    s_waitcnt lgkmcnt(4)
    v_mfma_f32_16x16x32_bf16 v[140:143], a[160:163], a[128:131], v[140:143]
    s_waitcnt vmcnt(11)
    s_barrier
    ds_read_b128 a[144:147], v3 offset:16384
    v_mfma_f32_16x16x32_bf16 v[144:147], a[160:163], a[132:135], v[144:147]
    s_add_u32 m0, s25, 65536
    s_nop 0
    buffer_load_dwordx4 v3, s[8:11], s30 offen offset:0 sc1 lds
    v_mfma_f32_16x16x32_bf16 v[148:151], a[164:167], a[128:131], v[148:151]
    ds_read_b128 a[148:151], v3 offset:17408
    v_mfma_f32_16x16x32_bf16 v[152:155], a[164:167], a[132:135], v[152:155]
    buffer_load_dwordx4 v3, s[8:11], s30 offen offset:1024 sc1 lds
    v_mfma_f32_16x16x32_bf16 v[240:243], a[168:171], a[128:131], v[240:243]
    ds_read_b128 a[152:155], v3 offset:18432
    v_mfma_f32_16x16x32_bf16 v[244:247], a[168:171], a[132:135], v[244:247]
    buffer_load_dwordx4 v3, s[8:11], s30 offen offset:2048 sc1 lds
    v_mfma_f32_16x16x32_bf16 v[248:251], a[172:175], a[128:131], v[248:251]
    ds_read_b128 a[156:159], v3 offset:19456
    v_mfma_f32_16x16x32_bf16 v[252:255], a[172:175], a[132:135], v[252:255]
    buffer_load_dwordx4 v3, s[8:11], s30 offen offset:3072 sc1 lds
    s_add_u32 s30, s30, 16384
    s_waitcnt vmcnt(9)
    v_mov_b32 v25, 1
    buffer_store_dword v25, v15, s[8:11], s44 offen sc1
    s_waitcnt lgkmcnt(4)
    v_mfma_f32_16x16x32_bf16 v[140:143], a[176:179], a[136:139], v[140:143]
    ds_read_b128 a[160:163], v3 offset:20480
    v_mfma_f32_16x16x32_bf16 v[144:147], a[176:179], a[140:143], v[144:147]
    v_mfma_f32_16x16x32_bf16 v[148:151], a[180:183], a[136:139], v[148:151]
    ds_read_b128 a[164:167], v3 offset:21504
    v_mfma_f32_16x16x32_bf16 v[152:155], a[180:183], a[140:143], v[152:155]
    v_mfma_f32_16x16x32_bf16 v[240:243], a[184:187], a[136:139], v[240:243]
    ds_read_b128 a[168:171], v3 offset:22528
    v_mfma_f32_16x16x32_bf16 v[244:247], a[184:187], a[140:143], v[244:247]
    v_mfma_f32_16x16x32_bf16 v[248:251], a[188:191], a[136:139], v[248:251]
    ds_read_b128 a[172:175], v3 offset:23552
    v_mfma_f32_16x16x32_bf16 v[252:255], a[188:191], a[140:143], v[252:255]
    s_waitcnt lgkmcnt(4)
    v_mfma_f32_16x16x32_bf16 v[188:191], a[144:147], a[0:3], 0
    ds_read_b128 a[176:179], v3 offset:24576
    v_mfma_f32_16x16x32_bf16 v[192:195], a[144:147], a[4:7], 0
    v_mfma_f32_16x16x32_bf16 v[196:199], a[148:151], a[0:3], 0
    ds_read_b128 a[180:183], v3 offset:25600
    v_mfma_f32_16x16x32_bf16 v[200:203], a[148:151], a[4:7], 0
    ds_read_b128 v[156:159], v6 offset:1792
    v_mfma_f32_16x16x32_bf16 v[204:207], a[152:155], a[0:3], 0
    ds_read_b128 a[184:187], v3 offset:26624
    ds_read_b128 v[160:163], v6 offset:1856
    v_mfma_f32_16x16x32_bf16 v[208:211], a[152:155], a[4:7], 0
    ds_read_b128 v[164:167], v6 offset:1920
    ds_read_b128 v[168:171], v6 offset:1984
    v_mfma_f32_16x16x32_bf16 v[212:215], a[156:159], a[0:3], 0
    ds_read_b128 a[188:191], v3 offset:27648
    v_mul_f32 v140, v10, v140
    v_mfma_f32_16x16x32_bf16 v[216:219], a[156:159], a[4:7], 0
    v_mul_f32 v141, v10, v141
    v_mul_f32 v142, v10, v142
    s_waitcnt lgkmcnt(8)
    v_mfma_f32_16x16x32_bf16 v[188:191], a[160:163], a[8:11], v[188:191]
    ds_read_b128 a[144:147], v3 offset:28672
    v_mul_f32 v143, v10, v143
    v_mfma_f32_16x16x32_bf16 v[192:195], a[160:163], a[12:15], v[192:195]
    ds_read_b128 a[0:3], v5 offset:0
    v_mul_f32 v148, v10, v148
    v_mfma_f32_16x16x32_bf16 v[196:199], a[164:167], a[8:11], v[196:199]
    ds_read_b128 a[148:151], v3 offset:29696
    v_mul_f32 v149, v10, v149
    v_mul_f32 v150, v10, v150
    v_mfma_f32_16x16x32_bf16 v[200:203], a[164:167], a[12:15], v[200:203]
    ds_read_b128 a[4:7], v5 offset:1024
    v_mul_f32 v151, v10, v151
    v_mfma_f32_16x16x32_bf16 v[204:207], a[168:171], a[8:11], v[204:207]
    ds_read_b128 a[152:155], v3 offset:30720
    s_waitcnt lgkmcnt(10)
    v_fmac_f32 v140, v12, v156
    v_fmac_f32 v141, v12, v157
    v_mfma_f32_16x16x32_bf16 v[208:211], a[168:171], a[12:15], v[208:211]
    ds_read_b128 v[56:59], v5 offset:2048
    v_fmac_f32 v142, v12, v158
    v_mfma_f32_16x16x32_bf16 v[212:215], a[172:175], a[8:11], v[212:215]
    ds_read_b128 a[156:159], v3 offset:31744
    v_fmac_f32 v143, v12, v159
    v_mfma_f32_16x16x32_bf16 v[216:219], a[172:175], a[12:15], v[216:219]
    ds_read_b128 v[60:63], v5 offset:3072
    s_waitcnt lgkmcnt(11)
    v_fmac_f32 v148, v12, v160
    v_fmac_f32 v149, v12, v161
    s_waitcnt lgkmcnt(8)
    v_mfma_f32_16x16x32_bf16 v[188:191], a[176:179], a[16:19], v[188:191]
    s_barrier
    ds_read_b128 a[160:163], v3 offset:32768
    v_fmac_f32 v150, v12, v162
    v_mfma_f32_16x16x32_bf16 v[192:195], a[176:179], a[20:23], v[192:195]
    s_add_u32 m0, s25, 0
    s_and_b32 s59, s3, 2
    s_lshl_b32 s59, s59, 12
    s_sub_u32 s30, s30, s59
    buffer_load_dwordx4 v3, s[8:11], s30 offen offset:0 sc1 lds
    v_fmac_f32 v151, v12, v163
    v_exp_f32 v140, v140
    v_mfma_f32_16x16x32_bf16 v[196:199], a[180:183], a[16:19], v[196:199]
    ds_read_b128 a[164:167], v3 offset:33792
    v_fmac_f32 v240, v8, v164
    v_mfma_f32_16x16x32_bf16 v[200:203], a[180:183], a[20:23], v[200:203]
    buffer_load_dwordx4 v3, s[8:11], s30 offen offset:1024 sc1 lds
    v_exp_f32 v141, v141
    v_mfma_f32_16x16x32_bf16 v[204:207], a[184:187], a[16:19], v[204:207]
    ds_read_b128 a[168:171], v3 offset:34816
    v_fmac_f32 v241, v8, v165
    v_exp_f32 v142, v142
    v_mfma_f32_16x16x32_bf16 v[208:211], a[184:187], a[20:23], v[208:211]
    buffer_load_dwordx4 v3, s[8:11], s30 offen offset:2048 sc1 lds
    v_fmac_f32 v242, v8, v166
    v_mfma_f32_16x16x32_bf16 v[212:215], a[188:191], a[16:19], v[212:215]
    ds_read_b128 a[172:175], v3 offset:35840
    v_exp_f32 v143, v143
    v_fmac_f32 v243, v8, v167
    v_mfma_f32_16x16x32_bf16 v[216:219], a[188:191], a[20:23], v[216:219]
    buffer_load_dwordx4 v3, s[8:11], s30 offen offset:3072 sc1 lds
    s_add_u32 s30, s30, 16384
    v_exp_f32 v148, v148
    s_waitcnt lgkmcnt(5)
    v_mfma_f32_16x16x32_bf16 v[188:191], a[144:147], a[24:27], v[188:191]
    ds_read_b128 a[176:179], v3 offset:36864
    v_fmac_f32 v248, v8, v168
    v_exp_f32 v149, v149
    v_mfma_f32_16x16x32_bf16 v[192:195], a[144:147], a[28:31], v[192:195]
    ds_read_b128 a[8:11], v5 offset:4096
    v_fmac_f32 v249, v8, v169
    v_mfma_f32_16x16x32_bf16 v[196:199], a[148:151], a[24:27], v[196:199]
    ds_read_b128 a[180:183], v3 offset:37888
    v_exp_f32 v150, v150
    v_mfma_f32_16x16x32_bf16 v[200:203], a[148:151], a[28:31], v[200:203]
    ds_read_b128 a[12:15], v5 offset:5120
    v_fmac_f32 v250, v8, v170
    v_exp_f32 v151, v151
    v_mfma_f32_16x16x32_bf16 v[204:207], a[152:155], a[24:27], v[204:207]
    ds_read_b128 a[184:187], v3 offset:38912
    v_fmac_f32 v251, v8, v171
    v_mfma_f32_16x16x32_bf16 v[208:211], a[152:155], a[28:31], v[208:211]
    v_add_f32 v140, 1.0, v140
    v_add_f32 v141, 1.0, v141
    v_mfma_f32_16x16x32_bf16 v[212:215], a[156:159], a[24:27], v[212:215]
    ds_read_b128 a[188:191], v3 offset:39936
    v_add_f32 v142, 1.0, v142
    v_mfma_f32_16x16x32_bf16 v[216:219], a[156:159], a[28:31], v[216:219]
    v_add_f32 v143, 1.0, v143
    s_waitcnt lgkmcnt(6)
    v_mfma_f32_16x16x32_bf16 v[188:191], a[160:163], a[32:35], v[188:191]
    ds_read_b128 a[144:147], v3 offset:40960
    v_add_f32 v148, 1.0, v148
    v_add_f32 v149, 1.0, v149
    v_mfma_f32_16x16x32_bf16 v[192:195], a[160:163], a[36:39], v[192:195]
    v_add_f32 v150, 1.0, v150
    v_mfma_f32_16x16x32_bf16 v[196:199], a[164:167], a[32:35], v[196:199]
    ds_read_b128 a[148:151], v3 offset:41984
    v_add_f32 v151, 1.0, v151
    v_rcp_f32 v140, v140
    v_mfma_f32_16x16x32_bf16 v[200:203], a[164:167], a[36:39], v[200:203]
    v_rcp_f32 v141, v141
    v_mfma_f32_16x16x32_bf16 v[204:207], a[168:171], a[32:35], v[204:207]
    ds_read_b128 a[152:155], v3 offset:43008
    v_rcp_f32 v142, v142
    v_mfma_f32_16x16x32_bf16 v[208:211], a[168:171], a[36:39], v[208:211]
    v_rcp_f32 v143, v143
    v_rcp_f32 v148, v148
    v_mfma_f32_16x16x32_bf16 v[212:215], a[172:175], a[32:35], v[212:215]
    ds_read_b128 a[156:159], v3 offset:44032
    v_rcp_f32 v149, v149
    v_mfma_f32_16x16x32_bf16 v[216:219], a[172:175], a[36:39], v[216:219]
    v_rcp_f32 v150, v150
    v_rcp_f32 v151, v151
    s_waitcnt lgkmcnt(4)
    v_mfma_f32_16x16x32_bf16 v[188:191], a[176:179], a[40:43], v[188:191]
    ds_read_b128 a[160:163], v3 offset:45056
    v_mul_f32 v240, v140, v240
    v_mfma_f32_16x16x32_bf16 v[192:195], a[176:179], a[44:47], v[192:195]
    v_mul_f32 v241, v141, v241
    v_mul_f32 v242, v142, v242
    v_mfma_f32_16x16x32_bf16 v[196:199], a[180:183], a[40:43], v[196:199]
    ds_read_b128 a[164:167], v3 offset:46080
    v_mul_f32 v243, v143, v243
    v_mfma_f32_16x16x32_bf16 v[200:203], a[180:183], a[44:47], v[200:203]
    v_mul_f32 v248, v148, v248
    v_mfma_f32_16x16x32_bf16 v[204:207], a[184:187], a[40:43], v[204:207]
    ds_read_b128 a[168:171], v3 offset:47104
    v_mul_f32 v249, v149, v249
    v_mul_f32 v250, v150, v250
    v_mfma_f32_16x16x32_bf16 v[208:211], a[184:187], a[44:47], v[208:211]
    v_mul_f32 v251, v151, v251
    v_mfma_f32_16x16x32_bf16 v[212:215], a[188:191], a[40:43], v[212:215]
    ds_read_b128 a[172:175], v3 offset:48128
    v_cvt_pk_bf16_f32 v16, v240, v241
    v_cvt_pk_bf16_f32 v17, v242, v243
    v_mfma_f32_16x16x32_bf16 v[216:219], a[188:191], a[44:47], v[216:219]
    v_cvt_pk_bf16_f32 v18, v248, v249
    s_waitcnt lgkmcnt(4)
    v_mfma_f32_16x16x32_bf16 v[188:191], a[144:147], a[48:51], v[188:191]
    s_waitcnt vmcnt(9)
    s_barrier
    ds_read_b128 a[176:179], v4 offset:0
    v_cvt_pk_bf16_f32 v19, v250, v251
    v_mfma_f32_16x16x32_bf16 v[192:195], a[144:147], a[52:55], v[192:195]
    buffer_store_dwordx4 v[16:19], v3, s[8:11], s28 offen offset:3072 sc1
    v_mul_f32 v144, v11, v144
    v_mfma_f32_16x16x32_bf16 v[196:199], a[148:151], a[48:51], v[196:199]
    ds_read_b128 a[180:183], v4 offset:1024
    v_mul_f32 v145, v11, v145
    v_mfma_f32_16x16x32_bf16 v[200:203], a[148:151], a[52:55], v[200:203]
    v_mul_f32 v146, v11, v146
    v_mul_f32 v147, v11, v147
    v_mfma_f32_16x16x32_bf16 v[204:207], a[152:155], a[48:51], v[204:207]
    ds_read_b128 a[184:187], v4 offset:2048
    v_mul_f32 v152, v11, v152
    v_mfma_f32_16x16x32_bf16 v[208:211], a[152:155], a[52:55], v[208:211]
    v_mul_f32 v153, v11, v153
    v_mfma_f32_16x16x32_bf16 v[212:215], a[156:159], a[48:51], v[212:215]
    ds_read_b128 a[188:191], v4 offset:3072
    v_mul_f32 v154, v11, v154
    v_mul_f32 v155, v11, v155
    v_mfma_f32_16x16x32_bf16 v[216:219], a[156:159], a[52:55], v[216:219]
    v_fmac_f32 v144, v13, v156
    buffer_load_dwordx4 v[52:55], v15, s[8:11], s40 offen sc1
    s_waitcnt lgkmcnt(4)
    v_mfma_f32_16x16x32_bf16 v[188:191], a[160:163], a[56:59], v[188:191]
    ds_read_b128 a[144:147], v4 offset:4096
    v_fmac_f32 v145, v13, v157
    v_fmac_f32 v146, v13, v158
    v_mfma_f32_16x16x32_bf16 v[192:195], a[160:163], a[60:63], v[192:195]
    v_fmac_f32 v147, v13, v159
    v_mfma_f32_16x16x32_bf16 v[196:199], a[164:167], a[56:59], v[196:199]
    ds_read_b128 a[148:151], v4 offset:5120
    v_fmac_f32 v152, v13, v160
    v_fmac_f32 v153, v13, v161
    v_mfma_f32_16x16x32_bf16 v[200:203], a[164:167], a[60:63], v[200:203]
    v_fmac_f32 v154, v13, v162
    v_mfma_f32_16x16x32_bf16 v[204:207], a[168:171], a[56:59], v[204:207]
    ds_read_b128 a[152:155], v4 offset:6144
    v_fmac_f32 v155, v13, v163
    v_mfma_f32_16x16x32_bf16 v[208:211], a[168:171], a[60:63], v[208:211]
    v_exp_f32 v144, v144
    v_fmac_f32 v244, v9, v164
    v_mfma_f32_16x16x32_bf16 v[212:215], a[172:175], a[56:59], v[212:215]
    ds_read_b128 a[156:159], v4 offset:7168
    v_exp_f32 v145, v145
    v_mfma_f32_16x16x32_bf16 v[216:219], a[172:175], a[60:63], v[216:219]
    v_fmac_f32 v245, v9, v165
    v_exp_f32 v146, v146
    s_waitcnt lgkmcnt(4)
    v_mfma_f32_16x16x32_bf16 v[188:191], a[176:179], a[64:67], v[188:191]
    ds_read_b128 a[160:163], v4 offset:8192
    v_fmac_f32 v246, v9, v166
    v_mfma_f32_16x16x32_bf16 v[192:195], a[176:179], a[68:71], v[192:195]
    v_exp_f32 v147, v147
    v_mfma_f32_16x16x32_bf16 v[196:199], a[180:183], a[64:67], v[196:199]
    ds_read_b128 a[164:167], v4 offset:9216
    v_fmac_f32 v247, v9, v167
    v_exp_f32 v152, v152
    v_mfma_f32_16x16x32_bf16 v[200:203], a[180:183], a[68:71], v[200:203]
    v_fmac_f32 v252, v9, v168
    v_mfma_f32_16x16x32_bf16 v[204:207], a[184:187], a[64:67], v[204:207]
    ds_read_b128 a[168:171], v4 offset:10240
    v_exp_f32 v153, v153
    v_fmac_f32 v253, v9, v169
    v_mfma_f32_16x16x32_bf16 v[208:211], a[184:187], a[68:71], v[208:211]
    v_exp_f32 v154, v154
    v_mfma_f32_16x16x32_bf16 v[212:215], a[188:191], a[64:67], v[212:215]
    ds_read_b128 a[172:175], v4 offset:11264
    v_fmac_f32 v254, v9, v170
    v_mfma_f32_16x16x32_bf16 v[216:219], a[188:191], a[68:71], v[216:219]
    v_exp_f32 v155, v155
    v_fmac_f32 v255, v9, v171
    s_waitcnt vmcnt(0)
    v_min_u32 v52, v52, v53
    v_min_u32 v54, v54, v55
    v_min_u32 v52, v52, v54
    s_nop 0
    v_readfirstlane_b32 s59, v52
    s_nop 0
    s_cmp_ge_u32 s59, 1
    s_cbranch_scc1 KCD_PD1
    s_mov_b32 s60, 20000
KCD_PL1:
    s_sub_u32 s60, s60, 1
    s_cmp_eq_u32 s60, 0
    s_cbranch_scc1 KCD_PD1
    s_sleep 1
    buffer_load_dwordx4 v[52:55], v15, s[8:11], s40 offen sc1
    s_waitcnt vmcnt(0)
    v_min_u32 v52, v52, v53
    v_min_u32 v54, v54, v55
    v_min_u32 v52, v52, v54
    s_nop 0
    v_readfirstlane_b32 s59, v52
    s_nop 0
    s_cmp_ge_u32 s59, 1
    s_cbranch_scc0 KCD_PL1
KCD_PD1:
    s_waitcnt lgkmcnt(4)
    v_mfma_f32_16x16x32_bf16 v[188:191], a[144:147], a[72:75], v[188:191]
    ds_read_b128 a[176:179], v4 offset:12288
    v_add_f32 v144, 1.0, v144
    v_mfma_f32_16x16x32_bf16 v[192:195], a[144:147], a[76:79], v[192:195]
    buffer_load_dwordx4 a[16:19], v3, s[8:11], s36 offen offset:0 sc1
    v_add_f32 v145, 1.0, v145
    v_add_f32 v146, 1.0, v146
    v_mfma_f32_16x16x32_bf16 v[196:199], a[148:151], a[72:75], v[196:199]
    ds_read_b128 a[180:183], v4 offset:13312
    v_add_f32 v147, 1.0, v147
    v_mfma_f32_16x16x32_bf16 v[200:203], a[148:151], a[76:79], v[200:203]
    buffer_load_dwordx4 a[20:23], v14, s[8:11], s36 offen offset:0 sc1
    v_add_f32 v152, 1.0, v152
    v_add_f32 v153, 1.0, v153
    v_mfma_f32_16x16x32_bf16 v[204:207], a[152:155], a[72:75], v[204:207]
    ds_read_b128 a[184:187], v4 offset:14336
    v_add_f32 v154, 1.0, v154
    v_mfma_f32_16x16x32_bf16 v[208:211], a[152:155], a[76:79], v[208:211]
    buffer_load_dwordx4 a[24:27], v3, s[8:11], s36 offen offset:1024 sc1
    v_add_f32 v155, 1.0, v155
    v_mfma_f32_16x16x32_bf16 v[212:215], a[156:159], a[72:75], v[212:215]
    ds_read_b128 a[188:191], v4 offset:15360
    v_rcp_f32 v144, v144
    v_rcp_f32 v145, v145
    v_mfma_f32_16x16x32_bf16 v[216:219], a[156:159], a[76:79], v[216:219]
    buffer_load_dwordx4 a[28:31], v14, s[8:11], s36 offen offset:1024 sc1
    v_rcp_f32 v146, v146
    s_waitcnt lgkmcnt(4)
    v_mfma_f32_16x16x32_bf16 v[188:191], a[160:163], a[80:83], v[188:191]
    s_barrier
    ds_read_b128 a[144:147], v4 offset:16384
    v_rcp_f32 v147, v147
    v_rcp_f32 v152, v152
    v_mfma_f32_16x16x32_bf16 v[192:195], a[160:163], a[84:87], v[192:195]
    buffer_load_dwordx4 a[32:35], v3, s[8:11], s36 offen offset:2048 sc1
    v_rcp_f32 v153, v153
    v_mfma_f32_16x16x32_bf16 v[196:199], a[164:167], a[80:83], v[196:199]
    ds_read_b128 a[148:151], v4 offset:17408
    v_rcp_f32 v154, v154
    v_mfma_f32_16x16x32_bf16 v[200:203], a[164:167], a[84:87], v[200:203]
    buffer_load_dwordx4 a[36:39], v14, s[8:11], s36 offen offset:2048 sc1
    v_rcp_f32 v155, v155
    v_mul_f32 v244, v144, v244
    v_mfma_f32_16x16x32_bf16 v[204:207], a[168:171], a[80:83], v[204:207]
    ds_read_b128 a[152:155], v4 offset:18432
    v_mul_f32 v245, v145, v245
    v_mfma_f32_16x16x32_bf16 v[208:211], a[168:171], a[84:87], v[208:211]
    buffer_load_dwordx4 a[40:43], v3, s[8:11], s36 offen offset:3072 sc1
    v_mul_f32 v246, v146, v246
    v_mul_f32 v247, v147, v247
    v_mfma_f32_16x16x32_bf16 v[212:215], a[172:175], a[80:83], v[212:215]
    ds_read_b128 a[156:159], v4 offset:19456
    v_mul_f32 v252, v152, v252
    v_mfma_f32_16x16x32_bf16 v[216:219], a[172:175], a[84:87], v[216:219]
    buffer_load_dwordx4 a[44:47], v14, s[8:11], s36 offen offset:3072 sc1
    v_mul_f32 v253, v153, v253
    s_waitcnt lgkmcnt(4)
    v_mfma_f32_16x16x32_bf16 v[188:191], a[176:179], a[88:91], v[188:191]
    ds_read_b128 a[160:163], v4 offset:20480
    v_mul_f32 v254, v154, v254
    v_mul_f32 v255, v155, v255
    v_mfma_f32_16x16x32_bf16 v[192:195], a[176:179], a[92:95], v[192:195]
    s_add_u32 s59, s36, 4096
    buffer_load_dwordx4 a[48:51], v3, s[8:11], s59 offen offset:0 sc1
    v_cvt_pk_bf16_f32 v20, v244, v245
    v_mfma_f32_16x16x32_bf16 v[196:199], a[180:183], a[88:91], v[196:199]
    ds_read_b128 a[164:167], v4 offset:21504
    v_cvt_pk_bf16_f32 v21, v246, v247
    v_cvt_pk_bf16_f32 v22, v252, v253
    v_mfma_f32_16x16x32_bf16 v[200:203], a[180:183], a[92:95], v[200:203]
    s_add_u32 s59, s36, 4096
    buffer_load_dwordx4 a[52:55], v14, s[8:11], s59 offen offset:0 sc1
    v_cvt_pk_bf16_f32 v23, v254, v255
    v_mfma_f32_16x16x32_bf16 v[204:207], a[184:187], a[88:91], v[204:207]
    ds_read_b128 a[168:171], v4 offset:22528
    buffer_store_dwordx4 v[20:23], v14, s[8:11], s28 offen offset:3072 sc1
    v_mfma_f32_16x16x32_bf16 v[208:211], a[184:187], a[92:95], v[208:211]
    s_add_u32 s59, s36, 4096
    buffer_load_dwordx4 a[56:59], v3, s[8:11], s59 offen offset:1024 sc1
    v_mfma_f32_16x16x32_bf16 v[212:215], a[188:191], a[88:91], v[212:215]
    ds_read_b128 a[172:175], v4 offset:23552
    v_mfma_f32_16x16x32_bf16 v[216:219], a[188:191], a[92:95], v[216:219]
    s_add_u32 s59, s36, 4096
    buffer_load_dwordx4 a[60:63], v14, s[8:11], s59 offen offset:1024 sc1
    s_waitcnt lgkmcnt(4)
    v_mfma_f32_16x16x32_bf16 v[188:191], a[144:147], a[96:99], v[188:191]
    ds_read_b128 a[176:179], v4 offset:24576
    v_mfma_f32_16x16x32_bf16 v[192:195], a[144:147], a[100:103], v[192:195]
    s_add_u32 s59, s36, 4096
    buffer_load_dwordx4 a[64:67], v3, s[8:11], s59 offen offset:2048 sc1
    v_mfma_f32_16x16x32_bf16 v[196:199], a[148:151], a[96:99], v[196:199]
    ds_read_b128 a[180:183], v4 offset:25600
    v_mfma_f32_16x16x32_bf16 v[200:203], a[148:151], a[100:103], v[200:203]
    s_add_u32 s59, s36, 4096
    buffer_load_dwordx4 a[68:71], v14, s[8:11], s59 offen offset:2048 sc1
    v_mfma_f32_16x16x32_bf16 v[204:207], a[152:155], a[96:99], v[204:207]
    ds_read_b128 a[184:187], v4 offset:26624
    v_mfma_f32_16x16x32_bf16 v[208:211], a[152:155], a[100:103], v[208:211]
    ds_read_b128 a[72:75], v5 offset:6144
    v_mfma_f32_16x16x32_bf16 v[212:215], a[156:159], a[96:99], v[212:215]
    ds_read_b128 a[188:191], v4 offset:27648
    v_mfma_f32_16x16x32_bf16 v[216:219], a[156:159], a[100:103], v[216:219]
    ds_read_b128 a[76:79], v5 offset:7168
    s_waitcnt lgkmcnt(6)
    v_mfma_f32_16x16x32_bf16 v[188:191], a[160:163], a[104:107], v[188:191]
    ds_read_b128 a[144:147], v4 offset:28672
    v_mfma_f32_16x16x32_bf16 v[192:195], a[160:163], a[108:111], v[192:195]
    ds_read_b128 a[80:83], v5 offset:8192
    v_mfma_f32_16x16x32_bf16 v[196:199], a[164:167], a[104:107], v[196:199]
    ds_read_b128 a[148:151], v4 offset:29696
    v_mfma_f32_16x16x32_bf16 v[200:203], a[164:167], a[108:111], v[200:203]
    ds_read_b128 a[84:87], v5 offset:9216
    v_mfma_f32_16x16x32_bf16 v[204:207], a[168:171], a[104:107], v[204:207]
    ds_read_b128 a[152:155], v4 offset:30720
    v_mfma_f32_16x16x32_bf16 v[208:211], a[168:171], a[108:111], v[208:211]
    ds_read_b128 a[88:91], v5 offset:10240
    v_mfma_f32_16x16x32_bf16 v[212:215], a[172:175], a[104:107], v[212:215]
    ds_read_b128 a[156:159], v4 offset:31744
    v_mfma_f32_16x16x32_bf16 v[216:219], a[172:175], a[108:111], v[216:219]
    ds_read_b128 a[92:95], v5 offset:11264
    s_waitcnt lgkmcnt(9)
    v_mfma_f32_16x16x32_bf16 v[188:191], a[176:179], a[112:115], v[188:191]
    s_barrier
    ds_read_b128 a[160:163], v3 offset:0
    v_mfma_f32_16x16x32_bf16 v[192:195], a[176:179], a[116:119], v[192:195]
    ds_read_b128 a[96:99], v5 offset:12288
    v_mfma_f32_16x16x32_bf16 v[196:199], a[180:183], a[112:115], v[196:199]
    ds_read_b128 a[164:167], v3 offset:1024
    v_mfma_f32_16x16x32_bf16 v[200:203], a[180:183], a[116:119], v[200:203]
    ds_read_b128 a[100:103], v5 offset:13312
    v_mfma_f32_16x16x32_bf16 v[204:207], a[184:187], a[112:115], v[204:207]
    ds_read_b128 a[168:171], v3 offset:2048
    v_mfma_f32_16x16x32_bf16 v[208:211], a[184:187], a[116:119], v[208:211]
    ds_read_b128 a[104:107], v5 offset:14336
    v_mfma_f32_16x16x32_bf16 v[212:215], a[188:191], a[112:115], v[212:215]
    ds_read_b128 a[172:175], v3 offset:3072
    v_mfma_f32_16x16x32_bf16 v[216:219], a[188:191], a[116:119], v[216:219]
    ds_read_b128 a[108:111], v5 offset:15360
    s_waitcnt lgkmcnt(9)
    v_mfma_f32_16x16x32_bf16 v[188:191], a[144:147], a[120:123], v[188:191]
    ds_read_b128 a[176:179], v3 offset:4096
    v_mfma_f32_16x16x32_bf16 v[192:195], a[144:147], a[124:127], v[192:195]
    ds_read_b128 a[112:115], v5 offset:16384
    v_mfma_f32_16x16x32_bf16 v[196:199], a[148:151], a[120:123], v[196:199]
    ds_read_b128 a[180:183], v3 offset:5120
    v_mfma_f32_16x16x32_bf16 v[200:203], a[148:151], a[124:127], v[200:203]
    ds_read_b128 a[116:119], v5 offset:17408
    v_mfma_f32_16x16x32_bf16 v[204:207], a[152:155], a[120:123], v[204:207]
    ds_read_b128 a[184:187], v3 offset:6144
    v_mfma_f32_16x16x32_bf16 v[208:211], a[152:155], a[124:127], v[208:211]
    ds_read_b128 v[64:67], v5 offset:18432
    v_mfma_f32_16x16x32_bf16 v[212:215], a[156:159], a[120:123], v[212:215]
    ds_read_b128 a[188:191], v3 offset:7168
    v_mfma_f32_16x16x32_bf16 v[216:219], a[156:159], a[124:127], v[216:219]
    s_waitcnt lgkmcnt(8)
    v_mfma_f32_16x16x32_bf16 v[188:191], a[160:163], a[128:131], v[188:191]
    v_mfma_f32_16x16x32_bf16 v[192:195], a[160:163], a[132:135], v[192:195]
    v_mfma_f32_16x16x32_bf16 v[196:199], a[164:167], a[128:131], v[196:199]
    v_mfma_f32_16x16x32_bf16 v[200:203], a[164:167], a[132:135], v[200:203]
    v_mfma_f32_16x16x32_bf16 v[204:207], a[168:171], a[128:131], v[204:207]
    v_mfma_f32_16x16x32_bf16 v[208:211], a[168:171], a[132:135], v[208:211]
    v_mfma_f32_16x16x32_bf16 v[212:215], a[172:175], a[128:131], v[212:215]
    v_mfma_f32_16x16x32_bf16 v[216:219], a[172:175], a[132:135], v[216:219]
    s_waitcnt lgkmcnt(0)
    v_mfma_f32_16x16x32_bf16 v[188:191], a[176:179], a[136:139], v[188:191]
    v_mfma_f32_16x16x32_bf16 v[192:195], a[176:179], a[140:143], v[192:195]
    v_mfma_f32_16x16x32_bf16 v[196:199], a[180:183], a[136:139], v[196:199]
    v_mfma_f32_16x16x32_bf16 v[200:203], a[180:183], a[140:143], v[200:203]
    v_mfma_f32_16x16x32_bf16 v[204:207], a[184:187], a[136:139], v[204:207]
    v_mfma_f32_16x16x32_bf16 v[208:211], a[184:187], a[140:143], v[208:211]
    v_mfma_f32_16x16x32_bf16 v[212:215], a[188:191], a[136:139], v[212:215]
    v_mfma_f32_16x16x32_bf16 v[216:219], a[188:191], a[140:143], v[216:219]
    v_mul_u32_u24 v4, 18432, v1
    v_add_u32 v4, v4, v3
    v_add_u32 v5, 73728, v4
    v_lshl_add_u32 v26, v1, 10, v3
    v_and_b32 v27, 1, v1
    v_lshl_add_u32 v27, v27, 10, v3
    v_add_u32 v27, 16384, v27
    s_waitcnt vmcnt(14)
    v_mfma_f32_16x16x32_bf16 a[120:123], a[192:195], a[16:19], 0
    ds_read_b128 v[156:159], v6 offset:2048
    ds_read_b128 v[160:163], v6 offset:2112
    s_waitcnt vmcnt(13)
    v_mfma_f32_16x16x32_bf16 a[124:127], a[192:195], a[20:23], 0
    buffer_load_dwordx4 a[128:131], v3, s[8:11], s37 offen offset:0 sc1
    ds_read_b128 v[164:167], v6 offset:2176
    s_waitcnt vmcnt(13)
    v_mfma_f32_16x16x32_bf16 a[120:123], a[196:199], a[24:27], a[120:123]
    s_waitcnt lgkmcnt(0)
    s_barrier
    ds_read_b128 v[168:171], v6 offset:2240
    s_waitcnt vmcnt(12)
    v_mfma_f32_16x16x32_bf16 a[124:127], a[196:199], a[28:31], a[124:127]
    buffer_load_dwordx4 a[132:135], v14, s[8:11], s37 offen offset:0 sc1
    v_mul_f32 v188, v10, v188
    s_waitcnt vmcnt(12)
    v_mfma_f32_16x16x32_bf16 a[120:123], a[200:203], a[32:35], a[120:123]
    v_mul_f32 v189, v10, v189
    v_mul_f32 v190, v10, v190
    s_waitcnt vmcnt(11)
    v_mfma_f32_16x16x32_bf16 a[124:127], a[200:203], a[36:39], a[124:127]
    buffer_load_dwordx4 a[136:139], v3, s[8:11], s37 offen offset:1024 sc1
    v_mul_f32 v191, v10, v191
    s_waitcnt vmcnt(11)
    v_mfma_f32_16x16x32_bf16 a[120:123], a[204:207], a[40:43], a[120:123]
    v_mul_f32 v196, v10, v196
    v_mul_f32 v197, v10, v197
    s_waitcnt vmcnt(10)
    v_mfma_f32_16x16x32_bf16 a[124:127], a[204:207], a[44:47], a[124:127]
    buffer_load_dwordx4 a[140:143], v14, s[8:11], s37 offen offset:1024 sc1
    v_mul_f32 v198, v10, v198
    s_waitcnt vmcnt(10)
    v_mfma_f32_16x16x32_bf16 a[120:123], a[208:211], a[48:51], a[120:123]
    v_mul_f32 v199, v10, v199
    v_fmac_f32 v188, v12, v156
    s_waitcnt vmcnt(9)
    v_mfma_f32_16x16x32_bf16 a[124:127], a[208:211], a[52:55], a[124:127]
    buffer_load_dwordx4 a[144:147], v3, s[8:11], s37 offen offset:2048 sc1
    v_fmac_f32 v189, v12, v157
    s_waitcnt vmcnt(8)
    v_mfma_f32_16x16x32_bf16 a[120:123], a[0:3], a[56:59], a[120:123]
    v_fmac_f32 v190, v12, v158
    v_fmac_f32 v191, v12, v159
    s_waitcnt vmcnt(7)
    v_mfma_f32_16x16x32_bf16 a[124:127], a[0:3], a[60:63], a[124:127]
    buffer_load_dwordx4 a[148:151], v14, s[8:11], s37 offen offset:2048 sc1
    v_fmac_f32 v196, v12, v160
    s_waitcnt vmcnt(7)
    v_mfma_f32_16x16x32_bf16 a[120:123], a[4:7], a[64:67], a[120:123]
    v_fmac_f32 v197, v12, v161
    v_fmac_f32 v198, v12, v162
    s_waitcnt vmcnt(6)
    v_mfma_f32_16x16x32_bf16 a[124:127], a[4:7], a[68:71], a[124:127]
    buffer_load_dwordx4 a[152:155], v3, s[8:11], s37 offen offset:3072 sc1
    v_fmac_f32 v199, v12, v163
    v_mfma_f32_16x16x32_bf16 a[156:159], a[212:215], a[16:19], 0
    v_exp_f32 v188, v188
    v_fmac_f32 v204, v8, v164
    v_mfma_f32_16x16x32_bf16 a[160:163], a[212:215], a[20:23], 0
    buffer_load_dwordx4 a[164:167], v14, s[8:11], s37 offen offset:3072 sc1
    v_exp_f32 v189, v189
    v_mfma_f32_16x16x32_bf16 a[156:159], a[216:219], a[24:27], a[156:159]
    v_fmac_f32 v205, v8, v165
    v_exp_f32 v190, v190
    v_mfma_f32_16x16x32_bf16 a[160:163], a[216:219], a[28:31], a[160:163]
    s_add_u32 s59, s37, 4096
    buffer_load_dwordx4 a[168:171], v3, s[8:11], s59 offen offset:0 sc1
    v_fmac_f32 v206, v8, v166
    v_mfma_f32_16x16x32_bf16 a[156:159], a[220:223], a[32:35], a[156:159]
    ds_write_b128 v4, a[120:123] offset:0
    v_exp_f32 v191, v191
    v_mfma_f32_16x16x32_bf16 a[160:163], a[220:223], a[36:39], a[160:163]
    ds_write_b128 v4, a[124:127] offset:1024
    s_add_u32 s59, s37, 4096
    buffer_load_dwordx4 a[172:175], v14, s[8:11], s59 offen offset:0 sc1
    v_mfma_f32_16x16x32_bf16 a[156:159], a[224:227], a[40:43], a[156:159]
    v_fmac_f32 v207, v8, v167
    v_exp_f32 v196, v196
    v_mfma_f32_16x16x32_bf16 a[160:163], a[224:227], a[44:47], a[160:163]
    s_add_u32 s59, s37, 4096
    buffer_load_dwordx4 a[176:179], v3, s[8:11], s59 offen offset:1024 sc1
    s_waitcnt lgkmcnt(2)
    v_fmac_f32 v212, v8, v168
    v_mfma_f32_16x16x32_bf16 a[156:159], a[228:231], a[48:51], a[156:159]
    v_exp_f32 v197, v197
    v_fmac_f32 v213, v8, v169
    v_mfma_f32_16x16x32_bf16 a[160:163], a[228:231], a[52:55], a[160:163]
    s_add_u32 s59, s37, 4096
    buffer_load_dwordx4 a[180:183], v14, s[8:11], s59 offen offset:1024 sc1
    v_exp_f32 v198, v198
    v_mfma_f32_16x16x32_bf16 a[156:159], v[60:63], a[56:59], a[156:159]
    v_fmac_f32 v214, v8, v170
    v_exp_f32 v199, v199
    v_mfma_f32_16x16x32_bf16 a[160:163], v[60:63], a[60:63], a[160:163]
    s_add_u32 s59, s37, 4096
    buffer_load_dwordx4 a[184:187], v3, s[8:11], s59 offen offset:2048 sc1
    v_fmac_f32 v215, v8, v171
    v_mfma_f32_16x16x32_bf16 a[156:159], a[8:11], a[64:67], a[156:159]
    v_add_f32 v188, 1.0, v188
    v_add_f32 v189, 1.0, v189
    v_mfma_f32_16x16x32_bf16 a[160:163], a[8:11], a[68:71], a[160:163]
    s_add_u32 s59, s37, 4096
    buffer_load_dwordx4 a[188:191], v14, s[8:11], s59 offen offset:2048 sc1
    v_add_f32 v190, 1.0, v190
    v_mfma_f32_16x16x32_bf16 a[120:123], a[232:235], a[16:19], 0
    v_add_f32 v191, 1.0, v191
    v_add_f32 v196, 1.0, v196
    v_mfma_f32_16x16x32_bf16 a[124:127], a[232:235], a[20:23], 0
    s_add_u32 s59, s32, 294912
    buffer_load_dwordx4 v[68:71], v3, s[8:11], s59 offen offset:0 sc1
    v_add_f32 v197, 1.0, v197
    v_mfma_f32_16x16x32_bf16 a[120:123], a[236:239], a[24:27], a[120:123]
    v_add_f32 v198, 1.0, v198
    v_add_f32 v199, 1.0, v199
    v_mfma_f32_16x16x32_bf16 a[124:127], a[236:239], a[28:31], a[124:127]
    s_add_u32 s59, s32, 258048
    buffer_load_dwordx4 v[72:75], v3, s[8:11], s59 offen offset:1024 sc1
    v_rcp_f32 v188, v188
    v_mfma_f32_16x16x32_bf16 a[120:123], a[240:243], a[32:35], a[120:123]
    ds_write_b128 v4, a[156:159] offset:2048
    v_rcp_f32 v189, v189
    v_mfma_f32_16x16x32_bf16 a[124:127], a[240:243], a[36:39], a[124:127]
    ds_write_b128 v4, a[160:163] offset:3072
    s_add_u32 s59, s32, 294912
    buffer_load_dwordx4 a[156:159], v3, s[8:11], s59 offen offset:1024 sc1
    v_mfma_f32_16x16x32_bf16 a[120:123], a[244:247], a[40:43], a[120:123]
    v_rcp_f32 v190, v190
    v_rcp_f32 v191, v191
    v_mfma_f32_16x16x32_bf16 a[124:127], a[244:247], a[44:47], a[124:127]
    s_add_u32 s59, s32, 258048
    buffer_load_dwordx4 a[160:163], v3, s[8:11], s59 offen offset:2048 sc1
    v_rcp_f32 v196, v196
    v_mfma_f32_16x16x32_bf16 a[120:123], a[248:251], a[48:51], a[120:123]
    v_rcp_f32 v197, v197
    v_rcp_f32 v198, v198
    v_mfma_f32_16x16x32_bf16 a[124:127], a[248:251], a[52:55], a[124:127]
    s_add_u32 s59, s32, 294912
    buffer_load_dwordx4 v[76:79], v3, s[8:11], s59 offen offset:2048 sc1
    v_rcp_f32 v199, v199
    v_mfma_f32_16x16x32_bf16 a[120:123], a[12:15], a[56:59], a[120:123]
    v_mul_f32 v204, v188, v204
    v_mul_f32 v205, v189, v205
    v_mfma_f32_16x16x32_bf16 a[124:127], a[12:15], a[60:63], a[124:127]
    s_add_u32 s59, s32, 258048
    buffer_load_dwordx4 v[80:83], v3, s[8:11], s59 offen offset:3072 sc1
    v_mul_f32 v206, v190, v206
    v_mfma_f32_16x16x32_bf16 a[120:123], a[72:75], a[64:67], a[120:123]
    v_mul_f32 v207, v191, v207
    v_mul_f32 v212, v196, v212
    v_mfma_f32_16x16x32_bf16 a[124:127], a[72:75], a[68:71], a[124:127]
    s_add_u32 s59, s32, 294912
    buffer_load_dwordx4 v[140:143], v3, s[8:11], s59 offen offset:3072 sc1
    v_mul_f32 v213, v197, v213
    v_mfma_f32_16x16x32_bf16 v[144:147], a[252:255], a[16:19], 0
    v_mul_f32 v214, v198, v214
    v_mul_f32 v215, v199, v215
    v_mfma_f32_16x16x32_bf16 v[148:151], a[252:255], a[20:23], 0
    v_cvt_pk_bf16_f32 v16, v204, v205
    v_cvt_pk_bf16_f32 v17, v206, v207
    v_mfma_f32_16x16x32_bf16 v[144:147], v[220:223], a[24:27], v[144:147]
    v_cvt_pk_bf16_f32 v18, v212, v213
    v_cvt_pk_bf16_f32 v19, v214, v215
    v_mfma_f32_16x16x32_bf16 v[148:151], v[220:223], a[28:31], v[148:151]
    s_add_u32 s28, s28, 4096
    buffer_store_dwordx4 v[16:19], v3, s[8:11], s28 offen offset:0 sc1
    v_mul_f32 v192, v11, v192
    v_mfma_f32_16x16x32_bf16 v[144:147], v[224:227], a[32:35], v[144:147]
    ds_write_b128 v4, a[120:123] offset:4096
    v_mul_f32 v193, v11, v193
    v_mfma_f32_16x16x32_bf16 v[148:151], v[224:227], a[36:39], v[148:151]
    ds_write_b128 v4, a[124:127] offset:5120
    s_add_u32 s59, s32, 262144
    buffer_load_dwordx4 a[120:123], v3, s[8:11], s59 offen offset:0 sc1
    v_mfma_f32_16x16x32_bf16 v[144:147], v[228:231], a[40:43], v[144:147]
    v_mul_f32 v194, v11, v194
    v_mul_f32 v195, v11, v195
    v_mfma_f32_16x16x32_bf16 v[148:151], v[228:231], a[44:47], v[148:151]
    v_mul_f32 v200, v11, v200
    v_mul_f32 v201, v11, v201
    v_mfma_f32_16x16x32_bf16 v[144:147], v[232:235], a[48:51], v[144:147]
    v_mul_f32 v202, v11, v202
    v_mul_f32 v203, v11, v203
    v_mfma_f32_16x16x32_bf16 v[148:151], v[232:235], a[52:55], v[148:151]
    v_fmac_f32 v192, v13, v156
    v_fmac_f32 v193, v13, v157
    v_mfma_f32_16x16x32_bf16 v[144:147], a[76:79], a[56:59], v[144:147]
    v_fmac_f32 v194, v13, v158
    v_fmac_f32 v195, v13, v159
    v_mfma_f32_16x16x32_bf16 v[148:151], a[76:79], a[60:63], v[148:151]
    v_fmac_f32 v200, v13, v160
    v_fmac_f32 v201, v13, v161
    v_mfma_f32_16x16x32_bf16 v[144:147], a[80:83], a[64:67], v[144:147]
    v_fmac_f32 v202, v13, v162
    v_fmac_f32 v203, v13, v163
    v_mfma_f32_16x16x32_bf16 v[148:151], a[80:83], a[68:71], v[148:151]
    v_exp_f32 v192, v192
    v_fmac_f32 v208, v9, v164
    v_mfma_f32_16x16x32_bf16 a[124:127], v[236:239], a[16:19], 0
    v_exp_f32 v193, v193
    v_fmac_f32 v209, v9, v165
    v_mfma_f32_16x16x32_bf16 v[152:155], v[236:239], a[20:23], 0
    v_exp_f32 v194, v194
    v_fmac_f32 v210, v9, v166
    v_mfma_f32_16x16x32_bf16 a[124:127], v[28:31], a[24:27], a[124:127]
    v_exp_f32 v195, v195
    v_fmac_f32 v211, v9, v167
    v_mfma_f32_16x16x32_bf16 v[152:155], v[28:31], a[28:31], v[152:155]
    v_exp_f32 v200, v200
    v_fmac_f32 v216, v9, v168
    v_mfma_f32_16x16x32_bf16 a[124:127], v[32:35], a[32:35], a[124:127]
    ds_write_b128 v4, v[144:147] offset:6144
    v_exp_f32 v201, v201
    v_mfma_f32_16x16x32_bf16 v[152:155], v[32:35], a[36:39], v[152:155]
    ds_write_b128 v4, v[148:151] offset:7168
    v_fmac_f32 v217, v9, v169
    v_mfma_f32_16x16x32_bf16 a[124:127], v[36:39], a[40:43], a[124:127]
    v_exp_f32 v202, v202
    v_fmac_f32 v218, v9, v170
    v_mfma_f32_16x16x32_bf16 v[152:155], v[36:39], a[44:47], v[152:155]
    v_exp_f32 v203, v203
    v_fmac_f32 v219, v9, v171
    v_mfma_f32_16x16x32_bf16 a[124:127], v[40:43], a[48:51], a[124:127]
    v_add_f32 v192, 1.0, v192
    v_add_f32 v193, 1.0, v193
    v_mfma_f32_16x16x32_bf16 v[152:155], v[40:43], a[52:55], v[152:155]
    v_add_f32 v194, 1.0, v194
    v_add_f32 v195, 1.0, v195
    v_mfma_f32_16x16x32_bf16 a[124:127], a[84:87], a[56:59], a[124:127]
    v_add_f32 v200, 1.0, v200
    v_add_f32 v201, 1.0, v201
    v_mfma_f32_16x16x32_bf16 v[152:155], a[84:87], a[60:63], v[152:155]
    v_add_f32 v202, 1.0, v202
    v_add_f32 v203, 1.0, v203
    v_mfma_f32_16x16x32_bf16 a[124:127], a[88:91], a[64:67], a[124:127]
    v_rcp_f32 v192, v192
    v_rcp_f32 v193, v193
    v_mfma_f32_16x16x32_bf16 v[152:155], a[88:91], a[68:71], v[152:155]
    v_rcp_f32 v194, v194
    v_rcp_f32 v195, v195
    v_mfma_f32_16x16x32_bf16 v[240:243], v[44:47], a[16:19], 0
    v_rcp_f32 v200, v200
    v_rcp_f32 v201, v201
    v_mfma_f32_16x16x32_bf16 v[244:247], v[44:47], a[20:23], 0
    v_rcp_f32 v202, v202
    v_rcp_f32 v203, v203
    v_mfma_f32_16x16x32_bf16 v[240:243], v[48:51], a[24:27], v[240:243]
    v_mul_f32 v208, v192, v208
    v_mul_f32 v209, v193, v209
    v_mfma_f32_16x16x32_bf16 v[244:247], v[48:51], a[28:31], v[244:247]
    v_mul_f32 v210, v194, v210
    v_mul_f32 v211, v195, v211
    v_mfma_f32_16x16x32_bf16 v[240:243], v[84:87], a[32:35], v[240:243]
    ds_write_b128 v4, a[124:127] offset:8192
    v_mul_f32 v216, v200, v216
    v_mfma_f32_16x16x32_bf16 v[244:247], v[84:87], a[36:39], v[244:247]
    ds_write_b128 v4, v[152:155] offset:9216
    v_mul_f32 v217, v201, v217
    v_mfma_f32_16x16x32_bf16 v[240:243], v[88:91], a[40:43], v[240:243]
    v_mul_f32 v218, v202, v218
    v_mul_f32 v219, v203, v219
    v_mfma_f32_16x16x32_bf16 v[244:247], v[88:91], a[44:47], v[244:247]
    v_cvt_pk_bf16_f32 v20, v208, v209
    v_cvt_pk_bf16_f32 v21, v210, v211
    v_mfma_f32_16x16x32_bf16 v[240:243], v[92:95], a[48:51], v[240:243]
    v_cvt_pk_bf16_f32 v22, v216, v217
    v_cvt_pk_bf16_f32 v23, v218, v219
    v_mfma_f32_16x16x32_bf16 v[244:247], v[92:95], a[52:55], v[244:247]
    buffer_store_dwordx4 v[20:23], v14, s[8:11], s28 offen offset:0 sc1
    v_mfma_f32_16x16x32_bf16 v[240:243], a[92:95], a[56:59], v[240:243]
    v_mfma_f32_16x16x32_bf16 v[244:247], a[92:95], a[60:63], v[244:247]
    s_add_u32 s59, s32, 299008
    buffer_load_dwordx4 a[124:127], v3, s[8:11], s59 offen offset:0 sc1
    v_mfma_f32_16x16x32_bf16 v[240:243], a[96:99], a[64:67], v[240:243]
    v_mfma_f32_16x16x32_bf16 v[244:247], a[96:99], a[68:71], v[244:247]
    s_add_u32 s59, s32, 262144
    buffer_load_dwordx4 v[248:251], v3, s[8:11], s59 offen offset:1024 sc1
    v_mfma_f32_16x16x32_bf16 v[252:255], v[96:99], a[16:19], 0
    v_mfma_f32_16x16x32_bf16 v[144:147], v[96:99], a[20:23], 0
    s_add_u32 s59, s32, 299008
    buffer_load_dwordx4 v[148:151], v3, s[8:11], s59 offen offset:1024 sc1
    v_mfma_f32_16x16x32_bf16 v[252:255], v[100:103], a[24:27], v[252:255]
    v_mfma_f32_16x16x32_bf16 v[144:147], v[100:103], a[28:31], v[144:147]
    s_add_u32 s59, s32, 262144
    buffer_load_dwordx4 v[152:155], v3, s[8:11], s59 offen offset:2048 sc1
    v_mfma_f32_16x16x32_bf16 v[252:255], v[104:107], a[32:35], v[252:255]
    ds_write_b128 v4, v[240:243] offset:10240
    v_mfma_f32_16x16x32_bf16 v[144:147], v[104:107], a[36:39], v[144:147]
    ds_write_b128 v4, v[244:247] offset:11264
    s_add_u32 s59, s32, 299008
    buffer_load_dwordx4 v[188:191], v3, s[8:11], s59 offen offset:2048 sc1
    v_mfma_f32_16x16x32_bf16 v[252:255], v[108:111], a[40:43], v[252:255]
    v_mfma_f32_16x16x32_bf16 v[144:147], v[108:111], a[44:47], v[144:147]
    s_add_u32 s59, s32, 262144
    buffer_load_dwordx4 v[192:195], v3, s[8:11], s59 offen offset:3072 sc1
    v_mfma_f32_16x16x32_bf16 v[252:255], v[112:115], a[48:51], v[252:255]
    v_mfma_f32_16x16x32_bf16 v[144:147], v[112:115], a[52:55], v[144:147]
    s_add_u32 s59, s32, 299008
    buffer_load_dwordx4 v[196:199], v3, s[8:11], s59 offen offset:3072 sc1
    v_mfma_f32_16x16x32_bf16 v[252:255], a[100:103], a[56:59], v[252:255]
    v_mfma_f32_16x16x32_bf16 v[144:147], a[100:103], a[60:63], v[144:147]
    s_add_u32 s59, s32, 266240
    buffer_load_dwordx4 v[200:203], v3, s[8:11], s59 offen offset:0 sc1
    v_mfma_f32_16x16x32_bf16 v[252:255], a[104:107], a[64:67], v[252:255]
    v_mfma_f32_16x16x32_bf16 v[144:147], a[104:107], a[68:71], v[144:147]
    s_add_u32 s59, s32, 303104
    buffer_load_dwordx4 v[204:207], v3, s[8:11], s59 offen offset:0 sc1
    v_mfma_f32_16x16x32_bf16 v[208:211], v[116:119], a[16:19], 0
    v_mfma_f32_16x16x32_bf16 v[212:215], v[116:119], a[20:23], 0
    buffer_load_dwordx4 v[216:219], v3, s[8:11], s38 offen offset:0 sc1
    v_mfma_f32_16x16x32_bf16 v[208:211], v[120:123], a[24:27], v[208:211]
    v_mfma_f32_16x16x32_bf16 v[212:215], v[120:123], a[28:31], v[212:215]
    v_mfma_f32_16x16x32_bf16 v[208:211], v[124:127], a[32:35], v[208:211]
    ds_write_b128 v4, v[252:255] offset:12288
    v_mfma_f32_16x16x32_bf16 v[212:215], v[124:127], a[36:39], v[212:215]
    ds_write_b128 v4, v[144:147] offset:13312
    buffer_load_dwordx4 v[156:159], v14, s[8:11], s38 offen offset:0 sc1
    v_mfma_f32_16x16x32_bf16 v[208:211], v[128:131], a[40:43], v[208:211]
    v_mfma_f32_16x16x32_bf16 v[212:215], v[128:131], a[44:47], v[212:215]
    buffer_load_dwordx4 v[160:163], v3, s[8:11], s38 offen offset:1024 sc1
    v_mfma_f32_16x16x32_bf16 v[208:211], v[132:135], a[48:51], v[208:211]
    v_mfma_f32_16x16x32_bf16 v[212:215], v[132:135], a[52:55], v[212:215]
    v_mfma_f32_16x16x32_bf16 v[208:211], a[108:111], a[56:59], v[208:211]
    v_mfma_f32_16x16x32_bf16 v[212:215], a[108:111], a[60:63], v[212:215]
    v_mfma_f32_16x16x32_bf16 v[208:211], a[112:115], a[64:67], v[208:211]
    v_mfma_f32_16x16x32_bf16 v[212:215], a[112:115], a[68:71], v[212:215]
    v_mfma_f32_16x16x32_bf16 v[164:167], v[136:139], a[16:19], 0
    v_mfma_f32_16x16x32_bf16 v[168:171], v[136:139], a[20:23], 0
    v_mfma_f32_16x16x32_bf16 v[164:167], v[172:175], a[24:27], v[164:167]
    v_mfma_f32_16x16x32_bf16 v[168:171], v[172:175], a[28:31], v[168:171]
    buffer_load_dwordx4 a[16:19], v14, s[8:11], s38 offen offset:1024 sc1
    v_mfma_f32_16x16x32_bf16 v[164:167], v[176:179], a[32:35], v[164:167]
    s_nop 0
    ds_write_b128 v4, v[208:211] offset:14336
    v_mfma_f32_16x16x32_bf16 v[168:171], v[176:179], a[36:39], v[168:171]
    ds_write_b128 v4, v[212:215] offset:15360
    buffer_load_dwordx4 a[20:23], v3, s[8:11], s38 offen offset:2048 sc1
    v_mfma_f32_16x16x32_bf16 v[164:167], v[180:183], a[40:43], v[164:167]
    v_mfma_f32_16x16x32_bf16 v[168:171], v[180:183], a[44:47], v[168:171]
    buffer_load_dwordx4 a[24:27], v14, s[8:11], s38 offen offset:2048 sc1
    v_mfma_f32_16x16x32_bf16 v[164:167], v[184:187], a[48:51], v[164:167]
    s_waitcnt vmcnt(15)
    v_mov_b32 v25, 2
    buffer_store_dword v25, v15, s[8:11], s44 offen sc1
    v_mfma_f32_16x16x32_bf16 v[168:171], v[184:187], a[52:55], v[168:171]
    buffer_load_dwordx4 a[28:31], v3, s[8:11], s38 offen offset:3072 sc1
    v_mfma_f32_16x16x32_bf16 v[164:167], a[116:119], a[56:59], v[164:167]
    v_mfma_f32_16x16x32_bf16 v[168:171], a[116:119], a[60:63], v[168:171]
    buffer_load_dwordx4 a[32:35], v14, s[8:11], s38 offen offset:3072 sc1
    v_mfma_f32_16x16x32_bf16 v[164:167], v[64:67], a[64:67], v[164:167]
    v_mfma_f32_16x16x32_bf16 v[168:171], v[64:67], a[68:71], v[168:171]
    s_add_u32 s59, s38, 4096
    buffer_load_dwordx4 a[36:39], v3, s[8:11], s59 offen offset:0 sc1
    v_mfma_f32_16x16x32_bf16 a[40:43], a[192:195], a[128:131], 0
    v_mfma_f32_16x16x32_bf16 a[44:47], a[192:195], a[132:135], 0
    s_add_u32 s59, s38, 4096
    buffer_load_dwordx4 a[48:51], v14, s[8:11], s59 offen offset:0 sc1
    v_mfma_f32_16x16x32_bf16 a[40:43], a[196:199], a[136:139], a[40:43]
    v_mfma_f32_16x16x32_bf16 a[44:47], a[196:199], a[140:143], a[44:47]
    s_add_u32 s59, s38, 4096
    buffer_load_dwordx4 a[52:55], v3, s[8:11], s59 offen offset:1024 sc1
    v_mfma_f32_16x16x32_bf16 a[40:43], a[200:203], a[144:147], a[40:43]
    ds_write_b128 v4, v[164:167] offset:16384
    v_mfma_f32_16x16x32_bf16 a[44:47], a[200:203], a[148:151], a[44:47]
    ds_write_b128 v4, v[168:171] offset:17408
    s_add_u32 s59, s38, 4096
    buffer_load_dwordx4 a[56:59], v14, s[8:11], s59 offen offset:1024 sc1
    v_mfma_f32_16x16x32_bf16 a[40:43], a[204:207], a[152:155], a[40:43]
    v_mfma_f32_16x16x32_bf16 a[44:47], a[204:207], a[164:167], a[44:47]
    s_add_u32 s59, s38, 4096
    buffer_load_dwordx4 a[60:63], v3, s[8:11], s59 offen offset:2048 sc1
    v_mfma_f32_16x16x32_bf16 a[40:43], a[208:211], a[168:171], a[40:43]
    v_mfma_f32_16x16x32_bf16 a[44:47], a[208:211], a[172:175], a[44:47]
    s_add_u32 s59, s38, 4096
    buffer_load_dwordx4 a[64:67], v14, s[8:11], s59 offen offset:2048 sc1
    v_mfma_f32_16x16x32_bf16 a[40:43], a[0:3], a[176:179], a[40:43]
    v_mfma_f32_16x16x32_bf16 a[44:47], a[0:3], a[180:183], a[44:47]
    v_mfma_f32_16x16x32_bf16 a[40:43], a[4:7], a[184:187], a[40:43]
    v_mfma_f32_16x16x32_bf16 a[44:47], a[4:7], a[188:191], a[44:47]
    v_mfma_f32_16x16x32_bf16 a[68:71], a[212:215], a[128:131], 0
    v_mfma_f32_16x16x32_bf16 v[240:243], a[212:215], a[132:135], 0
    v_mfma_f32_16x16x32_bf16 a[68:71], a[216:219], a[136:139], a[68:71]
    v_mfma_f32_16x16x32_bf16 v[240:243], a[216:219], a[140:143], v[240:243]
    v_mfma_f32_16x16x32_bf16 a[68:71], a[220:223], a[144:147], a[68:71]
    s_nop 1
    ds_write_b128 v5, a[40:43] offset:0
    v_mfma_f32_16x16x32_bf16 v[240:243], a[220:223], a[148:151], v[240:243]
    ds_write_b128 v5, a[44:47] offset:1024
    v_mfma_f32_16x16x32_bf16 a[68:71], a[224:227], a[152:155], a[68:71]
    v_mfma_f32_16x16x32_bf16 v[240:243], a[224:227], a[164:167], v[240:243]
    v_mfma_f32_16x16x32_bf16 a[68:71], a[228:231], a[168:171], a[68:71]
    v_mfma_f32_16x16x32_bf16 v[240:243], a[228:231], a[172:175], v[240:243]
    v_mfma_f32_16x16x32_bf16 a[68:71], v[60:63], a[176:179], a[68:71]
    v_mfma_f32_16x16x32_bf16 v[240:243], v[60:63], a[180:183], v[240:243]
    v_mfma_f32_16x16x32_bf16 a[68:71], a[8:11], a[184:187], a[68:71]
    v_mfma_f32_16x16x32_bf16 v[240:243], a[8:11], a[188:191], v[240:243]
    v_mfma_f32_16x16x32_bf16 a[40:43], a[232:235], a[128:131], 0
    v_mfma_f32_16x16x32_bf16 a[44:47], a[232:235], a[132:135], 0
    v_mfma_f32_16x16x32_bf16 a[40:43], a[236:239], a[136:139], a[40:43]
    v_mfma_f32_16x16x32_bf16 a[44:47], a[236:239], a[140:143], a[44:47]
    v_mfma_f32_16x16x32_bf16 a[40:43], a[240:243], a[144:147], a[40:43]
    s_nop 1
    ds_write_b128 v5, a[68:71] offset:2048
    v_mfma_f32_16x16x32_bf16 a[44:47], a[240:243], a[148:151], a[44:47]
    ds_write_b128 v5, v[240:243] offset:3072
    v_mfma_f32_16x16x32_bf16 a[40:43], a[244:247], a[152:155], a[40:43]
    v_mfma_f32_16x16x32_bf16 a[44:47], a[244:247], a[164:167], a[44:47]
    v_mfma_f32_16x16x32_bf16 a[40:43], a[248:251], a[168:171], a[40:43]
    v_mfma_f32_16x16x32_bf16 a[44:47], a[248:251], a[172:175], a[44:47]
    v_mfma_f32_16x16x32_bf16 a[40:43], a[12:15], a[176:179], a[40:43]
    v_mfma_f32_16x16x32_bf16 a[44:47], a[12:15], a[180:183], a[44:47]
    v_mfma_f32_16x16x32_bf16 a[40:43], a[72:75], a[184:187], a[40:43]
    v_mfma_f32_16x16x32_bf16 a[44:47], a[72:75], a[188:191], a[44:47]
    v_mfma_f32_16x16x32_bf16 a[68:71], a[252:255], a[128:131], 0
    v_mfma_f32_16x16x32_bf16 v[244:247], a[252:255], a[132:135], 0
    v_mfma_f32_16x16x32_bf16 a[68:71], v[220:223], a[136:139], a[68:71]
    v_mfma_f32_16x16x32_bf16 v[244:247], v[220:223], a[140:143], v[244:247]
    v_mfma_f32_16x16x32_bf16 a[68:71], v[224:227], a[144:147], a[68:71]
    s_nop 1
    ds_write_b128 v5, a[40:43] offset:4096
    v_mfma_f32_16x16x32_bf16 v[244:247], v[224:227], a[148:151], v[244:247]
    ds_write_b128 v5, a[44:47] offset:5120
    v_mfma_f32_16x16x32_bf16 a[68:71], v[228:231], a[152:155], a[68:71]
    v_mfma_f32_16x16x32_bf16 v[244:247], v[228:231], a[164:167], v[244:247]
    v_mfma_f32_16x16x32_bf16 a[68:71], v[232:235], a[168:171], a[68:71]
    v_mfma_f32_16x16x32_bf16 v[244:247], v[232:235], a[172:175], v[244:247]
    v_mfma_f32_16x16x32_bf16 a[68:71], a[76:79], a[176:179], a[68:71]
    v_mfma_f32_16x16x32_bf16 v[244:247], a[76:79], a[180:183], v[244:247]
    v_mfma_f32_16x16x32_bf16 a[68:71], a[80:83], a[184:187], a[68:71]
    v_mfma_f32_16x16x32_bf16 v[244:247], a[80:83], a[188:191], v[244:247]
    v_mfma_f32_16x16x32_bf16 a[40:43], v[236:239], a[128:131], 0
    v_mfma_f32_16x16x32_bf16 a[44:47], v[236:239], a[132:135], 0
    v_mfma_f32_16x16x32_bf16 a[40:43], v[28:31], a[136:139], a[40:43]
    v_mfma_f32_16x16x32_bf16 a[44:47], v[28:31], a[140:143], a[44:47]
    v_mfma_f32_16x16x32_bf16 a[40:43], v[32:35], a[144:147], a[40:43]
    s_nop 1
    ds_write_b128 v5, a[68:71] offset:6144
    v_mfma_f32_16x16x32_bf16 a[44:47], v[32:35], a[148:151], a[44:47]
    ds_write_b128 v5, v[244:247] offset:7168
    v_mfma_f32_16x16x32_bf16 a[40:43], v[36:39], a[152:155], a[40:43]
    v_mfma_f32_16x16x32_bf16 a[44:47], v[36:39], a[164:167], a[44:47]
    v_mfma_f32_16x16x32_bf16 a[40:43], v[40:43], a[168:171], a[40:43]
    v_mfma_f32_16x16x32_bf16 a[44:47], v[40:43], a[172:175], a[44:47]
    v_mfma_f32_16x16x32_bf16 a[40:43], a[84:87], a[176:179], a[40:43]
    buffer_load_dwordx4 v[52:55], v15, s[8:11], s40 offen sc1
    v_mfma_f32_16x16x32_bf16 a[44:47], a[84:87], a[180:183], a[44:47]
    v_mfma_f32_16x16x32_bf16 a[40:43], a[88:91], a[184:187], a[40:43]
    v_mfma_f32_16x16x32_bf16 a[44:47], a[88:91], a[188:191], a[44:47]
    v_mfma_f32_16x16x32_bf16 a[68:71], v[44:47], a[128:131], 0
    v_mfma_f32_16x16x32_bf16 v[252:255], v[44:47], a[132:135], 0
    v_mfma_f32_16x16x32_bf16 a[68:71], v[48:51], a[136:139], a[68:71]
    v_mfma_f32_16x16x32_bf16 v[252:255], v[48:51], a[140:143], v[252:255]
    v_mfma_f32_16x16x32_bf16 a[68:71], v[84:87], a[144:147], a[68:71]
    s_nop 1
    ds_write_b128 v5, a[40:43] offset:8192
    v_mfma_f32_16x16x32_bf16 v[252:255], v[84:87], a[148:151], v[252:255]
    ds_write_b128 v5, a[44:47] offset:9216
    v_mfma_f32_16x16x32_bf16 a[68:71], v[88:91], a[152:155], a[68:71]
    v_mfma_f32_16x16x32_bf16 v[252:255], v[88:91], a[164:167], v[252:255]
    v_mfma_f32_16x16x32_bf16 a[68:71], v[92:95], a[168:171], a[68:71]
    v_mfma_f32_16x16x32_bf16 v[252:255], v[92:95], a[172:175], v[252:255]
    v_mfma_f32_16x16x32_bf16 a[68:71], a[92:95], a[176:179], a[68:71]
    v_mfma_f32_16x16x32_bf16 v[252:255], a[92:95], a[180:183], v[252:255]
    v_mfma_f32_16x16x32_bf16 a[68:71], a[96:99], a[184:187], a[68:71]
    v_mfma_f32_16x16x32_bf16 v[252:255], a[96:99], a[188:191], v[252:255]
    v_mfma_f32_16x16x32_bf16 a[40:43], v[96:99], a[128:131], 0
    v_mfma_f32_16x16x32_bf16 a[44:47], v[96:99], a[132:135], 0
    v_mfma_f32_16x16x32_bf16 a[40:43], v[100:103], a[136:139], a[40:43]
    v_mfma_f32_16x16x32_bf16 a[44:47], v[100:103], a[140:143], a[44:47]
    v_mfma_f32_16x16x32_bf16 a[40:43], v[104:107], a[144:147], a[40:43]
    s_nop 1
    ds_write_b128 v5, a[68:71] offset:10240
    v_mfma_f32_16x16x32_bf16 a[44:47], v[104:107], a[148:151], a[44:47]
    ds_write_b128 v5, v[252:255] offset:11264
    v_mfma_f32_16x16x32_bf16 a[40:43], v[108:111], a[152:155], a[40:43]
    s_waitcnt vmcnt(0)
    v_min_u32 v52, v52, v53
    v_min_u32 v54, v54, v55
    v_min_u32 v52, v52, v54
    s_nop 0
    v_readfirstlane_b32 s59, v52
    s_nop 0
    s_cmp_ge_u32 s59, 2
    s_cbranch_scc1 KCD_PD2
    s_mov_b32 s60, 20000
KCD_PL2:
    s_sub_u32 s60, s60, 1
    s_cmp_eq_u32 s60, 0
    s_cbranch_scc1 KCD_PD2
    s_sleep 1
    buffer_load_dwordx4 v[52:55], v15, s[8:11], s40 offen sc1
    s_waitcnt vmcnt(0)
    v_min_u32 v52, v52, v53
    v_min_u32 v54, v54, v55
    v_min_u32 v52, v52, v54
    s_nop 0
    v_readfirstlane_b32 s59, v52
    s_nop 0
    s_cmp_ge_u32 s59, 2
    s_cbranch_scc0 KCD_PL2
KCD_PD2:
    v_mfma_f32_16x16x32_bf16 a[44:47], v[108:111], a[164:167], a[44:47]
    s_add_u32 s59, s36, 4096
    buffer_load_dwordx4 a[68:71], v3, s[8:11], s59 offen offset:3072 sc1
    v_mfma_f32_16x16x32_bf16 a[40:43], v[112:115], a[168:171], a[40:43]
    v_mfma_f32_16x16x32_bf16 a[44:47], v[112:115], a[172:175], a[44:47]
    s_add_u32 s59, s36, 4096
    buffer_load_dwordx4 v[144:147], v14, s[8:11], s59 offen offset:3072 sc1
    v_mfma_f32_16x16x32_bf16 a[40:43], a[100:103], a[176:179], a[40:43]
    v_mfma_f32_16x16x32_bf16 a[44:47], a[100:103], a[180:183], a[44:47]
    s_add_u32 s59, s36, 8192
    buffer_load_dwordx4 v[208:211], v3, s[8:11], s59 offen offset:0 sc1
    v_mfma_f32_16x16x32_bf16 a[40:43], a[104:107], a[184:187], a[40:43]
    v_mfma_f32_16x16x32_bf16 a[44:47], a[104:107], a[188:191], a[44:47]
    s_add_u32 s59, s36, 8192
    buffer_load_dwordx4 v[212:215], v14, s[8:11], s59 offen offset:0 sc1
    v_mfma_f32_16x16x32_bf16 v[164:167], v[116:119], a[128:131], 0
    v_mfma_f32_16x16x32_bf16 v[168:171], v[116:119], a[132:135], 0
    v_mfma_f32_16x16x32_bf16 v[164:167], v[120:123], a[136:139], v[164:167]
    v_mfma_f32_16x16x32_bf16 v[168:171], v[120:123], a[140:143], v[168:171]
    v_mfma_f32_16x16x32_bf16 v[164:167], v[124:127], a[144:147], v[164:167]
    ds_write_b128 v5, a[40:43] offset:12288
    v_mfma_f32_16x16x32_bf16 v[168:171], v[124:127], a[148:151], v[168:171]
    ds_write_b128 v5, a[44:47] offset:13312
    v_mfma_f32_16x16x32_bf16 v[164:167], v[128:131], a[152:155], v[164:167]
    v_mfma_f32_16x16x32_bf16 v[168:171], v[128:131], a[164:167], v[168:171]
    v_mfma_f32_16x16x32_bf16 v[164:167], v[132:135], a[168:171], v[164:167]
    v_mfma_f32_16x16x32_bf16 v[168:171], v[132:135], a[172:175], v[168:171]
    v_mfma_f32_16x16x32_bf16 v[164:167], a[108:111], a[176:179], v[164:167]
    v_mfma_f32_16x16x32_bf16 v[168:171], a[108:111], a[180:183], v[168:171]
    v_mfma_f32_16x16x32_bf16 v[164:167], a[112:115], a[184:187], v[164:167]
    v_mfma_f32_16x16x32_bf16 v[168:171], a[112:115], a[188:191], v[168:171]
    v_mfma_f32_16x16x32_bf16 a[40:43], v[136:139], a[128:131], 0
    v_mfma_f32_16x16x32_bf16 a[44:47], v[136:139], a[132:135], 0
    v_mfma_f32_16x16x32_bf16 a[40:43], v[172:175], a[136:139], a[40:43]
    v_mfma_f32_16x16x32_bf16 a[44:47], v[172:175], a[140:143], a[44:47]
    s_add_u32 s59, s37, 4096
    buffer_load_dwordx4 a[128:131], v3, s[8:11], s59 offen offset:3072 sc1
    v_mfma_f32_16x16x32_bf16 a[40:43], v[176:179], a[144:147], a[40:43]
    ds_write_b128 v5, v[164:167] offset:14336
    v_mfma_f32_16x16x32_bf16 a[44:47], v[176:179], a[148:151], a[44:47]
    ds_write_b128 v5, v[168:171] offset:15360
    s_add_u32 s59, s37, 4096
    buffer_load_dwordx4 a[132:135], v14, s[8:11], s59 offen offset:3072 sc1
    v_mfma_f32_16x16x32_bf16 a[40:43], v[180:183], a[152:155], a[40:43]
    v_mfma_f32_16x16x32_bf16 a[44:47], v[180:183], a[164:167], a[44:47]
    s_add_u32 s59, s37, 8192
    buffer_load_dwordx4 a[136:139], v3, s[8:11], s59 offen offset:0 sc1
    v_mfma_f32_16x16x32_bf16 a[40:43], v[184:187], a[168:171], a[40:43]
    v_mfma_f32_16x16x32_bf16 a[44:47], v[184:187], a[172:175], a[44:47]
    s_add_u32 s59, s37, 8192
    buffer_load_dwordx4 a[140:143], v14, s[8:11], s59 offen offset:0 sc1
    v_mfma_f32_16x16x32_bf16 a[40:43], a[116:119], a[176:179], a[40:43]
    v_mfma_f32_16x16x32_bf16 a[44:47], a[116:119], a[180:183], a[44:47]
    s_add_u32 s59, s38, 4096
    buffer_load_dwordx4 a[144:147], v3, s[8:11], s59 offen offset:3072 sc1
    v_mfma_f32_16x16x32_bf16 a[40:43], v[64:67], a[184:187], a[40:43]
    v_mfma_f32_16x16x32_bf16 a[44:47], v[64:67], a[188:191], a[44:47]
    s_add_u32 s59, s38, 4096
    buffer_load_dwordx4 a[148:151], v14, s[8:11], s59 offen offset:3072 sc1
    ds_read_b128 a[152:155], v4 offset:0
    ds_read_b128 a[164:167], v4 offset:1024
    ds_read_b128 a[168:171], v4 offset:2048
    ds_read_b128 a[172:175], v4 offset:3072
    ds_read_b128 a[176:179], v4 offset:4096
    ds_read_b128 a[180:183], v4 offset:5120
    ds_read_b128 a[184:187], v4 offset:6144
    ds_read_b128 a[188:191], v4 offset:7168
    s_waitcnt vmcnt(9) lgkmcnt(7)
    v_mfma_f32_16x16x32_bf16 a[152:155], v[56:59], a[68:71], a[152:155]
    s_waitcnt vmcnt(8) lgkmcnt(6)
    v_mfma_f32_16x16x32_bf16 a[164:167], v[56:59], v[144:147], a[164:167]
    s_waitcnt vmcnt(7)
    v_mfma_f32_16x16x32_bf16 a[152:155], v[68:71], v[208:211], a[152:155]
    s_waitcnt vmcnt(6)
    v_mfma_f32_16x16x32_bf16 a[164:167], v[68:71], v[212:215], a[164:167]
    ds_read_b128 v[240:243], v4 offset:8192
    ds_read_b128 v[244:247], v4 offset:9216
    s_waitcnt lgkmcnt(7)
    v_mfma_f32_16x16x32_bf16 a[168:171], v[72:75], a[68:71], a[168:171]
    ds_write_b128 v5, a[40:43] offset:16384
    s_waitcnt lgkmcnt(7)
    v_mfma_f32_16x16x32_bf16 a[172:175], v[72:75], v[144:147], a[172:175]
    ds_write_b128 v5, a[44:47] offset:17408
    v_mfma_f32_16x16x32_bf16 a[168:171], a[156:159], v[208:211], a[168:171]
    v_mfma_f32_16x16x32_bf16 a[172:175], a[156:159], v[212:215], a[172:175]
    ds_read_b128 a[40:43], v4 offset:10240
    ds_read_b128 a[44:47], v4 offset:11264
    s_waitcnt lgkmcnt(9)
    v_mfma_f32_16x16x32_bf16 a[176:179], a[160:163], a[68:71], a[176:179]
    ds_write_b128 v4, a[152:155] offset:0
    s_waitcnt lgkmcnt(9)
    v_mfma_f32_16x16x32_bf16 a[180:183], a[160:163], v[144:147], a[180:183]
    ds_write_b128 v4, a[164:167] offset:1024
    v_mfma_f32_16x16x32_bf16 a[176:179], v[76:79], v[208:211], a[176:179]
    v_mfma_f32_16x16x32_bf16 a[180:183], v[76:79], v[212:215], a[180:183]
    ds_read_b128 a[152:155], v4 offset:12288
    ds_read_b128 a[164:167], v4 offset:13312
    s_waitcnt lgkmcnt(11)
    v_mfma_f32_16x16x32_bf16 a[184:187], v[80:83], a[68:71], a[184:187]
    ds_write_b128 v4, a[168:171] offset:2048
    s_waitcnt lgkmcnt(11)
    v_mfma_f32_16x16x32_bf16 a[188:191], v[80:83], v[144:147], a[188:191]
    ds_write_b128 v4, a[172:175] offset:3072
    v_mfma_f32_16x16x32_bf16 a[184:187], v[140:143], v[208:211], a[184:187]
    v_mfma_f32_16x16x32_bf16 a[188:191], v[140:143], v[212:215], a[188:191]
    ds_read_b128 a[168:171], v4 offset:14336
    ds_read_b128 a[172:175], v4 offset:15360
    s_waitcnt lgkmcnt(13)
    v_mfma_f32_16x16x32_bf16 v[240:243], a[120:123], a[68:71], v[240:243]
    ds_write_b128 v4, a[176:179] offset:4096
    s_waitcnt lgkmcnt(13)
    v_mfma_f32_16x16x32_bf16 v[244:247], a[120:123], v[144:147], v[244:247]
    ds_write_b128 v4, a[180:183] offset:5120
    v_mfma_f32_16x16x32_bf16 v[240:243], a[124:127], v[208:211], v[240:243]
    v_mfma_f32_16x16x32_bf16 v[244:247], a[124:127], v[212:215], v[244:247]
    ds_read_b128 a[176:179], v4 offset:16384
    ds_read_b128 a[180:183], v4 offset:17408
    s_waitcnt lgkmcnt(13)
    v_mfma_f32_16x16x32_bf16 a[40:43], v[248:251], a[68:71], a[40:43]
    ds_write_b128 v4, a[184:187] offset:6144
    s_waitcnt lgkmcnt(13)
    v_mfma_f32_16x16x32_bf16 a[44:47], v[248:251], v[144:147], a[44:47]
    ds_write_b128 v4, a[188:191] offset:7168
    v_mfma_f32_16x16x32_bf16 a[40:43], v[148:151], v[208:211], a[40:43]
    v_mfma_f32_16x16x32_bf16 a[44:47], v[148:151], v[212:215], a[44:47]
    s_waitcnt lgkmcnt(11)
    v_mfma_f32_16x16x32_bf16 a[152:155], v[152:155], a[68:71], a[152:155]
    ds_write_b128 v4, v[240:243] offset:8192
    s_waitcnt lgkmcnt(11)
    v_mfma_f32_16x16x32_bf16 a[164:167], v[152:155], v[144:147], a[164:167]
    ds_write_b128 v4, v[244:247] offset:9216
    s_add_u32 s59, s38, 8192
    buffer_load_dwordx4 a[184:187], v3, s[8:11], s59 offen offset:0 sc1
    v_mfma_f32_16x16x32_bf16 a[152:155], v[188:191], v[208:211], a[152:155]
    v_mfma_f32_16x16x32_bf16 a[164:167], v[188:191], v[212:215], a[164:167]
    s_add_u32 s59, s38, 8192
    buffer_load_dwordx4 a[188:191], v14, s[8:11], s59 offen offset:0 sc1
    s_waitcnt lgkmcnt(9)
    v_mfma_f32_16x16x32_bf16 a[168:171], v[192:195], a[68:71], a[168:171]
    ds_write_b128 v4, a[40:43] offset:10240
    s_waitcnt lgkmcnt(9)
    v_mfma_f32_16x16x32_bf16 a[172:175], v[192:195], v[144:147], a[172:175]
    ds_write_b128 v4, a[44:47] offset:11264
    buffer_load_dwordx4 a[40:43], v3, s[8:11], s39 offen offset:0 sc1
    v_mfma_f32_16x16x32_bf16 a[168:171], v[196:199], v[208:211], a[168:171]
    v_mfma_f32_16x16x32_bf16 a[172:175], v[196:199], v[212:215], a[172:175]
    buffer_load_dwordx4 a[44:47], v14, s[8:11], s39 offen offset:0 sc1
    s_waitcnt lgkmcnt(7)
    v_mfma_f32_16x16x32_bf16 a[176:179], v[200:203], a[68:71], a[176:179]
    ds_write_b128 v4, a[152:155] offset:12288
    s_waitcnt lgkmcnt(7)
    v_mfma_f32_16x16x32_bf16 a[180:183], v[200:203], v[144:147], a[180:183]
    ds_write_b128 v4, a[164:167] offset:13312
    buffer_load_dwordx4 a[152:155], v3, s[8:11], s39 offen offset:1024 sc1
    v_mfma_f32_16x16x32_bf16 a[176:179], v[204:207], v[208:211], a[176:179]
    v_mfma_f32_16x16x32_bf16 a[180:183], v[204:207], v[212:215], a[180:183]
    buffer_load_dwordx4 a[68:71], v14, s[8:11], s39 offen offset:1024 sc1
    ds_read_b128 a[164:167], v5 offset:0
    ds_read_b128 v[252:255], v5 offset:1024
    ds_read_b128 v[52:55], v5 offset:2048
    ds_read_b128 v[164:167], v5 offset:3072
    ds_read_b128 v[168:171], v5 offset:4096
    ds_read_b128 v[240:243], v5 offset:5120
    ds_read_b128 v[244:247], v5 offset:6144
    ds_read_b128 v[144:147], v5 offset:7168
    s_waitcnt vmcnt(11) lgkmcnt(7)
    v_mfma_f32_16x16x32_bf16 a[164:167], v[56:59], a[128:131], a[164:167]
    ds_write_b128 v4, a[168:171] offset:14336
    s_waitcnt vmcnt(10) lgkmcnt(7)
    v_mfma_f32_16x16x32_bf16 v[252:255], v[56:59], a[132:135], v[252:255]
    ds_write_b128 v4, a[172:175] offset:15360
    s_waitcnt vmcnt(9)
    v_mfma_f32_16x16x32_bf16 a[164:167], v[68:71], a[136:139], a[164:167]
    s_waitcnt vmcnt(8)
    v_mfma_f32_16x16x32_bf16 v[252:255], v[68:71], a[140:143], v[252:255]
    ds_read_b128 a[168:171], v5 offset:8192
    ds_read_b128 a[172:175], v5 offset:9216
    s_waitcnt lgkmcnt(9)
    v_mfma_f32_16x16x32_bf16 v[52:55], v[72:75], a[128:131], v[52:55]
    ds_write_b128 v4, a[176:179] offset:16384
    s_waitcnt lgkmcnt(9)
    v_mfma_f32_16x16x32_bf16 v[164:167], v[72:75], a[132:135], v[164:167]
    ds_write_b128 v4, a[180:183] offset:17408
    v_mfma_f32_16x16x32_bf16 v[52:55], a[156:159], a[136:139], v[52:55]
    v_mfma_f32_16x16x32_bf16 v[164:167], a[156:159], a[140:143], v[164:167]
    ds_read_b128 a[176:179], v5 offset:10240
    ds_read_b128 a[180:183], v5 offset:11264
    s_waitcnt lgkmcnt(11)
    v_mfma_f32_16x16x32_bf16 v[168:171], a[160:163], a[128:131], v[168:171]
    s_waitcnt lgkmcnt(0)
    s_barrier
    ds_write_b128 v5, a[164:167] offset:0
    v_mfma_f32_16x16x32_bf16 v[240:243], a[160:163], a[132:135], v[240:243]
    ds_write_b128 v5, v[252:255] offset:1024
    v_mfma_f32_16x16x32_bf16 v[168:171], v[76:79], a[136:139], v[168:171]
    v_add_u32 v24, 0, v26
    ds_read_b128 v[16:19], v24 offset:0
    ds_read_b128 v[20:23], v24 offset:18432
    ds_read_b128 v[208:211], v24 offset:36864
    ds_read_b128 v[212:215], v24 offset:55296
    v_mfma_f32_16x16x32_bf16 v[240:243], v[76:79], a[140:143], v[240:243]
    ds_read_b128 a[164:167], v5 offset:12288
    ds_read_b128 v[252:255], v5 offset:13312
    v_mfma_f32_16x16x32_bf16 v[244:247], v[80:83], a[128:131], v[244:247]
    ds_write_b128 v5, v[52:55] offset:2048
    v_mfma_f32_16x16x32_bf16 v[144:147], v[80:83], a[132:135], v[144:147]
    ds_write_b128 v5, v[164:167] offset:3072
    s_waitcnt lgkmcnt(6)
    v_add_f32 v16, v16, v20
    v_mfma_f32_16x16x32_bf16 v[244:247], v[140:143], a[136:139], v[244:247]
    v_add_f32 v17, v17, v21
    v_add_f32 v18, v18, v22
    v_mfma_f32_16x16x32_bf16 v[144:147], v[140:143], a[140:143], v[144:147]
    v_add_f32 v19, v19, v23
    s_waitcnt lgkmcnt(4)
    v_add_f32 v208, v208, v212
    ds_read_b128 v[52:55], v5 offset:14336
    ds_read_b128 v[164:167], v5 offset:15360
    v_mfma_f32_16x16x32_bf16 a[168:171], a[120:123], a[128:131], a[168:171]
    ds_write_b128 v5, v[168:171] offset:4096
    v_add_f32 v209, v209, v213
    v_mfma_f32_16x16x32_bf16 a[172:175], a[120:123], a[132:135], a[172:175]
    ds_write_b128 v5, v[240:243] offset:5120
    v_add_f32 v210, v210, v214
    v_mfma_f32_16x16x32_bf16 a[168:171], a[124:127], a[136:139], a[168:171]
    v_add_f32 v211, v211, v215
    v_add_f32 v16, v16, v208
    v_mfma_f32_16x16x32_bf16 a[172:175], a[124:127], a[140:143], a[172:175]
    v_add_f32 v17, v17, v209
    v_add_f32 v18, v18, v210
    ds_read_b128 v[168:171], v5 offset:16384
    ds_read_b128 v[240:243], v5 offset:17408
    v_mfma_f32_16x16x32_bf16 a[176:179], v[248:251], a[128:131], a[176:179]
    ds_write_b128 v5, v[244:247] offset:6144
    v_add_f32 v19, v19, v211
    v_mfma_f32_16x16x32_bf16 a[180:183], v[248:251], a[132:135], a[180:183]
    ds_write_b128 v5, v[144:147] offset:7168
    buffer_store_dwordx4 v[16:19], v26, s[8:11], s45 offen sc1
    v_mfma_f32_16x16x32_bf16 a[176:179], v[148:151], a[136:139], a[176:179]
    v_add_u32 v24, 4096, v26
    ds_read_b128 v[16:19], v24 offset:0
    ds_read_b128 v[20:23], v24 offset:18432
    ds_read_b128 v[208:211], v24 offset:36864
    ds_read_b128 v[212:215], v24 offset:55296
    v_mfma_f32_16x16x32_bf16 a[180:183], v[148:151], a[140:143], a[180:183]
    s_waitcnt lgkmcnt(15)
    v_mfma_f32_16x16x32_bf16 a[164:167], v[152:155], a[128:131], a[164:167]
    ds_write_b128 v5, a[168:171] offset:8192
    s_waitcnt lgkmcnt(15)
    v_mfma_f32_16x16x32_bf16 v[252:255], v[152:155], a[132:135], v[252:255]
    ds_write_b128 v5, a[172:175] offset:9216
    s_waitcnt lgkmcnt(4)
    v_add_f32 v16, v16, v20
    v_mfma_f32_16x16x32_bf16 a[164:167], v[188:191], a[136:139], a[164:167]
    v_add_f32 v17, v17, v21
    v_add_f32 v18, v18, v22
    v_mfma_f32_16x16x32_bf16 v[252:255], v[188:191], a[140:143], v[252:255]
    v_add_f32 v19, v19, v23
    s_waitcnt lgkmcnt(2)
    v_add_f32 v208, v208, v212
    v_mfma_f32_16x16x32_bf16 v[52:55], v[192:195], a[128:131], v[52:55]
    ds_write_b128 v5, a[176:179] offset:10240
    v_add_f32 v209, v209, v213
    v_mfma_f32_16x16x32_bf16 v[164:167], v[192:195], a[132:135], v[164:167]
    ds_write_b128 v5, a[180:183] offset:11264
    v_add_f32 v210, v210, v214
    v_mfma_f32_16x16x32_bf16 v[52:55], v[196:199], a[136:139], v[52:55]
    v_add_f32 v211, v211, v215
    v_add_f32 v16, v16, v208
    v_mfma_f32_16x16x32_bf16 v[164:167], v[196:199], a[140:143], v[164:167]
    v_add_f32 v17, v17, v209
    v_add_f32 v18, v18, v210
    v_mfma_f32_16x16x32_bf16 v[168:171], v[200:203], a[128:131], v[168:171]
    ds_write_b128 v5, a[164:167] offset:12288
    v_add_f32 v19, v19, v211
    v_mfma_f32_16x16x32_bf16 v[240:243], v[200:203], a[132:135], v[240:243]
    ds_write_b128 v5, v[252:255] offset:13312
    buffer_load_dwordx4 a[168:171], v3, s[8:11], s39 offen offset:2048 sc1
    v_mfma_f32_16x16x32_bf16 v[168:171], v[204:207], a[136:139], v[168:171]
    s_add_u32 s59, s45, 4096
    buffer_store_dwordx4 v[16:19], v26, s[8:11], s59 offen sc1
    v_add_u32 v24, 8192, v26
    s_nop 0
    ds_read_b128 v[16:19], v24 offset:0
    ds_read_b128 v[20:23], v24 offset:18432
    ds_read_b128 v[208:211], v24 offset:36864
    ds_read_b128 v[212:215], v24 offset:55296
    v_mfma_f32_16x16x32_bf16 v[240:243], v[204:207], a[140:143], v[240:243]
    buffer_load_dwordx4 a[172:175], v14, s[8:11], s39 offen offset:2048 sc1
    v_mfma_f32_16x16x32_bf16 a[176:179], a[192:195], v[216:219], 0
    ds_write_b128 v5, v[52:55] offset:14336
    v_mfma_f32_16x16x32_bf16 a[180:183], a[192:195], v[156:159], 0
    ds_write_b128 v5, v[164:167] offset:15360
    buffer_load_dwordx4 a[164:167], v3, s[8:11], s39 offen offset:3072 sc1
    v_mfma_f32_16x16x32_bf16 a[176:179], a[196:199], v[160:163], a[176:179]
    v_mfma_f32_16x16x32_bf16 a[180:183], a[196:199], a[16:19], a[180:183]
    buffer_load_dwordx4 a[128:131], v14, s[8:11], s39 offen offset:3072 sc1
    s_waitcnt lgkmcnt(4)
    v_add_f32 v16, v16, v20
    v_mfma_f32_16x16x32_bf16 a[176:179], a[200:203], a[20:23], a[176:179]
    ds_write_b128 v5, v[168:171] offset:16384
    v_add_f32 v17, v17, v21
    v_mfma_f32_16x16x32_bf16 a[180:183], a[200:203], a[24:27], a[180:183]
    ds_write_b128 v5, v[240:243] offset:17408
    s_add_u32 s59, s39, 4096
    buffer_load_dwordx4 a[132:135], v3, s[8:11], s59 offen offset:0 sc1
    v_mfma_f32_16x16x32_bf16 a[176:179], a[204:207], a[28:31], a[176:179]
    v_add_f32 v18, v18, v22
    v_add_f32 v19, v19, v23
    v_mfma_f32_16x16x32_bf16 a[180:183], a[204:207], a[32:35], a[180:183]
    s_add_u32 s59, s39, 4096
    buffer_load_dwordx4 a[136:139], v14, s[8:11], s59 offen offset:0 sc1
    s_waitcnt lgkmcnt(4)
    v_add_f32 v208, v208, v212
    v_mfma_f32_16x16x32_bf16 a[176:179], a[208:211], a[36:39], a[176:179]
    v_add_f32 v209, v209, v213
    v_add_f32 v210, v210, v214
    v_mfma_f32_16x16x32_bf16 a[180:183], a[208:211], a[48:51], a[180:183]
    s_add_u32 s59, s39, 4096
    buffer_load_dwordx4 a[140:143], v3, s[8:11], s59 offen offset:1024 sc1
    v_add_f32 v211, v211, v215
    v_mfma_f32_16x16x32_bf16 a[176:179], a[0:3], a[52:55], a[176:179]
    v_add_f32 v16, v16, v208
    v_add_f32 v17, v17, v209
    v_mfma_f32_16x16x32_bf16 a[180:183], a[0:3], a[56:59], a[180:183]
    s_add_u32 s59, s39, 4096
    buffer_load_dwordx4 v[244:247], v14, s[8:11], s59 offen offset:1024 sc1
    v_add_f32 v18, v18, v210
    v_mfma_f32_16x16x32_bf16 a[176:179], a[4:7], a[60:63], a[176:179]
    v_add_f32 v19, v19, v211
    s_add_u32 s59, s45, 8192
    buffer_store_dwordx4 v[16:19], v26, s[8:11], s59 offen sc1
    v_mfma_f32_16x16x32_bf16 a[180:183], a[4:7], a[64:67], a[180:183]
    v_add_u32 v24, 12288, v26
    ds_read_b128 v[16:19], v24 offset:0
    ds_read_b128 v[20:23], v24 offset:18432
    ds_read_b128 v[208:211], v24 offset:36864
    ds_read_b128 v[212:215], v24 offset:55296
    s_waitcnt vmcnt(18)
    v_mfma_f32_16x16x32_bf16 a[176:179], v[56:59], a[144:147], a[176:179]
    s_waitcnt vmcnt(17)
    v_mfma_f32_16x16x32_bf16 a[180:183], v[56:59], a[148:151], a[180:183]
    s_waitcnt vmcnt(16)
    v_mfma_f32_16x16x32_bf16 a[176:179], v[68:71], a[184:187], a[176:179]
    s_waitcnt lgkmcnt(2)
    v_add_f32 v16, v16, v20
    v_add_f32 v17, v17, v21
    s_waitcnt vmcnt(15)
    v_mfma_f32_16x16x32_bf16 a[180:183], v[68:71], a[188:191], a[180:183]
    v_add_f32 v18, v18, v22
    v_add_f32 v19, v19, v23
    v_mfma_f32_16x16x32_bf16 v[144:147], a[212:215], v[216:219], 0
    s_waitcnt lgkmcnt(0)
    v_add_f32 v208, v208, v212
    v_add_f32 v209, v209, v213
    v_mfma_f32_16x16x32_bf16 v[252:255], a[212:215], v[156:159], 0
    v_add_f32 v210, v210, v214
    v_add_f32 v211, v211, v215
    v_mfma_f32_16x16x32_bf16 v[144:147], a[216:219], v[160:163], v[144:147]
    v_add_f32 v16, v16, v208
    v_add_f32 v17, v17, v209
    v_add_f32 v18, v18, v210
    v_add_f32 v19, v19, v211
    s_add_u32 s59, s45, 12288
    buffer_store_dwordx4 v[16:19], v26, s[8:11], s59 offen sc1
    v_add_u32 v24, 0, v27
    s_nop 0
    ds_read_b128 v[16:19], v24 offset:0
    ds_read_b128 v[20:23], v24 offset:18432
    ds_read_b128 v[208:211], v24 offset:36864
    ds_read_b128 v[212:215], v24 offset:55296
    s_waitcnt lgkmcnt(2)
    v_add_f32 v16, v16, v20
    v_add_f32 v17, v17, v21
    v_add_f32 v18, v18, v22
    v_add_f32 v19, v19, v23
    s_waitcnt lgkmcnt(0)
    v_add_f32 v208, v208, v212
    v_add_f32 v209, v209, v213
    v_add_f32 v210, v210, v214
    v_add_f32 v211, v211, v215
    v_add_f32 v16, v16, v208
    v_add_f32 v17, v17, v209
    v_add_f32 v18, v18, v210
    v_add_f32 v19, v19, v211
    buffer_store_dwordx4 v[16:19], v27, s[8:11], s45 offen sc1
    s_waitcnt lgkmcnt(0)
    s_barrier
    v_mfma_f32_16x16x32_bf16 v[252:255], a[216:219], a[16:19], v[252:255]
    v_add_u32 v24, 73728, v26
    ds_read_b128 v[16:19], v24 offset:0
    ds_read_b128 v[20:23], v24 offset:18432
    ds_read_b128 v[52:55], v24 offset:36864
    ds_read_b128 v[164:167], v24 offset:55296
    v_mfma_f32_16x16x32_bf16 v[144:147], a[220:223], a[20:23], v[144:147]
    ds_write_b128 v4, a[176:179] offset:0
    v_mfma_f32_16x16x32_bf16 v[252:255], a[220:223], a[24:27], v[252:255]
    ds_write_b128 v4, a[180:183] offset:1024
    v_mfma_f32_16x16x32_bf16 v[144:147], a[224:227], a[28:31], v[144:147]
    s_waitcnt lgkmcnt(4)
    v_add_f32 v16, v16, v20
    v_add_f32 v17, v17, v21
    v_mfma_f32_16x16x32_bf16 v[252:255], a[224:227], a[32:35], v[252:255]
    v_add_f32 v18, v18, v22
    v_add_f32 v19, v19, v23
    v_mfma_f32_16x16x32_bf16 v[144:147], a[228:231], a[36:39], v[144:147]
    s_waitcnt lgkmcnt(2)
    v_add_f32 v52, v52, v164
    v_add_f32 v53, v53, v165
    v_mfma_f32_16x16x32_bf16 v[252:255], a[228:231], a[48:51], v[252:255]
    v_add_f32 v54, v54, v166
    v_add_f32 v55, v55, v167
    v_mfma_f32_16x16x32_bf16 v[144:147], v[60:63], a[52:55], v[144:147]
    v_add_f32 v16, v16, v52
    v_add_f32 v17, v17, v53
    v_mfma_f32_16x16x32_bf16 v[252:255], v[60:63], a[56:59], v[252:255]
    v_add_f32 v18, v18, v54
    v_add_f32 v19, v19, v55
    v_mfma_f32_16x16x32_bf16 v[144:147], a[8:11], a[60:63], v[144:147]
    buffer_store_dwordx4 v[16:19], v26, s[8:11], s46 offen sc1
    v_add_u32 v24, 77824, v26
    s_nop 0
    ds_read_b128 v[16:19], v24 offset:0
    ds_read_b128 v[20:23], v24 offset:18432
    ds_read_b128 v[52:55], v24 offset:36864
    ds_read_b128 v[164:167], v24 offset:55296
    v_mfma_f32_16x16x32_bf16 v[252:255], a[8:11], a[64:67], v[252:255]
    v_mfma_f32_16x16x32_bf16 v[144:147], v[72:75], a[144:147], v[144:147]
    v_mfma_f32_16x16x32_bf16 v[252:255], v[72:75], a[148:151], v[252:255]
    v_mfma_f32_16x16x32_bf16 v[144:147], a[156:159], a[184:187], v[144:147]
    s_waitcnt lgkmcnt(2)
    v_add_f32 v16, v16, v20
    v_add_f32 v17, v17, v21
    v_mfma_f32_16x16x32_bf16 v[252:255], a[156:159], a[188:191], v[252:255]
    v_add_f32 v18, v18, v22
    v_add_f32 v19, v19, v23
    v_mfma_f32_16x16x32_bf16 a[176:179], a[232:235], v[216:219], 0
    s_waitcnt lgkmcnt(0)
    v_add_f32 v52, v52, v164
    v_add_f32 v53, v53, v165
    v_mfma_f32_16x16x32_bf16 a[180:183], a[232:235], v[156:159], 0
    v_add_f32 v54, v54, v166
    v_add_f32 v55, v55, v167
    v_mfma_f32_16x16x32_bf16 a[176:179], a[236:239], v[160:163], a[176:179]
    v_add_f32 v16, v16, v52
    v_add_f32 v17, v17, v53
    v_mfma_f32_16x16x32_bf16 a[180:183], a[236:239], a[16:19], a[180:183]
    v_add_f32 v18, v18, v54
    v_add_f32 v19, v19, v55
    v_mfma_f32_16x16x32_bf16 a[176:179], a[240:243], a[20:23], a[176:179]
    ds_write_b128 v4, v[144:147] offset:2048
    s_add_u32 s59, s46, 4096
    buffer_store_dwordx4 v[16:19], v26, s[8:11], s59 offen sc1
    v_mfma_f32_16x16x32_bf16 a[180:183], a[240:243], a[24:27], a[180:183]
    ds_write_b128 v4, v[252:255] offset:3072
    v_add_u32 v24, 81920, v26
    ds_read_b128 v[16:19], v24 offset:0
    ds_read_b128 v[20:23], v24 offset:18432
    ds_read_b128 v[52:55], v24 offset:36864
    ds_read_b128 v[164:167], v24 offset:55296
    v_mfma_f32_16x16x32_bf16 a[176:179], a[244:247], a[28:31], a[176:179]
    v_mfma_f32_16x16x32_bf16 a[180:183], a[244:247], a[32:35], a[180:183]
    v_mfma_f32_16x16x32_bf16 a[176:179], a[248:251], a[36:39], a[176:179]
    v_mfma_f32_16x16x32_bf16 a[180:183], a[248:251], a[48:51], a[180:183]
    s_waitcnt lgkmcnt(2)
    v_add_f32 v16, v16, v20
    v_add_f32 v17, v17, v21
    v_mfma_f32_16x16x32_bf16 a[176:179], a[12:15], a[52:55], a[176:179]
    v_add_f32 v18, v18, v22
    v_add_f32 v19, v19, v23
    v_mfma_f32_16x16x32_bf16 a[180:183], a[12:15], a[56:59], a[180:183]
    s_waitcnt lgkmcnt(0)
    v_add_f32 v52, v52, v164
    v_add_f32 v53, v53, v165
    v_mfma_f32_16x16x32_bf16 a[176:179], a[72:75], a[60:63], a[176:179]
    v_add_f32 v54, v54, v166
    v_add_f32 v55, v55, v167
    v_mfma_f32_16x16x32_bf16 a[180:183], a[72:75], a[64:67], a[180:183]
    v_add_f32 v16, v16, v52
    v_add_f32 v17, v17, v53
    v_mfma_f32_16x16x32_bf16 a[176:179], a[160:163], a[144:147], a[176:179]
    v_add_f32 v18, v18, v54
    v_add_f32 v19, v19, v55
    v_mfma_f32_16x16x32_bf16 a[180:183], a[160:163], a[148:151], a[180:183]
    s_add_u32 s59, s46, 8192
    buffer_store_dwordx4 v[16:19], v26, s[8:11], s59 offen sc1
    v_add_u32 v24, 86016, v26
    s_nop 0
    ds_read_b128 v[16:19], v24 offset:0
    ds_read_b128 v[20:23], v24 offset:18432
    ds_read_b128 v[52:55], v24 offset:36864
    ds_read_b128 v[164:167], v24 offset:55296
    v_mfma_f32_16x16x32_bf16 a[176:179], v[76:79], a[184:187], a[176:179]
    v_mfma_f32_16x16x32_bf16 a[180:183], v[76:79], a[188:191], a[180:183]
    v_mfma_f32_16x16x32_bf16 v[168:171], a[252:255], v[216:219], 0
    v_mfma_f32_16x16x32_bf16 v[240:243], a[252:255], v[156:159], 0
    s_waitcnt lgkmcnt(2)
    v_add_f32 v16, v16, v20
    v_add_f32 v17, v17, v21
    v_mfma_f32_16x16x32_bf16 v[168:171], v[220:223], v[160:163], v[168:171]
    v_add_f32 v18, v18, v22
    v_add_f32 v19, v19, v23
    v_mfma_f32_16x16x32_bf16 v[240:243], v[220:223], a[16:19], v[240:243]
    s_waitcnt lgkmcnt(0)
    v_add_f32 v52, v52, v164
    v_add_f32 v53, v53, v165
    v_mfma_f32_16x16x32_bf16 v[168:171], v[224:227], a[20:23], v[168:171]
    ds_write_b128 v4, a[176:179] offset:4096
    v_add_f32 v54, v54, v166
    v_mfma_f32_16x16x32_bf16 v[240:243], v[224:227], a[24:27], v[240:243]
    ds_write_b128 v4, a[180:183] offset:5120
    v_add_f32 v55, v55, v167
    v_mfma_f32_16x16x32_bf16 v[168:171], v[228:231], a[28:31], v[168:171]
    v_add_f32 v16, v16, v52
    v_add_f32 v17, v17, v53
    v_mfma_f32_16x16x32_bf16 v[240:243], v[228:231], a[32:35], v[240:243]
    v_add_f32 v18, v18, v54
    v_add_f32 v19, v19, v55
    v_mfma_f32_16x16x32_bf16 v[168:171], v[232:235], a[36:39], v[168:171]
    s_add_u32 s59, s46, 12288
    buffer_store_dwordx4 v[16:19], v26, s[8:11], s59 offen sc1
    v_add_u32 v24, 73728, v27
    s_nop 0
    ds_read_b128 v[16:19], v24 offset:0
    ds_read_b128 v[20:23], v24 offset:18432
    ds_read_b128 v[52:55], v24 offset:36864
    ds_read_b128 v[164:167], v24 offset:55296
    v_mfma_f32_16x16x32_bf16 v[240:243], v[232:235], a[48:51], v[240:243]
    v_mfma_f32_16x16x32_bf16 v[168:171], a[76:79], a[52:55], v[168:171]
    v_mfma_f32_16x16x32_bf16 v[240:243], a[76:79], a[56:59], v[240:243]
    v_mfma_f32_16x16x32_bf16 v[168:171], a[80:83], a[60:63], v[168:171]
    s_waitcnt lgkmcnt(2)
    v_add_f32 v16, v16, v20
    v_add_f32 v17, v17, v21
    v_mfma_f32_16x16x32_bf16 v[240:243], a[80:83], a[64:67], v[240:243]
    v_add_f32 v18, v18, v22
    v_add_f32 v19, v19, v23
    v_mfma_f32_16x16x32_bf16 v[168:171], v[80:83], a[144:147], v[168:171]
    s_waitcnt lgkmcnt(0)
    v_add_f32 v52, v52, v164
    v_add_f32 v53, v53, v165
    v_mfma_f32_16x16x32_bf16 v[240:243], v[80:83], a[148:151], v[240:243]
    v_add_f32 v54, v54, v166
    v_add_f32 v55, v55, v167
    v_mfma_f32_16x16x32_bf16 v[168:171], v[140:143], a[184:187], v[168:171]
    v_add_f32 v16, v16, v52
    v_add_f32 v17, v17, v53
    v_mfma_f32_16x16x32_bf16 v[240:243], v[140:143], a[188:191], v[240:243]
    v_add_f32 v18, v18, v54
    v_add_f32 v19, v19, v55
    v_mfma_f32_16x16x32_bf16 a[176:179], v[236:239], v[216:219], 0
    buffer_store_dwordx4 v[16:19], v27, s[8:11], s46 offen sc1
    v_mfma_f32_16x16x32_bf16 a[180:183], v[236:239], v[156:159], 0
    v_mfma_f32_16x16x32_bf16 a[176:179], v[28:31], v[160:163], a[176:179]
    v_mfma_f32_16x16x32_bf16 a[180:183], v[28:31], a[16:19], a[180:183]
    v_mfma_f32_16x16x32_bf16 a[176:179], v[32:35], a[20:23], a[176:179]
    ds_write_b128 v4, v[168:171] offset:6144
    v_mfma_f32_16x16x32_bf16 a[180:183], v[32:35], a[24:27], a[180:183]
    ds_write_b128 v4, v[240:243] offset:7168
    s_add_u32 s59, s39, 4096
    buffer_load_dwordx4 v[208:211], v3, s[8:11], s59 offen offset:2048 sc1
    v_mfma_f32_16x16x32_bf16 a[176:179], v[36:39], a[28:31], a[176:179]
    v_mfma_f32_16x16x32_bf16 a[180:183], v[36:39], a[32:35], a[180:183]
    s_add_u32 s59, s39, 4096
    buffer_load_dwordx4 v[212:215], v14, s[8:11], s59 offen offset:2048 sc1
    v_mfma_f32_16x16x32_bf16 a[176:179], v[40:43], a[36:39], a[176:179]
    v_mfma_f32_16x16x32_bf16 a[180:183], v[40:43], a[48:51], a[180:183]
    v_mfma_f32_16x16x32_bf16 a[176:179], a[84:87], a[52:55], a[176:179]
    v_mfma_f32_16x16x32_bf16 a[180:183], a[84:87], a[56:59], a[180:183]
    v_mfma_f32_16x16x32_bf16 a[176:179], a[88:91], a[60:63], a[176:179]
    v_mfma_f32_16x16x32_bf16 a[180:183], a[88:91], a[64:67], a[180:183]
    v_mfma_f32_16x16x32_bf16 a[176:179], a[120:123], a[144:147], a[176:179]
    v_mfma_f32_16x16x32_bf16 a[180:183], a[120:123], a[148:151], a[180:183]
    v_mfma_f32_16x16x32_bf16 a[176:179], a[124:127], a[184:187], a[176:179]
    v_mfma_f32_16x16x32_bf16 a[180:183], a[124:127], a[188:191], a[180:183]
    v_mfma_f32_16x16x32_bf16 v[144:147], v[44:47], v[216:219], 0
    s_waitcnt vmcnt(7)
    v_mov_b32 v25, 1
    buffer_store_dword v25, v15, s[8:11], s48 offen sc1
    v_mfma_f32_16x16x32_bf16 v[252:255], v[44:47], v[156:159], 0
    v_mfma_f32_16x16x32_bf16 v[144:147], v[48:51], v[160:163], v[144:147]
    v_mfma_f32_16x16x32_bf16 v[252:255], v[48:51], a[16:19], v[252:255]
    v_mfma_f32_16x16x32_bf16 v[144:147], v[84:87], a[20:23], v[144:147]
    ds_write_b128 v4, a[176:179] offset:8192
    v_mfma_f32_16x16x32_bf16 v[252:255], v[84:87], a[24:27], v[252:255]
    ds_write_b128 v4, a[180:183] offset:9216
    v_mfma_f32_16x16x32_bf16 v[144:147], v[88:91], a[28:31], v[144:147]
    v_mfma_f32_16x16x32_bf16 v[252:255], v[88:91], a[32:35], v[252:255]
    v_mfma_f32_16x16x32_bf16 v[144:147], v[92:95], a[36:39], v[144:147]
    v_mfma_f32_16x16x32_bf16 v[252:255], v[92:95], a[48:51], v[252:255]
    v_mfma_f32_16x16x32_bf16 v[144:147], a[92:95], a[52:55], v[144:147]
    v_mfma_f32_16x16x32_bf16 v[252:255], a[92:95], a[56:59], v[252:255]
    v_mfma_f32_16x16x32_bf16 v[144:147], a[96:99], a[60:63], v[144:147]
    v_mfma_f32_16x16x32_bf16 v[252:255], a[96:99], a[64:67], v[252:255]
    v_mfma_f32_16x16x32_bf16 v[144:147], v[248:251], a[144:147], v[144:147]
    v_mfma_f32_16x16x32_bf16 v[252:255], v[248:251], a[148:151], v[252:255]
    v_mfma_f32_16x16x32_bf16 v[144:147], v[148:151], a[184:187], v[144:147]
    v_mfma_f32_16x16x32_bf16 v[252:255], v[148:151], a[188:191], v[252:255]
    v_mfma_f32_16x16x32_bf16 a[176:179], v[96:99], v[216:219], 0
    v_mfma_f32_16x16x32_bf16 a[180:183], v[96:99], v[156:159], 0
    v_mfma_f32_16x16x32_bf16 a[176:179], v[100:103], v[160:163], a[176:179]
    v_mfma_f32_16x16x32_bf16 a[180:183], v[100:103], a[16:19], a[180:183]
    v_mfma_f32_16x16x32_bf16 a[176:179], v[104:107], a[20:23], a[176:179]
    s_nop 1
    ds_write_b128 v4, v[144:147] offset:10240
    v_mfma_f32_16x16x32_bf16 a[180:183], v[104:107], a[24:27], a[180:183]
    ds_write_b128 v4, v[252:255] offset:11264
    v_mfma_f32_16x16x32_bf16 a[176:179], v[108:111], a[28:31], a[176:179]
    v_mfma_f32_16x16x32_bf16 a[180:183], v[108:111], a[32:35], a[180:183]
    v_mfma_f32_16x16x32_bf16 a[176:179], v[112:115], a[36:39], a[176:179]
    v_mfma_f32_16x16x32_bf16 a[180:183], v[112:115], a[48:51], a[180:183]
    v_mfma_f32_16x16x32_bf16 a[176:179], a[100:103], a[52:55], a[176:179]
    v_mfma_f32_16x16x32_bf16 a[180:183], a[100:103], a[56:59], a[180:183]
    v_mfma_f32_16x16x32_bf16 a[176:179], a[104:107], a[60:63], a[176:179]
    v_mfma_f32_16x16x32_bf16 a[180:183], a[104:107], a[64:67], a[180:183]
    v_mfma_f32_16x16x32_bf16 a[176:179], v[152:155], a[144:147], a[176:179]
    v_mfma_f32_16x16x32_bf16 a[180:183], v[152:155], a[148:151], a[180:183]
    v_mfma_f32_16x16x32_bf16 a[176:179], v[188:191], a[184:187], a[176:179]
    v_mfma_f32_16x16x32_bf16 a[180:183], v[188:191], a[188:191], a[180:183]
    v_mfma_f32_16x16x32_bf16 v[52:55], v[116:119], v[216:219], 0
    v_mfma_f32_16x16x32_bf16 v[164:167], v[116:119], v[156:159], 0
    v_mfma_f32_16x16x32_bf16 v[52:55], v[120:123], v[160:163], v[52:55]
    v_mfma_f32_16x16x32_bf16 v[164:167], v[120:123], a[16:19], v[164:167]
    v_mfma_f32_16x16x32_bf16 v[52:55], v[124:127], a[20:23], v[52:55]
    s_nop 1
    ds_write_b128 v4, a[176:179] offset:12288
    v_mfma_f32_16x16x32_bf16 v[164:167], v[124:127], a[24:27], v[164:167]
    ds_write_b128 v4, a[180:183] offset:13312
    v_mfma_f32_16x16x32_bf16 v[52:55], v[128:131], a[28:31], v[52:55]
    v_mfma_f32_16x16x32_bf16 v[164:167], v[128:131], a[32:35], v[164:167]
    v_mfma_f32_16x16x32_bf16 v[52:55], v[132:135], a[36:39], v[52:55]
    v_mfma_f32_16x16x32_bf16 v[164:167], v[132:135], a[48:51], v[164:167]
    v_mfma_f32_16x16x32_bf16 v[52:55], a[108:111], a[52:55], v[52:55]
    v_mfma_f32_16x16x32_bf16 v[164:167], a[108:111], a[56:59], v[164:167]
    v_mfma_f32_16x16x32_bf16 v[52:55], a[112:115], a[60:63], v[52:55]
    v_mfma_f32_16x16x32_bf16 v[164:167], a[112:115], a[64:67], v[164:167]
    v_mfma_f32_16x16x32_bf16 v[52:55], v[192:195], a[144:147], v[52:55]
    v_mfma_f32_16x16x32_bf16 v[164:167], v[192:195], a[148:151], v[164:167]
    v_mfma_f32_16x16x32_bf16 v[52:55], v[196:199], a[184:187], v[52:55]
    v_mfma_f32_16x16x32_bf16 v[164:167], v[196:199], a[188:191], v[164:167]
    v_mfma_f32_16x16x32_bf16 a[176:179], v[136:139], v[216:219], 0
    v_mfma_f32_16x16x32_bf16 a[180:183], v[136:139], v[156:159], 0
    v_mfma_f32_16x16x32_bf16 a[176:179], v[172:175], v[160:163], a[176:179]
    v_mfma_f32_16x16x32_bf16 a[180:183], v[172:175], a[16:19], a[180:183]
    s_add_u32 s59, s39, 4096
    buffer_load_dwordx4 v[168:171], v3, s[8:11], s59 offen offset:3072 sc1
    v_mfma_f32_16x16x32_bf16 a[176:179], v[176:179], a[20:23], a[176:179]
    ds_write_b128 v4, v[52:55] offset:14336
    v_mfma_f32_16x16x32_bf16 a[180:183], v[176:179], a[24:27], a[180:183]
    ds_write_b128 v4, v[164:167] offset:15360
    s_add_u32 s59, s39, 4096
    buffer_load_dwordx4 a[16:19], v14, s[8:11], s59 offen offset:3072 sc1
    v_mfma_f32_16x16x32_bf16 a[176:179], v[180:183], a[28:31], a[176:179]
    v_mfma_f32_16x16x32_bf16 a[180:183], v[180:183], a[32:35], a[180:183]
    s_add_u32 s59, s39, 8192
    buffer_load_dwordx4 a[20:23], v3, s[8:11], s59 offen offset:0 sc1
    v_mfma_f32_16x16x32_bf16 a[176:179], v[184:187], a[36:39], a[176:179]
    v_mfma_f32_16x16x32_bf16 a[180:183], v[184:187], a[48:51], a[180:183]
    s_add_u32 s59, s39, 8192
    buffer_load_dwordx4 a[24:27], v14, s[8:11], s59 offen offset:0 sc1
    v_mfma_f32_16x16x32_bf16 a[176:179], a[116:119], a[52:55], a[176:179]
    v_mfma_f32_16x16x32_bf16 a[180:183], a[116:119], a[56:59], a[180:183]
    v_mfma_f32_16x16x32_bf16 a[176:179], v[64:67], a[60:63], a[176:179]
    v_mfma_f32_16x16x32_bf16 a[180:183], v[64:67], a[64:67], a[180:183]
    v_mfma_f32_16x16x32_bf16 a[176:179], v[200:203], a[144:147], a[176:179]
    s_waitcnt vmcnt(7)
    v_mov_b32 v25, 1
    buffer_store_dword v25, v15, s[8:11], s49 offen sc1
    v_mfma_f32_16x16x32_bf16 a[180:183], v[200:203], a[148:151], a[180:183]
    v_mfma_f32_16x16x32_bf16 a[176:179], v[204:207], a[184:187], a[176:179]
    v_mfma_f32_16x16x32_bf16 a[180:183], v[204:207], a[188:191], a[180:183]
    v_mfma_f32_16x16x32_bf16 a[28:31], a[192:195], a[40:43], 0
    v_mfma_f32_16x16x32_bf16 a[32:35], a[192:195], a[44:47], 0
    v_mfma_f32_16x16x32_bf16 a[28:31], a[196:199], a[152:155], a[28:31]
    v_mfma_f32_16x16x32_bf16 a[32:35], a[196:199], a[68:71], a[32:35]
    v_mfma_f32_16x16x32_bf16 a[28:31], a[200:203], a[168:171], a[28:31]
    s_nop 1
    ds_write_b128 v4, a[176:179] offset:16384
    v_mfma_f32_16x16x32_bf16 a[32:35], a[200:203], a[172:175], a[32:35]
    ds_write_b128 v4, a[180:183] offset:17408
    v_mfma_f32_16x16x32_bf16 a[28:31], a[204:207], a[164:167], a[28:31]
    v_mfma_f32_16x16x32_bf16 a[32:35], a[204:207], a[128:131], a[32:35]
    v_mfma_f32_16x16x32_bf16 a[28:31], a[208:211], a[132:135], a[28:31]
    s_waitcnt lgkmcnt(0)
    s_barrier
    v_mfma_f32_16x16x32_bf16 a[32:35], a[208:211], a[136:139], a[32:35]
    v_add_u32 v24, 0, v26
    ds_read_b128 v[16:19], v24 offset:0
    ds_read_b128 v[20:23], v24 offset:18432
    ds_read_b128 v[240:243], v24 offset:36864
    ds_read_b128 v[144:147], v24 offset:55296
    v_mfma_f32_16x16x32_bf16 a[28:31], a[0:3], a[140:143], a[28:31]
    v_mfma_f32_16x16x32_bf16 a[32:35], a[0:3], v[244:247], a[32:35]
    s_waitcnt vmcnt(7)
    v_mfma_f32_16x16x32_bf16 a[28:31], a[4:7], v[208:211], a[28:31]
    s_waitcnt lgkmcnt(2)
    v_add_f32 v16, v16, v20
    v_add_f32 v17, v17, v21
    s_waitcnt vmcnt(6)
    v_mfma_f32_16x16x32_bf16 a[32:35], a[4:7], v[212:215], a[32:35]
    v_add_f32 v18, v18, v22
    v_add_f32 v19, v19, v23
    s_waitcnt vmcnt(4)
    v_mfma_f32_16x16x32_bf16 a[28:31], v[56:59], v[168:171], a[28:31]
    s_waitcnt lgkmcnt(0)
    v_add_f32 v240, v240, v144
    v_add_f32 v241, v241, v145
    s_waitcnt vmcnt(3)
    v_mfma_f32_16x16x32_bf16 a[32:35], v[56:59], a[16:19], a[32:35]
    v_add_f32 v242, v242, v146
    v_add_f32 v243, v243, v147
    s_waitcnt vmcnt(2)
    v_mfma_f32_16x16x32_bf16 a[28:31], v[68:71], a[20:23], a[28:31]
    v_add_f32 v16, v16, v240
    v_add_f32 v17, v17, v241
    s_waitcnt vmcnt(1)
    v_mfma_f32_16x16x32_bf16 a[32:35], v[68:71], a[24:27], a[32:35]
    v_add_f32 v18, v18, v242
    v_add_f32 v19, v19, v243
    v_mfma_f32_16x16x32_bf16 a[36:39], a[212:215], a[40:43], 0
    buffer_store_dwordx4 v[16:19], v26, s[8:11], s47 offen sc1
    v_add_u32 v24, 4096, v26
    s_nop 0
    ds_read_b128 v[16:19], v24 offset:0
    ds_read_b128 v[20:23], v24 offset:18432
    ds_read_b128 v[240:243], v24 offset:36864
    ds_read_b128 v[144:147], v24 offset:55296
    v_mfma_f32_16x16x32_bf16 a[48:51], a[212:215], a[44:47], 0
    v_mfma_f32_16x16x32_bf16 a[36:39], a[216:219], a[152:155], a[36:39]
    v_mfma_f32_16x16x32_bf16 a[48:51], a[216:219], a[68:71], a[48:51]
    v_mfma_f32_16x16x32_bf16 a[36:39], a[220:223], a[168:171], a[36:39]
    ds_write_b128 v5, a[28:31] offset:0
    s_waitcnt lgkmcnt(3)
    v_add_f32 v16, v16, v20
    v_mfma_f32_16x16x32_bf16 a[48:51], a[220:223], a[172:175], a[48:51]
    ds_write_b128 v5, a[32:35] offset:1024
    v_add_f32 v17, v17, v21
    v_mfma_f32_16x16x32_bf16 a[36:39], a[224:227], a[164:167], a[36:39]
    v_add_f32 v18, v18, v22
    v_add_f32 v19, v19, v23
    v_mfma_f32_16x16x32_bf16 a[48:51], a[224:227], a[128:131], a[48:51]
    s_waitcnt lgkmcnt(2)
    v_add_f32 v240, v240, v144
    v_add_f32 v241, v241, v145
    v_mfma_f32_16x16x32_bf16 a[36:39], a[228:231], a[132:135], a[36:39]
    v_add_f32 v242, v242, v146
    v_add_f32 v243, v243, v147
    v_mfma_f32_16x16x32_bf16 a[48:51], a[228:231], a[136:139], a[48:51]
    v_add_f32 v16, v16, v240
    v_add_f32 v17, v17, v241
    v_mfma_f32_16x16x32_bf16 a[36:39], v[60:63], a[140:143], a[36:39]
    v_add_f32 v18, v18, v242
    v_add_f32 v19, v19, v243
    v_mfma_f32_16x16x32_bf16 a[48:51], v[60:63], v[244:247], a[48:51]
    s_add_u32 s59, s47, 4096
    buffer_store_dwordx4 v[16:19], v26, s[8:11], s59 offen sc1
    v_add_u32 v24, 8192, v26
    s_nop 0
    ds_read_b128 v[16:19], v24 offset:0
    ds_read_b128 v[20:23], v24 offset:18432
    ds_read_b128 v[240:243], v24 offset:36864
    ds_read_b128 v[144:147], v24 offset:55296
    v_mfma_f32_16x16x32_bf16 a[36:39], a[8:11], v[208:211], a[36:39]
    v_mfma_f32_16x16x32_bf16 a[48:51], a[8:11], v[212:215], a[48:51]
    v_mfma_f32_16x16x32_bf16 a[36:39], v[72:75], v[168:171], a[36:39]
    v_mfma_f32_16x16x32_bf16 a[48:51], v[72:75], a[16:19], a[48:51]
    s_waitcnt lgkmcnt(2)
    v_add_f32 v16, v16, v20
    v_add_f32 v17, v17, v21
    v_mfma_f32_16x16x32_bf16 a[36:39], a[156:159], a[20:23], a[36:39]
    v_add_f32 v18, v18, v22
    v_add_f32 v19, v19, v23
    v_mfma_f32_16x16x32_bf16 a[48:51], a[156:159], a[24:27], a[48:51]
    s_waitcnt lgkmcnt(0)
    v_add_f32 v240, v240, v144
    v_add_f32 v241, v241, v145
    v_mfma_f32_16x16x32_bf16 a[52:55], a[232:235], a[40:43], 0
    v_add_f32 v242, v242, v146
    v_add_f32 v243, v243, v147
    v_mfma_f32_16x16x32_bf16 a[56:59], a[232:235], a[44:47], 0
    v_add_f32 v16, v16, v240
    v_add_f32 v17, v17, v241
    v_mfma_f32_16x16x32_bf16 a[52:55], a[236:239], a[152:155], a[52:55]
    v_add_f32 v18, v18, v242
    v_add_f32 v19, v19, v243
    v_mfma_f32_16x16x32_bf16 a[56:59], a[236:239], a[68:71], a[56:59]
    s_add_u32 s59, s47, 8192
    buffer_store_dwordx4 v[16:19], v26, s[8:11], s59 offen sc1
    v_add_u32 v24, 12288, v26
    s_nop 0
    ds_read_b128 v[16:19], v24 offset:0
    ds_read_b128 v[20:23], v24 offset:18432
    ds_read_b128 v[240:243], v24 offset:36864
    ds_read_b128 v[144:147], v24 offset:55296
    v_mfma_f32_16x16x32_bf16 a[52:55], a[240:243], a[168:171], a[52:55]
    s_lshl_b32 s53, s21, 3
    s_lshl_b32 s54, s16, 1
    s_add_u32 s53, s53, s54
    s_and_b32 s54, s3, 1
    s_add_u32 s53, s53, s54
    s_lshl_b32 s23, s53, 10
    s_add_u32 s23, s23, 0x2a00000
    buffer_load_dwordx4 v[252:255], v7, s[8:11], s23 offen offset:0 sc1
    buffer_load_dwordx4 v[216:219], v7, s[8:11], s23 offen offset:16 sc1
    buffer_load_dwordx4 v[156:159], v7, s[8:11], s23 offen offset:32 sc1
    buffer_load_dwordx4 v[160:163], v7, s[8:11], s23 offen offset:48 sc1
    s_mul_i32 s54, s53, 18432
    s_mul_i32 s55, s17, 4608
    s_add_u32 s54, s54, s55
    s_add_u32 s54, s54, 0x240000
    s_lshr_b32 s56, s3, 1
    s_lshl_b32 s55, s56, 9
    s_add_u32 s55, s55, s54
    s_add_u32 s54, s54, 4096
    v_and_b32 v8, 15, v2
    v_lshlrev_b32 v9, 4, v8
    v_lshrrev_b32 v10, 5, v2
    v_lshl_add_u32 v9, v10, 8, v9
    v_bfe_u32 v10, v2, 4, 1
    v_lshl_add_u32 v9, v10, 3, v9
    buffer_load_dwordx2 v[52:53], v9, s[8:11], s55 offen offset:0 sc1
    buffer_load_dwordx2 v[54:55], v9, s[8:11], s55 offen offset:1024 sc1
    buffer_load_dwordx2 v[164:165], v9, s[8:11], s55 offen offset:2048 sc1
    buffer_load_dwordx2 v[166:167], v9, s[8:11], s55 offen offset:3072 sc1
    buffer_load_dwordx2 v[56:57], v9, s[8:11], s54 offen offset:0 sc1
    v_mul_u32_u24 v9, 1152, v8
    v_lshrrev_b32 v10, 4, v2
    v_lshl_add_u32 v9, v10, 3, v9
    s_mul_i32 s53, s53, 18432
    s_mul_i32 s54, s17, 288
    s_add_u32 s53, s53, s54
    s_lshl_b32 s54, s56, 5
    s_add_u32 s54, s54, s53
    ds_write_b128 v5, a[36:39] offset:2048
    v_mfma_f32_16x16x32_bf16 a[56:59], a[240:243], a[172:175], a[56:59]
    ds_write_b128 v5, a[48:51] offset:3072
    v_mfma_f32_16x16x32_bf16 a[52:55], a[244:247], a[164:167], a[52:55]
    v_mfma_f32_16x16x32_bf16 a[56:59], a[244:247], a[128:131], a[56:59]
    v_mfma_f32_16x16x32_bf16 a[52:55], a[248:251], a[132:135], a[52:55]
    s_waitcnt lgkmcnt(4)
    v_add_f32 v16, v16, v20
    v_add_f32 v17, v17, v21
    v_mfma_f32_16x16x32_bf16 a[56:59], a[248:251], a[136:139], a[56:59]
    v_add_f32 v18, v18, v22
    v_add_f32 v19, v19, v23
    v_mfma_f32_16x16x32_bf16 a[52:55], a[12:15], a[140:143], a[52:55]
    s_waitcnt lgkmcnt(2)
    v_add_f32 v240, v240, v144
    v_add_f32 v241, v241, v145
    v_mfma_f32_16x16x32_bf16 a[56:59], a[12:15], v[244:247], a[56:59]
    v_add_f32 v242, v242, v146
    v_add_f32 v243, v243, v147
    v_mfma_f32_16x16x32_bf16 a[52:55], a[72:75], v[208:211], a[52:55]
    v_add_f32 v16, v16, v240
    v_add_f32 v17, v17, v241
    v_mfma_f32_16x16x32_bf16 a[56:59], a[72:75], v[212:215], a[56:59]
    v_add_f32 v18, v18, v242
    v_add_f32 v19, v19, v243
    v_mfma_f32_16x16x32_bf16 a[52:55], a[160:163], v[168:171], a[52:55]
    s_add_u32 s59, s47, 12288
    buffer_store_dwordx4 v[16:19], v26, s[8:11], s59 offen sc1
    v_add_u32 v24, 0, v27
    s_nop 0
    ds_read_b128 v[16:19], v24 offset:0
    ds_read_b128 v[20:23], v24 offset:18432
    ds_read_b128 v[240:243], v24 offset:36864
    ds_read_b128 v[144:147], v24 offset:55296
    v_mfma_f32_16x16x32_bf16 a[56:59], a[160:163], a[16:19], a[56:59]
    v_mfma_f32_16x16x32_bf16 a[52:55], v[76:79], a[20:23], a[52:55]
    v_mfma_f32_16x16x32_bf16 a[56:59], v[76:79], a[24:27], a[56:59]
    v_mfma_f32_16x16x32_bf16 a[60:63], a[252:255], a[40:43], 0
    s_waitcnt lgkmcnt(2)
    v_add_f32 v16, v16, v20
    v_add_f32 v17, v17, v21
    v_mfma_f32_16x16x32_bf16 a[64:67], a[252:255], a[44:47], 0
    v_add_f32 v18, v18, v22
    v_add_f32 v19, v19, v23
    v_mfma_f32_16x16x32_bf16 a[60:63], v[220:223], a[152:155], a[60:63]
    s_waitcnt lgkmcnt(0)
    v_add_f32 v240, v240, v144
    v_add_f32 v241, v241, v145
    v_mfma_f32_16x16x32_bf16 a[64:67], v[220:223], a[68:71], a[64:67]
    v_add_f32 v242, v242, v146
    v_add_f32 v243, v243, v147
    v_mfma_f32_16x16x32_bf16 a[60:63], v[224:227], a[168:171], a[60:63]
    ds_write_b128 v5, a[52:55] offset:4096
    v_add_f32 v16, v16, v240
    v_mfma_f32_16x16x32_bf16 a[64:67], v[224:227], a[172:175], a[64:67]
    ds_write_b128 v5, a[56:59] offset:5120
    v_add_f32 v17, v17, v241
    v_mfma_f32_16x16x32_bf16 a[60:63], v[228:231], a[164:167], a[60:63]
    buffer_load_dwordx4 v[68:71], v15, s[8:11], s52 offen sc1
    v_add_f32 v18, v18, v242
    v_mfma_f32_16x16x32_bf16 a[64:67], v[228:231], a[128:131], a[64:67]
    v_add_f32 v19, v19, v243
    buffer_store_dwordx4 v[16:19], v27, s[8:11], s47 offen sc1
    v_mfma_f32_16x16x32_bf16 a[60:63], v[232:235], a[132:135], a[60:63]
    v_mfma_f32_16x16x32_bf16 a[64:67], v[232:235], a[136:139], a[64:67]
    v_mfma_f32_16x16x32_bf16 a[60:63], a[76:79], a[140:143], a[60:63]
    v_mfma_f32_16x16x32_bf16 a[64:67], a[76:79], v[244:247], a[64:67]
    v_mfma_f32_16x16x32_bf16 a[60:63], a[80:83], v[208:211], a[60:63]
    v_mfma_f32_16x16x32_bf16 a[64:67], a[80:83], v[212:215], a[64:67]
    v_mfma_f32_16x16x32_bf16 a[60:63], v[80:83], v[168:171], a[60:63]
    v_mfma_f32_16x16x32_bf16 a[64:67], v[80:83], a[16:19], a[64:67]
    v_mfma_f32_16x16x32_bf16 a[60:63], v[140:143], a[20:23], a[60:63]
    v_mfma_f32_16x16x32_bf16 a[64:67], v[140:143], a[24:27], a[64:67]
    v_mfma_f32_16x16x32_bf16 a[144:147], v[236:239], a[40:43], 0
    v_mfma_f32_16x16x32_bf16 a[148:151], v[236:239], a[44:47], 0
    v_mfma_f32_16x16x32_bf16 a[144:147], v[28:31], a[152:155], a[144:147]
    v_mfma_f32_16x16x32_bf16 a[148:151], v[28:31], a[68:71], a[148:151]
    v_mfma_f32_16x16x32_bf16 a[144:147], v[32:35], a[168:171], a[144:147]
    s_nop 1
    ds_write_b128 v5, a[60:63] offset:6144
    v_mfma_f32_16x16x32_bf16 a[148:151], v[32:35], a[172:175], a[148:151]
    ds_write_b128 v5, a[64:67] offset:7168
    v_mfma_f32_16x16x32_bf16 a[144:147], v[36:39], a[164:167], a[144:147]
    v_mfma_f32_16x16x32_bf16 a[148:151], v[36:39], a[128:131], a[148:151]
    v_mfma_f32_16x16x32_bf16 a[144:147], v[40:43], a[132:135], a[144:147]
    v_mfma_f32_16x16x32_bf16 a[148:151], v[40:43], a[136:139], a[148:151]
    v_mfma_f32_16x16x32_bf16 a[144:147], a[84:87], a[140:143], a[144:147]
    v_mfma_f32_16x16x32_bf16 a[148:151], a[84:87], v[244:247], a[148:151]
    v_mfma_f32_16x16x32_bf16 a[144:147], a[88:91], v[208:211], a[144:147]
    v_mfma_f32_16x16x32_bf16 a[148:151], a[88:91], v[212:215], a[148:151]
    v_mfma_f32_16x16x32_bf16 a[144:147], a[120:123], v[168:171], a[144:147]
    v_mfma_f32_16x16x32_bf16 a[148:151], a[120:123], a[16:19], a[148:151]
    v_mfma_f32_16x16x32_bf16 a[144:147], a[124:127], a[20:23], a[144:147]
    v_mfma_f32_16x16x32_bf16 a[148:151], a[124:127], a[24:27], a[148:151]
    v_mfma_f32_16x16x32_bf16 a[184:187], v[44:47], a[40:43], 0
    v_mfma_f32_16x16x32_bf16 a[188:191], v[44:47], a[44:47], 0
    v_mfma_f32_16x16x32_bf16 a[184:187], v[48:51], a[152:155], a[184:187]
    v_mfma_f32_16x16x32_bf16 a[188:191], v[48:51], a[68:71], a[188:191]
    v_mfma_f32_16x16x32_bf16 a[184:187], v[84:87], a[168:171], a[184:187]
    s_nop 1
    ds_write_b128 v5, a[144:147] offset:8192
    v_mfma_f32_16x16x32_bf16 a[188:191], v[84:87], a[172:175], a[188:191]
    ds_write_b128 v5, a[148:151] offset:9216
    v_mfma_f32_16x16x32_bf16 a[184:187], v[88:91], a[164:167], a[184:187]
    v_mfma_f32_16x16x32_bf16 a[188:191], v[88:91], a[128:131], a[188:191]
    v_mfma_f32_16x16x32_bf16 a[184:187], v[92:95], a[132:135], a[184:187]
    v_mfma_f32_16x16x32_bf16 a[188:191], v[92:95], a[136:139], a[188:191]
    v_mfma_f32_16x16x32_bf16 a[184:187], a[92:95], a[140:143], a[184:187]
    s_waitcnt vmcnt(10)
    v_add_f32 v252, v252, v216
    v_mfma_f32_16x16x32_bf16 a[188:191], a[92:95], v[244:247], a[188:191]
    v_add_f32 v253, v253, v217
    v_add_f32 v254, v254, v218
    v_mfma_f32_16x16x32_bf16 a[184:187], a[96:99], v[208:211], a[184:187]
    v_add_f32 v255, v255, v219
    s_waitcnt vmcnt(8)
    v_add_f32 v156, v156, v160
    v_mfma_f32_16x16x32_bf16 a[188:191], a[96:99], v[212:215], a[188:191]
    v_add_f32 v157, v157, v161
    v_add_f32 v158, v158, v162
    v_mfma_f32_16x16x32_bf16 a[184:187], v[248:251], v[168:171], a[184:187]
    v_add_f32 v159, v159, v163
    v_add_f32 v252, v252, v156
    v_mfma_f32_16x16x32_bf16 a[188:191], v[248:251], a[16:19], a[188:191]
    v_add_f32 v253, v253, v157
    v_add_f32 v254, v254, v158
    v_mfma_f32_16x16x32_bf16 a[184:187], v[148:151], a[20:23], a[184:187]
    v_add_f32 v255, v255, v159
    v_add_f32 v252, v252, v254
    v_mfma_f32_16x16x32_bf16 a[188:191], v[148:151], a[24:27], a[188:191]
    v_add_f32 v253, v253, v255
    v_mul_f32 v252, 0xbae38e39, v252
    v_mfma_f32_16x16x32_bf16 a[192:195], v[96:99], a[40:43], 0
    v_mul_f32 v253, 0x3ae38e39, v253
    v_fma_f32 v253, -v252, v252, v253
    v_mfma_f32_16x16x32_bf16 a[196:199], v[96:99], a[44:47], 0
    v_max_f32 v253, 0, v253
    v_add_f32 v253, 0x3727c5ac, v253
    v_mfma_f32_16x16x32_bf16 a[192:195], v[100:103], a[152:155], a[192:195]
    s_cmp_eq_u32 s16, 0
    s_cselect_b32 s59, 1, 0
    s_waitcnt vmcnt(1)
    v_max_u32 v68, s59, v68
    s_cmp_eq_u32 s16, 1
    s_cselect_b32 s59, 1, 0
    v_max_u32 v69, s59, v69
    s_cmp_eq_u32 s16, 2
    s_cselect_b32 s59, 1, 0
    v_max_u32 v70, s59, v70
    s_cmp_eq_u32 s16, 3
    s_cselect_b32 s59, 1, 0
    v_max_u32 v71, s59, v71
    v_min_u32 v68, v68, v69
    v_min_u32 v70, v70, v71
    v_min_u32 v68, v68, v70
    s_nop 0
    v_readfirstlane_b32 s59, v68
    s_nop 0
    s_cmp_ge_u32 s59, 1
    s_cbranch_scc1 KCD_PD3
    s_mov_b32 s60, 20000
KCD_PL3:
    s_sub_u32 s60, s60, 1
    s_cmp_eq_u32 s60, 0
    s_cbranch_scc1 KCD_PD3
    s_sleep 1
    buffer_load_dwordx4 v[68:71], v15, s[8:11], s52 offen sc1
    s_waitcnt vmcnt(0)
    s_cmp_eq_u32 s16, 0
    s_cselect_b32 s59, 1, 0
    v_max_u32 v68, s59, v68
    s_cmp_eq_u32 s16, 1
    s_cselect_b32 s59, 1, 0
    v_max_u32 v69, s59, v69
    s_cmp_eq_u32 s16, 2
    s_cselect_b32 s59, 1, 0
    v_max_u32 v70, s59, v70
    s_cmp_eq_u32 s16, 3
    s_cselect_b32 s59, 1, 0
    v_max_u32 v71, s59, v71
    v_min_u32 v68, v68, v69
    v_min_u32 v70, v70, v71
    v_min_u32 v68, v68, v70
    s_nop 0
    v_readfirstlane_b32 s59, v68
    s_nop 0
    s_cmp_ge_u32 s59, 1
    s_cbranch_scc0 KCD_PL3
KCD_PD3:
    s_add_u32 s57, s16, 3
    s_and_b32 s57, s57, 3
    s_mul_i32 s57, s57, 18432
    s_add_u32 s57, s57, s51
    buffer_load_dwordx4 v[60:63], v26, s[8:11], s57 offen sc1
    s_add_u32 s58, s57, 4096
    buffer_load_dwordx4 v[72:75], v26, s[8:11], s58 offen sc1
    s_add_u32 s58, s57, 8192
    buffer_load_dwordx4 v[76:79], v26, s[8:11], s58 offen sc1
    s_add_u32 s58, s57, 12288
    buffer_load_dwordx4 v[220:223], v26, s[8:11], s58 offen sc1
    buffer_load_dwordx4 v[224:227], v27, s[8:11], s57 offen sc1
    s_add_u32 s57, s16, 2
    s_and_b32 s57, s57, 3
    s_mul_i32 s57, s57, 18432
    s_add_u32 s57, s57, s51
    buffer_load_dwordx4 v[228:231], v26, s[8:11], s57 offen sc1
    s_add_u32 s58, s57, 4096
    buffer_load_dwordx4 v[240:243], v26, s[8:11], s58 offen sc1
    s_add_u32 s58, s57, 8192
    buffer_load_dwordx4 v[144:147], v26, s[8:11], s58 offen sc1
    s_add_u32 s58, s57, 12288
    buffer_load_dwordx4 v[232:235], v26, s[8:11], s58 offen sc1
    buffer_load_dwordx4 v[80:83], v27, s[8:11], s57 offen sc1
    v_rsq_f32 v11, v253
    v_mfma_f32_16x16x32_bf16 a[196:199], v[100:103], a[68:71], a[196:199]
    v_mfma_f32_16x16x32_bf16 a[192:195], v[104:107], a[168:171], a[192:195]
    ds_write_b128 v5, a[184:187] offset:10240
    v_mfma_f32_16x16x32_bf16 a[196:199], v[104:107], a[172:175], a[196:199]
    ds_write_b128 v5, a[188:191] offset:11264
    v_mfma_f32_16x16x32_bf16 a[192:195], v[108:111], a[164:167], a[192:195]
    v_mfma_f32_16x16x32_bf16 a[196:199], v[108:111], a[128:131], a[196:199]
    v_mfma_f32_16x16x32_bf16 a[192:195], v[112:115], a[132:135], a[192:195]
    v_mfma_f32_16x16x32_bf16 a[196:199], v[112:115], a[136:139], a[196:199]
    v_mfma_f32_16x16x32_bf16 a[192:195], a[100:103], a[140:143], a[192:195]
    v_mfma_f32_16x16x32_bf16 a[196:199], a[100:103], v[244:247], a[196:199]
    v_mfma_f32_16x16x32_bf16 a[192:195], a[104:107], v[208:211], a[192:195]
    v_mfma_f32_16x16x32_bf16 a[196:199], a[104:107], v[212:215], a[196:199]
    v_mfma_f32_16x16x32_bf16 a[192:195], v[152:155], v[168:171], a[192:195]
    v_mfma_f32_16x16x32_bf16 a[196:199], v[152:155], a[16:19], a[196:199]
    v_mfma_f32_16x16x32_bf16 a[192:195], v[188:191], a[20:23], a[192:195]
    v_mfma_f32_16x16x32_bf16 a[196:199], v[188:191], a[24:27], a[196:199]
    v_mfma_f32_16x16x32_bf16 a[176:179], v[116:119], a[40:43], 0
    v_mfma_f32_16x16x32_bf16 a[180:183], v[116:119], a[44:47], 0
    v_mfma_f32_16x16x32_bf16 a[176:179], v[120:123], a[152:155], a[176:179]
    v_mfma_f32_16x16x32_bf16 a[180:183], v[120:123], a[68:71], a[180:183]
    v_mfma_f32_16x16x32_bf16 a[176:179], v[124:127], a[168:171], a[176:179]
    s_nop 1
    ds_write_b128 v5, a[192:195] offset:12288
    v_mfma_f32_16x16x32_bf16 a[180:183], v[124:127], a[172:175], a[180:183]
    ds_write_b128 v5, a[196:199] offset:13312
    v_mfma_f32_16x16x32_bf16 a[176:179], v[128:131], a[164:167], a[176:179]
    v_mfma_f32_16x16x32_bf16 a[180:183], v[128:131], a[128:131], a[180:183]
    v_mfma_f32_16x16x32_bf16 a[176:179], v[132:135], a[132:135], a[176:179]
    v_mfma_f32_16x16x32_bf16 a[180:183], v[132:135], a[136:139], a[180:183]
    v_mfma_f32_16x16x32_bf16 a[176:179], a[108:111], a[140:143], a[176:179]
    v_mfma_f32_16x16x32_bf16 a[180:183], a[108:111], v[244:247], a[180:183]
    v_mfma_f32_16x16x32_bf16 a[176:179], a[112:115], v[208:211], a[176:179]
    v_mfma_f32_16x16x32_bf16 a[180:183], a[112:115], v[212:215], a[180:183]
    v_mfma_f32_16x16x32_bf16 a[176:179], v[192:195], v[168:171], a[176:179]
    v_mfma_f32_16x16x32_bf16 a[180:183], v[192:195], a[16:19], a[180:183]
    v_mfma_f32_16x16x32_bf16 a[176:179], v[196:199], a[20:23], a[176:179]
    v_mfma_f32_16x16x32_bf16 a[180:183], v[196:199], a[24:27], a[180:183]
    v_mfma_f32_16x16x32_bf16 a[200:203], v[136:139], a[40:43], 0
    v_mfma_f32_16x16x32_bf16 a[204:207], v[136:139], a[44:47], 0
    v_mfma_f32_16x16x32_bf16 a[200:203], v[172:175], a[152:155], a[200:203]
    v_mfma_f32_16x16x32_bf16 a[204:207], v[172:175], a[68:71], a[204:207]
    v_mfma_f32_16x16x32_bf16 a[200:203], v[176:179], a[168:171], a[200:203]
    s_nop 1
    ds_write_b128 v5, a[176:179] offset:14336
    v_mfma_f32_16x16x32_bf16 a[204:207], v[176:179], a[172:175], a[204:207]
    ds_write_b128 v5, a[180:183] offset:15360
    v_mfma_f32_16x16x32_bf16 a[200:203], v[180:183], a[164:167], a[200:203]
    s_add_u32 s57, s16, 1
    s_and_b32 s57, s57, 3
    s_mul_i32 s57, s57, 18432
    s_add_u32 s57, s57, s51
    buffer_load_dwordx4 v[140:143], v26, s[8:11], s57 offen sc1
    s_add_u32 s58, s57, 4096
    buffer_load_dwordx4 v[236:239], v26, s[8:11], s58 offen sc1
    s_add_u32 s58, s57, 8192
    buffer_load_dwordx4 v[28:31], v26, s[8:11], s58 offen sc1
    s_add_u32 s58, s57, 12288
    buffer_load_dwordx4 v[32:35], v26, s[8:11], s58 offen sc1
    buffer_load_dwordx4 v[36:39], v27, s[8:11], s57 offen sc1
    v_mfma_f32_16x16x32_bf16 a[204:207], v[180:183], a[128:131], a[204:207]
    v_mfma_f32_16x16x32_bf16 a[200:203], v[184:187], a[132:135], a[200:203]
    v_mfma_f32_16x16x32_bf16 a[204:207], v[184:187], a[136:139], a[204:207]
    v_mfma_f32_16x16x32_bf16 a[200:203], a[116:119], a[140:143], a[200:203]
    v_mfma_f32_16x16x32_bf16 a[204:207], a[116:119], v[244:247], a[204:207]
    v_mfma_f32_16x16x32_bf16 a[200:203], v[64:67], v[208:211], a[200:203]
    v_mfma_f32_16x16x32_bf16 a[204:207], v[64:67], v[212:215], a[204:207]
    v_mfma_f32_16x16x32_bf16 a[200:203], v[200:203], v[168:171], a[200:203]
    v_mfma_f32_16x16x32_bf16 a[204:207], v[200:203], a[16:19], a[204:207]
    v_mfma_f32_16x16x32_bf16 a[200:203], v[204:207], a[20:23], a[200:203]
    v_mfma_f32_16x16x32_bf16 a[204:207], v[204:207], a[24:27], a[204:207]
    s_nop 6
    ds_write_b128 v5, a[200:203] offset:16384
    ds_write_b128 v5, a[204:207] offset:17408
    s_waitcnt lgkmcnt(0)
    s_barrier
    v_add_u32 v24, 73728, v26
    ds_read_b128 v[40:43], v24 offset:0
    ds_read_b128 v[44:47], v24 offset:18432
    ds_read_b128 v[48:51], v24 offset:36864
    ds_read_b128 v[84:87], v24 offset:55296
    v_add_u32 v24, 77824, v26
    ds_read_b128 v[88:91], v24 offset:0
    ds_read_b128 v[92:95], v24 offset:18432
    ds_read_b128 v[248:251], v24 offset:36864
    ds_read_b128 v[148:151], v24 offset:55296
    v_add_u32 v24, 81920, v26
    ds_read_b128 v[96:99], v24 offset:0
    ds_read_b128 v[100:103], v24 offset:18432
    ds_read_b128 v[104:107], v24 offset:36864
    ds_read_b128 v[108:111], v24 offset:55296
    v_add_u32 v24, 86016, v26
    ds_read_b128 v[112:115], v24 offset:0
    ds_read_b128 v[152:155], v24 offset:18432
    ds_read_b128 v[188:191], v24 offset:36864
    ds_read_b128 v[116:119], v24 offset:55296
    v_add_u32 v24, 73728, v27
    ds_read_b128 v[120:123], v24 offset:0
    ds_read_b128 v[124:127], v24 offset:18432
    ds_read_b128 v[128:131], v24 offset:36864
    ds_read_b128 v[132:135], v24 offset:55296
    s_waitcnt vmcnt(0)
    s_mov_b32 s60, 20000
KCD_SL:
    v_max3_u32 v24, v140, v141, v142
    v_max3_u32 v24, v24, v39, v38
    v_max3_u32 v24, v24, v37, v36
    v_max3_u32 v24, v24, v35, v34
    v_max3_u32 v24, v24, v33, v32
    v_max3_u32 v24, v24, v31, v30
    v_max3_u32 v24, v24, v29, v28
    v_max3_u32 v24, v24, v239, v238
    v_max3_u32 v24, v24, v237, v236
    v_max_u32 v24, v24, v143
    v_cmp_eq_u32 vcc, -1, v24
    s_cbranch_vccz KCD_SD
    s_sub_u32 s60, s60, 1
    s_cmp_eq_u32 s60, 0
    s_cbranch_scc1 KCD_SD
    s_add_u32 s57, s16, 1
    s_and_b32 s57, s57, 3
    s_mul_i32 s57, s57, 18432
    s_add_u32 s57, s57, s51
    buffer_load_dwordx4 v[140:143], v26, s[8:11], s57 offen sc1
    s_add_u32 s58, s57, 4096
    buffer_load_dwordx4 v[236:239], v26, s[8:11], s58 offen sc1
    s_add_u32 s58, s57, 8192
    buffer_load_dwordx4 v[28:31], v26, s[8:11], s58 offen sc1
    s_add_u32 s58, s57, 12288
    buffer_load_dwordx4 v[32:35], v26, s[8:11], s58 offen sc1
    buffer_load_dwordx4 v[36:39], v27, s[8:11], s57 offen sc1
    s_waitcnt vmcnt(0)
    s_branch KCD_SL
KCD_SD:
    s_waitcnt lgkmcnt(15)
    v_add_f32 v40, v40, v44
    v_add_f32 v48, v48, v84
    v_add_f32 v140, v140, v228
    v_add_f32 v41, v41, v45
    v_add_f32 v49, v49, v85
    v_add_f32 v141, v141, v229
    v_add_f32 v42, v42, v46
    v_add_f32 v50, v50, v86
    v_add_f32 v142, v142, v230
    v_add_f32 v43, v43, v47
    v_add_f32 v51, v51, v87
    v_add_f32 v143, v143, v231
    v_add_f32 v40, v40, v48
    v_add_f32 v140, v140, v60
    v_add_f32 v41, v41, v49
    v_add_f32 v141, v141, v61
    v_add_f32 v42, v42, v50
    v_add_f32 v142, v142, v62
    v_add_f32 v43, v43, v51
    v_add_f32 v143, v143, v63
    v_add_f32 v40, v40, v140
    v_add_f32 v41, v41, v141
    v_add_f32 v42, v42, v142
    v_add_f32 v43, v43, v143
    v_lshlrev_b32 v44, 16, v52
    v_and_b32 v45, 0xffff0000, v52
    v_lshlrev_b32 v46, 16, v53
    v_and_b32 v47, 0xffff0000, v53
    v_fma_f32 v40, v40, v11, v44
    v_fma_f32 v41, v41, v11, v45
    v_fma_f32 v42, v42, v11, v46
    v_fma_f32 v43, v43, v11, v47
    v_cvt_pk_bf16_f32 v48, v40, v41
    v_cvt_pk_bf16_f32 v49, v42, v43
    buffer_store_dwordx2 v[48:49], v9, s[12:15], s54 offen offset:0
    s_waitcnt lgkmcnt(14)
    v_add_f32 v88, v88, v92
    s_waitcnt lgkmcnt(12)
    v_add_f32 v248, v248, v148
    v_add_f32 v236, v236, v240
    v_add_f32 v89, v89, v93
    v_add_f32 v249, v249, v149
    v_add_f32 v237, v237, v241
    v_add_f32 v90, v90, v94
    v_add_f32 v250, v250, v150
    v_add_f32 v238, v238, v242
    v_add_f32 v91, v91, v95
    v_add_f32 v251, v251, v151
    v_add_f32 v239, v239, v243
    v_add_f32 v88, v88, v248
    v_add_f32 v236, v236, v72
    v_add_f32 v89, v89, v249
    v_add_f32 v237, v237, v73
    v_add_f32 v90, v90, v250
    v_add_f32 v238, v238, v74
    v_add_f32 v91, v91, v251
    v_add_f32 v239, v239, v75
    v_add_f32 v88, v88, v236
    v_add_f32 v89, v89, v237
    v_add_f32 v90, v90, v238
    v_add_f32 v91, v91, v239
    v_lshlrev_b32 v92, 16, v54
    v_and_b32 v93, 0xffff0000, v54
    v_lshlrev_b32 v94, 16, v55
    v_and_b32 v95, 0xffff0000, v55
    v_fma_f32 v88, v88, v11, v92
    v_fma_f32 v89, v89, v11, v93
    v_fma_f32 v90, v90, v11, v94
    v_fma_f32 v91, v91, v11, v95
    v_cvt_pk_bf16_f32 v248, v88, v89
    v_cvt_pk_bf16_f32 v249, v90, v91
    buffer_store_dwordx2 v[248:249], v9, s[12:15], s54 offen offset:64
    s_waitcnt lgkmcnt(10)
    v_add_f32 v96, v96, v100
    s_waitcnt lgkmcnt(8)
    v_add_f32 v104, v104, v108
    v_add_f32 v28, v28, v144
    v_add_f32 v97, v97, v101
    v_add_f32 v105, v105, v109
    v_add_f32 v29, v29, v145
    v_add_f32 v98, v98, v102
    v_add_f32 v106, v106, v110
    v_add_f32 v30, v30, v146
    v_add_f32 v99, v99, v103
    v_add_f32 v107, v107, v111
    v_add_f32 v31, v31, v147
    v_add_f32 v96, v96, v104
    v_add_f32 v28, v28, v76
    v_add_f32 v97, v97, v105
    v_add_f32 v29, v29, v77
    v_add_f32 v98, v98, v106
    v_add_f32 v30, v30, v78
    v_add_f32 v99, v99, v107
    v_add_f32 v31, v31, v79
    v_add_f32 v96, v96, v28
    v_add_f32 v97, v97, v29
    v_add_f32 v98, v98, v30
    v_add_f32 v99, v99, v31
    v_lshlrev_b32 v100, 16, v164
    v_and_b32 v101, 0xffff0000, v164
    v_lshlrev_b32 v102, 16, v165
    v_and_b32 v103, 0xffff0000, v165
    v_fma_f32 v96, v96, v11, v100
    v_fma_f32 v97, v97, v11, v101
    v_fma_f32 v98, v98, v11, v102
    v_fma_f32 v99, v99, v11, v103
    v_cvt_pk_bf16_f32 v104, v96, v97
    v_cvt_pk_bf16_f32 v105, v98, v99
    buffer_store_dwordx2 v[104:105], v9, s[12:15], s54 offen offset:128
    s_waitcnt lgkmcnt(6)
    v_add_f32 v112, v112, v152
    s_waitcnt lgkmcnt(4)
    v_add_f32 v188, v188, v116
    v_add_f32 v32, v32, v232
    v_add_f32 v113, v113, v153
    v_add_f32 v189, v189, v117
    v_add_f32 v33, v33, v233
    v_add_f32 v114, v114, v154
    v_add_f32 v190, v190, v118
    v_add_f32 v34, v34, v234
    v_add_f32 v115, v115, v155
    v_add_f32 v191, v191, v119
    v_add_f32 v35, v35, v235
    v_add_f32 v112, v112, v188
    v_add_f32 v32, v32, v220
    v_add_f32 v113, v113, v189
    v_add_f32 v33, v33, v221
    v_add_f32 v114, v114, v190
    v_add_f32 v34, v34, v222
    v_add_f32 v115, v115, v191
    v_add_f32 v35, v35, v223
    v_add_f32 v112, v112, v32
    v_add_f32 v113, v113, v33
    v_add_f32 v114, v114, v34
    v_add_f32 v115, v115, v35
    v_lshlrev_b32 v152, 16, v166
    v_and_b32 v153, 0xffff0000, v166
    v_lshlrev_b32 v154, 16, v167
    v_and_b32 v155, 0xffff0000, v167
    v_fma_f32 v112, v112, v11, v152
    v_fma_f32 v113, v113, v11, v153
    v_fma_f32 v114, v114, v11, v154
    v_fma_f32 v115, v115, v11, v155
    v_cvt_pk_bf16_f32 v188, v112, v113
    v_cvt_pk_bf16_f32 v189, v114, v115
    buffer_store_dwordx2 v[188:189], v9, s[12:15], s54 offen offset:192
    s_waitcnt lgkmcnt(2)
    v_add_f32 v120, v120, v124
    s_waitcnt lgkmcnt(0)
    v_add_f32 v128, v128, v132
    v_add_f32 v36, v36, v80
    v_add_f32 v121, v121, v125
    v_add_f32 v129, v129, v133
    v_add_f32 v37, v37, v81
    v_add_f32 v122, v122, v126
    v_add_f32 v130, v130, v134
    v_add_f32 v38, v38, v82
    v_add_f32 v123, v123, v127
    v_add_f32 v131, v131, v135
    v_add_f32 v39, v39, v83
    v_add_f32 v120, v120, v128
    v_add_f32 v36, v36, v224
    v_add_f32 v121, v121, v129
    v_add_f32 v37, v37, v225
    v_add_f32 v122, v122, v130
    v_add_f32 v38, v38, v226
    v_add_f32 v123, v123, v131
    v_add_f32 v39, v39, v227
    v_add_f32 v120, v120, v36
    v_add_f32 v121, v121, v37
    v_add_f32 v122, v122, v38
    v_add_f32 v123, v123, v39
    v_lshlrev_b32 v124, 16, v56
    v_and_b32 v125, 0xffff0000, v56
    v_lshlrev_b32 v126, 16, v57
    v_and_b32 v127, 0xffff0000, v57
    v_fma_f32 v120, v120, v11, v124
    v_fma_f32 v121, v121, v11, v125
    v_fma_f32 v122, v122, v11, v126
    v_fma_f32 v123, v123, v11, v127
    v_cvt_pk_bf16_f32 v128, v120, v121
    v_cvt_pk_bf16_f32 v129, v122, v123
    buffer_store_dwordx2 v[128:129], v9, s[12:15], s53 offen offset:256
KF_END:
    s_endpgm
.section .rodata,"a"
.p2align 6
.amdhsa_kernel sequential_preLN__sliding_local_dilated__glu_gated_glu__prompt_kernel
  .amdhsa_next_free_vgpr 512
  .amdhsa_next_free_sgpr 64
  .amdhsa_accum_offset 256
  .amdhsa_group_segment_fixed_size 0
  .amdhsa_kernarg_size 80
  .amdhsa_user_sgpr_count 2
  .amdhsa_user_sgpr_kernarg_segment_ptr 1
  .amdhsa_system_sgpr_workgroup_id_x 1
.end_amdhsa_kernel
```
